```python
import torch

def _softmax(x, axis=-1):
    return torch.softmax(x, dim=axis)
def _gelu(x):
    return torch.nn.functional.gelu(x, approximate="tanh")
def _silu(x):
    return torch.nn.functional.silu(x)
def _sigmoid(x):
    return torch.sigmoid(x)
def _layernorm(x, axis=-1, eps=1e-5):
    m = x.mean(dim=axis, keepdim=True)
    v = x.var(dim=axis, keepdim=True, unbiased=False)
    return (x - m) / torch.sqrt(v + eps)
def _scatter_add(tgt, idx, src, axis=0):
    return tgt.clone().index_add_(axis, idx, src)
def _segment_sum(src, seg, n):
    out = torch.zeros((n,) + src.shape[1:], dtype=src.dtype)
    return out.index_add_(0, seg, src)
def _pad(x, pw):
    flat = tuple(v for pair in reversed(pw) for v in pair)
    return torch.nn.functional.pad(x, flat)

kernel_name = 'sequential_preLN__sliding_block__dense_activation_silu__prompt'

def setup_inputs():

    _w = (lambda a: (lambda t: t.to(torch.bfloat16) if t.is_floating_point() else t)(torch.as_tensor(a)))
    def _A_setup():
        B, S, D = 1, 2048, 512
        return {
            "x": _w((lambda *s: torch.randn(*s, dtype=torch.bfloat16) * 0.05)(B, S, D)),
            "wqkv": _w((lambda *s: torch.randn(*s, dtype=torch.bfloat16) * 0.05)(D, 3 * D)),
            "wo": _w((lambda *s: torch.randn(*s, dtype=torch.bfloat16) * 0.05)(D, D)),
        }
    _A_in = _A_setup()

    def _B_setup():
        B, S, D, F = 1, 2048, 512, 1792
        return {
            "x": _w((lambda *s: torch.randn(*s, dtype=torch.bfloat16) * 0.05)(B, S, D)),
            "w1": _w((lambda *s: torch.randn(*s, dtype=torch.bfloat16) * 0.8)(D, F) * (D ** -0.5)),
            "w2": _w((lambda *s: torch.randn(*s, dtype=torch.bfloat16) * 0.8)(F, D) * (F ** -0.5)),
        }
    _B_in = _B_setup()

    return {
        "A_x": _A_in["x"],
        "A_wqkv": _A_in["wqkv"],
        "A_wo": _A_in["wo"],
        "B_x": _B_in["x"],
        "B_w1": _B_in["w1"],
        "B_w2": _B_in["w2"],
    }

def reference(A_x, A_wqkv, A_wo, B_x, B_w1, B_w2):
    def _A_ref(x, wqkv, wo):
        B, S, D = x.shape
        H = 32; Dh = D // H; W = 256
        qkv = (lambda x, *d: x.permute(*d))((x @ wqkv).reshape(B, S, 3, H, Dh), 2, 0, 3, 1, 4)
        q, k, v = qkv[0], qkv[1], qkv[2]
        scores = torch.einsum("bhqd,bhkd->bhqk", q, k) * (Dh ** -0.5)
        idx = torch.arange(S)
        mask = (idx[:, None] - idx[None, :] >= 0) & (idx[:, None] - idx[None, :] < W)
        scores = torch.where(mask[None, None], scores, -1e9)
        p = _softmax(scores, axis=-1)
        o = torch.einsum("bhqk,bhkd->bhqd", p, v)
        return (lambda x, *d: x.permute(*d))(o, 0, 2, 1, 3).reshape(B, S, D) @ wo

    def _B_ref(x, w1, w2):
        h = torch.einsum("bsd,df->bsf", x, w1)
        h = _silu(h)
        out = torch.einsum("bsf,fd->bsd", h, w2)
        return out

    x = A_x
    h = x + _A_ref(_layernorm(x, axis=-1), A_wqkv, A_wo)
    h2 = h + _B_ref(_layernorm(h, axis=-1), B_w1, B_w2)
    return h2
```

```asm
; @launch grid=(256,1,1) block=(256,1,1) lds=163840
.amdgcn_target "amdgcn-amd-amdhsa--gfx950"
.text
.globl sequential_preLN__sliding_block__dense_activation_silu__prompt_kernel
.p2align 8
.type sequential_preLN__sliding_block__dense_activation_silu__prompt_kernel,@function
sequential_preLN__sliding_block__dense_activation_silu__prompt_kernel:
    s_load_dwordx2 s[8:9], s[0:1], 0
    s_load_dwordx2 s[12:13], s[0:1], 8
    s_load_dwordx2 s[32:33], s[0:1], 64
    s_cmp_ge_u32 s2, 256
    s_cbranch_scc1 L_end
    s_getpc_b64 s[92:93]
L_pc:
    v_lshrrev_b32 v5, 5, v0
    v_and_or_b32 v5, s2, -8, v5
    v_lshrrev_b32 v4, 6, v0
    v_lshlrev_b32 v5, 7, v5
    v_and_b32 v1, 63, v0
    v_min_u32 v5, L_codeend-L_pc-4, v5
    v_readfirstlane_b32 s3, v4
    global_load_dword v22, v5, s[92:93]
    s_and_b32 s4, s2, 7
    s_lshl_b32 s4, s4, 2
    s_lshr_b32 s5, s2, 6
    s_add_u32 s4, s4, s5
    s_bfe_u32 s5, s2, 0x30003
    v_lshrrev_b32 v7, 3, v1
    v_and_b32 v8, 7, v1
    v_lshrrev_b32 v9, 4, v1
    s_lshl_b32 s98, s4, 6
    s_lshl_b32 s99, s3, 4
    s_add_u32 s98, s98, s99
    v_add_lshl_u32 v10, v7, s98, 10
    v_xor_b32 v11, v8, v9
    v_lshl_add_u32 v23, v11, 4, v10
    v_and_b32 v9, 1, v9
    v_lshlrev_b32 v9, 2, v9
    v_xor_b32 v8, v8, v9
    v_lshlrev_b32 v27, 4, v8
    v_add_u32 v6, s99, v7
    v_mul_u32_u24 v6, 3072, v6
    s_lshl_b32 s98, s5, 7
    v_add3_u32 v25, v6, s98, v27
    s_lshl_b32 s101, s3, 11
    s_mov_b32 s10, 0x200000
    s_mov_b32 s11, 0x20000
    s_mov_b32 s14, 0x180000
    s_mov_b32 s15, 0x20000
    v_xor_b32 v24, 64, v23
    v_add_u32 v24, 7168, v24
    v_add_u32 v26, 23552, v25
    s_lshl_b32 s43, s4, 0
    s_add_u32 m0, s101, 16384
    s_add_u32 s100, s43, 0
    s_and_b32 s100, s100, 7
    s_lshl_b32 s64, s100, 7
    s_mul_i32 s56, s100, 196608
    s_waitcnt lgkmcnt(0)
    buffer_load_dwordx4 v23, s[8:11], s64 offen offset:0 nt lds
    buffer_load_dwordx4 v24, s[8:11], s64 offen offset:1024 nt lds
    s_add_u32 m0, s101, 80896
    s_nop 0
    buffer_load_dwordx4 v25, s[12:15], s56 offen offset:1024 lds
    buffer_load_dwordx4 v26, s[12:15], s56 offen offset:2048 lds
    s_add_u32 m0, s101, 24576
    s_add_u32 s100, s43, 1
    s_and_b32 s100, s100, 7
    s_lshl_b32 s65, s100, 7
    s_mul_i32 s57, s100, 196608
    s_load_dword s6, s[32:33], 0
    s_load_dwordx2 s[36:37], s[0:1], 56
    s_load_dwordx2 s[16:17], s[0:1], 16
    s_load_dwordx2 s[20:21], s[0:1], 32
    s_load_dwordx2 s[24:25], s[0:1], 40
    s_load_dwordx2 s[28:29], s[0:1], 48
    s_lshl_b32 s98, s4, 5
    s_lshl2_add_u32 s98, s5, s98
    s_add_u32 s98, s98, s3
    s_mul_i32 s98, s98, 208
    s_add_u32 s98, s98, L_tab-L_pc
    s_add_u32 s92, s92, s98
    s_addc_u32 s93, s93, 0
    s_load_dwordx16 s[76:91], s[92:93], 0
    s_load_dwordx8 s[44:51], s[92:93], 64
    s_load_dwordx4 s[52:55], s[92:93], 96
    s_lshl_b32 s1, s5, 7
    s_lshl_b32 s98, s3, 15
    s_add_u32 s1, s1, s98
    s_lshl_b32 s5, s3, 12
    v_lshlrev_b32 v2, 4, v1
    buffer_load_dwordx4 v23, s[8:11], s65 offen offset:0 nt lds
    s_mov_b32 s38, 0x0000ffff
    s_mov_b32 s39, 0x0000ffff
    s_mov_b32 s96, 0
    s_mov_b32 s97, 400000
    v_cmp_eq_u32 vcc, 0, v1
    v_mov_b32 v4, 0x20000000
    s_nop 0
    v_cndmask_b32 v3, v4, 0, vcc
    s_and_b32 s40, s3, 1
    s_lshr_b32 s41, s3, 1
    s_lshl_b32 s42, s40, 1
    s_or_b32 s42, s42, s41
    v_lshrrev_b32 v13, 5, v1
    buffer_load_dwordx4 v24, s[8:11], s65 offen offset:1024 nt lds
    s_add_u32 m0, s101, 89088
    v_bfe_u32 v37, v1, 3, 1
    v_bfe_u32 v4, v1, 2, 2
    v_lshlrev_b32 v4, 7, v4
    v_bfe_u32 v6, v1, 4, 1
    v_lshl_add_u32 v4, v6, 5, v4
    v_and_b32 v5, 3, v1
    v_lshl_add_u32 v36, v5, 3, v4
    v_xor_b32 v5, s41, v37
    v_lshl_add_u32 v5, v5, 6, v36
    v_lshl_add_u32 v5, v13, 10, v5
    v_and_b32 v6, 31, v1
    buffer_load_dwordx4 v25, s[12:15], s57 offen offset:1024 lds
    s_lshl_b32 s98, s40, 12
    s_add_u32 s98, s98, 16384
    v_lshl_add_u32 v6, v6, 7, s98
    v_bfe_u32 v7, v1, 1, 3
    v_xor_b32 v7, v7, v13
    s_xor_b32 s98, s42, 0
    s_lshl_b32 s99, s98, 11
    s_add_u32 s99, s99, 81920
    v_add_u32 v32, s99, v5
    s_lshl_b32 s98, s98, 1
    v_xor_b32 v11, s98, v7
    v_lshl_add_u32 v28, v11, 4, v6
    buffer_load_dwordx4 v26, s[12:15], s57 offen offset:2048 lds
    s_add_u32 m0, s101, 32768
    s_add_u32 s100, s43, 2
    s_and_b32 s100, s100, 7
    s_lshl_b32 s66, s100, 7
    s_mul_i32 s58, s100, 196608
    s_xor_b32 s98, s42, 1
    s_lshl_b32 s99, s98, 11
    s_add_u32 s99, s99, 81920
    v_add_u32 v33, s99, v5
    s_lshl_b32 s98, s98, 1
    v_xor_b32 v11, s98, v7
    v_lshl_add_u32 v29, v11, 4, v6
    buffer_load_dwordx4 v23, s[8:11], s66 offen offset:0 nt lds
    s_xor_b32 s98, s42, 2
    s_lshl_b32 s99, s98, 11
    s_add_u32 s99, s99, 81920
    v_add_u32 v34, s99, v5
    s_lshl_b32 s98, s98, 1
    v_xor_b32 v11, s98, v7
    v_lshl_add_u32 v30, v11, 4, v6
    s_xor_b32 s98, s42, 3
    s_lshl_b32 s99, s98, 11
    s_add_u32 s99, s99, 81920
    v_add_u32 v35, s99, v5
    s_lshl_b32 s98, s98, 1
    buffer_load_dwordx4 v24, s[8:11], s66 offen offset:1024 nt lds
    s_add_u32 m0, s101, 97280
    v_xor_b32 v11, s98, v7
    v_lshl_add_u32 v31, v11, 4, v6
    v_lshrrev_b32 v4, 4, v1
    v_xor_b32 v4, v4, v1
    v_and_b32 v4, 1, v4
    v_add_u32 v4, -1, v4
    v_and_b32 v38, 0x3f803f80, v4
    v_and_b32 v39, 0x3f803f80, v4
    v_and_b32 v40, 0x3f803f80, v4
    v_and_b32 v41, 0x3f803f80, v4
    buffer_load_dwordx4 v25, s[12:15], s58 offen offset:1024 lds
    buffer_load_dwordx4 v26, s[12:15], s58 offen offset:2048 lds
    s_add_u32 m0, s101, 40960
    s_add_u32 s100, s43, 3
    s_and_b32 s100, s100, 7
    s_lshl_b32 s67, s100, 7
    s_mul_i32 s59, s100, 196608
    buffer_load_dwordx4 v23, s[8:11], s67 offen offset:0 nt lds
    buffer_load_dwordx4 v24, s[8:11], s67 offen offset:1024 nt lds
    s_mov_b32 s18, 0x80000
    s_mov_b32 s19, 0x20000
    s_mov_b32 s22, 0x1c0000
    s_mov_b32 s23, 0x20000
    s_mov_b32 s26, 0x1c0000
    s_mov_b32 s27, 0x20000
    s_mov_b32 s30, 0x200000
    s_mov_b32 s31, 0x20000
    s_mov_b32 s34, 0x10000000
    s_mov_b32 s35, 0x20000
    s_or_b32 s7, s2, s3
    v_subrev_u32 v140, 65536, v32
    v_add_u32 v148, 65536, v32
    v_subrev_u32 v141, 65536, v33
    v_add_u32 v149, 65536, v33
    v_subrev_u32 v142, 65536, v34
    v_add_u32 v150, 65536, v34
    v_subrev_u32 v143, 65536, v35
    v_add_u32 v151, 65536, v35
    v_and_b32 v4, 31, v1
    s_lshl_b32 s98, s40, 9
    v_lshl_add_u32 v138, v4, 4, s98
    s_lshl_b32 s98, s41, 3
    v_add_u32 v139, s98, v138
    v_bfe_u32 v5, v1, 2, 1
    v_cmp_eq_u32 vcc, v5, v13
    v_mov_b32 v5, 7936
    s_lshl_b32 s98, s41, 8
    v_cndmask_b32 v139, v5, v139, vcc
    v_lshl_add_u32 v42, v4, 3, s98
    s_lshl_b32 s98, s40, 2
    v_add_u32 v43, s98, v42
    v_sub_u32 v14, 1, v13
    v_cvt_f32_u32 v14, v14
    s_lshl_b32 s98, s3, 7
    v_lshl_add_u32 v132, v4, 2, s98
    v_lshl_add_u32 v133, v13, 4, s98
    v_add_u32 v128, 4096, v2
    v_and_b32 v4, 15, v1
    v_lshl_add_u32 v4, v13, 4, v4
    v_lshlrev_b32 v44, 4, v4
    v_bfe_u32 v5, v1, 4, 1
    v_lshl_add_u32 v129, v5, 12, v44
    s_lshl_b32 s98, s41, 12
    s_lshl_b32 s99, s40, 10
    s_add_u32 s98, s98, s99
    v_add_u32 v130, s98, v2
    v_lshl_add_u32 v6, v5, 11, v44
    v_add_u32 v131, s98, v6
    v_add_u32 v131, 155648, v131
    v_add_u32 v16, 8192, v130
    v_add_u32 v130, 147456, v130
    v_bfe_u32 v4, v1, 1, 2
    v_lshlrev_b32 v6, 12, v4
    v_and_b32 v5, 1, v1
    v_lshl_add_u32 v45, v5, 7, v6
    v_bfe_u32 v4, v1, 1, 3
    v_xor_b32 v4, v4, v13
    s_lshl_b32 s98, s40, 2
    v_xor_b32 v4, s98, v4
    v_and_b32 v5, 31, v1
    v_lshlrev_b32 v5, 7, v5
    v_lshl_add_u32 v15, v4, 4, v5
    v_mov_b32 v17, 0
    v_add_u32 v134, s101, v2
    v_add_u32 v135, 147456, v134
    v_add_u32 v136, s101, v44
    v_add_u32 v136, 155648, v136
    v_lshrrev_b32 v18, 3, v1
    v_mul_u32_u24 v18, 1024, v18
    v_add_u32 v18, v18, v27
    v_add_u32 v19, 7168, v18
    v_add_u32 v20, 14336, v18
    v_add_u32 v21, 21504, v18
    v_lshrrev_b32 v4, 3, v1
    v_mul_u32_u24 v124, 3584, v4
    v_add_u32 v124, v124, v27
    v_add_u32 v125, 27648, v124
    s_and_b32 s98, s4, 1
    s_waitcnt lgkmcnt(0)
    v_add_u32 v15, s90, v15
    s_lshl_b32 s42, s98, 14
    v_and_b32 v4, 31, v1
    v_lshlrev_b32 v5, 2, v13
    v_sub_u32 v4, v4, v5
    v_cvt_f32_i32 v4, v4
    v_mov_b32 v5, 0x71800000
    v_mov_b32 v6, 0xf1800000
    v_fmaak_f32 v160, v4, v5, 0x00000000
    v_med3_f32 v160, v160, v6, 0
    v_sub_f32 v176, v6, v160
    v_fmaak_f32 v161, v4, v5, 0xf1800000
    v_med3_f32 v161, v161, v6, 0
    v_sub_f32 v177, v6, v161
    v_fmaak_f32 v162, v4, v5, 0xf2000000
    v_med3_f32 v162, v162, v6, 0
    v_sub_f32 v178, v6, v162
    v_fmaak_f32 v163, v4, v5, 0xf2400000
    v_med3_f32 v163, v163, v6, 0
    v_sub_f32 v179, v6, v163
    v_fmaak_f32 v164, v4, v5, 0xf3000000
    v_med3_f32 v164, v164, v6, 0
    v_sub_f32 v180, v6, v164
    v_fmaak_f32 v165, v4, v5, 0xf3100000
    v_med3_f32 v165, v165, v6, 0
    v_sub_f32 v181, v6, v165
    v_fmaak_f32 v166, v4, v5, 0xf3200000
    v_med3_f32 v166, v166, v6, 0
    v_sub_f32 v182, v6, v166
    v_fmaak_f32 v167, v4, v5, 0xf3300000
    v_med3_f32 v167, v167, v6, 0
    v_sub_f32 v183, v6, v167
    s_waitcnt vmcnt(10)
    s_barrier
    ds_read_b128 a[0:3], v28 offset:0
    s_add_u32 m0, s101, 105472
    s_nop 0
    buffer_load_dwordx4 v25, s[12:15], s59 offen offset:1024 lds
    ds_read_b64_tr_b16 a[128:129], v32 offset:0
    ds_read_b64_tr_b16 a[130:131], v32 offset:512
    ds_read_b128 a[4:7], v29 offset:0
    ds_read_b64_tr_b16 a[132:133], v33 offset:0
    ds_read_b64_tr_b16 a[134:135], v33 offset:512
    s_waitcnt lgkmcnt(3)
    v_mfma_f32_32x32x16_bf16 v[48:63], a[128:131], a[0:3], 0
    ds_read_b128 a[8:11], v30 offset:0
    ds_read_b64_tr_b16 a[136:137], v34 offset:0
    ds_read_b64_tr_b16 a[138:139], v34 offset:512
    v_fmaak_f32 v168, v4, v5, 0xf3800000
    v_med3_f32 v168, v168, v6, 0
    v_sub_f32 v184, v6, v168
    v_mfma_f32_32x32x16_bf16 v[96:111], a[0:3], a[0:3], 0
    buffer_load_dwordx4 v26, s[12:15], s59 offen offset:2048 lds
    s_add_u32 m0, s101, 49152
    s_add_u32 s100, s43, 4
    s_and_b32 s100, s100, 7
    s_lshl_b32 s68, s100, 7
    s_mul_i32 s60, s100, 196608
    v_mfma_f32_16x16x32_bf16 v[84:87], v[38:41], a[0:3], 0
    v_fmaak_f32 v169, v4, v5, 0xf3880000
    v_med3_f32 v169, v169, v6, 0
    v_mfma_f32_16x16x32_bf16 v[88:91], v[38:41], a[128:131], 0
    v_sub_f32 v185, v6, v169
    s_waitcnt lgkmcnt(3)
    v_mfma_f32_32x32x16_bf16 v[48:63], a[132:135], a[4:7], v[48:63]
    ds_read_b128 a[12:15], v31 offset:0
    ds_read_b64_tr_b16 a[140:141], v35 offset:0
    ds_read_b64_tr_b16 a[142:143], v35 offset:512
    buffer_load_dwordx4 v23, s[8:11], s68 offen offset:0 nt lds
    v_fmaak_f32 v170, v4, v5, 0xf3900000
    v_med3_f32 v170, v170, v6, 0
    v_mfma_f32_16x16x32_bf16 v[88:91], v[38:41], a[132:135], v[88:91]
    v_sub_f32 v186, v6, v170
    s_mul_i32 s6, s6, 0x9E3779B1
    s_mov_b32 s0, s36
    s_cmp_eq_u32 s7, 0
    s_cbranch_scc1 L_tagsrc
L_tagsrc_done:
    s_lshl2_add_u32 s100, s2, s3
    s_lshl_b32 s100, s100, 9
    v_lshlrev_b32 v9, 7, v1
    s_mov_b64 exec, 15
    buffer_load_dword v22, v9, s[16:19], s100 offen
    s_mov_b64 exec, -1
    s_waitcnt vmcnt(10)
    s_barrier
    s_waitcnt lgkmcnt(3)
    v_mfma_f32_32x32x16_bf16 v[48:63], a[136:139], a[8:11], v[48:63]
    ds_read_b128 a[16:19], v28 offset:8192
    ds_read_b64_tr_b16 a[144:145], v32 offset:8192
    ds_read_b64_tr_b16 a[146:147], v32 offset:8704
    v_fmaak_f32 v171, v4, v5, 0xf3980000
    v_med3_f32 v171, v171, v6, 0
    v_sub_f32 v187, v6, v171
    v_mfma_f32_32x32x16_bf16 v[96:111], a[8:11], a[8:11], v[96:111]
    buffer_load_dwordx4 v24, s[8:11], s68 offen offset:1024 nt lds
    s_add_u32 m0, s101, 113664
    v_fmaak_f32 v172, v4, v5, 0xf3c00000
    v_med3_f32 v172, v172, v6, 0
    v_sub_f32 v188, v6, v172
    v_fmaak_f32 v173, v4, v5, 0xf3c80000
    v_mfma_f32_16x16x32_bf16 v[84:87], v[38:41], a[8:11], v[84:87]
    v_med3_f32 v173, v173, v6, 0
    s_waitcnt lgkmcnt(3)
    v_mfma_f32_32x32x16_bf16 v[48:63], a[140:143], a[12:15], v[48:63]
    ds_read_b128 a[20:23], v29 offset:8192
    ds_read_b64_tr_b16 a[148:149], v33 offset:8192
    ds_read_b64_tr_b16 a[150:151], v33 offset:8704
    buffer_load_dwordx4 v25, s[12:15], s60 offen offset:1024 lds
    v_sub_f32 v189, v6, v173
    s_waitcnt lgkmcnt(3)
    v_mfma_f32_32x32x16_bf16 v[48:63], a[144:147], a[16:19], v[48:63]
    ds_read_b128 a[24:27], v30 offset:8192
    ds_read_b64_tr_b16 a[128:129], v34 offset:8192
    ds_read_b64_tr_b16 a[130:131], v34 offset:8704
    v_fmaak_f32 v174, v4, v5, 0xf3d00000
    v_med3_f32 v174, v174, v6, 0
    v_sub_f32 v190, v6, v174
    v_mfma_f32_32x32x16_bf16 v[96:111], a[16:19], a[16:19], v[96:111]
    buffer_load_dwordx4 v26, s[12:15], s60 offen offset:2048 lds
    s_add_u32 m0, s101, 57344
    s_add_u32 s100, s43, 5
    s_and_b32 s100, s100, 7
    s_lshl_b32 s69, s100, 7
    s_mul_i32 s61, s100, 196608
    v_mfma_f32_16x16x32_bf16 v[84:87], v[38:41], a[16:19], v[84:87]
    v_fmaak_f32 v175, v4, v5, 0xf3d80000
    v_med3_f32 v175, v175, v6, 0
    v_mfma_f32_16x16x32_bf16 v[88:91], v[38:41], a[144:147], v[88:91]
    v_sub_f32 v191, v6, v175
    s_waitcnt lgkmcnt(3)
    v_mfma_f32_32x32x16_bf16 v[48:63], a[148:151], a[20:23], v[48:63]
    ds_read_b128 a[28:31], v31 offset:8192
    ds_read_b64_tr_b16 a[132:133], v35 offset:8192
    ds_read_b64_tr_b16 a[134:135], v35 offset:8704
    buffer_load_dwordx4 v23, s[8:11], s69 offen offset:0 nt lds
    s_add_u32 s98, s4, 0
    s_cmp_ge_u32 s98, 4
    s_cselect_b32 s98, 0x3f803f80, 0
    v_mfma_f32_16x16x32_bf16 v[88:91], v[38:41], a[148:151], v[88:91]
    s_mov_b32 s99, s98
    s_waitcnt vmcnt(10)
    s_barrier
    s_waitcnt lgkmcnt(3)
    v_mfma_f32_32x32x16_bf16 v[48:63], a[128:131], a[24:27], v[48:63]
    ds_read_b128 a[32:35], v28 offset:16384
    ds_read_b64_tr_b16 a[136:137], v32 offset:16384
    ds_read_b64_tr_b16 a[138:139], v32 offset:16896
    buffer_load_dwordx4 v24, s[8:11], s69 offen offset:1024 nt lds
    s_add_u32 m0, s101, 121856
    v_mov_b64 v[192:193], s[98:99]
    v_mfma_f32_32x32x16_bf16 v[96:111], a[24:27], a[24:27], v[96:111]
    v_mov_b64 v[194:195], s[98:99]
    v_mov_b64 v[196:197], s[98:99]
    v_mov_b64 v[198:199], s[98:99]
    v_mov_b64 v[200:201], s[98:99]
    v_mov_b64 v[202:203], s[98:99]
    v_mov_b64 v[204:205], s[98:99]
    v_mfma_f32_16x16x32_bf16 v[84:87], v[38:41], a[24:27], v[84:87]
    buffer_load_dwordx4 v25, s[12:15], s61 offen offset:1024 lds
    s_waitcnt lgkmcnt(3)
    v_mfma_f32_32x32x16_bf16 v[48:63], a[132:135], a[28:31], v[48:63]
    ds_read_b128 a[36:39], v29 offset:16384
    ds_read_b64_tr_b16 a[140:141], v33 offset:16384
    ds_read_b64_tr_b16 a[142:143], v33 offset:16896
    v_mov_b64 v[206:207], s[98:99]
    s_add_u32 s98, s4, 1
    s_waitcnt lgkmcnt(3)
    v_mfma_f32_32x32x16_bf16 v[48:63], a[136:139], a[32:35], v[48:63]
    ds_read_b128 a[40:43], v30 offset:16384
    ds_read_b64_tr_b16 a[144:145], v34 offset:16384
    ds_read_b64_tr_b16 a[146:147], v34 offset:16896
    buffer_load_dwordx4 v26, s[12:15], s61 offen offset:2048 lds
    s_add_u32 m0, s101, 65536
    s_add_u32 s100, s43, 6
    s_and_b32 s100, s100, 7
    s_lshl_b32 s70, s100, 7
    s_mul_i32 s62, s100, 196608
    v_mfma_f32_32x32x16_bf16 v[96:111], a[32:35], a[32:35], v[96:111]
    s_cmp_ge_u32 s98, 4
    s_cselect_b32 s98, 0x3f803f80, 0
    s_mov_b32 s99, s98
    v_mov_b64 v[208:209], s[98:99]
    v_mov_b64 v[210:211], s[98:99]
    v_mov_b64 v[212:213], s[98:99]
    v_mfma_f32_16x16x32_bf16 v[84:87], v[38:41], a[32:35], v[84:87]
    buffer_load_dwordx4 v23, s[8:11], s70 offen offset:0 nt lds
    v_mov_b64 v[214:215], s[98:99]
    v_mfma_f32_16x16x32_bf16 v[88:91], v[38:41], a[136:139], v[88:91]
    v_mov_b64 v[216:217], s[98:99]
    s_waitcnt lgkmcnt(3)
    v_mfma_f32_32x32x16_bf16 v[48:63], a[140:143], a[36:39], v[48:63]
    ds_read_b128 a[44:47], v31 offset:16384
    ds_read_b64_tr_b16 a[148:149], v35 offset:16384
    ds_read_b64_tr_b16 a[150:151], v35 offset:16896
    v_mov_b64 v[218:219], s[98:99]
    v_mov_b64 v[220:221], s[98:99]
    v_mov_b64 v[222:223], s[98:99]
    v_mfma_f32_16x16x32_bf16 v[88:91], v[38:41], a[140:143], v[88:91]
    buffer_load_dwordx4 v24, s[8:11], s70 offen offset:1024 nt lds
    s_waitcnt vmcnt(11)
    s_barrier
    s_waitcnt lgkmcnt(3)
    v_mfma_f32_32x32x16_bf16 v[48:63], a[144:147], a[40:43], v[48:63]
    ds_read_b128 a[48:51], v28 offset:24576
    ds_read_b64_tr_b16 a[128:129], v32 offset:24576
    ds_read_b64_tr_b16 a[130:131], v32 offset:25088
    s_add_u32 s98, s4, 2
    s_cmp_ge_u32 s98, 4
    s_cselect_b32 s98, 0x3f803f80, 0
    v_mfma_f32_32x32x16_bf16 v[96:111], a[40:43], a[40:43], v[96:111]
    s_mov_b32 s99, s98
    v_mov_b64 v[224:225], s[98:99]
    v_mov_b64 v[226:227], s[98:99]
    v_mov_b64 v[228:229], s[98:99]
    v_mov_b64 v[230:231], s[98:99]
    v_mov_b64 v[232:233], s[98:99]
    v_mfma_f32_16x16x32_bf16 v[84:87], v[38:41], a[40:43], v[84:87]
    s_add_u32 m0, s101, 130048
    s_nop 0
    buffer_load_dwordx4 v25, s[12:15], s62 offen offset:1024 lds
    s_waitcnt lgkmcnt(3)
    v_mfma_f32_32x32x16_bf16 v[48:63], a[148:151], a[44:47], v[48:63]
    ds_read_b128 a[52:55], v29 offset:24576
    ds_read_b64_tr_b16 a[132:133], v33 offset:24576
    ds_read_b64_tr_b16 a[134:135], v33 offset:25088
    v_mov_b64 v[234:235], s[98:99]
    v_mov_b64 v[236:237], s[98:99]
    s_waitcnt lgkmcnt(3)
    v_mfma_f32_32x32x16_bf16 v[48:63], a[128:131], a[48:51], v[48:63]
    ds_read_b128 a[56:59], v30 offset:24576
    ds_read_b64_tr_b16 a[136:137], v34 offset:24576
    ds_read_b64_tr_b16 a[138:139], v34 offset:25088
    buffer_load_dwordx4 v26, s[12:15], s62 offen offset:2048 lds
    s_add_u32 m0, s101, 145408
    v_mov_b64 v[238:239], s[98:99]
    v_mfma_f32_32x32x16_bf16 v[96:111], a[48:51], a[48:51], v[96:111]
    v_mfma_f32_16x16x32_bf16 v[84:87], v[38:41], a[48:51], v[84:87]
    buffer_load_dwordx4 v25, s[12:15], s56 offen offset:2048 lds
    v_mfma_f32_16x16x32_bf16 v[88:91], v[38:41], a[128:131], v[88:91]
    s_waitcnt lgkmcnt(3)
    v_mfma_f32_32x32x16_bf16 v[48:63], a[132:135], a[52:55], v[48:63]
    ds_read_b128 a[60:63], v31 offset:24576
    ds_read_b64_tr_b16 a[140:141], v35 offset:24576
    ds_read_b64_tr_b16 a[142:143], v35 offset:25088
    v_mfma_f32_16x16x32_bf16 v[88:91], v[38:41], a[132:135], v[88:91]
    buffer_load_dwordx4 v26, s[12:15], s56 offen offset:3072 lds
    s_waitcnt vmcnt(10)
    s_barrier
    s_waitcnt lgkmcnt(3)
    v_mfma_f32_32x32x16_bf16 v[48:63], a[136:139], a[56:59], v[48:63]
    ds_read_b128 a[64:67], v28 offset:32768
    ds_read_b64_tr_b16 a[144:145], v32 offset:32768
    ds_read_b64_tr_b16 a[146:147], v32 offset:33280
    v_mfma_f32_32x32x16_bf16 v[96:111], a[56:59], a[56:59], v[96:111]
    v_mfma_f32_16x16x32_bf16 v[84:87], v[38:41], a[56:59], v[84:87]
    s_add_u32 m0, s101, 73728
    s_add_u32 s100, s43, 7
    s_and_b32 s100, s100, 7
    s_lshl_b32 s71, s100, 7
    s_mul_i32 s63, s100, 196608
    buffer_load_dwordx4 v23, s[8:11], s71 offen offset:0 nt lds
    s_waitcnt lgkmcnt(3)
    v_mfma_f32_32x32x16_bf16 v[48:63], a[140:143], a[60:63], v[48:63]
    ds_read_b128 a[68:71], v29 offset:32768
    ds_read_b64_tr_b16 a[148:149], v33 offset:32768
    ds_read_b64_tr_b16 a[150:151], v33 offset:33280
    s_waitcnt lgkmcnt(3)
    v_mfma_f32_32x32x16_bf16 v[48:63], a[144:147], a[64:67], v[48:63]
    ds_read_b128 a[72:75], v30 offset:32768
    ds_read_b64_tr_b16 a[128:129], v34 offset:32768
    ds_read_b64_tr_b16 a[130:131], v34 offset:33280
    buffer_load_dwordx4 v24, s[8:11], s71 offen offset:1024 nt lds
    s_add_u32 m0, s101, 138240
    v_mfma_f32_32x32x16_bf16 v[96:111], a[64:67], a[64:67], v[96:111]
    v_mfma_f32_16x16x32_bf16 v[84:87], v[38:41], a[64:67], v[84:87]
    buffer_load_dwordx4 v25, s[12:15], s63 offen offset:1024 lds
    v_mfma_f32_16x16x32_bf16 v[88:91], v[38:41], a[144:147], v[88:91]
    s_waitcnt lgkmcnt(3)
    v_mfma_f32_32x32x16_bf16 v[48:63], a[148:151], a[68:71], v[48:63]
    ds_read_b128 a[76:79], v31 offset:32768
    ds_read_b64_tr_b16 a[132:133], v35 offset:32768
    ds_read_b64_tr_b16 a[134:135], v35 offset:33280
    v_mfma_f32_16x16x32_bf16 v[88:91], v[38:41], a[148:151], v[88:91]
    buffer_load_dwordx4 v26, s[12:15], s63 offen offset:2048 lds
    s_waitcnt vmcnt(10)
    s_barrier
    s_waitcnt lgkmcnt(3)
    v_mfma_f32_32x32x16_bf16 v[48:63], a[128:131], a[72:75], v[48:63]
    ds_read_b128 a[80:83], v28 offset:40960
    ds_read_b64_tr_b16 a[136:137], v32 offset:40960
    ds_read_b64_tr_b16 a[138:139], v32 offset:41472
    v_mfma_f32_32x32x16_bf16 v[96:111], a[72:75], a[72:75], v[96:111]
    v_mfma_f32_16x16x32_bf16 v[84:87], v[38:41], a[72:75], v[84:87]
    s_add_u32 m0, s101, 153600
    s_nop 0
    buffer_load_dwordx4 v25, s[12:15], s57 offen offset:2048 lds
    s_waitcnt lgkmcnt(3)
    v_mfma_f32_32x32x16_bf16 v[48:63], a[132:135], a[76:79], v[48:63]
    ds_read_b128 a[84:87], v29 offset:40960
    ds_read_b64_tr_b16 a[140:141], v33 offset:40960
    ds_read_b64_tr_b16 a[142:143], v33 offset:41472
    s_waitcnt lgkmcnt(3)
    v_mfma_f32_32x32x16_bf16 v[48:63], a[136:139], a[80:83], v[48:63]
    ds_read_b128 a[88:91], v30 offset:40960
    ds_read_b64_tr_b16 a[144:145], v34 offset:40960
    ds_read_b64_tr_b16 a[146:147], v34 offset:41472
    buffer_load_dwordx4 v26, s[12:15], s57 offen offset:3072 lds
    s_add_u32 m0, s101, 96256
    v_mfma_f32_32x32x16_bf16 v[96:111], a[80:83], a[80:83], v[96:111]
    v_mfma_f32_16x16x32_bf16 v[84:87], v[38:41], a[80:83], v[84:87]
    buffer_load_dwordx4 v25, s[12:15], s58 offen offset:2048 lds
    v_mfma_f32_16x16x32_bf16 v[88:91], v[38:41], a[136:139], v[88:91]
    s_waitcnt lgkmcnt(3)
    v_mfma_f32_32x32x16_bf16 v[48:63], a[140:143], a[84:87], v[48:63]
    ds_read_b128 a[92:95], v31 offset:40960
    ds_read_b64_tr_b16 a[148:149], v35 offset:40960
    ds_read_b64_tr_b16 a[150:151], v35 offset:41472
    v_mfma_f32_16x16x32_bf16 v[88:91], v[38:41], a[140:143], v[88:91]
    buffer_load_dwordx4 v26, s[12:15], s58 offen offset:3072 lds
    s_waitcnt vmcnt(10)
    s_barrier
    s_waitcnt lgkmcnt(3)
    v_mfma_f32_32x32x16_bf16 v[48:63], a[144:147], a[88:91], v[48:63]
    ds_read_b128 a[96:99], v28 offset:49152
    ds_read_b64_tr_b16 a[128:129], v32 offset:49152
    ds_read_b64_tr_b16 a[130:131], v32 offset:49664
    v_mfma_f32_32x32x16_bf16 v[96:111], a[88:91], a[88:91], v[96:111]
    v_mfma_f32_16x16x32_bf16 v[84:87], v[38:41], a[88:91], v[84:87]
    global_load_dword v12, v17, s[36:37] sc1
    s_add_u32 m0, s101, 104448
    s_waitcnt lgkmcnt(3)
    v_mfma_f32_32x32x16_bf16 v[48:63], a[148:151], a[92:95], v[48:63]
    ds_read_b128 a[100:103], v29 offset:49152
    ds_read_b64_tr_b16 a[132:133], v33 offset:49152
    ds_read_b64_tr_b16 a[134:135], v33 offset:49664
    s_waitcnt lgkmcnt(3)
    v_mfma_f32_32x32x16_bf16 v[48:63], a[128:131], a[96:99], v[48:63]
    ds_read_b128 a[104:107], v30 offset:49152
    ds_read_b64_tr_b16 a[136:137], v34 offset:49152
    ds_read_b64_tr_b16 a[138:139], v34 offset:49664
    buffer_load_dwordx4 v25, s[12:15], s59 offen offset:2048 lds
    v_mfma_f32_32x32x16_bf16 v[96:111], a[96:99], a[96:99], v[96:111]
    v_mfma_f32_16x16x32_bf16 v[84:87], v[38:41], a[96:99], v[84:87]
    buffer_load_dwordx4 v26, s[12:15], s59 offen offset:3072 lds
    s_add_u32 m0, s101, 8192
    v_mfma_f32_16x16x32_bf16 v[88:91], v[38:41], a[128:131], v[88:91]
    s_waitcnt lgkmcnt(3)
    v_mfma_f32_32x32x16_bf16 v[48:63], a[132:135], a[100:103], v[48:63]
    ds_read_b128 a[108:111], v31 offset:49152
    ds_read_b64_tr_b16 a[140:141], v35 offset:49152
    ds_read_b64_tr_b16 a[142:143], v35 offset:49664
    v_mfma_f32_16x16x32_bf16 v[88:91], v[38:41], a[132:135], v[88:91]
    buffer_load_dwordx4 v25, s[12:15], s56 offen offset:0 lds
    s_waitcnt vmcnt(8)
    s_barrier
    s_waitcnt lgkmcnt(3)
    v_mfma_f32_32x32x16_bf16 v[48:63], a[136:139], a[104:107], v[48:63]
    ds_read_b128 a[112:115], v28 offset:57344
    ds_read_b64_tr_b16 a[144:145], v32 offset:57344
    ds_read_b64_tr_b16 a[146:147], v32 offset:57856
    v_mfma_f32_32x32x16_bf16 v[96:111], a[104:107], a[104:107], v[96:111]
    v_mfma_f32_16x16x32_bf16 v[84:87], v[38:41], a[104:107], v[84:87]
    buffer_load_dwordx4 v26, s[12:15], s56 offen offset:1024 lds
    s_add_u32 m0, s101, 112640
    s_waitcnt lgkmcnt(3)
    v_mfma_f32_32x32x16_bf16 v[48:63], a[140:143], a[108:111], v[48:63]
    ds_read_b128 a[116:119], v29 offset:57344
    ds_read_b64_tr_b16 a[148:149], v33 offset:57344
    ds_read_b64_tr_b16 a[150:151], v33 offset:57856
    s_waitcnt lgkmcnt(5)
    v_mfma_f32_32x32x16_bf16 v[96:111], a[112:115], a[112:115], v[96:111]
    v_mfma_f32_16x16x32_bf16 v[84:87], v[38:41], a[112:115], v[84:87]
    buffer_load_dwordx4 v25, s[12:15], s60 offen offset:2048 lds
    s_waitcnt lgkmcnt(3)
    v_mfma_f32_16x16x32_bf16 v[88:91], v[38:41], a[144:147], v[88:91]
    v_mfma_f32_32x32x16_bf16 v[48:63], a[144:147], a[112:115], v[48:63]
    ds_read_b128 a[120:123], v30 offset:57344
    ds_read_b64_tr_b16 a[128:129], v34 offset:57344
    ds_read_b64_tr_b16 a[130:131], v34 offset:57856
    s_waitcnt lgkmcnt(3)
    v_mfma_f32_16x16x32_bf16 v[88:91], v[38:41], a[148:151], v[88:91]
    buffer_load_dwordx4 v26, s[12:15], s60 offen offset:3072 lds
    s_add_u32 m0, s101, 120832
    v_mfma_f32_32x32x16_bf16 v[48:63], a[148:151], a[116:119], v[48:63]
    ds_read_b128 a[124:127], v31 offset:57344
    ds_read_b64_tr_b16 a[132:133], v35 offset:57344
    ds_read_b64_tr_b16 a[134:135], v35 offset:57856
    s_waitcnt lgkmcnt(5)
    v_mfma_f32_32x32x16_bf16 v[96:111], a[120:123], a[120:123], v[96:111]
    v_mfma_f32_16x16x32_bf16 v[84:87], v[38:41], a[120:123], v[84:87]
    buffer_load_dwordx4 v25, s[12:15], s61 offen offset:2048 lds
    s_waitcnt vmcnt(10)
    s_barrier
    s_waitcnt lgkmcnt(3)
    v_mfma_f32_32x32x16_bf16 v[48:63], a[128:131], a[120:123], v[48:63]
    ds_read_b64_tr_b16 a[136:137], v148 offset:0
    ds_read_b64_tr_b16 a[138:139], v148 offset:512
    ds_read_b128 a[200:203], v15
    v_xor_b32 v15, 32, v15
    s_mov_b32 vcc_lo, 0xaaaaaaaa
    s_mov_b32 vcc_hi, 0xaaaaaaaa
    s_waitcnt lgkmcnt(3)
    v_mfma_f32_32x32x16_bf16 v[48:63], a[132:135], a[124:127], v[48:63]
    ds_read_b64_tr_b16 a[140:141], v149 offset:0
    ds_read_b64_tr_b16 a[142:143], v149 offset:512
    ds_read_b64_tr_b16 a[144:145], v150 offset:0
    buffer_load_dwordx4 v26, s[12:15], s61 offen offset:3072 lds
    ds_read_b128 a[204:207], v15
    v_cndmask_b32 v7, v89, v88, s[38:39]
    ds_write_b32 v43, v7 offset:2560
    s_waitcnt lgkmcnt(6)
    v_mfma_f32_32x32x16_bf16 v[64:79], a[0:3], a[136:139], 0
    ds_read_b64_tr_b16 a[146:147], v150 offset:512
    ds_read_b64_tr_b16 a[148:149], v151 offset:0
    ds_read_b64_tr_b16 a[150:151], v151 offset:512
    s_mov_b32 s98, 0xcccccccc
    s_mov_b32 s99, 0xcccccccc
    v_cndmask_b32 v84, v85, v84, s[38:39]
    v_cndmask_b32 v96, v96, v97, vcc
    v_mfma_f32_16x16x32_bf16 v[92:95], v[38:41], a[136:139], 0
    v_cndmask_b32 v98, v98, v99, vcc
    v_cndmask_b32 v100, v100, v101, vcc
    s_waitcnt lgkmcnt(6)
    v_mfma_f32_32x32x16_bf16 v[64:79], a[4:7], a[140:143], v[64:79]
    ds_read_b64_tr_b16 a[128:129], v148 offset:8192
    ds_read_b64_tr_b16 a[130:131], v148 offset:8704
    v_cndmask_b32 v102, v102, v103, vcc
    v_cndmask_b32 v104, v104, v105, vcc
    v_cndmask_b32 v106, v106, v107, vcc
    v_cndmask_b32 v108, v108, v109, vcc
    v_cndmask_b32 v110, v110, v111, vcc
    v_mfma_f32_16x16x32_bf16 v[92:95], v[38:41], a[140:143], v[92:95]
    s_mov_b32 vcc_lo, 0xff00ff00
    s_mov_b32 vcc_hi, 0xff00ff00
    v_cndmask_b32 v96, v96, v98, s[98:99]
    v_cndmask_b32 v100, v100, v102, s[98:99]
    v_cndmask_b32 v104, v104, v106, s[98:99]
    v_cndmask_b32 v108, v108, v110, s[98:99]
    v_cndmask_b32 v96, v96, v100, vcc
    v_cndmask_b32 v104, v104, v108, vcc
    v_cndmask_b32 v85, v104, v96, s[38:39]
    ds_write_b64 v139, v[84:85] offset:0
    s_waitcnt lgkmcnt(0)
    s_barrier
    v_mfma_f32_32x32x16_bf16 v[64:79], a[8:11], a[144:147], v[64:79]
    ds_read_b64_tr_b16 a[132:133], v149 offset:8192
    ds_read_b64_tr_b16 a[134:135], v149 offset:8704
    s_add_u32 m0, s101, 129024
    s_nop 0
    buffer_load_dwordx4 v25, s[12:15], s62 offen offset:2048 lds
    ds_read_b128 v[112:115], v138 offset:0
    ds_read_b64 v[120:121], v42 offset:2560
    v_mfma_f32_32x32x16_bf16 v[64:79], a[12:15], a[148:151], v[64:79]
    ds_read_b64_tr_b16 a[136:137], v150 offset:8192
    ds_read_b64_tr_b16 a[138:139], v150 offset:8704
    v_mov_b64 v[146:147], 0
    s_waitcnt lgkmcnt(3)
    v_add_f32 v156, v112, v114
    v_add_f32 v157, v113, v115
    v_mul_f32 v156, 0xbb000000, v156
    v_mfma_f32_32x32x16_bf16 v[64:79], a[16:19], a[128:131], v[64:79]
    ds_read_b64_tr_b16 a[140:141], v151 offset:8192
    ds_read_b64_tr_b16 a[142:143], v151 offset:8704
    buffer_load_dwordx4 v26, s[12:15], s62 offen offset:3072 lds
    s_add_u32 m0, s101, 137216
    v_mul_f32 v157, 0x3b000000, v157
    v_fma_f32 v157, -v156, v156, v157
    v_max_f32 v157, 0, v157
    v_mfma_f32_16x16x32_bf16 v[92:95], v[38:41], a[128:131], v[92:95]
    v_add_f32 v157, 0x3727c5ac, v157
    v_rsq_f32 v46, v157
    s_waitcnt vmcnt(4) lgkmcnt(0)
    s_barrier
    v_mfma_f32_32x32x16_bf16 v[64:79], a[20:23], a[132:135], v[64:79]
    ds_read_b64_tr_b16 a[144:145], v32 offset:16384
    ds_read_b64_tr_b16 a[146:147], v32 offset:16896
    buffer_load_dwordx4 v25, s[12:15], s63 offen offset:2048 lds
    v_cvt_pk_bf16_f32 v152, v156, v156
    v_and_b32 v11, 0xffff0000, v152
    v_sub_f32 v11, v156, v11
    v_cvt_pk_bf16_f32 v152, v156, v11
    v_mfma_f32_16x16x32_bf16 v[92:95], v[38:41], a[132:135], v[92:95]
    v_mov_b32 v153, v152
    v_mov_b64 v[154:155], 0
    v_mfma_f32_32x32x16_bf16 v[64:79], a[24:27], a[136:139], v[64:79]
    ds_read_b64_tr_b16 a[148:149], v33 offset:16384
    ds_read_b64_tr_b16 a[150:151], v33 offset:16896
    buffer_load_dwordx4 v26, s[12:15], s63 offen offset:3072 lds
    s_add_u32 m0, s101, 24576
    ds_write_b32 v132, v46 offset:7168
    v_add_f32 v158, v120, v121
    v_mfma_f32_32x32x16_bf16 v[64:79], a[28:31], a[140:143], v[64:79]
    ds_read_b64_tr_b16 a[128:129], v34 offset:16384
    ds_read_b64_tr_b16 a[130:131], v34 offset:16896
    v_mul_f32 v158, v14, v158
    v_cvt_pk_bf16_f32 v144, v158, v158
    v_and_b32 v10, 0xffff0000, v144
    v_sub_f32 v10, v158, v10
    s_waitcnt lgkmcnt(5)
    v_mfma_f32_32x32x16_bf16 v[64:79], a[32:35], a[144:147], v[64:79]
    ds_read_b64_tr_b16 a[132:133], v35 offset:16384
    ds_read_b64_tr_b16 a[134:135], v35 offset:16896
    buffer_load_dwordx4 v25, s[12:15], s57 offen offset:0 lds
    v_cvt_pk_bf16_f32 v145, v10, v10
    s_nop 1
    v_mfma_f32_32x32x16_bf16 v[48:63], v[144:147], v[152:155], v[48:63]
    s_waitcnt lgkmcnt(4)
    ds_read_b128 v[112:115], v133 offset:7168
    ds_read_b128 v[116:119], v133 offset:7200
    v_mfma_f32_16x16x32_bf16 v[92:95], v[38:41], a[144:147], v[92:95]
    buffer_load_dwordx4 v26, s[12:15], s57 offen offset:1024 lds
    s_add_u32 m0, s101, 32768
    v_mfma_f32_32x32x16_bf16 v[64:79], a[36:39], a[148:151], v[64:79]
    ds_read_b64_tr_b16 a[136:137], v32 offset:24576
    ds_read_b64_tr_b16 a[138:139], v32 offset:25088
    ds_read_b128 v[80:83], v133 offset:7232
    ds_read_b128 v[84:87], v133 offset:7264
    v_subrev_u32 v148, 139264, v148
    v_subrev_u32 v149, 139264, v149
    v_subrev_u32 v150, 139264, v150
    v_mfma_f32_16x16x32_bf16 v[92:95], v[38:41], a[148:151], v[92:95]
    buffer_load_dwordx4 v25, s[12:15], s58 offen offset:0 lds
    v_subrev_u32 v151, 139264, v151
    s_waitcnt lgkmcnt(8)
    v_mfma_f32_32x32x16_bf16 v[64:79], a[40:43], a[128:131], v[64:79]
    ds_read_b64_tr_b16 a[140:141], v33 offset:24576
    ds_read_b64_tr_b16 a[142:143], v33 offset:25088
    v_mul_f32 v48, v46, v48
    v_mul_f32 v49, v46, v49
    v_mul_f32 v50, v46, v50
    v_mul_f32 v51, v46, v51
    s_waitcnt lgkmcnt(8)
    v_mfma_f32_32x32x16_bf16 v[64:79], a[44:47], a[132:135], v[64:79]
    ds_read_b64_tr_b16 a[144:145], v34 offset:24576
    ds_read_b64_tr_b16 a[146:147], v34 offset:25088
    buffer_load_dwordx4 v26, s[12:15], s58 offen offset:1024 lds
    s_add_u32 m0, s101, 40960
    v_mul_f32 v52, v46, v52
    v_mul_f32 v53, v46, v53
    s_waitcnt lgkmcnt(6)
    v_mfma_f32_32x32x16_bf16 v[64:79], a[48:51], a[136:139], v[64:79]
    ds_read_b64_tr_b16 a[148:149], v35 offset:24576
    ds_read_b64_tr_b16 a[150:151], v35 offset:25088
    v_mul_f32 v54, v46, v54
    v_mul_f32 v55, v46, v55
    v_cvt_pk_bf16_f32 v96, v48, v49
    v_cvt_pk_bf16_f32 v97, v50, v51
    v_cvt_pk_bf16_f32 v98, v52, v53
    v_mfma_f32_16x16x32_bf16 v[92:95], v[38:41], a[136:139], v[92:95]
    buffer_load_dwordx4 v25, s[12:15], s59 offen offset:0 lds
    v_cvt_pk_bf16_f32 v99, v54, v55
    s_waitcnt lgkmcnt(4)
    v_mfma_f32_32x32x16_bf16 v[64:79], a[52:55], a[140:143], v[64:79]
    ds_read_b64_tr_b16 a[128:129], v32 offset:32768
    ds_read_b64_tr_b16 a[130:131], v32 offset:33280
    buffer_store_dwordx4 v[96:99], v2, s[32:35], s84 offen sc1
    ds_write_b128 v130, v[96:99] offset:0
    v_mul_f32 v56, v46, v56
    v_mul_f32 v57, v46, v57
    v_mul_f32 v58, v46, v58
    v_mfma_f32_16x16x32_bf16 v[92:95], v[38:41], a[140:143], v[92:95]
    v_mul_f32 v59, v46, v59
    v_mul_f32 v60, v46, v60
    s_waitcnt lgkmcnt(5)
    v_mfma_f32_32x32x16_bf16 v[64:79], a[56:59], a[144:147], v[64:79]
    ds_read_b64_tr_b16 a[132:133], v33 offset:32768
    ds_read_b64_tr_b16 a[134:135], v33 offset:33280
    v_mul_f32 v61, v46, v61
    v_mul_f32 v62, v46, v62
    v_mul_f32 v63, v46, v63
    v_cvt_pk_bf16_f32 v100, v56, v57
    s_waitcnt lgkmcnt(5)
    v_mfma_f32_32x32x16_bf16 v[64:79], a[60:63], a[148:151], v[64:79]
    ds_read_b64_tr_b16 a[136:137], v34 offset:32768
    ds_read_b64_tr_b16 a[138:139], v34 offset:33280
    v_cvt_pk_bf16_f32 v101, v58, v59
    v_cvt_pk_bf16_f32 v102, v60, v61
    v_cvt_pk_bf16_f32 v103, v62, v63
    buffer_store_dwordx4 v[100:103], v128, s[32:35], s84 offen sc1
    s_waitcnt lgkmcnt(5)
    v_mfma_f32_32x32x16_bf16 v[64:79], a[64:67], a[128:131], v[64:79]
    ds_read_b64_tr_b16 a[140:141], v35 offset:32768
    ds_read_b64_tr_b16 a[142:143], v35 offset:33280
    ds_write_b128 v130, v[100:103] offset:2048
    v_mfma_f32_16x16x32_bf16 v[92:95], v[38:41], a[128:131], v[92:95]
    s_waitcnt vmcnt(7) lgkmcnt(1)
    s_barrier
    v_mfma_f32_32x32x16_bf16 v[64:79], a[68:71], a[132:135], v[64:79]
    ds_read_b64_tr_b16 a[144:145], v32 offset:40960
    ds_read_b64_tr_b16 a[146:147], v32 offset:41472
    v_mfma_f32_16x16x32_bf16 v[92:95], v[38:41], a[132:135], v[92:95]
    v_mfma_f32_32x32x16_bf16 v[64:79], a[72:75], a[136:139], v[64:79]
    ds_read_b64_tr_b16 a[148:149], v33 offset:40960
    ds_read_b64_tr_b16 a[150:151], v33 offset:41472
    v_mfma_f32_32x32x16_bf16 v[64:79], a[76:79], a[140:143], v[64:79]
    ds_read_b64_tr_b16 a[128:129], v34 offset:40960
    ds_read_b64_tr_b16 a[130:131], v34 offset:41472
    s_waitcnt lgkmcnt(4)
    v_mfma_f32_32x32x16_bf16 v[64:79], a[80:83], a[144:147], v[64:79]
    ds_read_b64_tr_b16 a[132:133], v35 offset:40960
    ds_read_b64_tr_b16 a[134:135], v35 offset:41472
    buffer_load_dwordx4 v26, s[12:15], s59 offen offset:1024 lds
    s_add_u32 m0, s101, 49152
    v_mfma_f32_16x16x32_bf16 v[92:95], v[38:41], a[144:147], v[92:95]
    s_waitcnt lgkmcnt(4)
    v_mfma_f32_32x32x16_bf16 v[64:79], a[84:87], a[148:151], v[64:79]
    ds_read_b64_tr_b16 a[136:137], v32 offset:49152
    ds_read_b64_tr_b16 a[138:139], v32 offset:49664
    v_mfma_f32_16x16x32_bf16 v[92:95], v[38:41], a[148:151], v[92:95]
    buffer_load_dwordx4 v25, s[12:15], s60 offen offset:0 lds
    s_waitcnt lgkmcnt(4)
    v_mfma_f32_32x32x16_bf16 v[64:79], a[88:91], a[128:131], v[64:79]
    ds_read_b64_tr_b16 a[140:141], v33 offset:49152
    ds_read_b64_tr_b16 a[142:143], v33 offset:49664
    s_waitcnt lgkmcnt(4)
    v_mfma_f32_32x32x16_bf16 v[64:79], a[92:95], a[132:135], v[64:79]
    ds_read_b64_tr_b16 a[144:145], v34 offset:49152
    ds_read_b64_tr_b16 a[146:147], v34 offset:49664
    buffer_load_dwordx4 v26, s[12:15], s60 offen offset:1024 lds
    s_add_u32 m0, s101, 57344
    s_waitcnt lgkmcnt(4)
    v_mfma_f32_32x32x16_bf16 v[64:79], a[96:99], a[136:139], v[64:79]
    ds_read_b64_tr_b16 a[148:149], v35 offset:49152
    ds_read_b64_tr_b16 a[150:151], v35 offset:49664
    v_mfma_f32_16x16x32_bf16 v[92:95], v[38:41], a[136:139], v[92:95]
    buffer_load_dwordx4 v25, s[12:15], s61 offen offset:0 lds
    s_waitcnt lgkmcnt(4)
    v_mfma_f32_32x32x16_bf16 v[64:79], a[100:103], a[140:143], v[64:79]
    ds_read_b64_tr_b16 a[128:129], v32 offset:57344
    ds_read_b64_tr_b16 a[130:131], v32 offset:57856
    v_mfma_f32_16x16x32_bf16 v[92:95], v[38:41], a[140:143], v[92:95]
    s_waitcnt lgkmcnt(4)
    v_mfma_f32_32x32x16_bf16 v[64:79], a[104:107], a[144:147], v[64:79]
    ds_read_b64_tr_b16 a[132:133], v33 offset:57344
    ds_read_b64_tr_b16 a[134:135], v33 offset:57856
    buffer_load_dwordx4 v26, s[12:15], s61 offen offset:1024 lds
    s_add_u32 m0, s101, 65536
    s_waitcnt lgkmcnt(4)
    v_mfma_f32_32x32x16_bf16 v[64:79], a[108:111], a[148:151], v[64:79]
    ds_read_b64_tr_b16 a[136:137], v34 offset:57344
    ds_read_b64_tr_b16 a[138:139], v34 offset:57856
    s_waitcnt lgkmcnt(4)
    v_mfma_f32_16x16x32_bf16 v[92:95], v[38:41], a[128:131], v[92:95]
    buffer_load_dwordx4 v25, s[12:15], s62 offen offset:0 lds
    v_mfma_f32_32x32x16_bf16 v[64:79], a[112:115], a[128:131], v[64:79]
    ds_read_b64_tr_b16 a[140:141], v35 offset:57344
    ds_read_b64_tr_b16 a[142:143], v35 offset:57856
    s_waitcnt lgkmcnt(4)
    v_mfma_f32_16x16x32_bf16 v[92:95], v[38:41], a[132:135], v[92:95]
    s_nop 7
    v_cndmask_b32 v7, v93, v92, s[38:39]
    buffer_load_dwordx4 v26, s[12:15], s62 offen offset:1024 lds
    s_add_u32 m0, s101, 73728
    ds_write_b32 v43, v7 offset:3072
    s_waitcnt vmcnt(12)
    s_barrier
    v_mfma_f32_32x32x16_bf16 v[64:79], a[116:119], a[132:135], v[64:79]
    ds_read_b64_tr_b16 a[144:145], v148 offset:0
    ds_read_b64_tr_b16 a[146:147], v148 offset:512
    s_waitcnt lgkmcnt(0)
    s_barrier
    v_mfma_f32_32x32x16_bf16 v[64:79], a[120:123], a[136:139], v[64:79]
    ds_read_b64_tr_b16 a[148:149], v149 offset:0
    ds_read_b64_tr_b16 a[150:151], v149 offset:512
    buffer_load_dwordx4 v25, s[12:15], s63 offen offset:0 lds
    ds_read_b64 v[120:121], v42 offset:3072
    v_mul_f32 v46, 0x3eb8aa3b, v46
    s_waitcnt lgkmcnt(0)
    v_add_f32 v158, v120, v121
    v_mul_f32 v158, v14, v158
    v_cvt_pk_bf16_f32 v144, v158, v158
    v_and_b32 v10, 0xffff0000, v144
    v_sub_f32 v10, v158, v10
    v_cvt_pk_bf16_f32 v145, v10, v10
    v_mfma_f32_32x32x16_bf16 v[64:79], a[124:127], a[140:143], v[64:79]
    ds_read_b64_tr_b16 a[128:129], v150 offset:0
    ds_read_b64_tr_b16 a[130:131], v150 offset:512
    buffer_load_dwordx4 v26, s[12:15], s63 offen offset:1024 lds
    s_xor_b32 s100, s42, 0
    s_add_u32 m0, s100, s5
    s_mul_i32 s100, s100, 8
    s_add_u32 m0, m0, 81920
    s_add_u32 s100, s100, s1
    v_mfma_f32_32x32x16_bf16 v[48:63], a[144:147], a[0:3], 0
    ds_read_b64_tr_b16 a[132:133], v151 offset:0
    ds_read_b64_tr_b16 a[134:135], v151 offset:512
    v_mfma_f32_32x32x16_bf16 v[64:79], v[152:155], v[144:147], v[64:79]
    s_add_u32 s98, s4, 3
    s_cmp_ge_u32 s98, 4
    s_cselect_b32 s98, 0x3f803f80, 0
    s_mov_b32 s99, s98
    s_nop 7
    v_mul_f32 v64, v112, v64
    v_mfma_f32_16x16x32_bf16 v[88:91], v[38:41], a[144:147], 0
    buffer_load_dwordx4 v18, s[16:19], s100 offen offset:0 lds
    v_mul_f32 v65, v113, v65
    v_mul_f32 v66, v114, v66
    v_mfma_f32_32x32x16_bf16 v[48:63], a[148:151], a[4:7], v[48:63]
    ds_read_b64_tr_b16 a[136:137], v140 offset:8192
    ds_read_b64_tr_b16 a[138:139], v140 offset:8704
    v_mul_f32 v67, v115, v67
    v_mul_f32 v68, v116, v68
    v_mul_f32 v69, v117, v69
    v_mul_f32 v70, v118, v70
    v_mul_f32 v71, v119, v71
    v_cvt_pk_bf16_f32 v104, v64, v65
    v_cvt_pk_bf16_f32 v105, v66, v67
    v_cvt_pk_bf16_f32 v106, v68, v69
    v_cvt_pk_bf16_f32 v107, v70, v71
    buffer_store_dwordx4 v[104:107], v129, s[32:35], s84 offen offset:1024 sc1
    ds_write_b128 v131, v[104:107] offset:0
    v_mul_f32 v72, v80, v72
    v_mul_f32 v73, v81, v73
    v_mul_f32 v74, v82, v74
    v_mul_f32 v75, v83, v75
    v_mul_f32 v76, v84, v76
    v_mfma_f32_16x16x32_bf16 v[88:91], v[38:41], a[148:151], v[88:91]
    v_mul_f32 v77, v85, v77
    v_mul_f32 v78, v86, v78
    v_mul_f32 v79, v87, v79
    v_cvt_pk_bf16_f32 v108, v72, v73
    v_cvt_pk_bf16_f32 v109, v74, v75
    v_cvt_pk_bf16_f32 v110, v76, v77
    v_cvt_pk_bf16_f32 v111, v78, v79
    buffer_store_dwordx4 v[108:111], v129, s[32:35], s84 offen offset:1536 sc1
    ds_write_b128 v131, v[108:111] offset:512
    v_mov_b64 v[240:241], s[98:99]
    v_mov_b64 v[242:243], s[98:99]
    v_mov_b64 v[244:245], s[98:99]
    v_mov_b64 v[246:247], s[98:99]
    s_waitcnt lgkmcnt(6)
    v_mfma_f32_32x32x16_bf16 v[48:63], a[128:131], a[8:11], v[48:63]
    ds_read_b64_tr_b16 a[140:141], v141 offset:8192
    ds_read_b64_tr_b16 a[142:143], v141 offset:8704
    v_mov_b64 v[248:249], s[98:99]
    v_mov_b64 v[250:251], s[98:99]
    v_mov_b64 v[252:253], s[98:99]
    v_mov_b64 v[254:255], s[98:99]
    v_mov_b32 v4, 0x3f803f80
    v_accvgpr_write_b32 a232, v4
    v_accvgpr_write_b32 a233, v4
    v_accvgpr_write_b32 a234, v4
    v_accvgpr_write_b32 a235, v4
    v_accvgpr_write_b32 a236, v4
    v_accvgpr_write_b32 a237, v4
    v_accvgpr_write_b32 a238, v4
    v_accvgpr_write_b32 a239, v4
    v_accvgpr_write_b32 a240, v4
    v_accvgpr_write_b32 a241, v4
    s_waitcnt lgkmcnt(6)
    v_mfma_f32_32x32x16_bf16 v[48:63], a[132:135], a[12:15], v[48:63]
    ds_read_b64_tr_b16 a[144:145], v142 offset:8192
    ds_read_b64_tr_b16 a[146:147], v142 offset:8704
    v_accvgpr_write_b32 a242, v4
    v_accvgpr_write_b32 a243, v4
    v_accvgpr_write_b32 a244, v4
    v_accvgpr_write_b32 a245, v4
    v_accvgpr_write_b32 a246, v4
    s_waitcnt lgkmcnt(6)
    v_mfma_f32_32x32x16_bf16 v[48:63], a[136:139], a[16:19], v[48:63]
    ds_read_b64_tr_b16 a[148:149], v143 offset:8192
    ds_read_b64_tr_b16 a[150:151], v143 offset:8704
    v_accvgpr_write_b32 a247, v4
    v_mfma_f32_16x16x32_bf16 v[88:91], v[38:41], a[136:139], v[88:91]
    s_waitcnt vmcnt(9) lgkmcnt(0)
    s_barrier
    v_mfma_f32_32x32x16_bf16 v[48:63], a[140:143], a[20:23], v[48:63]
    ds_read_b64_tr_b16 a[128:129], v140 offset:16384
    ds_read_b64_tr_b16 a[130:131], v140 offset:16896
    buffer_load_dwordx4 v19, s[16:19], s100 offen offset:1024 lds
    v_mfma_f32_16x16x32_bf16 v[88:91], v[38:41], a[140:143], v[88:91]
    v_mfma_f32_32x32x16_bf16 v[48:63], a[144:147], a[24:27], v[48:63]
    ds_read_b64_tr_b16 a[132:133], v141 offset:16384
    ds_read_b64_tr_b16 a[134:135], v141 offset:16896
    v_mfma_f32_32x32x16_bf16 v[48:63], a[148:151], a[28:31], v[48:63]
    ds_read_b64_tr_b16 a[136:137], v142 offset:16384
    ds_read_b64_tr_b16 a[138:139], v142 offset:16896
    buffer_load_dwordx4 v20, s[16:19], s100 offen offset:2048 lds
    s_waitcnt lgkmcnt(4)
    v_mfma_f32_32x32x16_bf16 v[48:63], a[128:131], a[32:35], v[48:63]
    ds_read_b64_tr_b16 a[140:141], v143 offset:16384
    ds_read_b64_tr_b16 a[142:143], v143 offset:16896
    v_mfma_f32_16x16x32_bf16 v[88:91], v[38:41], a[128:131], v[88:91]
    buffer_load_dwordx4 v21, s[16:19], s100 offen offset:3072 lds
    s_xor_b32 s100, s42, 16384
    s_add_u32 m0, s100, s5
    s_mul_i32 s100, s100, 8
    s_add_u32 m0, m0, 81920
    s_add_u32 s100, s100, s1
    s_waitcnt lgkmcnt(4)
    v_mfma_f32_32x32x16_bf16 v[48:63], a[132:135], a[36:39], v[48:63]
    ds_read_b64_tr_b16 a[144:145], v140 offset:24576
    ds_read_b64_tr_b16 a[146:147], v140 offset:25088
    v_mfma_f32_16x16x32_bf16 v[88:91], v[38:41], a[132:135], v[88:91]
    buffer_load_dwordx4 v18, s[16:19], s100 offen offset:0 lds
    s_waitcnt lgkmcnt(4)
    v_mfma_f32_32x32x16_bf16 v[48:63], a[136:139], a[40:43], v[48:63]
    ds_read_b64_tr_b16 a[148:149], v141 offset:24576
    ds_read_b64_tr_b16 a[150:151], v141 offset:25088
    s_waitcnt lgkmcnt(4)
    v_mfma_f32_32x32x16_bf16 v[48:63], a[140:143], a[44:47], v[48:63]
    ds_read_b64_tr_b16 a[128:129], v142 offset:24576
    ds_read_b64_tr_b16 a[130:131], v142 offset:25088
    buffer_load_dwordx4 v19, s[16:19], s100 offen offset:1024 lds
    s_waitcnt lgkmcnt(4)
    v_mfma_f32_32x32x16_bf16 v[48:63], a[144:147], a[48:51], v[48:63]
    ds_read_b64_tr_b16 a[132:133], v143 offset:24576
    ds_read_b64_tr_b16 a[134:135], v143 offset:25088
    v_mfma_f32_16x16x32_bf16 v[88:91], v[38:41], a[144:147], v[88:91]
    buffer_load_dwordx4 v20, s[16:19], s100 offen offset:2048 lds
    s_waitcnt lgkmcnt(4)
    v_mfma_f32_32x32x16_bf16 v[48:63], a[148:151], a[52:55], v[48:63]
    ds_read_b64_tr_b16 a[136:137], v140 offset:32768
    ds_read_b64_tr_b16 a[138:139], v140 offset:33280
    v_mfma_f32_16x16x32_bf16 v[88:91], v[38:41], a[148:151], v[88:91]
    s_waitcnt lgkmcnt(4)
    v_mfma_f32_32x32x16_bf16 v[48:63], a[128:131], a[56:59], v[48:63]
    ds_read_b64_tr_b16 a[140:141], v141 offset:32768
    ds_read_b64_tr_b16 a[142:143], v141 offset:33280
    buffer_load_dwordx4 v21, s[16:19], s100 offen offset:3072 lds
    s_waitcnt lgkmcnt(4)
    v_mfma_f32_32x32x16_bf16 v[48:63], a[132:135], a[60:63], v[48:63]
    ds_read_b64_tr_b16 a[144:145], v142 offset:32768
    ds_read_b64_tr_b16 a[146:147], v142 offset:33280
    s_waitcnt lgkmcnt(4)
    v_mfma_f32_32x32x16_bf16 v[48:63], a[136:139], a[64:67], v[48:63]
    ds_read_b64_tr_b16 a[148:149], v143 offset:32768
    ds_read_b64_tr_b16 a[150:151], v143 offset:33280
    buffer_load_dwordx4 a[168:171], v18, s[24:27], s89 offen offset:0 nt
    v_mfma_f32_16x16x32_bf16 v[88:91], v[38:41], a[136:139], v[88:91]
    s_waitcnt vmcnt(11) lgkmcnt(0)
    s_barrier
    v_mfma_f32_32x32x16_bf16 v[48:63], a[140:143], a[68:71], v[48:63]
    ds_read_b64_tr_b16 a[128:129], v140 offset:40960
    ds_read_b64_tr_b16 a[130:131], v140 offset:41472
    v_mfma_f32_16x16x32_bf16 v[88:91], v[38:41], a[140:143], v[88:91]
    buffer_load_dwordx4 a[172:175], v19, s[24:27], s89 offen offset:1024 nt
    v_mfma_f32_32x32x16_bf16 v[48:63], a[144:147], a[72:75], v[48:63]
    ds_read_b64_tr_b16 a[132:133], v141 offset:40960
    ds_read_b64_tr_b16 a[134:135], v141 offset:41472
    v_cmp_eq_u32 vcc, 0, v12
    s_nop 0
    s_cbranch_vccnz L_tagspin
L_tagok:
    s_waitcnt vmcnt(9)
    buffer_store_dword v12, v3, s[32:35], s85 offen sc1
    v_readfirstlane_b32 s6, v12
    v_mfma_f32_32x32x16_bf16 v[48:63], a[148:151], a[76:79], v[48:63]
    ds_read_b64_tr_b16 a[136:137], v142 offset:40960
    ds_read_b64_tr_b16 a[138:139], v142 offset:41472
    s_waitcnt lgkmcnt(4)
    v_mfma_f32_32x32x16_bf16 v[48:63], a[128:131], a[80:83], v[48:63]
    ds_read_b64_tr_b16 a[140:141], v143 offset:40960
    ds_read_b64_tr_b16 a[142:143], v143 offset:41472
    buffer_load_dwordx4 a[160:163], v124, s[20:23], s88 offen offset:0
    v_mfma_f32_16x16x32_bf16 v[88:91], v[38:41], a[128:131], v[88:91]
    s_waitcnt lgkmcnt(4)
    v_mfma_f32_32x32x16_bf16 v[48:63], a[132:135], a[84:87], v[48:63]
    ds_read_b64_tr_b16 a[144:145], v140 offset:49152
    ds_read_b64_tr_b16 a[146:147], v140 offset:49664
    v_mfma_f32_16x16x32_bf16 v[88:91], v[38:41], a[132:135], v[88:91]
    buffer_load_dwordx4 a[164:167], v125, s[20:23], s88 offen offset:1024
    s_xor_b32 s100, s42, 32768
    s_add_u32 m0, s100, s5
    s_mul_i32 s100, s100, 8
    s_add_u32 m0, m0, 81920
    s_add_u32 s100, s100, s1
    s_waitcnt lgkmcnt(4)
    v_mfma_f32_32x32x16_bf16 v[48:63], a[136:139], a[88:91], v[48:63]
    ds_read_b64_tr_b16 a[148:149], v141 offset:49152
    ds_read_b64_tr_b16 a[150:151], v141 offset:49664
    s_waitcnt lgkmcnt(4)
    v_mfma_f32_32x32x16_bf16 v[48:63], a[140:143], a[92:95], v[48:63]
    ds_read_b64_tr_b16 a[128:129], v142 offset:49152
    ds_read_b64_tr_b16 a[130:131], v142 offset:49664
    buffer_load_dwordx4 v18, s[16:19], s100 offen offset:0 lds
    s_waitcnt lgkmcnt(4)
    v_mfma_f32_32x32x16_bf16 v[48:63], a[144:147], a[96:99], v[48:63]
    ds_read_b64_tr_b16 a[132:133], v143 offset:49152
    ds_read_b64_tr_b16 a[134:135], v143 offset:49664
    v_mfma_f32_16x16x32_bf16 v[88:91], v[38:41], a[144:147], v[88:91]
    buffer_load_dwordx4 v19, s[16:19], s100 offen offset:1024 lds
    s_waitcnt lgkmcnt(4)
    v_mfma_f32_32x32x16_bf16 v[48:63], a[148:151], a[100:103], v[48:63]
    ds_read_b64_tr_b16 a[136:137], v140 offset:57344
    ds_read_b64_tr_b16 a[138:139], v140 offset:57856
    v_mfma_f32_16x16x32_bf16 v[88:91], v[38:41], a[148:151], v[88:91]
    s_waitcnt lgkmcnt(4)
    v_mfma_f32_32x32x16_bf16 v[48:63], a[128:131], a[104:107], v[48:63]
    ds_read_b64_tr_b16 a[140:141], v141 offset:57344
    ds_read_b64_tr_b16 a[142:143], v141 offset:57856
    buffer_load_dwordx4 v20, s[16:19], s100 offen offset:2048 lds
    s_waitcnt lgkmcnt(4)
    v_mfma_f32_32x32x16_bf16 v[48:63], a[132:135], a[108:111], v[48:63]
    ds_read_b64_tr_b16 a[144:145], v142 offset:57344
    ds_read_b64_tr_b16 a[146:147], v142 offset:57856
    s_waitcnt lgkmcnt(4)
    v_mfma_f32_16x16x32_bf16 v[88:91], v[38:41], a[136:139], v[88:91]
    buffer_load_dwordx4 v21, s[16:19], s100 offen offset:3072 lds
    s_xor_b32 s100, s42, 49152
    s_add_u32 m0, s100, s5
    s_mul_i32 s100, s100, 8
    s_add_u32 m0, m0, 81920
    s_add_u32 s100, s100, s1
    v_mfma_f32_32x32x16_bf16 v[48:63], a[136:139], a[112:115], v[48:63]
    ds_read_b64_tr_b16 a[148:149], v143 offset:57344
    ds_read_b64_tr_b16 a[150:151], v143 offset:57856
    s_waitcnt lgkmcnt(4)
    v_mfma_f32_16x16x32_bf16 v[88:91], v[38:41], a[140:143], v[88:91]
    buffer_load_dwordx4 v18, s[16:19], s100 offen offset:0 lds
    s_nop 6
    v_cndmask_b32 v7, v89, v88, s[38:39]
    ds_write_b32 v43, v7 offset:2048
    v_mfma_f32_32x32x16_bf16 v[48:63], a[140:143], a[116:119], v[48:63]
    s_waitcnt lgkmcnt(0)
    s_barrier
    ds_read_b64 v[120:121], v42 offset:2048
    v_mfma_f32_32x32x16_bf16 v[48:63], a[144:147], a[120:123], v[48:63]
    buffer_load_dwordx4 v19, s[16:19], s100 offen offset:1024 lds
    v_mfma_f32_32x32x16_bf16 v[48:63], a[148:151], a[124:127], v[48:63]
    ds_read_b128 a[228:231], v135 offset:1024
    ds_read_b128 a[224:227], v135
    s_waitcnt lgkmcnt(2)
    v_add_f32 v158, v120, v121
    v_mul_f32 v158, v14, v158
    v_cvt_pk_bf16_f32 v144, v158, v158
    buffer_load_dwordx4 v20, s[16:19], s100 offen offset:2048 lds
    v_and_b32 v10, 0xffff0000, v144
    v_sub_f32 v10, v158, v10
    v_cvt_pk_bf16_f32 v145, v10, v10
    s_nop 1
    v_mfma_f32_32x32x16_bf16 v[48:63], v[144:147], v[152:155], v[48:63]
    s_mov_b64 exec, s[38:39]
    ds_read_b128 a[240:243], v136 offset:1024
    ds_read_b128 a[244:247], v136 offset:1536
    ds_read_b128 a[232:235], v136
    ds_read_b128 a[236:239], v136 offset:512
    s_mov_b64 exec, -1
    s_getreg_b32 s0, hwreg(HW_REG_XCC_ID, 0, 4)
    buffer_load_dwordx4 v21, s[16:19], s100 offen offset:3072 lds
    v_xor_b32 v17, s0, v12
    buffer_store_dword v17, v3, s[32:35], s86 offen sc1
    s_nop 1
    v_pk_mul_f32 v[48:49], v[48:49], v[46:47] op_sel_hi:[1,0]
    v_pk_mul_f32 v[50:51], v[50:51], v[46:47] op_sel_hi:[1,0]
    v_pk_mul_f32 v[52:53], v[52:53], v[46:47] op_sel_hi:[1,0]
    v_pk_mul_f32 v[54:55], v[54:55], v[46:47] op_sel_hi:[1,0]
    v_cvt_pk_bf16_f32 v96, v48, v49
    v_cvt_pk_bf16_f32 v97, v50, v51
    v_cvt_pk_bf16_f32 v98, v52, v53
    v_cvt_pk_bf16_f32 v99, v54, v55
    ds_write_b128 v16, v[96:99] offset:0
    v_pk_mul_f32 v[56:57], v[56:57], v[46:47] op_sel_hi:[1,0]
    v_pk_mul_f32 v[58:59], v[58:59], v[46:47] op_sel_hi:[1,0]
    v_pk_mul_f32 v[60:61], v[60:61], v[46:47] op_sel_hi:[1,0]
    v_pk_mul_f32 v[62:63], v[62:63], v[46:47] op_sel_hi:[1,0]
    v_cvt_pk_bf16_f32 v100, v56, v57
    v_cvt_pk_bf16_f32 v101, v58, v59
    v_cvt_pk_bf16_f32 v102, v60, v61
    v_cvt_pk_bf16_f32 v103, v62, v63
    ds_write_b128 v16, v[100:103] offset:2048
    s_waitcnt lgkmcnt(0)
    s_barrier
    ds_read_b128 a[252:255], v134 offset:9216
    ds_read_b128 a[248:251], v134 offset:8192
    s_waitcnt lgkmcnt(1)
    v_mfma_f32_32x32x16_bf16 v[48:63], a[228:231], a[252:255], v[160:175]
    v_mfma_f32_32x32x16_bf16 v[64:79], a[224:227], a[252:255], 0
    buffer_load_dword v10, v45, s[32:35], s82 offen offset:0 sc1
    v_lshl_add_u32 v4, v13, 9, v36
    v_add_u32 v4, s5, v4
    v_add_u32 v4, 147456, v4
    v_lshl_add_u32 v22, v37, 6, v4
    v_xor_b32 v23, 64, v22
    v_add_u32 v5, s5, v2
    v_add_u32 v5, 147456, v5
    s_waitcnt vmcnt(11)
    ds_write_b128 v5, a[160:163] offset:0
    s_waitcnt vmcnt(10)
    ds_write_b128 v5, a[164:167] offset:1024
    ds_write_b128 v5, a[168:171] offset:2048
    ds_write_b128 v5, a[172:175] offset:3072
    v_exp_f32 v48, v48
    v_exp_f32 v49, v49
    v_exp_f32 v50, v50
    v_exp_f32 v51, v51
    v_exp_f32 v52, v52
    v_exp_f32 v53, v53
    v_exp_f32 v54, v54
    v_exp_f32 v55, v55
    v_cvt_pk_bf16_f32 v112, v48, v49
    v_cvt_pk_bf16_f32 v113, v50, v51
    v_cvt_pk_bf16_f32 v114, v52, v53
    v_cvt_pk_bf16_f32 v115, v54, v55
    v_exp_f32 v56, v56
    v_exp_f32 v57, v57
    v_mfma_f32_32x32x16_bf16 v[96:111], a[240:243], v[112:115], 0
    v_exp_f32 v58, v58
    v_exp_f32 v59, v59
    v_exp_f32 v60, v60
    v_exp_f32 v61, v61
    v_exp_f32 v62, v62
    v_exp_f32 v63, v63
    v_cvt_pk_bf16_f32 v116, v56, v57
    v_cvt_pk_bf16_f32 v117, v58, v59
    v_cvt_pk_bf16_f32 v118, v60, v61
    v_cvt_pk_bf16_f32 v119, v62, v63
    v_exp_f32 v64, v64
    v_exp_f32 v65, v65
    v_mfma_f32_32x32x16_bf16 v[96:111], a[244:247], v[116:119], v[96:111]
    v_exp_f32 v66, v66
    v_exp_f32 v67, v67
    v_exp_f32 v68, v68
    v_exp_f32 v69, v69
    v_exp_f32 v70, v70
    v_exp_f32 v71, v71
    v_cvt_pk_bf16_f32 v112, v64, v65
    v_cvt_pk_bf16_f32 v113, v66, v67
    v_cvt_pk_bf16_f32 v114, v68, v69
    v_cvt_pk_bf16_f32 v115, v70, v71
    v_exp_f32 v72, v72
    v_exp_f32 v73, v73
    v_mfma_f32_32x32x16_bf16 v[96:111], a[232:235], v[112:115], v[96:111]
    s_waitcnt lgkmcnt(0)
    ds_read_b64_tr_b16 a[184:185], v22 offset:2048
    ds_read_b64_tr_b16 a[186:187], v22 offset:3072
    ds_read_b64_tr_b16 a[188:189], v23 offset:2048
    ds_read_b64_tr_b16 a[190:191], v23 offset:3072
    ds_read_b64_tr_b16 a[176:177], v22 offset:0
    ds_read_b64_tr_b16 a[178:179], v22 offset:1024
    ds_read_b64_tr_b16 a[180:181], v23 offset:0
    ds_read_b64_tr_b16 a[182:183], v23 offset:1024
    v_exp_f32 v74, v74
    v_exp_f32 v75, v75
    v_exp_f32 v76, v76
    v_exp_f32 v77, v77
    v_exp_f32 v78, v78
    v_exp_f32 v79, v79
    v_cvt_pk_bf16_f32 v116, v72, v73
    v_cvt_pk_bf16_f32 v117, v74, v75
    v_cvt_pk_bf16_f32 v118, v76, v77
    v_cvt_pk_bf16_f32 v119, v78, v79
    v_and_b32 v4, 31, v1
    s_lshl_b32 s98, s3, 2
    v_mfma_f32_32x32x16_bf16 v[96:111], a[236:239], v[116:119], v[96:111]
    s_waitcnt lgkmcnt(6)
    buffer_store_dwordx4 a[184:187], v2, s[32:35], s83 offen offset:0 sc1
    s_waitcnt lgkmcnt(4)
    buffer_store_dwordx4 a[188:191], v2, s[32:35], s83 offen offset:1024 sc1
    s_waitcnt lgkmcnt(2)
    v_mfma_f32_16x16x32_bf16 v[120:123], v[38:41], a[176:179], 0
    s_waitcnt lgkmcnt(0)
    v_mfma_f32_16x16x32_bf16 v[124:127], v[38:41], a[180:183], 0
    s_waitcnt vmcnt(2)
    v_cmp_ne_u32 vcc, s6, v10
    s_nop 0
    s_and_b64 vcc, vcc, s[80:81]
    s_cbranch_vccz L_halook
    v_mov_b32 v10, 0
L_poll0:
    buffer_load_dword v10, v45, s[32:35], s82 offen offset:0 sc1
    s_add_u32 s96, s96, 1
    s_cmp_gt_u32 s96, s97
    s_waitcnt vmcnt(0)
    s_cbranch_scc1 L_pdone0
    v_cmp_ne_u32 vcc, s6, v10
    s_nop 0
    s_and_b64 vcc, vcc, s[80:81]
    s_cbranch_vccnz L_poll0
L_pdone0:
L_halook:
    buffer_load_dwordx4 v[156:159], v2, s[32:35], s79 offen offset:2048 sc1
    s_mov_b64 exec, s[38:39]
    buffer_load_dwordx4 v[248:251], v44, s[32:35], s79 offen offset:3072 sc1
    buffer_load_dwordx4 v[252:255], v44, s[32:35], s79 offen offset:3584 sc1
    s_mov_b64 exec, -1
    buffer_load_dwordx4 v[152:155], v2, s[32:35], s79 offen offset:0 sc1
    s_mov_b64 exec, s[38:39]
    buffer_load_dwordx4 v[240:243], v44, s[32:35], s79 offen offset:1024 sc1
    buffer_load_dwordx4 v[244:247], v44, s[32:35], s79 offen offset:1536 sc1
    s_mov_b64 exec, -1
    v_lshl_add_u32 v4, v4, 4, s98
    v_cndmask_b32 v120, v121, v120, s[38:39]
    v_cndmask_b32 v124, v125, v124, s[38:39]
    ds_write_b32 v4, v120 offset:5120
    ds_write_b32 v4, v124 offset:5632
    v_lshlrev_b32 v5, 3, v1
    v_and_b32 v4, 15, v1
    v_lshlrev_b32 v22, 2, v4
    v_lshlrev_b32 v9, 7, v4
    v_and_b32 v4, 31, v1
    v_lshlrev_b32 v4, 3, v4
    v_lshl_add_u32 v23, v13, 11, v4
    v_lshrrev_b32 v4, 1, v1
    v_min_u32 v4, 13, v4
    v_add_u32 v8, s3, v4
    v_and_b32 v8, 3, v8
    v_lshl_add_u32 v4, v4, 2, v8
    v_and_b32 v8, 1, v1
    v_lshl_add_u32 v4, v4, 1, v8
    v_lshlrev_b32 v24, 7, v4
    v_mov_b32 v28, 0x2b800000
    v_mov_b32 v29, 0x53800000
    s_waitcnt lgkmcnt(0)
    s_barrier
    ds_read_b128 v[120:123], v2 offset:5120
    v_mov_b32 v7, v12
    v_mfma_f32_32x32x16_bf16 v[48:63], a[224:227], a[248:251], v[160:175]
    buffer_load_dwordx4 v[148:151], v2, s[32:35], s78 offen offset:2048 sc1
    s_waitcnt vmcnt(6)
    v_mfma_f32_32x32x16_bf16 v[64:79], v[156:159], a[252:255], 0
    s_nop 8
    v_exp_f32 v48, v48
    v_exp_f32 v49, v49
    v_exp_f32 v50, v50
    v_exp_f32 v51, v51
    v_exp_f32 v52, v52
    s_mov_b64 exec, s[38:39]
    buffer_load_dwordx4 v[232:235], v44, s[32:35], s78 offen offset:3072 sc1
    buffer_load_dwordx4 v[236:239], v44, s[32:35], s78 offen offset:3584 sc1
    s_mov_b64 exec, -1
    v_exp_f32 v53, v53
    v_exp_f32 v54, v54
    v_exp_f32 v55, v55
    v_cvt_pk_bf16_f32 v112, v48, v49
    v_cvt_pk_bf16_f32 v113, v50, v51
    v_cvt_pk_bf16_f32 v114, v52, v53
    v_cvt_pk_bf16_f32 v115, v54, v55
    v_exp_f32 v56, v56
    v_exp_f32 v57, v57
    v_mfma_f32_32x32x16_bf16 v[80:95], a[232:235], v[112:115], 0
    v_exp_f32 v58, v58
    v_exp_f32 v59, v59
    v_exp_f32 v60, v60
    v_exp_f32 v61, v61
    v_exp_f32 v62, v62
    v_exp_f32 v63, v63
    v_cvt_pk_bf16_f32 v116, v56, v57
    v_cvt_pk_bf16_f32 v117, v58, v59
    v_cvt_pk_bf16_f32 v118, v60, v61
    s_waitcnt lgkmcnt(0)
    v_add_f32 v120, v120, v121
    v_add_f32 v122, v122, v123
    v_add_f32 v6, v120, v122
    buffer_store_dwordx2 v[6:7], v5, s[32:35], s45 offen sc1
    v_cvt_pk_bf16_f32 v119, v62, v63
    v_exp_f32 v64, v64
    v_exp_f32 v65, v65
    v_mfma_f32_32x32x16_bf16 v[80:95], a[236:239], v[116:119], v[80:95]
    v_exp_f32 v66, v66
    v_exp_f32 v67, v67
    v_exp_f32 v68, v68
    v_mfma_f32_32x32x16_bf16 v[48:63], v[156:159], a[248:251], 0
    v_exp_f32 v69, v69
    buffer_load_dwordx4 v[144:147], v2, s[32:35], s78 offen offset:0 sc1
    v_exp_f32 v70, v70
    v_exp_f32 v71, v71
    v_cvt_pk_bf16_f32 v112, v64, v65
    v_cvt_pk_bf16_f32 v113, v66, v67
    v_cvt_pk_bf16_f32 v114, v68, v69
    v_cvt_pk_bf16_f32 v115, v70, v71
    v_exp_f32 v72, v72
    v_exp_f32 v73, v73
    s_waitcnt vmcnt(9)
    v_mfma_f32_32x32x16_bf16 v[96:111], v[248:251], v[112:115], v[96:111]
    v_exp_f32 v74, v74
    s_mov_b64 exec, s[38:39]
    buffer_load_dwordx4 v[224:227], v44, s[32:35], s78 offen offset:1024 sc1
    buffer_load_dwordx4 v[228:231], v44, s[32:35], s78 offen offset:1536 sc1
    s_mov_b64 exec, -1
    v_exp_f32 v75, v75
    v_exp_f32 v76, v76
    v_exp_f32 v77, v77
    v_exp_f32 v78, v78
    v_exp_f32 v79, v79
    v_cvt_pk_bf16_f32 v116, v72, v73
    v_cvt_pk_bf16_f32 v117, v74, v75
    v_cvt_pk_bf16_f32 v118, v76, v77
    v_cvt_pk_bf16_f32 v119, v78, v79
    v_exp_f32 v48, v48
    v_exp_f32 v49, v49
    s_waitcnt vmcnt(10)
    v_mfma_f32_32x32x16_bf16 v[96:111], v[252:255], v[116:119], v[96:111]
    v_exp_f32 v50, v50
    v_exp_f32 v51, v51
    v_exp_f32 v52, v52
    s_waitcnt vmcnt(9)
    v_mfma_f32_32x32x16_bf16 v[64:79], v[152:155], a[252:255], 0
    v_exp_f32 v53, v53
    v_exp_f32 v54, v54
    buffer_load_dwordx4 v[140:143], v2, s[32:35], s77 offen offset:2048 sc1
    v_exp_f32 v55, v55
    v_cvt_pk_bf16_f32 v112, v48, v49
    v_cvt_pk_bf16_f32 v113, v50, v51
    v_cvt_pk_bf16_f32 v114, v52, v53
    v_cvt_pk_bf16_f32 v115, v54, v55
    v_exp_f32 v56, v56
    v_exp_f32 v57, v57
    v_mfma_f32_32x32x16_bf16 v[80:95], v[248:251], v[112:115], v[80:95]
    s_load_dwordx16 s[56:71], s[92:93], 144
    v_exp_f32 v58, v58
    v_exp_f32 v59, v59
    s_mov_b64 exec, s[38:39]
    buffer_load_dwordx4 v[216:219], v44, s[32:35], s77 offen offset:3072 sc1
    buffer_load_dwordx4 v[220:223], v44, s[32:35], s77 offen offset:3584 sc1
    s_mov_b64 exec, -1
    v_exp_f32 v60, v60
    v_exp_f32 v61, v61
    v_exp_f32 v62, v62
    v_exp_f32 v63, v63
    v_cvt_pk_bf16_f32 v116, v56, v57
    v_cvt_pk_bf16_f32 v117, v58, v59
    v_cvt_pk_bf16_f32 v118, v60, v61
    v_cvt_pk_bf16_f32 v119, v62, v63
    v_exp_f32 v64, v64
    v_exp_f32 v65, v65
    v_mfma_f32_32x32x16_bf16 v[80:95], v[252:255], v[116:119], v[80:95]
    v_exp_f32 v66, v66
    v_exp_f32 v67, v67
    v_exp_f32 v68, v68
    v_mfma_f32_32x32x16_bf16 v[48:63], v[152:155], a[248:251], 0
    v_exp_f32 v69, v69
    v_exp_f32 v70, v70
    v_exp_f32 v71, v71
    buffer_load_dwordx4 v[136:139], v2, s[32:35], s77 offen offset:0 sc1
    v_cvt_pk_bf16_f32 v112, v64, v65
    v_cvt_pk_bf16_f32 v113, v66, v67
    v_cvt_pk_bf16_f32 v114, v68, v69
    v_cvt_pk_bf16_f32 v115, v70, v71
    v_exp_f32 v72, v72
    v_exp_f32 v73, v73
    s_waitcnt vmcnt(12)
    v_mfma_f32_32x32x16_bf16 v[96:111], v[240:243], v[112:115], v[96:111]
    v_exp_f32 v74, v74
    v_exp_f32 v75, v75
    v_exp_f32 v76, v76
    s_mov_b64 exec, s[38:39]
    buffer_load_dwordx4 v[208:211], v44, s[32:35], s77 offen offset:1024 sc1
    buffer_load_dwordx4 v[212:215], v44, s[32:35], s77 offen offset:1536 sc1
    s_mov_b64 exec, -1
    v_exp_f32 v77, v77
    v_exp_f32 v78, v78
    v_exp_f32 v79, v79
    v_cvt_pk_bf16_f32 v116, v72, v73
    v_cvt_pk_bf16_f32 v117, v74, v75
    v_cvt_pk_bf16_f32 v118, v76, v77
    v_cvt_pk_bf16_f32 v119, v78, v79
    v_exp_f32 v48, v48
    v_exp_f32 v49, v49
    s_waitcnt vmcnt(13)
    v_mfma_f32_32x32x16_bf16 v[96:111], v[244:247], v[116:119], v[96:111]
    v_exp_f32 v50, v50
    v_exp_f32 v51, v51
    v_exp_f32 v52, v52
    s_waitcnt vmcnt(12)
    v_mfma_f32_32x32x16_bf16 v[64:79], v[148:151], a[252:255], 0
    v_exp_f32 v53, v53
    v_exp_f32 v54, v54
    v_exp_f32 v55, v55
    v_cvt_pk_bf16_f32 v112, v48, v49
    buffer_load_dwordx4 v[132:135], v2, s[32:35], s76 offen offset:2048 sc1
    v_cvt_pk_bf16_f32 v113, v50, v51
    v_cvt_pk_bf16_f32 v114, v52, v53
    v_cvt_pk_bf16_f32 v115, v54, v55
    v_exp_f32 v56, v56
    v_exp_f32 v57, v57
    v_mfma_f32_32x32x16_bf16 v[80:95], v[240:243], v[112:115], v[80:95]
    v_exp_f32 v58, v58
    v_exp_f32 v59, v59
    v_exp_f32 v60, v60
    v_exp_f32 v61, v61
    s_mov_b64 exec, s[38:39]
    buffer_load_dwordx4 v[200:203], v44, s[32:35], s76 offen offset:3072 sc1
    buffer_load_dwordx4 v[204:207], v44, s[32:35], s76 offen offset:3584 sc1
    s_mov_b64 exec, -1
    v_exp_f32 v62, v62
    v_exp_f32 v63, v63
    v_cvt_pk_bf16_f32 v116, v56, v57
    v_cvt_pk_bf16_f32 v117, v58, v59
    v_cvt_pk_bf16_f32 v118, v60, v61
    v_cvt_pk_bf16_f32 v119, v62, v63
    v_exp_f32 v64, v64
    v_exp_f32 v65, v65
    v_mfma_f32_32x32x16_bf16 v[80:95], v[244:247], v[116:119], v[80:95]
    v_exp_f32 v66, v66
    v_exp_f32 v67, v67
    v_exp_f32 v68, v68
    v_mfma_f32_32x32x16_bf16 v[48:63], v[148:151], a[248:251], 0
    v_exp_f32 v69, v69
    v_exp_f32 v70, v70
    v_exp_f32 v71, v71
    v_cvt_pk_bf16_f32 v112, v64, v65
    v_cvt_pk_bf16_f32 v113, v66, v67
    v_cvt_pk_bf16_f32 v114, v68, v69
    buffer_load_dwordx4 v[128:131], v2, s[32:35], s76 offen offset:0 sc1
    v_cvt_pk_bf16_f32 v115, v70, v71
    v_exp_f32 v72, v72
    v_exp_f32 v73, v73
    s_waitcnt vmcnt(15)
    v_mfma_f32_32x32x16_bf16 v[96:111], v[232:235], v[112:115], v[96:111]
    v_exp_f32 v74, v74
    v_exp_f32 v75, v75
    v_exp_f32 v76, v76
    v_exp_f32 v77, v77
    v_exp_f32 v78, v78
    s_mov_b64 exec, s[38:39]
    buffer_load_dwordx4 v[192:195], v44, s[32:35], s76 offen offset:1024 sc1
    buffer_load_dwordx4 v[196:199], v44, s[32:35], s76 offen offset:1536 sc1
    s_mov_b64 exec, -1
    v_exp_f32 v79, v79
    v_cvt_pk_bf16_f32 v116, v72, v73
    v_cvt_pk_bf16_f32 v117, v74, v75
    v_cvt_pk_bf16_f32 v118, v76, v77
    v_cvt_pk_bf16_f32 v119, v78, v79
    v_exp_f32 v48, v48
    v_exp_f32 v49, v49
    s_waitcnt vmcnt(16)
    v_mfma_f32_32x32x16_bf16 v[96:111], v[236:239], v[116:119], v[96:111]
    v_exp_f32 v50, v50
    v_exp_f32 v51, v51
    v_exp_f32 v52, v52
    s_waitcnt vmcnt(14)
    v_mfma_f32_32x32x16_bf16 v[64:79], v[144:147], a[252:255], 0
    v_exp_f32 v53, v53
    v_exp_f32 v54, v54
    v_exp_f32 v55, v55
    v_cvt_pk_bf16_f32 v112, v48, v49
    v_cvt_pk_bf16_f32 v113, v50, v51
    v_cvt_pk_bf16_f32 v114, v52, v53
    v_cvt_pk_bf16_f32 v115, v54, v55
    v_exp_f32 v56, v56
    buffer_load_dword v11, v9, s[32:35], s87 offen sc1
    v_exp_f32 v57, v57
    v_mfma_f32_32x32x16_bf16 v[80:95], v[232:235], v[112:115], v[80:95]
    v_exp_f32 v58, v58
    v_exp_f32 v59, v59
    v_exp_f32 v60, v60
    v_exp_f32 v61, v61
    v_exp_f32 v62, v62
    v_exp_f32 v63, v63
    v_lshrrev_b32 v18, 3, v1
    v_mul_u32_u24 v18, 3584, v18
    v_add_u32 v18, v18, v27
    v_add_u32 v19, 27648, v18
    v_add_u32 v20, 55296, v18
    v_add_u32 v21, 82944, v18
    s_and_b32 s100, s4, 2
    s_lshl_b32 s42, s100, 14
    v_cvt_pk_bf16_f32 v116, v56, v57
    s_xor_b32 s100, s42, 0
    s_add_u32 m0, s100, s5
    s_mul_i32 s100, s100, 28
    s_add_u32 m0, m0, 16384
    s_add_u32 s100, s100, s46
    v_cvt_pk_bf16_f32 v117, v58, v59
    buffer_load_dwordx4 v18, s[20:23], s100 offen offset:0 lds
    v_cvt_pk_bf16_f32 v118, v60, v61
    v_cvt_pk_bf16_f32 v119, v62, v63
    v_exp_f32 v64, v64
    v_exp_f32 v65, v65
    v_mfma_f32_32x32x16_bf16 v[80:95], v[236:239], v[116:119], v[80:95]
    v_exp_f32 v66, v66
    v_exp_f32 v67, v67
    v_exp_f32 v68, v68
    v_mfma_f32_32x32x16_bf16 v[48:63], v[144:147], a[248:251], 0
    v_exp_f32 v69, v69
    v_exp_f32 v70, v70
    v_exp_f32 v71, v71
    v_cvt_pk_bf16_f32 v112, v64, v65
    v_cvt_pk_bf16_f32 v113, v66, v67
    buffer_load_dwordx4 v19, s[20:23], s100 offen offset:1024 lds
    v_cvt_pk_bf16_f32 v114, v68, v69
    v_cvt_pk_bf16_f32 v115, v70, v71
    v_exp_f32 v72, v72
    v_exp_f32 v73, v73
    s_waitcnt vmcnt(16)
    v_mfma_f32_32x32x16_bf16 v[96:111], v[224:227], v[112:115], v[96:111]
    buffer_store_dword v12, v3, s[32:35], s44 offen sc1
    v_exp_f32 v74, v74
    v_exp_f32 v75, v75
    v_exp_f32 v76, v76
    v_exp_f32 v77, v77
    v_exp_f32 v78, v78
    v_exp_f32 v79, v79
    v_cvt_pk_bf16_f32 v116, v72, v73
    v_cvt_pk_bf16_f32 v117, v74, v75
    v_cvt_pk_bf16_f32 v118, v76, v77
    v_cvt_pk_bf16_f32 v119, v78, v79
    v_exp_f32 v48, v48
    v_exp_f32 v49, v49
    s_waitcnt vmcnt(16)
    v_mfma_f32_32x32x16_bf16 v[96:111], v[228:231], v[116:119], v[96:111]
    v_exp_f32 v50, v50
    buffer_load_dwordx4 v20, s[20:23], s100 offen offset:2048 lds
    v_exp_f32 v51, v51
    v_exp_f32 v52, v52
    s_waitcnt vmcnt(16)
    v_mfma_f32_32x32x16_bf16 v[64:79], v[140:143], a[252:255], 0
    v_exp_f32 v53, v53
    v_exp_f32 v54, v54
    v_exp_f32 v55, v55
    v_cvt_pk_bf16_f32 v112, v48, v49
    v_cvt_pk_bf16_f32 v113, v50, v51
    v_cvt_pk_bf16_f32 v114, v52, v53
    v_cvt_pk_bf16_f32 v115, v54, v55
    v_exp_f32 v56, v56
    v_exp_f32 v57, v57
    v_mfma_f32_32x32x16_bf16 v[80:95], v[224:227], v[112:115], v[80:95]
    v_exp_f32 v58, v58
    buffer_load_dwordx4 v21, s[20:23], s100 offen offset:3072 lds
    s_xor_b32 s100, s42, 16384
    s_add_u32 m0, s100, s5
    s_mul_i32 s100, s100, 28
    s_add_u32 m0, m0, 16384
    s_add_u32 s100, s100, s46
    v_exp_f32 v59, v59
    v_exp_f32 v60, v60
    v_exp_f32 v61, v61
    v_exp_f32 v62, v62
    v_exp_f32 v63, v63
    v_cvt_pk_bf16_f32 v116, v56, v57
    v_cvt_pk_bf16_f32 v117, v58, v59
    v_cvt_pk_bf16_f32 v118, v60, v61
    v_cvt_pk_bf16_f32 v119, v62, v63
    v_exp_f32 v64, v64
    v_exp_f32 v65, v65
    v_mfma_f32_32x32x16_bf16 v[80:95], v[228:231], v[116:119], v[80:95]
    buffer_load_dwordx4 v18, s[20:23], s100 offen offset:0 lds
    v_exp_f32 v66, v66
    v_exp_f32 v67, v67
    v_exp_f32 v68, v68
    v_mfma_f32_32x32x16_bf16 v[48:63], v[140:143], a[248:251], 0
    v_exp_f32 v69, v69
    v_exp_f32 v70, v70
    v_exp_f32 v71, v71
    v_cvt_pk_bf16_f32 v112, v64, v65
    v_cvt_pk_bf16_f32 v113, v66, v67
    v_cvt_pk_bf16_f32 v114, v68, v69
    v_cvt_pk_bf16_f32 v115, v70, v71
    v_exp_f32 v72, v72
    v_exp_f32 v73, v73
    s_waitcnt vmcnt(17)
    v_mfma_f32_32x32x16_bf16 v[96:111], v[216:219], v[112:115], v[96:111]
    buffer_load_dwordx4 v19, s[20:23], s100 offen offset:1024 lds
    v_exp_f32 v74, v74
    v_exp_f32 v75, v75
    v_exp_f32 v76, v76
    v_exp_f32 v77, v77
    v_exp_f32 v78, v78
    v_exp_f32 v79, v79
    v_cvt_pk_bf16_f32 v116, v72, v73
    v_cvt_pk_bf16_f32 v117, v74, v75
    v_cvt_pk_bf16_f32 v118, v76, v77
    v_cvt_pk_bf16_f32 v119, v78, v79
    v_exp_f32 v48, v48
    v_exp_f32 v49, v49
    s_waitcnt vmcnt(17)
    v_mfma_f32_32x32x16_bf16 v[96:111], v[220:223], v[116:119], v[96:111]
    v_exp_f32 v50, v50
    buffer_load_dwordx4 v20, s[20:23], s100 offen offset:2048 lds
    v_exp_f32 v51, v51
    v_exp_f32 v52, v52
    s_waitcnt vmcnt(17)
    v_mfma_f32_32x32x16_bf16 v[64:79], v[136:139], a[252:255], 0
    v_exp_f32 v53, v53
    v_exp_f32 v54, v54
    v_exp_f32 v55, v55
    v_cvt_pk_bf16_f32 v112, v48, v49
    v_cvt_pk_bf16_f32 v113, v50, v51
    v_cvt_pk_bf16_f32 v114, v52, v53
    v_cvt_pk_bf16_f32 v115, v54, v55
    v_exp_f32 v56, v56
    v_exp_f32 v57, v57
    v_mfma_f32_32x32x16_bf16 v[80:95], v[216:219], v[112:115], v[80:95]
    v_exp_f32 v58, v58
    buffer_load_dwordx4 v21, s[20:23], s100 offen offset:3072 lds
    s_xor_b32 s100, s42, 32768
    s_add_u32 m0, s100, s5
    s_mul_i32 s100, s100, 28
    s_add_u32 m0, m0, 16384
    s_add_u32 s100, s100, s46
    v_exp_f32 v59, v59
    v_exp_f32 v60, v60
    v_exp_f32 v61, v61
    v_exp_f32 v62, v62
    v_exp_f32 v63, v63
    v_cvt_pk_bf16_f32 v116, v56, v57
    v_cvt_pk_bf16_f32 v117, v58, v59
    v_cvt_pk_bf16_f32 v118, v60, v61
    v_cvt_pk_bf16_f32 v119, v62, v63
    v_exp_f32 v64, v64
    v_exp_f32 v65, v65
    v_mfma_f32_32x32x16_bf16 v[80:95], v[220:223], v[116:119], v[80:95]
    buffer_load_dwordx4 v18, s[20:23], s100 offen offset:0 lds
    v_exp_f32 v66, v66
    v_exp_f32 v67, v67
    v_exp_f32 v68, v68
    v_mfma_f32_32x32x16_bf16 v[48:63], v[136:139], a[248:251], 0
    v_exp_f32 v69, v69
    v_exp_f32 v70, v70
    v_exp_f32 v71, v71
    v_cvt_pk_bf16_f32 v112, v64, v65
    v_cvt_pk_bf16_f32 v113, v66, v67
    v_cvt_pk_bf16_f32 v114, v68, v69
    v_cvt_pk_bf16_f32 v115, v70, v71
    v_exp_f32 v72, v72
    v_exp_f32 v73, v73
    s_waitcnt vmcnt(18)
    v_mfma_f32_32x32x16_bf16 v[96:111], v[208:211], v[112:115], v[96:111]
    buffer_load_dwordx4 v19, s[20:23], s100 offen offset:1024 lds
    v_exp_f32 v74, v74
    v_exp_f32 v75, v75
    v_exp_f32 v76, v76
    v_exp_f32 v77, v77
    v_exp_f32 v78, v78
    v_exp_f32 v79, v79
    v_cvt_pk_bf16_f32 v116, v72, v73
    v_cvt_pk_bf16_f32 v117, v74, v75
    v_cvt_pk_bf16_f32 v118, v76, v77
    v_cvt_pk_bf16_f32 v119, v78, v79
    v_exp_f32 v48, v48
    v_exp_f32 v49, v49
    s_waitcnt vmcnt(18)
    v_mfma_f32_32x32x16_bf16 v[96:111], v[212:215], v[116:119], v[96:111]
    v_exp_f32 v50, v50
    buffer_load_dwordx4 v20, s[20:23], s100 offen offset:2048 lds
    v_exp_f32 v51, v51
    v_exp_f32 v52, v52
    s_waitcnt vmcnt(18)
    v_mfma_f32_32x32x16_bf16 v[64:79], v[132:135], a[252:255], v[176:191]
    v_exp_f32 v53, v53
    v_exp_f32 v54, v54
    v_exp_f32 v55, v55
    v_cvt_pk_bf16_f32 v112, v48, v49
    v_cvt_pk_bf16_f32 v113, v50, v51
    v_cvt_pk_bf16_f32 v114, v52, v53
    v_cvt_pk_bf16_f32 v115, v54, v55
    v_exp_f32 v56, v56
    v_exp_f32 v57, v57
    v_mfma_f32_32x32x16_bf16 v[80:95], v[208:211], v[112:115], v[80:95]
    v_exp_f32 v58, v58
    buffer_load_dwordx4 v21, s[20:23], s100 offen offset:3072 lds
    s_xor_b32 s100, s42, 49152
    s_add_u32 m0, s100, s5
    s_mul_i32 s100, s100, 28
    s_add_u32 m0, m0, 16384
    s_add_u32 s100, s100, s46
    v_exp_f32 v59, v59
    v_exp_f32 v60, v60
    v_exp_f32 v61, v61
    v_exp_f32 v62, v62
    v_exp_f32 v63, v63
    v_cvt_pk_bf16_f32 v116, v56, v57
    v_cvt_pk_bf16_f32 v117, v58, v59
    v_cvt_pk_bf16_f32 v118, v60, v61
    v_cvt_pk_bf16_f32 v119, v62, v63
    v_exp_f32 v64, v64
    v_exp_f32 v65, v65
    v_mfma_f32_32x32x16_bf16 v[80:95], v[212:215], v[116:119], v[80:95]
    buffer_load_dwordx4 v18, s[20:23], s100 offen offset:0 lds
    v_exp_f32 v66, v66
    v_exp_f32 v67, v67
    v_exp_f32 v68, v68
    v_mfma_f32_32x32x16_bf16 v[48:63], v[132:135], a[248:251], 0
    v_exp_f32 v69, v69
    v_exp_f32 v70, v70
    v_exp_f32 v71, v71
    v_cvt_pk_bf16_f32 v112, v64, v65
    v_cvt_pk_bf16_f32 v113, v66, v67
    v_cvt_pk_bf16_f32 v114, v68, v69
    v_cvt_pk_bf16_f32 v115, v70, v71
    v_exp_f32 v72, v72
    v_exp_f32 v73, v73
    s_waitcnt vmcnt(19)
    v_mfma_f32_32x32x16_bf16 v[96:111], v[200:203], v[112:115], v[96:111]
    buffer_load_dwordx4 v19, s[20:23], s100 offen offset:1024 lds
    s_load_dwordx8 s[76:83], s[92:93], 112
    buffer_load_dword v25, v24, s[32:35], s51 offen offset:0 sc1
    v_exp_f32 v74, v74
    v_exp_f32 v75, v75
    v_exp_f32 v76, v76
    v_exp_f32 v77, v77
    v_exp_f32 v78, v78
    v_exp_f32 v79, v79
    v_cvt_pk_bf16_f32 v116, v72, v73
    v_cvt_pk_bf16_f32 v117, v74, v75
    v_cvt_pk_bf16_f32 v118, v76, v77
    v_cvt_pk_bf16_f32 v119, v78, v79
    v_exp_f32 v48, v48
    v_exp_f32 v49, v49
    s_waitcnt vmcnt(20)
    v_mfma_f32_32x32x16_bf16 v[96:111], v[204:207], v[116:119], v[96:111]
    v_exp_f32 v50, v50
    buffer_load_dwordx4 v20, s[20:23], s100 offen offset:2048 lds
    v_exp_f32 v51, v51
    v_exp_f32 v52, v52
    s_waitcnt vmcnt(20)
    v_mfma_f32_32x32x16_bf16 v[64:79], v[128:131], a[248:251], v[176:191]
    v_exp_f32 v53, v53
    v_exp_f32 v54, v54
    v_exp_f32 v55, v55
    v_cvt_pk_bf16_f32 v112, v48, v49
    v_cvt_pk_bf16_f32 v113, v50, v51
    v_cvt_pk_bf16_f32 v114, v52, v53
    v_cvt_pk_bf16_f32 v115, v54, v55
    v_exp_f32 v56, v56
    v_exp_f32 v57, v57
    v_mfma_f32_32x32x16_bf16 v[80:95], v[200:203], v[112:115], v[80:95]
    s_waitcnt vmcnt(17)
    v_xor_b32 v11, s6, v11
    v_cmp_le_u32 vcc, 16, v11
    s_nop 0
    s_cbranch_vccnz L_xccspin
L_xccok:
    v_cmp_ne_u32 vcc, s0, v11
    s_nop 0
    s_cmp_eq_u64 vcc, 0
    s_cselect_b32 s7, 1, 0
    v_exp_f32 v58, v58
    v_exp_f32 v59, v59
    v_exp_f32 v60, v60
    v_exp_f32 v61, v61
    v_exp_f32 v62, v62
    v_exp_f32 v63, v63
    v_cvt_pk_bf16_f32 v116, v56, v57
    v_cvt_pk_bf16_f32 v117, v58, v59
    v_cvt_pk_bf16_f32 v118, v60, v61
    v_cvt_pk_bf16_f32 v119, v62, v63
    v_exp_f32 v64, v64
    v_exp_f32 v65, v65
    v_mfma_f32_32x32x16_bf16 v[80:95], v[204:207], v[116:119], v[80:95]
    v_exp_f32 v66, v66
    v_exp_f32 v67, v67
    v_exp_f32 v68, v68
    v_exp_f32 v69, v69
    v_exp_f32 v70, v70
    v_exp_f32 v71, v71
    v_cvt_pk_bf16_f32 v112, v64, v65
    v_cvt_pk_bf16_f32 v113, v66, v67
    v_cvt_pk_bf16_f32 v114, v68, v69
    v_cvt_pk_bf16_f32 v115, v70, v71
    v_exp_f32 v72, v72
    v_exp_f32 v73, v73
    v_mfma_f32_32x32x16_bf16 v[80:95], v[192:195], v[112:115], v[80:95]
    v_exp_f32 v74, v74
    v_exp_f32 v75, v75
    v_exp_f32 v76, v76
    v_exp_f32 v77, v77
    v_exp_f32 v78, v78
    v_exp_f32 v79, v79
    v_cvt_pk_bf16_f32 v116, v72, v73
    v_cvt_pk_bf16_f32 v117, v74, v75
    v_cvt_pk_bf16_f32 v118, v76, v77
    v_cvt_pk_bf16_f32 v119, v78, v79
    v_add_u32 v8, 114688, v2
    s_nop 0
    v_mfma_f32_32x32x16_bf16 v[80:95], v[196:199], v[116:119], v[80:95]
    v_max3_f32 v4, abs(v96), abs(v97), abs(v98)
    v_max3_f32 v4, abs(v99), abs(v100), v4
    v_max3_f32 v4, abs(v101), abs(v102), v4
    v_max3_f32 v4, abs(v103), v4, v4
    v_fma_f32 v4, v4, 0, v104
    v_med3_f32 v5, v4, v28, v29
    v_cmp_neq_f32 vcc, v4, v5
    s_nop 0
    s_cbranch_vccnz L_fallback
    v_rcp_f32 v4, v104
    s_nop 0
    v_mul_f32 v96, v4, v96
    v_mul_f32 v97, v4, v97
    v_mul_f32 v98, v4, v98
    v_mul_f32 v99, v4, v99
    v_mul_f32 v100, v4, v100
    v_mul_f32 v101, v4, v101
    v_mul_f32 v102, v4, v102
    v_mul_f32 v103, v4, v103
    v_cvt_pk_bf16_f32 v112, v96, v97
    v_cvt_pk_bf16_f32 v113, v98, v99
    v_cvt_pk_bf16_f32 v114, v100, v101
    v_cvt_pk_bf16_f32 v115, v102, v103
    buffer_store_dwordx4 v[112:115], v8, s[32:35], s91 offen sc1
    v_max3_f32 v4, abs(v80), abs(v81), abs(v82)
    v_max3_f32 v4, abs(v83), abs(v84), v4
    v_max3_f32 v4, abs(v85), abs(v86), v4
    v_max3_f32 v4, abs(v87), v4, v4
    v_fma_f32 v4, v4, 0, v88
    v_med3_f32 v5, v4, v28, v29
    v_cmp_neq_f32 vcc, v4, v5
    s_nop 0
    s_cbranch_vccnz L_fallback
    v_rcp_f32 v4, v88
    s_nop 0
    v_pk_mul_f32 v[80:81], v[80:81], v[4:5] op_sel_hi:[1,0]
    v_pk_mul_f32 v[82:83], v[82:83], v[4:5] op_sel_hi:[1,0]
    v_pk_mul_f32 v[84:85], v[84:85], v[4:5] op_sel_hi:[1,0]
    v_pk_mul_f32 v[86:87], v[86:87], v[4:5] op_sel_hi:[1,0]
    v_cvt_pk_bf16_f32 v116, v80, v81
    v_cvt_pk_bf16_f32 v117, v82, v83
    v_cvt_pk_bf16_f32 v118, v84, v85
    v_cvt_pk_bf16_f32 v119, v86, v87
    buffer_store_dwordx4 v[116:119], v2, s[32:35], s91 offen sc1
L_attn_ok:
    s_lshl_b32 s98, s40, 10
    v_add_u32 v16, s98, v2
    v_xor_b32 v17, 1024, v16
    v_accvgpr_read_b32 v56, a200
    v_accvgpr_read_b32 v57, a201
    v_accvgpr_read_b32 v58, a202
    v_accvgpr_read_b32 v59, a203
    v_accvgpr_read_b32 v60, a204
    v_accvgpr_read_b32 v61, a205
    v_accvgpr_read_b32 v62, a206
    v_accvgpr_read_b32 v63, a207
    v_lshl_add_u32 v4, v13, 9, v36
    v_lshl_add_u32 v28, v37, 6, v4
    v_permlane32_swap_b32 v56, v58
    v_permlane32_swap_b32 v57, v59
    v_permlane32_swap_b32 v60, v62
    v_permlane32_swap_b32 v61, v63
    v_lshlrev_b32 v240, 16, v56
    v_and_b32 v241, 0xffff0000, v56
    v_lshlrev_b32 v242, 16, v57
    v_and_b32 v243, 0xffff0000, v57
    v_lshlrev_b32 v244, 16, v58
    v_and_b32 v245, 0xffff0000, v58
    v_lshlrev_b32 v246, 16, v59
    v_and_b32 v247, 0xffff0000, v59
    v_lshlrev_b32 v248, 16, v60
    v_and_b32 v249, 0xffff0000, v60
    v_lshlrev_b32 v250, 16, v61
    v_and_b32 v251, 0xffff0000, v61
    v_lshlrev_b32 v252, 16, v62
    v_and_b32 v253, 0xffff0000, v62
    v_lshlrev_b32 v254, 16, v63
    v_and_b32 v255, 0xffff0000, v63
    s_lshl_b32 s98, s40, 6
    v_xor_b32 v4, s98, v28
    s_lshl_b32 s98, s40, 15
    s_add_u32 s98, s98, 81920
    v_add_u32 v26, s98, v4
    v_xor_b32 v27, 64, v26
    s_waitcnt vmcnt(0)
    s_cmp_eq_u32 s7, 0
    s_cbranch_scc1 L_slow0
    buffer_store_dword v12, v3, s[32:35], s49 offen
L_back0:
    buffer_load_dword v11, v22, s[32:35], s50 offen offset:0 sc1
    ds_read_b64_tr_b16 a[228:229], v27 offset:0
    ds_read_b64_tr_b16 a[230:231], v27 offset:1024
    ds_read_b64_tr_b16 a[224:225], v26 offset:0
    ds_read_b64_tr_b16 a[226:227], v26 offset:1024
    ds_read_b64_tr_b16 a[236:237], v27 offset:2048
    ds_read_b64_tr_b16 a[238:239], v27 offset:3072
    ds_read_b64_tr_b16 a[232:233], v26 offset:2048
    ds_read_b64_tr_b16 a[234:235], v26 offset:3072
    s_xor_b32 s98, s5, 4096
    s_add_u32 s98, s98, 147456
    v_add_u32 v29, s98, v2
    v_xor_b32 v30, 4096, v29
    v_bfe_u32 v8, v1, 4, 1
    v_lshlrev_b32 v8, 3, v8
    v_lshl_add_u32 v8, v22, 2, v8
    v_lshl_add_u32 v8, v13, 29, v8
    s_waitcnt vmcnt(0)
    v_cmp_ne_u32 vcc, s6, v11
    s_nop 0
    s_cbranch_vccz L_ook
    v_mov_b32 v10, 0
L_poll1:
    buffer_load_dword v10, v22, s[32:35], s50 offen offset:0 sc1
    s_add_u32 s96, s96, 1
    s_cmp_gt_u32 s96, s97
    s_waitcnt vmcnt(0)
    s_cbranch_scc1 L_pdone1
    v_cmp_ne_u32 vcc, s6, v10
    s_nop 0
    s_cbranch_vccnz L_poll1
L_pdone1:
L_ook:
    s_add_u32 s98, s48, 0
    buffer_load_dwordx4 v[128:131], v2, s[32:35], s98 offen offset:0 sc1
    buffer_load_dwordx4 v[132:135], v2, s[32:35], s98 offen offset:1024 sc1
    buffer_load_dwordx4 v[136:139], v2, s[32:35], s98 offen offset:2048 sc1
    buffer_load_dwordx4 v[140:143], v2, s[32:35], s98 offen offset:3072 sc1
    s_add_u32 s98, s48, 4096
    buffer_load_dwordx4 v[144:147], v2, s[32:35], s98 offen offset:0 sc1
    buffer_load_dwordx4 v[148:151], v2, s[32:35], s98 offen offset:1024 sc1
    buffer_load_dwordx4 v[152:155], v2, s[32:35], s98 offen offset:2048 sc1
    buffer_load_dwordx4 v[156:159], v2, s[32:35], s98 offen offset:3072 sc1
    s_add_u32 s98, s48, 8192
    buffer_load_dwordx4 v[160:163], v2, s[32:35], s98 offen offset:0 sc1
    buffer_load_dwordx4 v[164:167], v2, s[32:35], s98 offen offset:1024 sc1
    buffer_load_dwordx4 v[168:171], v2, s[32:35], s98 offen offset:2048 sc1
    buffer_load_dwordx4 v[172:175], v2, s[32:35], s98 offen offset:3072 sc1
    s_add_u32 s98, s48, 12288
    buffer_load_dwordx4 v[176:179], v2, s[32:35], s98 offen offset:0 sc1
    buffer_load_dwordx4 v[180:183], v2, s[32:35], s98 offen offset:1024 sc1
    v_cmp_ne_u32 vcc, s6, v25
    s_nop 0
    s_cbranch_vccnz L_aspin0
L_aok0:
    s_waitcnt vmcnt(13) lgkmcnt(0)
    v_mfma_f32_32x32x16_bf16 v[224:239], a[228:231], v[128:131], 0
    ds_read_b64_tr_b16 a[244:245], v27 offset:4096
    ds_read_b64_tr_b16 a[246:247], v27 offset:5120
    buffer_load_dwordx4 v[184:187], v2, s[32:35], s98 offen offset:2048 sc1
    v_mfma_f32_32x32x16_bf16 v[240:255], a[224:227], v[128:131], v[240:255]
    ds_read_b64_tr_b16 a[240:241], v26 offset:4096
    ds_read_b64_tr_b16 a[242:243], v26 offset:5120
    s_waitcnt vmcnt(13)
    v_mfma_f32_32x32x16_bf16 v[224:239], a[236:239], v[132:135], v[224:239]
    ds_read_b64_tr_b16 a[252:253], v27 offset:6144
    ds_read_b64_tr_b16 a[254:255], v27 offset:7168
    buffer_load_dwordx4 v[188:191], v2, s[32:35], s98 offen offset:3072 sc1
    v_mfma_f32_32x32x16_bf16 v[240:255], a[232:235], v[132:135], v[240:255]
    ds_read_b64_tr_b16 a[248:249], v26 offset:6144
    ds_read_b64_tr_b16 a[250:251], v26 offset:7168
    s_waitcnt vmcnt(13) lgkmcnt(6)
    v_mfma_f32_32x32x16_bf16 v[224:239], a[244:247], v[136:139], v[224:239]
    ds_read_b64_tr_b16 a[228:229], v27 offset:8192
    ds_read_b64_tr_b16 a[230:231], v27 offset:9216
    buffer_load_dwordx2 v[120:121], v23, s[32:35], s47 offen offset:0 sc1
    buffer_load_dwordx2 v[122:123], v23, s[32:35], s47 offen offset:512 sc1
    buffer_load_dwordx2 v[124:125], v23, s[32:35], s47 offen offset:1024 sc1
    buffer_load_dwordx2 v[126:127], v23, s[32:35], s47 offen offset:1536 sc1
    s_waitcnt lgkmcnt(6)
    v_mfma_f32_32x32x16_bf16 v[240:255], a[240:243], v[136:139], v[240:255]
    ds_read_b64_tr_b16 a[224:225], v26 offset:8192
    ds_read_b64_tr_b16 a[226:227], v26 offset:9216
    s_waitcnt vmcnt(16) lgkmcnt(6)
    v_mfma_f32_32x32x16_bf16 v[224:239], a[252:255], v[140:143], v[224:239]
    ds_read_b64_tr_b16 a[236:237], v27 offset:10240
    ds_read_b64_tr_b16 a[238:239], v27 offset:11264
    buffer_load_dwordx4 v21, s[20:23], s100 offen offset:3072 lds
    s_waitcnt lgkmcnt(6)
    v_mfma_f32_32x32x16_bf16 v[240:255], a[248:251], v[140:143], v[240:255]
    ds_read_b64_tr_b16 a[232:233], v26 offset:10240
    ds_read_b64_tr_b16 a[234:235], v26 offset:11264
    s_waitcnt vmcnt(16) lgkmcnt(6)
    v_mfma_f32_32x32x16_bf16 v[224:239], a[228:231], v[144:147], v[224:239]
    ds_read_b64_tr_b16 a[244:245], v27 offset:12288
    ds_read_b64_tr_b16 a[246:247], v27 offset:13312
    s_lshl1_add_u32 s43, s56, s52
    buffer_load_dwordx4 a[0:3], v16, s[32:35], s43 offen offset:0 sc1
    s_waitcnt lgkmcnt(6)
    v_mfma_f32_32x32x16_bf16 v[240:255], a[224:227], v[144:147], v[240:255]
    ds_read_b64_tr_b16 a[240:241], v26 offset:12288
    ds_read_b64_tr_b16 a[242:243], v26 offset:13312
    s_waitcnt vmcnt(16) lgkmcnt(6)
    v_mfma_f32_32x32x16_bf16 v[224:239], a[236:239], v[148:151], v[224:239]
    ds_read_b64_tr_b16 a[252:253], v27 offset:14336
    ds_read_b64_tr_b16 a[254:255], v27 offset:15360
    buffer_load_dwordx4 a[4:7], v17, s[32:35], s43 offen offset:0 sc1
    s_waitcnt lgkmcnt(6)
    v_mfma_f32_32x32x16_bf16 v[240:255], a[232:235], v[148:151], v[240:255]
    ds_read_b64_tr_b16 a[248:249], v26 offset:14336
    ds_read_b64_tr_b16 a[250:251], v26 offset:15360
    s_waitcnt vmcnt(16) lgkmcnt(6)
    v_mfma_f32_32x32x16_bf16 v[224:239], a[244:247], v[152:155], v[224:239]
    ds_read_b64_tr_b16 a[228:229], v27 offset:16384
    ds_read_b64_tr_b16 a[230:231], v27 offset:17408
    buffer_load_dwordx4 a[8:11], v16, s[32:35], s43 offen offset:2048 sc1
    s_waitcnt lgkmcnt(6)
    v_mfma_f32_32x32x16_bf16 v[240:255], a[240:243], v[152:155], v[240:255]
    ds_read_b64_tr_b16 a[224:225], v26 offset:16384
    ds_read_b64_tr_b16 a[226:227], v26 offset:17408
    s_waitcnt vmcnt(16) lgkmcnt(6)
    v_mfma_f32_32x32x16_bf16 v[224:239], a[252:255], v[156:159], v[224:239]
    ds_read_b64_tr_b16 a[236:237], v27 offset:18432
    ds_read_b64_tr_b16 a[238:239], v27 offset:19456
    buffer_load_dwordx4 a[12:15], v17, s[32:35], s43 offen offset:2048 sc1
    s_waitcnt lgkmcnt(6)
    v_mfma_f32_32x32x16_bf16 v[240:255], a[248:251], v[156:159], v[240:255]
    ds_read_b64_tr_b16 a[232:233], v26 offset:18432
    ds_read_b64_tr_b16 a[234:235], v26 offset:19456
    s_waitcnt vmcnt(16) lgkmcnt(6)
    v_mfma_f32_32x32x16_bf16 v[224:239], a[228:231], v[160:163], v[224:239]
    ds_read_b64_tr_b16 a[244:245], v27 offset:20480
    ds_read_b64_tr_b16 a[246:247], v27 offset:21504
    s_lshl1_add_u32 s43, s57, s52
    buffer_load_dwordx4 a[16:19], v16, s[32:35], s43 offen offset:0 sc1
    s_waitcnt lgkmcnt(6)
    v_mfma_f32_32x32x16_bf16 v[240:255], a[224:227], v[160:163], v[240:255]
    ds_read_b64_tr_b16 a[240:241], v26 offset:20480
    ds_read_b64_tr_b16 a[242:243], v26 offset:21504
    s_waitcnt vmcnt(16) lgkmcnt(6)
    v_mfma_f32_32x32x16_bf16 v[224:239], a[236:239], v[164:167], v[224:239]
    ds_read_b64_tr_b16 a[252:253], v27 offset:22528
    ds_read_b64_tr_b16 a[254:255], v27 offset:23552
    buffer_load_dwordx4 a[20:23], v17, s[32:35], s43 offen offset:0 sc1
    s_waitcnt lgkmcnt(6)
    v_mfma_f32_32x32x16_bf16 v[240:255], a[232:235], v[164:167], v[240:255]
    ds_read_b64_tr_b16 a[248:249], v26 offset:22528
    ds_read_b64_tr_b16 a[250:251], v26 offset:23552
    s_waitcnt vmcnt(16) lgkmcnt(6)
    v_mfma_f32_32x32x16_bf16 v[224:239], a[244:247], v[168:171], v[224:239]
    ds_read_b64_tr_b16 a[228:229], v27 offset:24576
    ds_read_b64_tr_b16 a[230:231], v27 offset:25600
    buffer_load_dwordx4 a[24:27], v16, s[32:35], s43 offen offset:2048 sc1
    s_waitcnt lgkmcnt(6)
    v_mfma_f32_32x32x16_bf16 v[240:255], a[240:243], v[168:171], v[240:255]
    ds_read_b64_tr_b16 a[224:225], v26 offset:24576
    ds_read_b64_tr_b16 a[226:227], v26 offset:25600
    s_waitcnt vmcnt(16) lgkmcnt(6)
    v_mfma_f32_32x32x16_bf16 v[224:239], a[252:255], v[172:175], v[224:239]
    ds_read_b64_tr_b16 a[236:237], v27 offset:26624
    ds_read_b64_tr_b16 a[238:239], v27 offset:27648
    buffer_load_dwordx4 a[28:31], v17, s[32:35], s43 offen offset:2048 sc1
    s_waitcnt lgkmcnt(6)
    v_mfma_f32_32x32x16_bf16 v[240:255], a[248:251], v[172:175], v[240:255]
    ds_read_b64_tr_b16 a[232:233], v26 offset:26624
    ds_read_b64_tr_b16 a[234:235], v26 offset:27648
    s_waitcnt vmcnt(16) lgkmcnt(6)
    v_mfma_f32_32x32x16_bf16 v[224:239], a[228:231], v[176:179], v[224:239]
    ds_read_b64_tr_b16 a[244:245], v27 offset:28672
    ds_read_b64_tr_b16 a[246:247], v27 offset:29696
    s_lshl1_add_u32 s43, s58, s52
    buffer_load_dwordx4 a[32:35], v16, s[32:35], s43 offen offset:0 sc1
    s_waitcnt lgkmcnt(6)
    v_mfma_f32_32x32x16_bf16 v[240:255], a[224:227], v[176:179], v[240:255]
    ds_read_b64_tr_b16 a[240:241], v26 offset:28672
    ds_read_b64_tr_b16 a[242:243], v26 offset:29696
    s_waitcnt vmcnt(16) lgkmcnt(6)
    v_mfma_f32_32x32x16_bf16 v[224:239], a[236:239], v[180:183], v[224:239]
    ds_read_b64_tr_b16 a[252:253], v27 offset:30720
    ds_read_b64_tr_b16 a[254:255], v27 offset:31744
    buffer_load_dwordx4 a[36:39], v17, s[32:35], s43 offen offset:0 sc1
    s_waitcnt lgkmcnt(6)
    v_mfma_f32_32x32x16_bf16 v[240:255], a[232:235], v[180:183], v[240:255]
    ds_read_b64_tr_b16 a[248:249], v26 offset:30720
    ds_read_b64_tr_b16 a[250:251], v26 offset:31744
    s_waitcnt vmcnt(16) lgkmcnt(6)
    v_mfma_f32_32x32x16_bf16 v[224:239], a[244:247], v[184:187], v[224:239]
    s_waitcnt vmcnt(15) lgkmcnt(2)
    v_mfma_f32_32x32x16_bf16 v[224:239], a[252:255], v[188:191], v[224:239]
    v_mfma_f32_32x32x16_bf16 v[240:255], a[240:243], v[184:187], v[240:255]
    s_waitcnt lgkmcnt(0)
    v_mfma_f32_32x32x16_bf16 v[240:255], a[248:251], v[188:191], v[240:255]
    s_nop 8
    ds_write_b128 v29, v[224:227] offset:0
    ds_write_b128 v29, v[228:231] offset:1024
    ds_write_b128 v29, v[232:235] offset:2048
    ds_write_b128 v29, v[236:239] offset:3072
    s_waitcnt vmcnt(10) lgkmcnt(0)
    s_barrier
    ds_read_b128 v[224:227], v30 offset:0
    ds_read_b128 v[228:231], v30 offset:1024
    ds_read_b128 v[232:235], v30 offset:2048
    ds_read_b128 v[236:239], v30 offset:3072
    s_waitcnt lgkmcnt(3)
    v_pk_add_f32 v[240:241], v[240:241], v[224:225]
    v_pk_add_f32 v[242:243], v[242:243], v[226:227]
    v_cvt_pk_bf16_f32 v128, v240, v241
    v_cvt_pk_bf16_f32 v129, v242, v243
    s_waitcnt lgkmcnt(2)
    v_pk_add_f32 v[244:245], v[244:245], v[228:229]
    v_pk_add_f32 v[246:247], v[246:247], v[230:231]
    v_cvt_pk_bf16_f32 v130, v244, v245
    v_cvt_pk_bf16_f32 v131, v246, v247
    s_waitcnt lgkmcnt(1)
    v_pk_add_f32 v[248:249], v[248:249], v[232:233]
    v_pk_add_f32 v[250:251], v[250:251], v[234:235]
    v_cvt_pk_bf16_f32 v132, v248, v249
    v_cvt_pk_bf16_f32 v133, v250, v251
    s_waitcnt lgkmcnt(0)
    v_pk_add_f32 v[252:253], v[252:253], v[236:237]
    v_pk_add_f32 v[254:255], v[254:255], v[238:239]
    v_cvt_pk_bf16_f32 v134, v252, v253
    v_cvt_pk_bf16_f32 v135, v254, v255
    buffer_store_dwordx4 v[128:131], v2, s[28:31], s53 offen sc1
    buffer_store_dwordx4 v[132:135], v2, s[28:31], s53 offen offset:1024 sc1
    v_pk_mul_f32 v[224:225], v[240:241], v[240:241]
    v_pk_add_f32 v[226:227], v[240:241], v[242:243]
    v_pk_fma_f32 v[224:225], v[242:243], v[242:243], v[224:225]
    v_pk_fma_f32 v[224:225], v[244:245], v[244:245], v[224:225]
    v_pk_add_f32 v[226:227], v[226:227], v[244:245]
    v_pk_fma_f32 v[224:225], v[246:247], v[246:247], v[224:225]
    v_pk_add_f32 v[226:227], v[226:227], v[246:247]
    v_pk_fma_f32 v[224:225], v[248:249], v[248:249], v[224:225]
    v_pk_add_f32 v[226:227], v[226:227], v[248:249]
    v_pk_fma_f32 v[224:225], v[250:251], v[250:251], v[224:225]
    v_pk_add_f32 v[226:227], v[226:227], v[250:251]
    v_pk_fma_f32 v[224:225], v[252:253], v[252:253], v[224:225]
    v_pk_add_f32 v[226:227], v[226:227], v[252:253]
    v_pk_fma_f32 v[224:225], v[254:255], v[254:255], v[224:225]
    v_pk_add_f32 v[226:227], v[226:227], v[254:255]
    v_add_f32 v228, v226, v227
    v_add_f32 v229, v224, v225
    v_mov_b64 v[224:225], v[228:229]
    s_nop 1
    v_permlane32_swap_b32 v224, v228
    v_permlane32_swap_b32 v225, v229
    v_pk_add_f32 v[228:229], v[228:229], v[224:225]
    buffer_store_dwordx2 v[228:229], v8, s[32:35], s54 offen sc1
    s_add_u32 s46, s46, 128
    s_lshr_b32 s42, s42, 1
    s_xor_b32 s100, s42, 0
    s_add_u32 m0, s100, s5
    s_mul_i32 s100, s100, 28
    s_add_u32 m0, m0, 81920
    s_add_u32 s100, s100, s46
    buffer_load_dwordx4 v18, s[20:23], s100 offen offset:0 lds
    buffer_load_dwordx4 v19, s[20:23], s100 offen offset:1024 lds
    buffer_load_dwordx4 v20, s[20:23], s100 offen offset:2048 lds
    buffer_load_dwordx4 v21, s[20:23], s100 offen offset:3072 lds
    s_xor_b32 s100, s42, 16384
    s_add_u32 m0, s100, s5
    s_mul_i32 s100, s100, 28
    s_add_u32 m0, m0, 81920
    s_add_u32 s100, s100, s46
    buffer_load_dwordx4 v18, s[20:23], s100 offen offset:0 lds
    buffer_load_dwordx4 v19, s[20:23], s100 offen offset:1024 lds
    buffer_load_dwordx4 v20, s[20:23], s100 offen offset:2048 lds
    buffer_load_dwordx4 v21, s[20:23], s100 offen offset:3072 lds
    s_xor_b32 s100, s42, 32768
    s_add_u32 m0, s100, s5
    s_mul_i32 s100, s100, 28
    s_add_u32 m0, m0, 81920
    s_add_u32 s100, s100, s46
    v_add_u32 v26, 16384, v28
    v_xor_b32 v27, 64, v26
    v_add_u32 v24, 81920, v28
    v_xor_b32 v15, 64, v24
    v_lshlrev_b32 v6, 3, v1
    v_mov_b64 v[32:33], 0
    v_mov_b64 v[38:39], 0
    v_lshlrev_b32 v7, 7, v1
    s_waitcnt vmcnt(8)
    s_cmp_eq_u32 s7, 0
    s_cbranch_scc1 L_slow1
    buffer_store_dword v12, v3, s[32:35], s55 offen
L_back1:
    buffer_load_dword v25, v22, s[32:35], s77 offen offset:0 sc1
    s_mul_i32 s98, s41, 114688
    v_add_u32 v28, s98, v2
    s_xor_b32 s98, s41, 1
    s_mul_i32 s98, s98, 114688
    v_add_u32 v29, s98, v2
    v_min_u32 v4, 52, v22
    v_bfe_u32 v5, v1, 4, 1
    v_mul_u32_u24 v5, 384, v5
    v_add_u32 v5, v4, v5
    s_cmp_lg_u32 s81, 0
    s_cbranch_scc1 L_idle
    s_waitcnt vmcnt(2)
    s_barrier
    ds_read_b64_tr_b16 a[224:225], v26 offset:0
    ds_read_b64_tr_b16 a[226:227], v26 offset:1024
    ds_read_b64_tr_b16 a[228:229], v27 offset:0
    ds_read_b64_tr_b16 a[230:231], v27 offset:1024
    ds_read_b64_tr_b16 a[232:233], v24 offset:0
    ds_read_b64_tr_b16 a[234:235], v24 offset:1024
    ds_read_b64_tr_b16 a[236:237], v15 offset:0
    ds_read_b64_tr_b16 a[238:239], v15 offset:1024
    s_waitcnt vmcnt(0)
    v_cmp_ne_u32 vcc, s6, v25
    s_nop 0
    s_cbranch_vccz L_hok
    v_mov_b32 v10, 0
L_poll2:
    buffer_load_dword v10, v22, s[32:35], s77 offen offset:0 sc1
    s_add_u32 s96, s96, 1
    s_cmp_gt_u32 s96, s97
    s_waitcnt vmcnt(0)
    s_cbranch_scc1 L_pdone2
    v_cmp_ne_u32 vcc, s6, v10
    s_nop 0
    s_cbranch_vccnz L_poll2
L_pdone2:
L_hok:
    s_add_u32 s98, s76, 0
    buffer_load_dwordx4 v[48:51], v2, s[28:31], s98 offen offset:0 sc1
    buffer_load_dwordx4 v[52:55], v2, s[28:31], s98 offen offset:1024 sc1
    buffer_load_dwordx4 v[56:59], v2, s[28:31], s98 offen offset:2048 sc1
    buffer_load_dwordx4 v[60:63], v2, s[28:31], s98 offen offset:3072 sc1
    s_add_u32 s98, s76, 4096
    buffer_load_dwordx4 v[64:67], v2, s[28:31], s98 offen offset:0 sc1
    buffer_load_dwordx4 v[68:71], v2, s[28:31], s98 offen offset:1024 sc1
    buffer_load_dwordx4 v[72:75], v2, s[28:31], s98 offen offset:2048 sc1
    buffer_load_dwordx4 v18, s[20:23], s100 offen offset:0 lds
    buffer_load_dwordx4 v[76:79], v2, s[28:31], s98 offen offset:3072 sc1
    buffer_load_dwordx4 v19, s[20:23], s100 offen offset:1024 lds
    v_min3_u32 v8, v121, v123, v125
    v_max3_u32 v9, v121, v123, v125
    v_min3_u32 v8, v127, v127, v8
    v_max3_u32 v9, v127, v127, v9
    v_xor_b32 v8, s6, v8
    v_xor_b32 v9, s6, v9
    v_or_b32 v8, v8, v9
    v_cmp_ne_u32 vcc, 0, v8
    s_nop 0
    s_cbranch_vccnz L_csspin
L_csok:
    v_add_f32 v120, v120, v122
    v_add_f32 v124, v124, v126
    v_add_f32 v120, v120, v124
    v_mov_b32 v121, v120
    s_lshl_b32 s99, s3, 9
    v_add_u32 v4, s99, v6
    v_permlane32_swap_b32 v120, v121
    v_add_f32 v120, v120, v121
    v_mul_f32 v120, v14, v120
    v_cvt_pk_bf16_f32 v122, v120, v120
    v_and_b32 v121, 0xffff0000, v122
    v_sub_f32 v121, v120, v121
    v_cvt_pk_bf16_f32 v123, v121, v121
    ds_write_b64 v4, v[122:123] offset:8192
    s_waitcnt vmcnt(9) lgkmcnt(7)
    v_mfma_f32_32x32x16_bf16 v[176:191], a[224:227], v[48:51], 0
    ds_read_b64_tr_b16 a[240:241], v26 offset:2048
    ds_read_b64_tr_b16 a[242:243], v26 offset:3072
    s_add_u32 s98, s76, 8192
    buffer_load_dwordx4 v[80:83], v2, s[28:31], s98 offen offset:0 sc1
    s_waitcnt lgkmcnt(7)
    v_mfma_f32_32x32x16_bf16 v[192:207], a[228:231], v[48:51], 0
    ds_read_b64_tr_b16 a[244:245], v27 offset:2048
    ds_read_b64_tr_b16 a[246:247], v27 offset:3072
    s_waitcnt lgkmcnt(7)
    v_mfma_f32_32x32x16_bf16 v[208:223], a[232:235], v[48:51], 0
    ds_read_b64_tr_b16 a[248:249], v24 offset:2048
    ds_read_b64_tr_b16 a[250:251], v24 offset:3072
    buffer_load_dwordx4 v20, s[20:23], s100 offen offset:2048 lds
    s_waitcnt lgkmcnt(7)
    v_mfma_f32_32x32x16_bf16 v[224:239], a[236:239], v[48:51], 0
    ds_read_b64_tr_b16 a[252:253], v15 offset:2048
    ds_read_b64_tr_b16 a[254:255], v15 offset:3072
    s_waitcnt vmcnt(10) lgkmcnt(6)
    v_mfma_f32_32x32x16_bf16 v[176:191], a[240:243], v[52:55], v[176:191]
    ds_read_b64_tr_b16 a[224:225], v26 offset:4096
    ds_read_b64_tr_b16 a[226:227], v26 offset:5120
    buffer_load_dwordx4 v[84:87], v2, s[28:31], s98 offen offset:1024 sc1
    s_waitcnt lgkmcnt(6)
    v_mfma_f32_32x32x16_bf16 v[192:207], a[244:247], v[52:55], v[192:207]
    ds_read_b64_tr_b16 a[228:229], v27 offset:4096
    ds_read_b64_tr_b16 a[230:231], v27 offset:5120
    s_waitcnt lgkmcnt(6)
    v_mfma_f32_32x32x16_bf16 v[208:223], a[248:251], v[52:55], v[208:223]
    ds_read_b64_tr_b16 a[232:233], v24 offset:4096
    ds_read_b64_tr_b16 a[234:235], v24 offset:5120
    buffer_load_dwordx4 v21, s[20:23], s100 offen offset:3072 lds
    s_xor_b32 s100, s42, 49152
    s_add_u32 m0, s100, s5
    s_mul_i32 s100, s100, 28
    s_add_u32 m0, m0, 81920
    s_add_u32 s100, s100, s46
    s_waitcnt lgkmcnt(6)
    v_mfma_f32_32x32x16_bf16 v[224:239], a[252:255], v[52:55], v[224:239]
    ds_read_b64_tr_b16 a[236:237], v15 offset:4096
    ds_read_b64_tr_b16 a[238:239], v15 offset:5120
    s_waitcnt vmcnt(11) lgkmcnt(6)
    v_mfma_f32_32x32x16_bf16 v[176:191], a[224:227], v[56:59], v[176:191]
    ds_read_b64_tr_b16 a[240:241], v26 offset:6144
    ds_read_b64_tr_b16 a[242:243], v26 offset:7168
    buffer_load_dwordx4 v[88:91], v2, s[28:31], s98 offen offset:2048 sc1
    s_waitcnt lgkmcnt(6)
    v_mfma_f32_32x32x16_bf16 v[192:207], a[228:231], v[56:59], v[192:207]
    ds_read_b64_tr_b16 a[244:245], v27 offset:6144
    ds_read_b64_tr_b16 a[246:247], v27 offset:7168
    s_waitcnt lgkmcnt(6)
    v_mfma_f32_32x32x16_bf16 v[208:223], a[232:235], v[56:59], v[208:223]
    ds_read_b64_tr_b16 a[248:249], v24 offset:6144
    ds_read_b64_tr_b16 a[250:251], v24 offset:7168
    buffer_load_dwordx4 v18, s[20:23], s100 offen offset:0 lds
    s_waitcnt lgkmcnt(6)
    v_mfma_f32_32x32x16_bf16 v[224:239], a[236:239], v[56:59], v[224:239]
    ds_read_b64_tr_b16 a[252:253], v15 offset:6144
    ds_read_b64_tr_b16 a[254:255], v15 offset:7168
    s_waitcnt vmcnt(12) lgkmcnt(6)
    v_mfma_f32_32x32x16_bf16 v[176:191], a[240:243], v[60:63], v[176:191]
    ds_read_b64_tr_b16 a[224:225], v26 offset:8192
    ds_read_b64_tr_b16 a[226:227], v26 offset:9216
    buffer_load_dwordx4 v[92:95], v2, s[28:31], s98 offen offset:3072 sc1
    s_waitcnt lgkmcnt(6)
    v_mfma_f32_32x32x16_bf16 v[192:207], a[244:247], v[60:63], v[192:207]
    ds_read_b64_tr_b16 a[228:229], v27 offset:8192
    ds_read_b64_tr_b16 a[230:231], v27 offset:9216
    s_waitcnt lgkmcnt(6)
    v_mfma_f32_32x32x16_bf16 v[208:223], a[248:251], v[60:63], v[208:223]
    ds_read_b64_tr_b16 a[232:233], v24 offset:8192
    ds_read_b64_tr_b16 a[234:235], v24 offset:9216
    buffer_load_dwordx4 v19, s[20:23], s100 offen offset:1024 lds
    s_waitcnt lgkmcnt(6)
    v_mfma_f32_32x32x16_bf16 v[224:239], a[252:255], v[60:63], v[224:239]
    ds_read_b64_tr_b16 a[236:237], v15 offset:8192
    ds_read_b64_tr_b16 a[238:239], v15 offset:9216
    s_waitcnt vmcnt(13) lgkmcnt(6)
    v_mfma_f32_32x32x16_bf16 v[176:191], a[224:227], v[64:67], v[176:191]
    ds_read_b64_tr_b16 a[240:241], v26 offset:10240
    ds_read_b64_tr_b16 a[242:243], v26 offset:11264
    s_add_u32 s98, s76, 12288
    buffer_load_dwordx4 v[96:99], v2, s[28:31], s98 offen offset:0 sc1
    s_waitcnt lgkmcnt(6)
    v_mfma_f32_32x32x16_bf16 v[192:207], a[228:231], v[64:67], v[192:207]
    ds_read_b64_tr_b16 a[244:245], v27 offset:10240
    ds_read_b64_tr_b16 a[246:247], v27 offset:11264
    s_waitcnt lgkmcnt(6)
    v_mfma_f32_32x32x16_bf16 v[208:223], a[232:235], v[64:67], v[208:223]
    ds_read_b64_tr_b16 a[248:249], v24 offset:10240
    ds_read_b64_tr_b16 a[250:251], v24 offset:11264
    buffer_load_dwordx4 v20, s[20:23], s100 offen offset:2048 lds
    s_waitcnt lgkmcnt(6)
    v_mfma_f32_32x32x16_bf16 v[224:239], a[236:239], v[64:67], v[224:239]
    ds_read_b64_tr_b16 a[252:253], v15 offset:10240
    ds_read_b64_tr_b16 a[254:255], v15 offset:11264
    s_waitcnt vmcnt(14) lgkmcnt(6)
    v_mfma_f32_32x32x16_bf16 v[176:191], a[240:243], v[68:71], v[176:191]
    ds_read_b64_tr_b16 a[224:225], v26 offset:12288
    ds_read_b64_tr_b16 a[226:227], v26 offset:13312
    buffer_load_dwordx4 v[100:103], v2, s[28:31], s98 offen offset:1024 sc1
    s_waitcnt lgkmcnt(6)
    v_mfma_f32_32x32x16_bf16 v[192:207], a[244:247], v[68:71], v[192:207]
    ds_read_b64_tr_b16 a[228:229], v27 offset:12288
    ds_read_b64_tr_b16 a[230:231], v27 offset:13312
    s_waitcnt lgkmcnt(6)
    v_mfma_f32_32x32x16_bf16 v[208:223], a[248:251], v[68:71], v[208:223]
    ds_read_b64_tr_b16 a[232:233], v24 offset:12288
    ds_read_b64_tr_b16 a[234:235], v24 offset:13312
    buffer_load_dwordx4 v21, s[20:23], s100 offen offset:3072 lds
    s_waitcnt lgkmcnt(6)
    v_mfma_f32_32x32x16_bf16 v[224:239], a[252:255], v[68:71], v[224:239]
    ds_read_b64_tr_b16 a[236:237], v15 offset:12288
    ds_read_b64_tr_b16 a[238:239], v15 offset:13312
    s_waitcnt vmcnt(15) lgkmcnt(6)
    v_mfma_f32_32x32x16_bf16 v[176:191], a[224:227], v[72:75], v[176:191]
    ds_read_b64_tr_b16 a[240:241], v26 offset:14336
    ds_read_b64_tr_b16 a[242:243], v26 offset:15360
    buffer_load_dwordx4 v[104:107], v2, s[28:31], s98 offen offset:2048 sc1
    s_waitcnt lgkmcnt(6)
    v_mfma_f32_32x32x16_bf16 v[192:207], a[228:231], v[72:75], v[192:207]
    ds_read_b64_tr_b16 a[244:245], v27 offset:14336
    ds_read_b64_tr_b16 a[246:247], v27 offset:15360
    s_waitcnt lgkmcnt(6)
    v_mfma_f32_32x32x16_bf16 v[208:223], a[232:235], v[72:75], v[208:223]
    ds_read_b64_tr_b16 a[248:249], v24 offset:14336
    ds_read_b64_tr_b16 a[250:251], v24 offset:15360
    buffer_load_dwordx4 v[108:111], v2, s[28:31], s98 offen offset:3072 sc1
    s_waitcnt lgkmcnt(6)
    v_mfma_f32_32x32x16_bf16 v[224:239], a[236:239], v[72:75], v[224:239]
    ds_read_b64_tr_b16 a[252:253], v15 offset:14336
    ds_read_b64_tr_b16 a[254:255], v15 offset:15360
    s_waitcnt vmcnt(15) lgkmcnt(6)
    v_mfma_f32_32x32x16_bf16 v[176:191], a[240:243], v[76:79], v[176:191]
    ds_read_b64_tr_b16 a[224:225], v26 offset:16384
    ds_read_b64_tr_b16 a[226:227], v26 offset:17408
    s_add_u32 s98, s76, 16384
    buffer_load_dwordx4 v[112:115], v2, s[28:31], s98 offen offset:0 sc1
    s_waitcnt lgkmcnt(6)
    v_mfma_f32_32x32x16_bf16 v[192:207], a[244:247], v[76:79], v[192:207]
    ds_read_b64_tr_b16 a[228:229], v27 offset:16384
    ds_read_b64_tr_b16 a[230:231], v27 offset:17408
    s_waitcnt lgkmcnt(6)
    v_mfma_f32_32x32x16_bf16 v[208:223], a[248:251], v[76:79], v[208:223]
    ds_read_b64_tr_b16 a[232:233], v24 offset:16384
    ds_read_b64_tr_b16 a[234:235], v24 offset:17408
    buffer_load_dwordx4 v[116:119], v2, s[28:31], s98 offen offset:1024 sc1
    s_waitcnt lgkmcnt(6)
    v_mfma_f32_32x32x16_bf16 v[224:239], a[252:255], v[76:79], v[224:239]
    ds_read_b64_tr_b16 a[236:237], v15 offset:16384
    ds_read_b64_tr_b16 a[238:239], v15 offset:17408
    s_waitcnt vmcnt(15) lgkmcnt(6)
    v_mfma_f32_32x32x16_bf16 v[176:191], a[224:227], v[80:83], v[176:191]
    ds_read_b64_tr_b16 a[240:241], v26 offset:18432
    ds_read_b64_tr_b16 a[242:243], v26 offset:19456
    buffer_load_dwordx4 v[120:123], v2, s[28:31], s98 offen offset:2048 sc1
    s_waitcnt lgkmcnt(6)
    v_mfma_f32_32x32x16_bf16 v[192:207], a[228:231], v[80:83], v[192:207]
    ds_read_b64_tr_b16 a[244:245], v27 offset:18432
    ds_read_b64_tr_b16 a[246:247], v27 offset:19456
    s_waitcnt lgkmcnt(6)
    v_mfma_f32_32x32x16_bf16 v[208:223], a[232:235], v[80:83], v[208:223]
    ds_read_b64_tr_b16 a[248:249], v24 offset:18432
    ds_read_b64_tr_b16 a[250:251], v24 offset:19456
    buffer_load_dwordx4 v[124:127], v2, s[28:31], s98 offen offset:3072 sc1
    s_waitcnt lgkmcnt(6)
    v_mfma_f32_32x32x16_bf16 v[224:239], a[236:239], v[80:83], v[224:239]
    ds_read_b64_tr_b16 a[252:253], v15 offset:18432
    ds_read_b64_tr_b16 a[254:255], v15 offset:19456
    s_waitcnt vmcnt(15) lgkmcnt(6)
    v_mfma_f32_32x32x16_bf16 v[176:191], a[240:243], v[84:87], v[176:191]
    ds_read_b64_tr_b16 a[224:225], v26 offset:20480
    ds_read_b64_tr_b16 a[226:227], v26 offset:21504
    s_add_u32 s98, s76, 20480
    buffer_load_dwordx4 v[128:131], v2, s[28:31], s98 offen offset:0 sc1
    s_waitcnt lgkmcnt(6)
    v_mfma_f32_32x32x16_bf16 v[192:207], a[244:247], v[84:87], v[192:207]
    ds_read_b64_tr_b16 a[228:229], v27 offset:20480
    ds_read_b64_tr_b16 a[230:231], v27 offset:21504
    s_waitcnt lgkmcnt(6)
    v_mfma_f32_32x32x16_bf16 v[208:223], a[248:251], v[84:87], v[208:223]
    ds_read_b64_tr_b16 a[232:233], v24 offset:20480
    ds_read_b64_tr_b16 a[234:235], v24 offset:21504
    buffer_load_dwordx4 v[132:135], v2, s[28:31], s98 offen offset:1024 sc1
    s_waitcnt lgkmcnt(6)
    v_mfma_f32_32x32x16_bf16 v[224:239], a[252:255], v[84:87], v[224:239]
    ds_read_b64_tr_b16 a[236:237], v15 offset:20480
    ds_read_b64_tr_b16 a[238:239], v15 offset:21504
    s_waitcnt vmcnt(15) lgkmcnt(6)
    v_mfma_f32_32x32x16_bf16 v[176:191], a[224:227], v[88:91], v[176:191]
    ds_read_b64_tr_b16 a[240:241], v26 offset:22528
    ds_read_b64_tr_b16 a[242:243], v26 offset:23552
    buffer_load_dwordx4 v[136:139], v2, s[28:31], s98 offen offset:2048 sc1
    s_waitcnt lgkmcnt(6)
    v_mfma_f32_32x32x16_bf16 v[192:207], a[228:231], v[88:91], v[192:207]
    ds_read_b64_tr_b16 a[244:245], v27 offset:22528
    ds_read_b64_tr_b16 a[246:247], v27 offset:23552
    s_waitcnt lgkmcnt(6)
    v_mfma_f32_32x32x16_bf16 v[208:223], a[232:235], v[88:91], v[208:223]
    ds_read_b64_tr_b16 a[248:249], v24 offset:22528
    ds_read_b64_tr_b16 a[250:251], v24 offset:23552
    buffer_load_dwordx4 v[140:143], v2, s[28:31], s98 offen offset:3072 sc1
    s_waitcnt lgkmcnt(6)
    v_mfma_f32_32x32x16_bf16 v[224:239], a[236:239], v[88:91], v[224:239]
    ds_read_b64_tr_b16 a[252:253], v15 offset:22528
    ds_read_b64_tr_b16 a[254:255], v15 offset:23552
    s_waitcnt vmcnt(15) lgkmcnt(6)
    v_mfma_f32_32x32x16_bf16 v[176:191], a[240:243], v[92:95], v[176:191]
    ds_read_b64_tr_b16 a[224:225], v26 offset:24576
    ds_read_b64_tr_b16 a[226:227], v26 offset:25600
    s_add_u32 s98, s76, 24576
    buffer_load_dwordx4 v[144:147], v2, s[28:31], s98 offen offset:0 sc1
    s_waitcnt lgkmcnt(6)
    v_mfma_f32_32x32x16_bf16 v[192:207], a[244:247], v[92:95], v[192:207]
    ds_read_b64_tr_b16 a[228:229], v27 offset:24576
    ds_read_b64_tr_b16 a[230:231], v27 offset:25600
    s_waitcnt lgkmcnt(6)
    v_mfma_f32_32x32x16_bf16 v[208:223], a[248:251], v[92:95], v[208:223]
    ds_read_b64_tr_b16 a[232:233], v24 offset:24576
    ds_read_b64_tr_b16 a[234:235], v24 offset:25600
    buffer_load_dwordx4 v[148:151], v2, s[28:31], s98 offen offset:1024 sc1
    s_waitcnt lgkmcnt(6)
    v_mfma_f32_32x32x16_bf16 v[224:239], a[252:255], v[92:95], v[224:239]
    ds_read_b64_tr_b16 a[236:237], v15 offset:24576
    ds_read_b64_tr_b16 a[238:239], v15 offset:25600
    s_waitcnt vmcnt(15) lgkmcnt(6)
    v_mfma_f32_32x32x16_bf16 v[176:191], a[224:227], v[96:99], v[176:191]
    ds_read_b64_tr_b16 a[240:241], v26 offset:26624
    ds_read_b64_tr_b16 a[242:243], v26 offset:27648
    buffer_load_dwordx4 v[152:155], v2, s[28:31], s98 offen offset:2048 sc1
    s_waitcnt lgkmcnt(6)
    v_mfma_f32_32x32x16_bf16 v[192:207], a[228:231], v[96:99], v[192:207]
    ds_read_b64_tr_b16 a[244:245], v27 offset:26624
    ds_read_b64_tr_b16 a[246:247], v27 offset:27648
    s_waitcnt lgkmcnt(6)
    v_mfma_f32_32x32x16_bf16 v[208:223], a[232:235], v[96:99], v[208:223]
    ds_read_b64_tr_b16 a[248:249], v24 offset:26624
    ds_read_b64_tr_b16 a[250:251], v24 offset:27648
    buffer_load_dwordx4 v[156:159], v2, s[28:31], s98 offen offset:3072 sc1
    s_waitcnt lgkmcnt(6)
    v_mfma_f32_32x32x16_bf16 v[224:239], a[236:239], v[96:99], v[224:239]
    ds_read_b64_tr_b16 a[252:253], v15 offset:26624
    ds_read_b64_tr_b16 a[254:255], v15 offset:27648
    s_waitcnt vmcnt(15) lgkmcnt(6)
    v_mfma_f32_32x32x16_bf16 v[176:191], a[240:243], v[100:103], v[176:191]
    ds_read_b64_tr_b16 a[224:225], v26 offset:28672
    ds_read_b64_tr_b16 a[226:227], v26 offset:29696
    s_add_u32 s98, s76, 28672
    buffer_load_dwordx4 v[160:163], v2, s[28:31], s98 offen offset:0 sc1
    s_waitcnt lgkmcnt(6)
    v_mfma_f32_32x32x16_bf16 v[192:207], a[244:247], v[100:103], v[192:207]
    ds_read_b64_tr_b16 a[228:229], v27 offset:28672
    ds_read_b64_tr_b16 a[230:231], v27 offset:29696
    s_waitcnt lgkmcnt(6)
    v_mfma_f32_32x32x16_bf16 v[208:223], a[248:251], v[100:103], v[208:223]
    ds_read_b64_tr_b16 a[232:233], v24 offset:28672
    ds_read_b64_tr_b16 a[234:235], v24 offset:29696
    buffer_load_dwordx4 v[164:167], v2, s[28:31], s98 offen offset:1024 sc1
    s_waitcnt lgkmcnt(6)
    v_mfma_f32_32x32x16_bf16 v[224:239], a[252:255], v[100:103], v[224:239]
    ds_read_b64_tr_b16 a[236:237], v15 offset:28672
    ds_read_b64_tr_b16 a[238:239], v15 offset:29696
    s_waitcnt vmcnt(15) lgkmcnt(6)
    v_mfma_f32_32x32x16_bf16 v[176:191], a[224:227], v[104:107], v[176:191]
    ds_read_b64_tr_b16 a[240:241], v26 offset:30720
    ds_read_b64_tr_b16 a[242:243], v26 offset:31744
    buffer_load_dwordx4 v[168:171], v2, s[28:31], s98 offen offset:2048 sc1
    s_waitcnt lgkmcnt(6)
    v_mfma_f32_32x32x16_bf16 v[192:207], a[228:231], v[104:107], v[192:207]
    ds_read_b64_tr_b16 a[244:245], v27 offset:30720
    ds_read_b64_tr_b16 a[246:247], v27 offset:31744
    s_waitcnt lgkmcnt(6)
    v_mfma_f32_32x32x16_bf16 v[208:223], a[232:235], v[104:107], v[208:223]
    ds_read_b64_tr_b16 a[248:249], v24 offset:30720
    ds_read_b64_tr_b16 a[250:251], v24 offset:31744
    buffer_load_dwordx4 v[172:175], v2, s[28:31], s98 offen offset:3072 sc1
    s_waitcnt lgkmcnt(6)
    v_mfma_f32_32x32x16_bf16 v[224:239], a[236:239], v[104:107], v[224:239]
    ds_read_b64_tr_b16 a[252:253], v15 offset:30720
    ds_read_b64_tr_b16 a[254:255], v15 offset:31744
    s_barrier
    s_waitcnt vmcnt(16) lgkmcnt(6)
    v_mfma_f32_32x32x16_bf16 v[176:191], a[240:243], v[108:111], v[176:191]
    ds_read_b64_tr_b16 a[224:225], v26 offset:32768
    ds_read_b64_tr_b16 a[226:227], v26 offset:33792
    buffer_load_dwordx4 v[48:51], v2, s[32:35], s78 offen offset:0 sc1
    s_waitcnt lgkmcnt(6)
    v_mfma_f32_32x32x16_bf16 v[192:207], a[244:247], v[108:111], v[192:207]
    ds_read_b64_tr_b16 a[228:229], v27 offset:32768
    ds_read_b64_tr_b16 a[230:231], v27 offset:33792
    s_waitcnt lgkmcnt(6)
    v_mfma_f32_32x32x16_bf16 v[208:223], a[248:251], v[108:111], v[208:223]
    ds_read_b64_tr_b16 a[232:233], v24 offset:32768
    ds_read_b64_tr_b16 a[234:235], v24 offset:33792
    buffer_load_dwordx4 v[52:55], v2, s[32:35], s78 offen offset:1024 sc1
    s_waitcnt lgkmcnt(6)
    v_mfma_f32_32x32x16_bf16 v[224:239], a[252:255], v[108:111], v[224:239]
    ds_read_b64_tr_b16 a[236:237], v15 offset:32768
    ds_read_b64_tr_b16 a[238:239], v15 offset:33792
    s_waitcnt vmcnt(17) lgkmcnt(6)
    v_mfma_f32_32x32x16_bf16 v[176:191], a[224:227], v[112:115], v[176:191]
    ds_read_b64_tr_b16 a[240:241], v26 offset:34816
    ds_read_b64_tr_b16 a[242:243], v26 offset:35840
    buffer_load_dwordx4 v[56:59], v2, s[32:35], s78 offen offset:2048 sc1
    s_waitcnt lgkmcnt(6)
    v_mfma_f32_32x32x16_bf16 v[192:207], a[228:231], v[112:115], v[192:207]
    ds_read_b64_tr_b16 a[244:245], v27 offset:34816
    ds_read_b64_tr_b16 a[246:247], v27 offset:35840
    s_waitcnt lgkmcnt(6)
    v_mfma_f32_32x32x16_bf16 v[208:223], a[232:235], v[112:115], v[208:223]
    ds_read_b64_tr_b16 a[248:249], v24 offset:34816
    ds_read_b64_tr_b16 a[250:251], v24 offset:35840
    buffer_load_dwordx4 v[60:63], v2, s[32:35], s78 offen offset:3072 sc1
    ds_read_b64 v[30:31], v6 offset:8192
    s_waitcnt lgkmcnt(7)
    v_mfma_f32_32x32x16_bf16 v[224:239], a[236:239], v[112:115], v[224:239]
    ds_read_b64_tr_b16 a[252:253], v15 offset:34816
    ds_read_b64_tr_b16 a[254:255], v15 offset:35840
    ds_read_b64 v[34:35], v6 offset:8704
    s_waitcnt vmcnt(18) lgkmcnt(8)
    v_mfma_f32_32x32x16_bf16 v[176:191], a[240:243], v[116:119], v[176:191]
    ds_read_b64_tr_b16 a[224:225], v26 offset:36864
    ds_read_b64_tr_b16 a[226:227], v26 offset:37888
    buffer_load_dwordx4 a[40:43], v16, s[32:35], s43 offen offset:2048 sc1
    ds_read_b64 v[36:37], v6 offset:9216
    s_waitcnt lgkmcnt(9)
    v_mfma_f32_32x32x16_bf16 v[192:207], a[244:247], v[116:119], v[192:207]
    ds_read_b64_tr_b16 a[228:229], v27 offset:36864
    ds_read_b64_tr_b16 a[230:231], v27 offset:37888
    ds_read_b64 v[40:41], v6 offset:9728
    s_waitcnt lgkmcnt(10)
    v_mfma_f32_32x32x16_bf16 v[208:223], a[248:251], v[116:119], v[208:223]
    ds_read_b64_tr_b16 a[232:233], v24 offset:36864
    ds_read_b64_tr_b16 a[234:235], v24 offset:37888
    buffer_load_dwordx4 a[44:47], v17, s[32:35], s43 offen offset:2048 sc1
    s_waitcnt lgkmcnt(9)
    v_mfma_f32_32x32x16_bf16 v[224:239], a[252:255], v[116:119], v[224:239]
    ds_read_b64_tr_b16 a[236:237], v15 offset:36864
    ds_read_b64_tr_b16 a[238:239], v15 offset:37888
    s_waitcnt vmcnt(19) lgkmcnt(8)
    v_mfma_f32_32x32x16_bf16 v[176:191], a[224:227], v[120:123], v[176:191]
    ds_read_b64_tr_b16 a[240:241], v26 offset:38912
    ds_read_b64_tr_b16 a[242:243], v26 offset:39936
    s_lshl1_add_u32 s43, s59, s52
    buffer_load_dwordx4 a[48:51], v16, s[32:35], s43 offen offset:0 sc1
    s_waitcnt lgkmcnt(7)
    v_mfma_f32_32x32x16_bf16 v[192:207], a[228:231], v[120:123], v[192:207]
    ds_read_b64_tr_b16 a[244:245], v27 offset:38912
    ds_read_b64_tr_b16 a[246:247], v27 offset:39936
    s_waitcnt lgkmcnt(6)
    v_mfma_f32_32x32x16_bf16 v[208:223], a[232:235], v[120:123], v[208:223]
    ds_read_b64_tr_b16 a[248:249], v24 offset:38912
    ds_read_b64_tr_b16 a[250:251], v24 offset:39936
    buffer_load_dwordx4 a[52:55], v17, s[32:35], s43 offen offset:0 sc1
    s_waitcnt lgkmcnt(6)
    v_mfma_f32_32x32x16_bf16 v[224:239], a[236:239], v[120:123], v[224:239]
    ds_read_b64_tr_b16 a[252:253], v15 offset:38912
    ds_read_b64_tr_b16 a[254:255], v15 offset:39936
    s_waitcnt vmcnt(20) lgkmcnt(6)
    v_mfma_f32_32x32x16_bf16 v[176:191], a[240:243], v[124:127], v[176:191]
    ds_read_b64_tr_b16 a[224:225], v26 offset:40960
    ds_read_b64_tr_b16 a[226:227], v26 offset:41984
    buffer_load_dwordx4 a[56:59], v16, s[32:35], s43 offen offset:2048 sc1
    s_waitcnt lgkmcnt(6)
    v_mfma_f32_32x32x16_bf16 v[192:207], a[244:247], v[124:127], v[192:207]
    ds_read_b64_tr_b16 a[228:229], v27 offset:40960
    ds_read_b64_tr_b16 a[230:231], v27 offset:41984
    s_waitcnt lgkmcnt(6)
    v_mfma_f32_32x32x16_bf16 v[208:223], a[248:251], v[124:127], v[208:223]
    ds_read_b64_tr_b16 a[232:233], v24 offset:40960
    ds_read_b64_tr_b16 a[234:235], v24 offset:41984
    buffer_load_dwordx4 a[60:63], v17, s[32:35], s43 offen offset:2048 sc1
    s_waitcnt lgkmcnt(6)
    v_mfma_f32_32x32x16_bf16 v[224:239], a[252:255], v[124:127], v[224:239]
    ds_read_b64_tr_b16 a[236:237], v15 offset:40960
    ds_read_b64_tr_b16 a[238:239], v15 offset:41984
    s_waitcnt vmcnt(21) lgkmcnt(6)
    v_mfma_f32_32x32x16_bf16 v[176:191], a[224:227], v[128:131], v[176:191]
    ds_read_b64_tr_b16 a[240:241], v26 offset:43008
    ds_read_b64_tr_b16 a[242:243], v26 offset:44032
    s_lshl1_add_u32 s43, s60, s52
    buffer_load_dwordx4 a[64:67], v16, s[32:35], s43 offen offset:0 sc1
    s_waitcnt lgkmcnt(6)
    v_mfma_f32_32x32x16_bf16 v[192:207], a[228:231], v[128:131], v[192:207]
    ds_read_b64_tr_b16 a[244:245], v27 offset:43008
    ds_read_b64_tr_b16 a[246:247], v27 offset:44032
    s_waitcnt lgkmcnt(6)
    v_mfma_f32_32x32x16_bf16 v[208:223], a[232:235], v[128:131], v[208:223]
    ds_read_b64_tr_b16 a[248:249], v24 offset:43008
    ds_read_b64_tr_b16 a[250:251], v24 offset:44032
    buffer_load_dwordx4 a[68:71], v17, s[32:35], s43 offen offset:0 sc1
    s_waitcnt lgkmcnt(6)
    v_mfma_f32_32x32x16_bf16 v[224:239], a[236:239], v[128:131], v[224:239]
    ds_read_b64_tr_b16 a[252:253], v15 offset:43008
    ds_read_b64_tr_b16 a[254:255], v15 offset:44032
    s_waitcnt vmcnt(22) lgkmcnt(6)
    v_mfma_f32_32x32x16_bf16 v[176:191], a[240:243], v[132:135], v[176:191]
    ds_read_b64_tr_b16 a[224:225], v26 offset:45056
    ds_read_b64_tr_b16 a[226:227], v26 offset:46080
    buffer_load_dwordx4 a[72:75], v16, s[32:35], s43 offen offset:2048 sc1
    s_waitcnt lgkmcnt(6)
    v_mfma_f32_32x32x16_bf16 v[192:207], a[244:247], v[132:135], v[192:207]
    ds_read_b64_tr_b16 a[228:229], v27 offset:45056
    ds_read_b64_tr_b16 a[230:231], v27 offset:46080
    s_waitcnt lgkmcnt(6)
    v_mfma_f32_32x32x16_bf16 v[208:223], a[248:251], v[132:135], v[208:223]
    ds_read_b64_tr_b16 a[232:233], v24 offset:45056
    ds_read_b64_tr_b16 a[234:235], v24 offset:46080
    buffer_load_dwordx4 a[76:79], v17, s[32:35], s43 offen offset:2048 sc1
    s_waitcnt lgkmcnt(6)
    v_mfma_f32_32x32x16_bf16 v[224:239], a[252:255], v[132:135], v[224:239]
    ds_read_b64_tr_b16 a[236:237], v15 offset:45056
    ds_read_b64_tr_b16 a[238:239], v15 offset:46080
    s_waitcnt vmcnt(23) lgkmcnt(6)
    v_mfma_f32_32x32x16_bf16 v[176:191], a[224:227], v[136:139], v[176:191]
    ds_read_b64_tr_b16 a[240:241], v26 offset:47104
    ds_read_b64_tr_b16 a[242:243], v26 offset:48128
    s_lshl1_add_u32 s43, s61, s52
    buffer_load_dwordx4 a[80:83], v16, s[32:35], s43 offen offset:0 sc1
    s_waitcnt lgkmcnt(6)
    v_mfma_f32_32x32x16_bf16 v[192:207], a[228:231], v[136:139], v[192:207]
    ds_read_b64_tr_b16 a[244:245], v27 offset:47104
    ds_read_b64_tr_b16 a[246:247], v27 offset:48128
    s_waitcnt lgkmcnt(6)
    v_mfma_f32_32x32x16_bf16 v[208:223], a[232:235], v[136:139], v[208:223]
    ds_read_b64_tr_b16 a[248:249], v24 offset:47104
    ds_read_b64_tr_b16 a[250:251], v24 offset:48128
    buffer_load_dwordx4 a[84:87], v17, s[32:35], s43 offen offset:0 sc1
    s_waitcnt lgkmcnt(6)
    v_mfma_f32_32x32x16_bf16 v[224:239], a[236:239], v[136:139], v[224:239]
    ds_read_b64_tr_b16 a[252:253], v15 offset:47104
    ds_read_b64_tr_b16 a[254:255], v15 offset:48128
    s_waitcnt vmcnt(24) lgkmcnt(6)
    v_mfma_f32_32x32x16_bf16 v[176:191], a[240:243], v[140:143], v[176:191]
    ds_read_b64_tr_b16 a[224:225], v26 offset:49152
    ds_read_b64_tr_b16 a[226:227], v26 offset:50176
    buffer_load_dwordx4 a[88:91], v16, s[32:35], s43 offen offset:2048 sc1
    s_waitcnt lgkmcnt(6)
    v_mfma_f32_32x32x16_bf16 v[192:207], a[244:247], v[140:143], v[192:207]
    ds_read_b64_tr_b16 a[228:229], v27 offset:49152
    ds_read_b64_tr_b16 a[230:231], v27 offset:50176
    s_waitcnt lgkmcnt(6)
    v_mfma_f32_32x32x16_bf16 v[208:223], a[248:251], v[140:143], v[208:223]
    ds_read_b64_tr_b16 a[232:233], v24 offset:49152
    ds_read_b64_tr_b16 a[234:235], v24 offset:50176
    buffer_load_dwordx4 a[92:95], v17, s[32:35], s43 offen offset:2048 sc1
    s_waitcnt lgkmcnt(6)
    v_mfma_f32_32x32x16_bf16 v[224:239], a[252:255], v[140:143], v[224:239]
    ds_read_b64_tr_b16 a[236:237], v15 offset:49152
    ds_read_b64_tr_b16 a[238:239], v15 offset:50176
    s_waitcnt vmcnt(25) lgkmcnt(6)
    v_mfma_f32_32x32x16_bf16 v[176:191], a[224:227], v[144:147], v[176:191]
    ds_read_b64_tr_b16 a[240:241], v26 offset:51200
    ds_read_b64_tr_b16 a[242:243], v26 offset:52224
    s_lshl1_add_u32 s43, s62, s52
    buffer_load_dwordx4 a[96:99], v16, s[32:35], s43 offen offset:0 sc1
    s_waitcnt lgkmcnt(6)
    v_mfma_f32_32x32x16_bf16 v[192:207], a[228:231], v[144:147], v[192:207]
    ds_read_b64_tr_b16 a[244:245], v27 offset:51200
    ds_read_b64_tr_b16 a[246:247], v27 offset:52224
    s_waitcnt lgkmcnt(6)
    v_mfma_f32_32x32x16_bf16 v[208:223], a[232:235], v[144:147], v[208:223]
    ds_read_b64_tr_b16 a[248:249], v24 offset:51200
    ds_read_b64_tr_b16 a[250:251], v24 offset:52224
    buffer_load_dwordx4 a[100:103], v17, s[32:35], s43 offen offset:0 sc1
    s_waitcnt lgkmcnt(6)
    v_mfma_f32_32x32x16_bf16 v[224:239], a[236:239], v[144:147], v[224:239]
    ds_read_b64_tr_b16 a[252:253], v15 offset:51200
    ds_read_b64_tr_b16 a[254:255], v15 offset:52224
    s_waitcnt vmcnt(26) lgkmcnt(6)
    v_mfma_f32_32x32x16_bf16 v[176:191], a[240:243], v[148:151], v[176:191]
    ds_read_b64_tr_b16 a[224:225], v26 offset:53248
    ds_read_b64_tr_b16 a[226:227], v26 offset:54272
    buffer_load_dwordx4 a[104:107], v16, s[32:35], s43 offen offset:2048 sc1
    s_waitcnt vmcnt(19)
    v_add_f32 v48, v48, v52
    s_waitcnt vmcnt(17)
    v_add_f32 v56, v56, v60
    s_waitcnt lgkmcnt(6)
    v_mfma_f32_32x32x16_bf16 v[192:207], a[244:247], v[148:151], v[192:207]
    ds_read_b64_tr_b16 a[228:229], v27 offset:53248
    ds_read_b64_tr_b16 a[230:231], v27 offset:54272
    v_add_f32 v48, v48, v56
    v_add_f32 v49, v49, v53
    s_waitcnt lgkmcnt(6)
    v_mfma_f32_32x32x16_bf16 v[208:223], a[248:251], v[148:151], v[208:223]
    ds_read_b64_tr_b16 a[232:233], v24 offset:53248
    ds_read_b64_tr_b16 a[234:235], v24 offset:54272
    buffer_load_dwordx4 a[108:111], v17, s[32:35], s43 offen offset:2048 sc1
    v_add_f32 v57, v57, v61
    v_add_f32 v49, v49, v57
    s_waitcnt lgkmcnt(6)
    v_mfma_f32_32x32x16_bf16 v[224:239], a[252:255], v[148:151], v[224:239]
    ds_read_b64_tr_b16 a[236:237], v15 offset:53248
    ds_read_b64_tr_b16 a[238:239], v15 offset:54272
    v_add_f32 v50, v50, v54
    v_add_f32 v58, v58, v62
    s_waitcnt lgkmcnt(6)
    v_mfma_f32_32x32x16_bf16 v[176:191], a[224:227], v[152:155], v[176:191]
    ds_read_b64_tr_b16 a[240:241], v26 offset:55296
    ds_read_b64_tr_b16 a[242:243], v26 offset:56320
    s_lshl1_add_u32 s43, s63, s52
    buffer_load_dwordx4 a[112:115], v16, s[32:35], s43 offen offset:0 sc1
    v_add_f32 v50, v50, v58
    v_add_f32 v51, v51, v55
    s_waitcnt lgkmcnt(6)
    v_mfma_f32_32x32x16_bf16 v[192:207], a[228:231], v[152:155], v[192:207]
    ds_read_b64_tr_b16 a[244:245], v27 offset:55296
    ds_read_b64_tr_b16 a[246:247], v27 offset:56320
    v_add_f32 v59, v59, v63
    v_add_f32 v51, v51, v59
    s_waitcnt lgkmcnt(6)
    v_mfma_f32_32x32x16_bf16 v[208:223], a[232:235], v[152:155], v[208:223]
    ds_read_b64_tr_b16 a[248:249], v24 offset:55296
    ds_read_b64_tr_b16 a[250:251], v24 offset:56320
    buffer_load_dwordx4 a[116:119], v17, s[32:35], s43 offen offset:0 sc1
    s_nop 0
    v_permlane16_swap_b32 v48, v50
    s_waitcnt lgkmcnt(6)
    v_mfma_f32_32x32x16_bf16 v[224:239], a[236:239], v[152:155], v[224:239]
    ds_read_b64_tr_b16 a[252:253], v15 offset:55296
    ds_read_b64_tr_b16 a[254:255], v15 offset:56320
    v_permlane16_swap_b32 v49, v51
    v_add_f32 v48, v48, v50
    s_waitcnt lgkmcnt(6)
    v_mfma_f32_32x32x16_bf16 v[176:191], a[240:243], v[156:159], v[176:191]
    ds_read_b64_tr_b16 a[224:225], v26 offset:57344
    ds_read_b64_tr_b16 a[226:227], v26 offset:58368
    buffer_load_dwordx4 a[120:123], v16, s[32:35], s43 offen offset:2048 sc1
    v_add_f32 v49, v49, v51
    v_mov_b64 v[50:51], v[48:49]
    s_waitcnt lgkmcnt(6)
    v_mfma_f32_32x32x16_bf16 v[192:207], a[244:247], v[156:159], v[192:207]
    ds_read_b64_tr_b16 a[228:229], v27 offset:57344
    ds_read_b64_tr_b16 a[230:231], v27 offset:58368
    s_nop 0
    v_permlane32_swap_b32 v48, v50
    s_waitcnt lgkmcnt(6)
    v_mfma_f32_32x32x16_bf16 v[208:223], a[248:251], v[156:159], v[208:223]
    ds_read_b64_tr_b16 a[232:233], v24 offset:57344
    ds_read_b64_tr_b16 a[234:235], v24 offset:58368
    buffer_load_dwordx4 a[124:127], v17, s[32:35], s43 offen offset:2048 sc1
    v_permlane32_swap_b32 v49, v51
    v_add_f32 v48, v48, v50
    s_waitcnt lgkmcnt(6)
    v_mfma_f32_32x32x16_bf16 v[224:239], a[252:255], v[156:159], v[224:239]
    ds_read_b64_tr_b16 a[236:237], v15 offset:57344
    ds_read_b64_tr_b16 a[238:239], v15 offset:58368
    v_add_f32 v49, v49, v51
    v_mul_f32 v48, 0xbb000000, v48
    s_waitcnt lgkmcnt(6)
    v_mfma_f32_32x32x16_bf16 v[176:191], a[224:227], v[160:163], v[176:191]
    ds_read_b64_tr_b16 a[240:241], v26 offset:59392
    ds_read_b64_tr_b16 a[242:243], v26 offset:60416
    s_lshl1_add_u32 s43, s64, s52
    buffer_load_dwordx4 a[128:131], v16, s[32:35], s43 offen offset:0 sc1
    v_mul_f32 v49, 0x3b000000, v49
    v_fma_f32 v49, -v48, v48, v49
    s_waitcnt lgkmcnt(6)
    v_mfma_f32_32x32x16_bf16 v[192:207], a[228:231], v[160:163], v[192:207]
    ds_read_b64_tr_b16 a[244:245], v27 offset:59392
    ds_read_b64_tr_b16 a[246:247], v27 offset:60416
    v_max_f32 v49, 0, v49
    v_add_f32 v49, 0x3727c5ac, v49
    s_waitcnt lgkmcnt(6)
    v_mfma_f32_32x32x16_bf16 v[208:223], a[232:235], v[160:163], v[208:223]
    ds_read_b64_tr_b16 a[248:249], v24 offset:59392
    ds_read_b64_tr_b16 a[250:251], v24 offset:60416
    buffer_load_dwordx4 a[132:135], v17, s[32:35], s43 offen offset:0 sc1
    v_rsq_f32 v46, v49
    v_sqrt_f32 v47, v49
    s_waitcnt lgkmcnt(6)
    v_mfma_f32_32x32x16_bf16 v[224:239], a[236:239], v[160:163], v[224:239]
    ds_read_b64_tr_b16 a[252:253], v15 offset:59392
    ds_read_b64_tr_b16 a[254:255], v15 offset:60416
    v_cvt_pk_bf16_f32 v42, v48, v48
    v_and_b32 v50, 0xffff0000, v42
    s_waitcnt lgkmcnt(6)
    v_mfma_f32_32x32x16_bf16 v[176:191], a[240:243], v[164:167], v[176:191]
    ds_read_b64_tr_b16 a[224:225], v26 offset:61440
    ds_read_b64_tr_b16 a[226:227], v26 offset:62464
    buffer_load_dwordx4 a[136:139], v16, s[32:35], s43 offen offset:2048 sc1
    v_sub_f32 v50, v48, v50
    v_cvt_pk_bf16_f32 v42, v48, v50
    s_waitcnt lgkmcnt(6)
    v_mfma_f32_32x32x16_bf16 v[192:207], a[244:247], v[164:167], v[192:207]
    ds_read_b64_tr_b16 a[228:229], v27 offset:61440
    ds_read_b64_tr_b16 a[230:231], v27 offset:62464
    v_mov_b32 v43, v42
    v_mov_b64 v[44:45], v[42:43]
    s_waitcnt lgkmcnt(6)
    v_mfma_f32_32x32x16_bf16 v[208:223], a[248:251], v[164:167], v[208:223]
    ds_read_b64_tr_b16 a[232:233], v24 offset:61440
    ds_read_b64_tr_b16 a[234:235], v24 offset:62464
    buffer_load_dwordx4 a[140:143], v17, s[32:35], s43 offen offset:2048 sc1
    v_mul_f32 v46, 0xbfb8aa3b, v46
    s_waitcnt lgkmcnt(6)
    v_mfma_f32_32x32x16_bf16 v[224:239], a[252:255], v[164:167], v[224:239]
    ds_read_b64_tr_b16 a[236:237], v15 offset:61440
    ds_read_b64_tr_b16 a[238:239], v15 offset:62464
    s_waitcnt lgkmcnt(6)
    v_mfma_f32_32x32x16_bf16 v[176:191], a[224:227], v[168:171], v[176:191]
    ds_read_b64_tr_b16 a[240:241], v26 offset:63488
    ds_read_b64_tr_b16 a[242:243], v26 offset:64512
    s_lshl1_add_u32 s43, s65, s52
    buffer_load_dwordx4 a[144:147], v16, s[32:35], s43 offen offset:0 sc1
    s_waitcnt lgkmcnt(6)
    v_mfma_f32_32x32x16_bf16 v[192:207], a[228:231], v[168:171], v[192:207]
    ds_read_b64_tr_b16 a[244:245], v27 offset:63488
    ds_read_b64_tr_b16 a[246:247], v27 offset:64512
    s_waitcnt lgkmcnt(6)
    v_mfma_f32_32x32x16_bf16 v[208:223], a[232:235], v[168:171], v[208:223]
    ds_read_b64_tr_b16 a[248:249], v24 offset:63488
    ds_read_b64_tr_b16 a[250:251], v24 offset:64512
    buffer_load_dwordx4 a[148:151], v17, s[32:35], s43 offen offset:0 sc1
    s_waitcnt lgkmcnt(6)
    v_mfma_f32_32x32x16_bf16 v[224:239], a[236:239], v[168:171], v[224:239]
    ds_read_b64_tr_b16 a[252:253], v15 offset:63488
    ds_read_b64_tr_b16 a[254:255], v15 offset:64512
    s_waitcnt lgkmcnt(6)
    v_mfma_f32_32x32x16_bf16 v[176:191], a[240:243], v[172:175], v[176:191]
    buffer_load_dwordx4 a[152:155], v16, s[32:35], s43 offen offset:2048 sc1
    s_waitcnt lgkmcnt(4)
    v_mfma_f32_32x32x16_bf16 v[192:207], a[244:247], v[172:175], v[192:207]
    s_waitcnt lgkmcnt(2)
    v_mfma_f32_32x32x16_bf16 v[208:223], a[248:251], v[172:175], v[208:223]
    buffer_load_dwordx4 a[156:159], v17, s[32:35], s43 offen offset:2048 sc1
    s_waitcnt lgkmcnt(0)
    v_mfma_f32_32x32x16_bf16 v[224:239], a[252:255], v[172:175], v[224:239]
    v_mfma_f32_32x32x16_bf16 v[176:191], v[30:33], v[42:45], v[176:191]
    v_mfma_f32_32x32x16_bf16 v[192:207], v[32:35], v[42:45], v[192:207]
    v_mfma_f32_32x32x16_bf16 v[208:223], v[36:39], v[42:45], v[208:223]
    v_mfma_f32_32x32x16_bf16 v[224:239], v[38:41], v[42:45], v[224:239]
    s_nop 8
    v_pk_mul_f32 v[6:7], v[176:177], v[46:47] op_sel_hi:[1,0]
    s_lshl1_add_u32 s43, s66, s52
    buffer_load_dwordx4 a[160:163], v16, s[32:35], s43 offen offset:0 sc1
    v_pk_mul_f32 v[8:9], v[178:179], v[46:47] op_sel_hi:[1,0]
    v_exp_f32 v6, v6
    v_exp_f32 v7, v7
    v_exp_f32 v8, v8
    v_exp_f32 v9, v9
    v_pk_fma_f32 v[6:7], v[6:7], v[46:47], v[46:47] op_sel:[0,1,1] op_sel_hi:[1,1,1]
    v_pk_fma_f32 v[8:9], v[8:9], v[46:47], v[46:47] op_sel:[0,1,1] op_sel_hi:[1,1,1]
    v_rcp_f32 v6, v6
    v_rcp_f32 v7, v7
    v_rcp_f32 v8, v8
    buffer_load_dwordx4 a[164:167], v17, s[32:35], s43 offen offset:0 sc1
    v_rcp_f32 v9, v9
    v_pk_mul_f32 v[176:177], v[176:177], v[6:7]
    v_pk_mul_f32 v[178:179], v[178:179], v[8:9]
    v_cvt_pk_bf16_f32 v176, v176, v177
    v_cvt_pk_bf16_f32 v177, v178, v179
    v_pk_mul_f32 v[6:7], v[180:181], v[46:47] op_sel_hi:[1,0]
    v_pk_mul_f32 v[8:9], v[182:183], v[46:47] op_sel_hi:[1,0]
    v_exp_f32 v6, v6
    v_exp_f32 v7, v7
    v_exp_f32 v8, v8
    v_exp_f32 v9, v9
    buffer_load_dwordx4 a[168:171], v16, s[32:35], s43 offen offset:2048 sc1
    v_pk_fma_f32 v[6:7], v[6:7], v[46:47], v[46:47] op_sel:[0,1,1] op_sel_hi:[1,1,1]
    v_pk_fma_f32 v[8:9], v[8:9], v[46:47], v[46:47] op_sel:[0,1,1] op_sel_hi:[1,1,1]
    v_rcp_f32 v6, v6
    v_rcp_f32 v7, v7
    v_rcp_f32 v8, v8
    v_rcp_f32 v9, v9
    v_pk_mul_f32 v[180:181], v[180:181], v[6:7]
    v_pk_mul_f32 v[182:183], v[182:183], v[8:9]
    v_cvt_pk_bf16_f32 v178, v180, v181
    v_cvt_pk_bf16_f32 v179, v182, v183
    buffer_store_dwordx4 v[176:179], v2, s[32:35], s79 offen offset:0 sc1
    v_pk_mul_f32 v[6:7], v[184:185], v[46:47] op_sel_hi:[1,0]
    v_pk_mul_f32 v[8:9], v[186:187], v[46:47] op_sel_hi:[1,0]
    v_exp_f32 v6, v6
    v_exp_f32 v7, v7
    v_exp_f32 v8, v8
    v_exp_f32 v9, v9
    v_pk_fma_f32 v[6:7], v[6:7], v[46:47], v[46:47] op_sel:[0,1,1] op_sel_hi:[1,1,1]
    v_pk_fma_f32 v[8:9], v[8:9], v[46:47], v[46:47] op_sel:[0,1,1] op_sel_hi:[1,1,1]
    v_rcp_f32 v6, v6
    v_rcp_f32 v7, v7
    v_rcp_f32 v8, v8
    v_rcp_f32 v9, v9
    v_pk_mul_f32 v[184:185], v[184:185], v[6:7]
    v_pk_mul_f32 v[186:187], v[186:187], v[8:9]
    v_cvt_pk_bf16_f32 v180, v184, v185
    v_cvt_pk_bf16_f32 v181, v186, v187
    buffer_load_dwordx4 a[172:175], v17, s[32:35], s43 offen offset:2048 sc1
    v_pk_mul_f32 v[6:7], v[188:189], v[46:47] op_sel_hi:[1,0]
    v_pk_mul_f32 v[8:9], v[190:191], v[46:47] op_sel_hi:[1,0]
    v_exp_f32 v6, v6
    v_exp_f32 v7, v7
    v_exp_f32 v8, v8
    v_exp_f32 v9, v9
    v_pk_fma_f32 v[6:7], v[6:7], v[46:47], v[46:47] op_sel:[0,1,1] op_sel_hi:[1,1,1]
    v_pk_fma_f32 v[8:9], v[8:9], v[46:47], v[46:47] op_sel:[0,1,1] op_sel_hi:[1,1,1]
    v_rcp_f32 v6, v6
    v_rcp_f32 v7, v7
    s_lshl1_add_u32 s43, s67, s52
    buffer_load_dwordx4 a[176:179], v16, s[32:35], s43 offen offset:0 sc1
    v_rcp_f32 v8, v8
    v_rcp_f32 v9, v9
    v_pk_mul_f32 v[188:189], v[188:189], v[6:7]
    v_pk_mul_f32 v[190:191], v[190:191], v[8:9]
    v_cvt_pk_bf16_f32 v182, v188, v189
    v_cvt_pk_bf16_f32 v183, v190, v191
    buffer_store_dwordx4 v[180:183], v2, s[32:35], s79 offen offset:1024 sc1
    v_pk_mul_f32 v[6:7], v[192:193], v[46:47] op_sel_hi:[1,0]
    v_pk_mul_f32 v[8:9], v[194:195], v[46:47] op_sel_hi:[1,0]
    v_exp_f32 v6, v6
    v_exp_f32 v7, v7
    v_exp_f32 v8, v8
    v_exp_f32 v9, v9
    v_pk_fma_f32 v[6:7], v[6:7], v[46:47], v[46:47] op_sel:[0,1,1] op_sel_hi:[1,1,1]
    v_pk_fma_f32 v[8:9], v[8:9], v[46:47], v[46:47] op_sel:[0,1,1] op_sel_hi:[1,1,1]
    v_rcp_f32 v6, v6
    v_rcp_f32 v7, v7
    v_rcp_f32 v8, v8
    v_rcp_f32 v9, v9
    v_pk_mul_f32 v[192:193], v[192:193], v[6:7]
    v_pk_mul_f32 v[194:195], v[194:195], v[8:9]
    v_cvt_pk_bf16_f32 v192, v192, v193
    v_cvt_pk_bf16_f32 v193, v194, v195
    buffer_load_dwordx4 a[180:183], v17, s[32:35], s43 offen offset:0 sc1
    v_pk_mul_f32 v[6:7], v[196:197], v[46:47] op_sel_hi:[1,0]
    v_pk_mul_f32 v[8:9], v[198:199], v[46:47] op_sel_hi:[1,0]
    v_exp_f32 v6, v6
    v_exp_f32 v7, v7
    v_exp_f32 v8, v8
    v_exp_f32 v9, v9
    v_pk_fma_f32 v[6:7], v[6:7], v[46:47], v[46:47] op_sel:[0,1,1] op_sel_hi:[1,1,1]
    v_pk_fma_f32 v[8:9], v[8:9], v[46:47], v[46:47] op_sel:[0,1,1] op_sel_hi:[1,1,1]
    v_rcp_f32 v6, v6
    v_rcp_f32 v7, v7
    buffer_load_dwordx4 a[184:187], v16, s[32:35], s43 offen offset:2048 sc1
    v_rcp_f32 v8, v8
    v_rcp_f32 v9, v9
    v_pk_mul_f32 v[196:197], v[196:197], v[6:7]
    v_pk_mul_f32 v[198:199], v[198:199], v[8:9]
    v_cvt_pk_bf16_f32 v194, v196, v197
    v_cvt_pk_bf16_f32 v195, v198, v199
    buffer_store_dwordx4 v[192:195], v2, s[32:35], s79 offen offset:2048 sc1
    v_pk_mul_f32 v[6:7], v[200:201], v[46:47] op_sel_hi:[1,0]
    v_pk_mul_f32 v[8:9], v[202:203], v[46:47] op_sel_hi:[1,0]
    v_exp_f32 v6, v6
    v_exp_f32 v7, v7
    v_exp_f32 v8, v8
    v_exp_f32 v9, v9
    v_pk_fma_f32 v[6:7], v[6:7], v[46:47], v[46:47] op_sel:[0,1,1] op_sel_hi:[1,1,1]
    v_pk_fma_f32 v[8:9], v[8:9], v[46:47], v[46:47] op_sel:[0,1,1] op_sel_hi:[1,1,1]
    v_rcp_f32 v6, v6
    v_rcp_f32 v7, v7
    v_rcp_f32 v8, v8
    v_rcp_f32 v9, v9
    v_pk_mul_f32 v[200:201], v[200:201], v[6:7]
    v_pk_mul_f32 v[202:203], v[202:203], v[8:9]
    v_cvt_pk_bf16_f32 v196, v200, v201
    v_cvt_pk_bf16_f32 v197, v202, v203
    buffer_load_dwordx4 a[188:191], v17, s[32:35], s43 offen offset:2048 sc1
    v_pk_mul_f32 v[6:7], v[204:205], v[46:47] op_sel_hi:[1,0]
    v_pk_mul_f32 v[8:9], v[206:207], v[46:47] op_sel_hi:[1,0]
    v_exp_f32 v6, v6
    v_exp_f32 v7, v7
    v_exp_f32 v8, v8
    v_exp_f32 v9, v9
    v_pk_fma_f32 v[6:7], v[6:7], v[46:47], v[46:47] op_sel:[0,1,1] op_sel_hi:[1,1,1]
    v_pk_fma_f32 v[8:9], v[8:9], v[46:47], v[46:47] op_sel:[0,1,1] op_sel_hi:[1,1,1]
    v_rcp_f32 v6, v6
    v_rcp_f32 v7, v7
    s_lshl1_add_u32 s43, s68, s52
    buffer_load_dwordx4 a[192:195], v16, s[32:35], s43 offen offset:0 sc1
    v_rcp_f32 v8, v8
    v_rcp_f32 v9, v9
    v_pk_mul_f32 v[204:205], v[204:205], v[6:7]
    v_pk_mul_f32 v[206:207], v[206:207], v[8:9]
    v_cvt_pk_bf16_f32 v198, v204, v205
    v_cvt_pk_bf16_f32 v199, v206, v207
    buffer_store_dwordx4 v[196:199], v2, s[32:35], s79 offen offset:3072 sc1
    v_pk_mul_f32 v[6:7], v[208:209], v[46:47] op_sel_hi:[1,0]
    v_pk_mul_f32 v[8:9], v[210:211], v[46:47] op_sel_hi:[1,0]
    v_exp_f32 v6, v6
    v_exp_f32 v7, v7
    v_exp_f32 v8, v8
    v_exp_f32 v9, v9
    v_pk_fma_f32 v[6:7], v[6:7], v[46:47], v[46:47] op_sel:[0,1,1] op_sel_hi:[1,1,1]
    v_pk_fma_f32 v[8:9], v[8:9], v[46:47], v[46:47] op_sel:[0,1,1] op_sel_hi:[1,1,1]
    v_rcp_f32 v6, v6
    v_rcp_f32 v7, v7
    v_rcp_f32 v8, v8
    v_rcp_f32 v9, v9
    v_pk_mul_f32 v[208:209], v[208:209], v[6:7]
    v_pk_mul_f32 v[210:211], v[210:211], v[8:9]
    v_cvt_pk_bf16_f32 v208, v208, v209
    v_cvt_pk_bf16_f32 v209, v210, v211
    buffer_load_dwordx4 a[196:199], v17, s[32:35], s43 offen offset:0 sc1
    v_pk_mul_f32 v[6:7], v[212:213], v[46:47] op_sel_hi:[1,0]
    v_pk_mul_f32 v[8:9], v[214:215], v[46:47] op_sel_hi:[1,0]
    v_exp_f32 v6, v6
    v_exp_f32 v7, v7
    v_exp_f32 v8, v8
    v_exp_f32 v9, v9
    v_pk_fma_f32 v[6:7], v[6:7], v[46:47], v[46:47] op_sel:[0,1,1] op_sel_hi:[1,1,1]
    v_pk_fma_f32 v[8:9], v[8:9], v[46:47], v[46:47] op_sel:[0,1,1] op_sel_hi:[1,1,1]
    v_rcp_f32 v6, v6
    v_rcp_f32 v7, v7
    buffer_load_dwordx4 a[200:203], v16, s[32:35], s43 offen offset:2048 sc1
    v_rcp_f32 v8, v8
    v_rcp_f32 v9, v9
    v_pk_mul_f32 v[212:213], v[212:213], v[6:7]
    v_pk_mul_f32 v[214:215], v[214:215], v[8:9]
    v_cvt_pk_bf16_f32 v210, v212, v213
    v_cvt_pk_bf16_f32 v211, v214, v215
    s_add_u32 s79, s79, 4096
    buffer_store_dwordx4 v[208:211], v2, s[32:35], s79 offen offset:0 sc1
    v_pk_mul_f32 v[6:7], v[216:217], v[46:47] op_sel_hi:[1,0]
    v_pk_mul_f32 v[8:9], v[218:219], v[46:47] op_sel_hi:[1,0]
    v_exp_f32 v6, v6
    v_exp_f32 v7, v7
    v_exp_f32 v8, v8
    v_exp_f32 v9, v9
    v_pk_fma_f32 v[6:7], v[6:7], v[46:47], v[46:47] op_sel:[0,1,1] op_sel_hi:[1,1,1]
    v_pk_fma_f32 v[8:9], v[8:9], v[46:47], v[46:47] op_sel:[0,1,1] op_sel_hi:[1,1,1]
    v_rcp_f32 v6, v6
    v_rcp_f32 v7, v7
    v_rcp_f32 v8, v8
    v_rcp_f32 v9, v9
    v_pk_mul_f32 v[216:217], v[216:217], v[6:7]
    v_pk_mul_f32 v[218:219], v[218:219], v[8:9]
    v_cvt_pk_bf16_f32 v212, v216, v217
    v_cvt_pk_bf16_f32 v213, v218, v219
    buffer_load_dwordx4 a[204:207], v17, s[32:35], s43 offen offset:2048 sc1
    v_pk_mul_f32 v[6:7], v[220:221], v[46:47] op_sel_hi:[1,0]
    v_pk_mul_f32 v[8:9], v[222:223], v[46:47] op_sel_hi:[1,0]
    v_exp_f32 v6, v6
    v_exp_f32 v7, v7
    v_exp_f32 v8, v8
    v_exp_f32 v9, v9
    v_pk_fma_f32 v[6:7], v[6:7], v[46:47], v[46:47] op_sel:[0,1,1] op_sel_hi:[1,1,1]
    v_pk_fma_f32 v[8:9], v[8:9], v[46:47], v[46:47] op_sel:[0,1,1] op_sel_hi:[1,1,1]
    v_rcp_f32 v6, v6
    v_rcp_f32 v7, v7
    s_lshl1_add_u32 s43, s69, s52
    buffer_load_dwordx4 a[208:211], v16, s[32:35], s43 offen offset:0 sc1
    v_rcp_f32 v8, v8
    v_rcp_f32 v9, v9
    v_pk_mul_f32 v[220:221], v[220:221], v[6:7]
    v_pk_mul_f32 v[222:223], v[222:223], v[8:9]
    v_cvt_pk_bf16_f32 v214, v220, v221
    v_cvt_pk_bf16_f32 v215, v222, v223
    buffer_store_dwordx4 v[212:215], v2, s[32:35], s79 offen offset:1024 sc1
    v_pk_mul_f32 v[6:7], v[224:225], v[46:47] op_sel_hi:[1,0]
    v_pk_mul_f32 v[8:9], v[226:227], v[46:47] op_sel_hi:[1,0]
    v_exp_f32 v6, v6
    v_exp_f32 v7, v7
    v_exp_f32 v8, v8
    v_exp_f32 v9, v9
    v_pk_fma_f32 v[6:7], v[6:7], v[46:47], v[46:47] op_sel:[0,1,1] op_sel_hi:[1,1,1]
    v_pk_fma_f32 v[8:9], v[8:9], v[46:47], v[46:47] op_sel:[0,1,1] op_sel_hi:[1,1,1]
    v_rcp_f32 v6, v6
    v_rcp_f32 v7, v7
    v_rcp_f32 v8, v8
    v_rcp_f32 v9, v9
    v_pk_mul_f32 v[224:225], v[224:225], v[6:7]
    v_pk_mul_f32 v[226:227], v[226:227], v[8:9]
    v_cvt_pk_bf16_f32 v224, v224, v225
    v_cvt_pk_bf16_f32 v225, v226, v227
    buffer_load_dwordx4 a[212:215], v17, s[32:35], s43 offen offset:0 sc1
    v_pk_mul_f32 v[6:7], v[228:229], v[46:47] op_sel_hi:[1,0]
    v_pk_mul_f32 v[8:9], v[230:231], v[46:47] op_sel_hi:[1,0]
    v_exp_f32 v6, v6
    v_exp_f32 v7, v7
    v_exp_f32 v8, v8
    v_exp_f32 v9, v9
    v_pk_fma_f32 v[6:7], v[6:7], v[46:47], v[46:47] op_sel:[0,1,1] op_sel_hi:[1,1,1]
    v_pk_fma_f32 v[8:9], v[8:9], v[46:47], v[46:47] op_sel:[0,1,1] op_sel_hi:[1,1,1]
    v_rcp_f32 v6, v6
    v_rcp_f32 v7, v7
    buffer_load_dwordx4 a[216:219], v16, s[32:35], s43 offen offset:2048 sc1
    v_rcp_f32 v8, v8
    v_rcp_f32 v9, v9
    v_pk_mul_f32 v[228:229], v[228:229], v[6:7]
    v_pk_mul_f32 v[230:231], v[230:231], v[8:9]
    v_cvt_pk_bf16_f32 v226, v228, v229
    v_cvt_pk_bf16_f32 v227, v230, v231
    buffer_store_dwordx4 v[224:227], v2, s[32:35], s79 offen offset:2048 sc1
    v_pk_mul_f32 v[6:7], v[232:233], v[46:47] op_sel_hi:[1,0]
    v_pk_mul_f32 v[8:9], v[234:235], v[46:47] op_sel_hi:[1,0]
    v_exp_f32 v6, v6
    v_exp_f32 v7, v7
    v_exp_f32 v8, v8
    v_exp_f32 v9, v9
    v_pk_fma_f32 v[6:7], v[6:7], v[46:47], v[46:47] op_sel:[0,1,1] op_sel_hi:[1,1,1]
    v_pk_fma_f32 v[8:9], v[8:9], v[46:47], v[46:47] op_sel:[0,1,1] op_sel_hi:[1,1,1]
    v_rcp_f32 v6, v6
    v_rcp_f32 v7, v7
    v_rcp_f32 v8, v8
    v_rcp_f32 v9, v9
    v_pk_mul_f32 v[232:233], v[232:233], v[6:7]
    v_pk_mul_f32 v[234:235], v[234:235], v[8:9]
    v_cvt_pk_bf16_f32 v228, v232, v233
    v_cvt_pk_bf16_f32 v229, v234, v235
    buffer_load_dwordx4 a[220:223], v17, s[32:35], s43 offen offset:2048 sc1
    v_pk_mul_f32 v[6:7], v[236:237], v[46:47] op_sel_hi:[1,0]
    v_pk_mul_f32 v[8:9], v[238:239], v[46:47] op_sel_hi:[1,0]
    v_exp_f32 v6, v6
    v_exp_f32 v7, v7
    v_exp_f32 v8, v8
    v_exp_f32 v9, v9
    v_pk_fma_f32 v[6:7], v[6:7], v[46:47], v[46:47] op_sel:[0,1,1] op_sel_hi:[1,1,1]
    v_pk_fma_f32 v[8:9], v[8:9], v[46:47], v[46:47] op_sel:[0,1,1] op_sel_hi:[1,1,1]
    v_rcp_f32 v6, v6
    v_rcp_f32 v7, v7
    v_rcp_f32 v8, v8
    v_rcp_f32 v9, v9
    v_pk_mul_f32 v[236:237], v[236:237], v[6:7]
    v_pk_mul_f32 v[238:239], v[238:239], v[8:9]
    v_cvt_pk_bf16_f32 v230, v236, v237
    v_cvt_pk_bf16_f32 v231, v238, v239
    buffer_store_dwordx4 v[228:231], v2, s[32:35], s79 offen offset:3072 sc1
    s_waitcnt vmcnt(0)
    s_cmp_eq_u32 s7, 0
    s_cbranch_scc1 L_slow2
    buffer_store_dword v12, v3, s[32:35], s80 offen offset:0
L_back2:
    buffer_load_dword v10, v5, s[32:35], s82 offen offset:0 sc1
    s_waitcnt vmcnt(0)
    v_cmp_ne_u32 vcc, s6, v10
    s_nop 0
    s_cbranch_vccz L_aok
    v_mov_b32 v10, 0
L_poll3:
    buffer_load_dword v10, v5, s[32:35], s82 offen offset:0 sc1
    s_add_u32 s96, s96, 1
    s_cmp_gt_u32 s96, s97
    s_waitcnt vmcnt(0)
    s_cbranch_scc1 L_pdone3
    v_cmp_ne_u32 vcc, s6, v10
    s_nop 0
    s_cbranch_vccnz L_poll3
L_pdone3:
L_aok:
    buffer_load_dwordx4 v[48:51], v28, s[32:35], s56 offen offset:0 sc1
    buffer_load_dwordx4 v[52:55], v29, s[32:35], s56 offen offset:0 sc1
    buffer_load_dwordx4 v[56:59], v28, s[32:35], s56 offen offset:1024 sc1
    buffer_load_dwordx4 v[60:63], v29, s[32:35], s56 offen offset:1024 sc1
    buffer_load_dwordx4 v[64:67], v28, s[32:35], s57 offen offset:0 sc1
    buffer_load_dwordx4 v[68:71], v29, s[32:35], s57 offen offset:0 sc1
    buffer_load_dwordx4 v[72:75], v28, s[32:35], s57 offen offset:1024 sc1
    buffer_load_dwordx4 v[76:79], v29, s[32:35], s57 offen offset:1024 sc1
    buffer_load_dwordx4 v[80:83], v28, s[32:35], s58 offen offset:0 sc1
    buffer_load_dwordx4 v[84:87], v29, s[32:35], s58 offen offset:0 sc1
    buffer_load_dwordx4 v[88:91], v28, s[32:35], s58 offen offset:1024 sc1
    buffer_load_dwordx4 v[92:95], v29, s[32:35], s58 offen offset:1024 sc1
    s_waitcnt vmcnt(11)
    v_mfma_f32_32x32x16_bf16 v[240:255], a[0:3], v[48:51], v[240:255]
    buffer_load_dwordx4 v[96:99], v28, s[32:35], s59 offen offset:0 sc1
    v_mfma_f32_32x32x16_bf16 v[176:191], a[4:7], v[48:51], 0
    s_waitcnt vmcnt(11)
    v_mfma_f32_32x32x16_bf16 v[192:207], a[0:3], v[52:55], 0
    buffer_load_dwordx4 v[100:103], v29, s[32:35], s59 offen offset:0 sc1
    v_mfma_f32_32x32x16_bf16 v[208:223], a[4:7], v[52:55], 0
    s_waitcnt vmcnt(11)
    v_mfma_f32_32x32x16_bf16 v[240:255], a[8:11], v[56:59], v[240:255]
    buffer_load_dwordx4 v[104:107], v28, s[32:35], s59 offen offset:1024 sc1
    v_mfma_f32_32x32x16_bf16 v[176:191], a[12:15], v[56:59], v[176:191]
    s_waitcnt vmcnt(11)
    v_mfma_f32_32x32x16_bf16 v[192:207], a[8:11], v[60:63], v[192:207]
    buffer_load_dwordx4 v[108:111], v29, s[32:35], s59 offen offset:1024 sc1
    v_mfma_f32_32x32x16_bf16 v[208:223], a[12:15], v[60:63], v[208:223]
    s_waitcnt vmcnt(11)
    v_mfma_f32_32x32x16_bf16 v[240:255], a[16:19], v[64:67], v[240:255]
    buffer_load_dwordx4 v[112:115], v28, s[32:35], s60 offen offset:0 sc1
    v_mfma_f32_32x32x16_bf16 v[176:191], a[20:23], v[64:67], v[176:191]
    s_waitcnt vmcnt(11)
    v_mfma_f32_32x32x16_bf16 v[192:207], a[16:19], v[68:71], v[192:207]
    buffer_load_dwordx4 v[116:119], v29, s[32:35], s60 offen offset:0 sc1
    v_mfma_f32_32x32x16_bf16 v[208:223], a[20:23], v[68:71], v[208:223]
    s_waitcnt vmcnt(11)
    v_mfma_f32_32x32x16_bf16 v[240:255], a[24:27], v[72:75], v[240:255]
    buffer_load_dwordx4 v[120:123], v28, s[32:35], s60 offen offset:1024 sc1
    v_mfma_f32_32x32x16_bf16 v[176:191], a[28:31], v[72:75], v[176:191]
    s_waitcnt vmcnt(11)
    v_mfma_f32_32x32x16_bf16 v[192:207], a[24:27], v[76:79], v[192:207]
    buffer_load_dwordx4 v[124:127], v29, s[32:35], s60 offen offset:1024 sc1
    v_mfma_f32_32x32x16_bf16 v[208:223], a[28:31], v[76:79], v[208:223]
    s_waitcnt vmcnt(11)
    v_mfma_f32_32x32x16_bf16 v[240:255], a[32:35], v[80:83], v[240:255]
    buffer_load_dwordx4 v[128:131], v28, s[32:35], s61 offen offset:0 sc1
    v_mfma_f32_32x32x16_bf16 v[176:191], a[36:39], v[80:83], v[176:191]
    s_waitcnt vmcnt(11)
    v_mfma_f32_32x32x16_bf16 v[192:207], a[32:35], v[84:87], v[192:207]
    buffer_load_dwordx4 v[132:135], v29, s[32:35], s61 offen offset:0 sc1
    v_mfma_f32_32x32x16_bf16 v[208:223], a[36:39], v[84:87], v[208:223]
    s_waitcnt vmcnt(11)
    v_mfma_f32_32x32x16_bf16 v[240:255], a[40:43], v[88:91], v[240:255]
    buffer_load_dwordx4 v[136:139], v28, s[32:35], s61 offen offset:1024 sc1
    v_mfma_f32_32x32x16_bf16 v[176:191], a[44:47], v[88:91], v[176:191]
    s_waitcnt vmcnt(11)
    v_mfma_f32_32x32x16_bf16 v[192:207], a[40:43], v[92:95], v[192:207]
    buffer_load_dwordx4 v[140:143], v29, s[32:35], s61 offen offset:1024 sc1
    v_mfma_f32_32x32x16_bf16 v[208:223], a[44:47], v[92:95], v[208:223]
    s_waitcnt vmcnt(11)
    v_mfma_f32_32x32x16_bf16 v[240:255], a[48:51], v[96:99], v[240:255]
    buffer_load_dwordx4 v[144:147], v28, s[32:35], s62 offen offset:0 sc1
    v_mfma_f32_32x32x16_bf16 v[176:191], a[52:55], v[96:99], v[176:191]
    s_waitcnt vmcnt(11)
    v_mfma_f32_32x32x16_bf16 v[192:207], a[48:51], v[100:103], v[192:207]
    buffer_load_dwordx4 v[148:151], v29, s[32:35], s62 offen offset:0 sc1
    v_mfma_f32_32x32x16_bf16 v[208:223], a[52:55], v[100:103], v[208:223]
    s_waitcnt vmcnt(11)
    v_mfma_f32_32x32x16_bf16 v[240:255], a[56:59], v[104:107], v[240:255]
    buffer_load_dwordx4 v[152:155], v28, s[32:35], s62 offen offset:1024 sc1
    v_mfma_f32_32x32x16_bf16 v[176:191], a[60:63], v[104:107], v[176:191]
    s_waitcnt vmcnt(11)
    v_mfma_f32_32x32x16_bf16 v[192:207], a[56:59], v[108:111], v[192:207]
    buffer_load_dwordx4 v[156:159], v29, s[32:35], s62 offen offset:1024 sc1
    v_mfma_f32_32x32x16_bf16 v[208:223], a[60:63], v[108:111], v[208:223]
    s_waitcnt vmcnt(11)
    v_mfma_f32_32x32x16_bf16 v[240:255], a[64:67], v[112:115], v[240:255]
    buffer_load_dwordx4 v[160:163], v28, s[32:35], s63 offen offset:0 sc1
    v_mfma_f32_32x32x16_bf16 v[176:191], a[68:71], v[112:115], v[176:191]
    s_waitcnt vmcnt(11)
    v_mfma_f32_32x32x16_bf16 v[192:207], a[64:67], v[116:119], v[192:207]
    buffer_load_dwordx4 v[164:167], v29, s[32:35], s63 offen offset:0 sc1
    v_mfma_f32_32x32x16_bf16 v[208:223], a[68:71], v[116:119], v[208:223]
    s_waitcnt vmcnt(11)
    v_mfma_f32_32x32x16_bf16 v[240:255], a[72:75], v[120:123], v[240:255]
    buffer_load_dwordx4 v[168:171], v28, s[32:35], s63 offen offset:1024 sc1
    v_mfma_f32_32x32x16_bf16 v[176:191], a[76:79], v[120:123], v[176:191]
    s_waitcnt vmcnt(11)
    v_mfma_f32_32x32x16_bf16 v[192:207], a[72:75], v[124:127], v[192:207]
    buffer_load_dwordx4 v[172:175], v29, s[32:35], s63 offen offset:1024 sc1
    v_mfma_f32_32x32x16_bf16 v[208:223], a[76:79], v[124:127], v[208:223]
    s_waitcnt vmcnt(11)
    v_mfma_f32_32x32x16_bf16 v[240:255], a[80:83], v[128:131], v[240:255]
    buffer_load_dwordx4 v[48:51], v28, s[32:35], s64 offen offset:0 sc1
    v_mfma_f32_32x32x16_bf16 v[176:191], a[84:87], v[128:131], v[176:191]
    s_waitcnt vmcnt(11)
    v_mfma_f32_32x32x16_bf16 v[192:207], a[80:83], v[132:135], v[192:207]
    buffer_load_dwordx4 v[52:55], v29, s[32:35], s64 offen offset:0 sc1
    v_mfma_f32_32x32x16_bf16 v[208:223], a[84:87], v[132:135], v[208:223]
    s_waitcnt vmcnt(11)
    v_mfma_f32_32x32x16_bf16 v[240:255], a[88:91], v[136:139], v[240:255]
    buffer_load_dwordx4 v[56:59], v28, s[32:35], s64 offen offset:1024 sc1
    v_mfma_f32_32x32x16_bf16 v[176:191], a[92:95], v[136:139], v[176:191]
    s_waitcnt vmcnt(11)
    v_mfma_f32_32x32x16_bf16 v[192:207], a[88:91], v[140:143], v[192:207]
    buffer_load_dwordx4 v[60:63], v29, s[32:35], s64 offen offset:1024 sc1
    v_mfma_f32_32x32x16_bf16 v[208:223], a[92:95], v[140:143], v[208:223]
    s_waitcnt vmcnt(11)
    v_mfma_f32_32x32x16_bf16 v[240:255], a[96:99], v[144:147], v[240:255]
    buffer_load_dwordx4 v[64:67], v28, s[32:35], s65 offen offset:0 sc1
    v_mfma_f32_32x32x16_bf16 v[176:191], a[100:103], v[144:147], v[176:191]
    s_waitcnt vmcnt(11)
    v_mfma_f32_32x32x16_bf16 v[192:207], a[96:99], v[148:151], v[192:207]
    buffer_load_dwordx4 v[68:71], v29, s[32:35], s65 offen offset:0 sc1
    v_mfma_f32_32x32x16_bf16 v[208:223], a[100:103], v[148:151], v[208:223]
    s_waitcnt vmcnt(11)
    v_mfma_f32_32x32x16_bf16 v[240:255], a[104:107], v[152:155], v[240:255]
    buffer_load_dwordx4 v[72:75], v28, s[32:35], s65 offen offset:1024 sc1
    v_mfma_f32_32x32x16_bf16 v[176:191], a[108:111], v[152:155], v[176:191]
    s_waitcnt vmcnt(11)
    v_mfma_f32_32x32x16_bf16 v[192:207], a[104:107], v[156:159], v[192:207]
    buffer_load_dwordx4 v[76:79], v29, s[32:35], s65 offen offset:1024 sc1
    v_mfma_f32_32x32x16_bf16 v[208:223], a[108:111], v[156:159], v[208:223]
    s_waitcnt vmcnt(11)
    v_mfma_f32_32x32x16_bf16 v[240:255], a[112:115], v[160:163], v[240:255]
    buffer_load_dwordx4 v[80:83], v28, s[32:35], s66 offen offset:0 sc1
    v_mfma_f32_32x32x16_bf16 v[176:191], a[116:119], v[160:163], v[176:191]
    s_waitcnt vmcnt(11)
    v_mfma_f32_32x32x16_bf16 v[192:207], a[112:115], v[164:167], v[192:207]
    buffer_load_dwordx4 v[84:87], v29, s[32:35], s66 offen offset:0 sc1
    v_mfma_f32_32x32x16_bf16 v[208:223], a[116:119], v[164:167], v[208:223]
    s_waitcnt vmcnt(11)
    v_mfma_f32_32x32x16_bf16 v[240:255], a[120:123], v[168:171], v[240:255]
    buffer_load_dwordx4 v[88:91], v28, s[32:35], s66 offen offset:1024 sc1
    v_mfma_f32_32x32x16_bf16 v[176:191], a[124:127], v[168:171], v[176:191]
    s_waitcnt vmcnt(11)
    v_mfma_f32_32x32x16_bf16 v[192:207], a[120:123], v[172:175], v[192:207]
    buffer_load_dwordx4 v[92:95], v29, s[32:35], s66 offen offset:1024 sc1
    v_mfma_f32_32x32x16_bf16 v[208:223], a[124:127], v[172:175], v[208:223]
    s_waitcnt vmcnt(11)
    v_mfma_f32_32x32x16_bf16 v[240:255], a[128:131], v[48:51], v[240:255]
    buffer_load_dwordx4 v[96:99], v28, s[32:35], s67 offen offset:0 sc1
    v_mfma_f32_32x32x16_bf16 v[176:191], a[132:135], v[48:51], v[176:191]
    s_waitcnt vmcnt(11)
    v_mfma_f32_32x32x16_bf16 v[192:207], a[128:131], v[52:55], v[192:207]
    buffer_load_dwordx4 v[100:103], v29, s[32:35], s67 offen offset:0 sc1
    v_mfma_f32_32x32x16_bf16 v[208:223], a[132:135], v[52:55], v[208:223]
    s_waitcnt vmcnt(11)
    v_mfma_f32_32x32x16_bf16 v[240:255], a[136:139], v[56:59], v[240:255]
    buffer_load_dwordx4 v[104:107], v28, s[32:35], s67 offen offset:1024 sc1
    v_mfma_f32_32x32x16_bf16 v[176:191], a[140:143], v[56:59], v[176:191]
    s_waitcnt vmcnt(11)
    v_mfma_f32_32x32x16_bf16 v[192:207], a[136:139], v[60:63], v[192:207]
    buffer_load_dwordx4 v[108:111], v29, s[32:35], s67 offen offset:1024 sc1
    v_mfma_f32_32x32x16_bf16 v[208:223], a[140:143], v[60:63], v[208:223]
    s_waitcnt vmcnt(11)
    v_mfma_f32_32x32x16_bf16 v[240:255], a[144:147], v[64:67], v[240:255]
    buffer_load_dwordx4 v[112:115], v28, s[32:35], s68 offen offset:0 sc1
    v_mfma_f32_32x32x16_bf16 v[176:191], a[148:151], v[64:67], v[176:191]
    s_waitcnt vmcnt(11)
    v_mfma_f32_32x32x16_bf16 v[192:207], a[144:147], v[68:71], v[192:207]
    buffer_load_dwordx4 v[116:119], v29, s[32:35], s68 offen offset:0 sc1
    v_mfma_f32_32x32x16_bf16 v[208:223], a[148:151], v[68:71], v[208:223]
    s_waitcnt vmcnt(11)
    v_mfma_f32_32x32x16_bf16 v[240:255], a[152:155], v[72:75], v[240:255]
    buffer_load_dwordx4 v[120:123], v28, s[32:35], s68 offen offset:1024 sc1
    v_mfma_f32_32x32x16_bf16 v[176:191], a[156:159], v[72:75], v[176:191]
    s_waitcnt vmcnt(11)
    v_mfma_f32_32x32x16_bf16 v[192:207], a[152:155], v[76:79], v[192:207]
    buffer_load_dwordx4 v[124:127], v29, s[32:35], s68 offen offset:1024 sc1
    v_mfma_f32_32x32x16_bf16 v[208:223], a[156:159], v[76:79], v[208:223]
    s_waitcnt vmcnt(11)
    v_mfma_f32_32x32x16_bf16 v[240:255], a[160:163], v[80:83], v[240:255]
    buffer_load_dwordx4 v[128:131], v28, s[32:35], s69 offen offset:0 sc1
    v_and_b32 v8, 31, v1
    v_lshlrev_b32 v8, 8, v8
    s_lshl_b32 s98, s41, 13
    s_lshl2_add_u32 s98, s5, s98
    s_add_u32 s98, s98, 16384
    v_add_u32 v8, s98, v8
    v_and_b32 v9, 7, v1
    v_xor_b32 v9, v9, v13
    s_lshl_b32 s98, s40, 3
    v_xor_b32 v9, s98, v9
    v_lshl_add_u32 v224, v9, 4, v8
    v_xor_b32 v225, 32, v224
    v_xor_b32 v226, 64, v224
    v_xor_b32 v227, 96, v224
    v_xor_b32 v228, 128, v224
    v_xor_b32 v229, 160, v224
    v_xor_b32 v230, 192, v224
    v_xor_b32 v231, 224, v224
    v_xor_b32 v232, 8192, v224
    v_xor_b32 v233, 8192, v225
    v_xor_b32 v234, 8192, v226
    v_xor_b32 v235, 8192, v227
    v_xor_b32 v236, 8192, v228
    v_xor_b32 v237, 8192, v229
    v_xor_b32 v238, 8192, v230
    v_xor_b32 v239, 8192, v231
    v_lshrrev_b32 v8, 3, v1
    v_and_b32 v9, 7, v1
    v_lshlrev_b32 v4, 1, v9
    v_xor_b32 v4, v4, v8
    v_lshlrev_b32 v4, 4, v4
    v_lshl_add_u32 v4, v8, 8, v4
    s_add_u32 s98, s5, 16384
    v_add_u32 v6, s98, v4
    v_xor_b32 v7, 16, v6
    v_lshlrev_b32 v9, 4, v9
    v_lshl_add_u32 v9, v8, 10, v9
    v_add_u32 v15, s83, v9
    s_mov_b32 s98, 8192
    v_mfma_f32_32x32x16_bf16 v[176:191], a[164:167], v[80:83], v[176:191]
    s_waitcnt vmcnt(11)
    v_mfma_f32_32x32x16_bf16 v[192:207], a[160:163], v[84:87], v[192:207]
    buffer_load_dwordx4 v[132:135], v29, s[32:35], s69 offen offset:0 sc1
    v_mfma_f32_32x32x16_bf16 v[208:223], a[164:167], v[84:87], v[208:223]
    s_waitcnt vmcnt(11)
    v_mfma_f32_32x32x16_bf16 v[240:255], a[168:171], v[88:91], v[240:255]
    buffer_load_dwordx4 v[136:139], v28, s[32:35], s69 offen offset:1024 sc1
    v_mfma_f32_32x32x16_bf16 v[176:191], a[172:175], v[88:91], v[176:191]
    s_waitcnt vmcnt(11)
    v_mfma_f32_32x32x16_bf16 v[192:207], a[168:171], v[92:95], v[192:207]
    buffer_load_dwordx4 v[140:143], v29, s[32:35], s69 offen offset:1024 sc1
    v_mfma_f32_32x32x16_bf16 v[208:223], a[172:175], v[92:95], v[208:223]
    s_waitcnt vmcnt(11)
    v_mfma_f32_32x32x16_bf16 v[240:255], a[176:179], v[96:99], v[240:255]
    v_mfma_f32_32x32x16_bf16 v[176:191], a[180:183], v[96:99], v[176:191]
    s_waitcnt vmcnt(10)
    v_mfma_f32_32x32x16_bf16 v[192:207], a[176:179], v[100:103], v[192:207]
    v_mfma_f32_32x32x16_bf16 v[208:223], a[180:183], v[100:103], v[208:223]
    s_waitcnt vmcnt(9)
    v_mfma_f32_32x32x16_bf16 v[240:255], a[184:187], v[104:107], v[240:255]
    v_mfma_f32_32x32x16_bf16 v[176:191], a[188:191], v[104:107], v[176:191]
    s_waitcnt vmcnt(8)
    v_mfma_f32_32x32x16_bf16 v[192:207], a[184:187], v[108:111], v[192:207]
    v_mfma_f32_32x32x16_bf16 v[208:223], a[188:191], v[108:111], v[208:223]
    s_waitcnt vmcnt(6)
    v_mfma_f32_32x32x16_bf16 v[208:223], a[196:199], v[116:119], v[208:223]
    s_waitcnt vmcnt(4)
    v_mfma_f32_32x32x16_bf16 v[208:223], a[204:207], v[124:127], v[208:223]
    s_waitcnt vmcnt(2)
    v_mfma_f32_32x32x16_bf16 v[208:223], a[212:215], v[132:135], v[208:223]
    s_waitcnt vmcnt(0)
    v_mfma_f32_32x32x16_bf16 v[208:223], a[220:223], v[140:143], v[208:223]
    v_mfma_f32_32x32x16_bf16 v[192:207], a[192:195], v[116:119], v[192:207]
    v_mfma_f32_32x32x16_bf16 v[192:207], a[200:203], v[124:127], v[192:207]
    s_nop 9
    ds_write_b128 v236, v[208:211]
    ds_write_b128 v237, v[212:215]
    v_mfma_f32_32x32x16_bf16 v[192:207], a[208:211], v[132:135], v[192:207]
    ds_write_b128 v238, v[216:219]
    ds_write_b128 v239, v[220:223]
    v_mfma_f32_32x32x16_bf16 v[192:207], a[216:219], v[140:143], v[192:207]
    v_mfma_f32_32x32x16_bf16 v[176:191], a[196:199], v[112:115], v[176:191]
    v_mfma_f32_32x32x16_bf16 v[176:191], a[204:207], v[120:123], v[176:191]
    s_nop 9
    ds_write_b128 v232, v[192:195]
    ds_write_b128 v233, v[196:199]
    v_mfma_f32_32x32x16_bf16 v[176:191], a[212:215], v[128:131], v[176:191]
    ds_write_b128 v234, v[200:203]
    ds_write_b128 v235, v[204:207]
    v_mfma_f32_32x32x16_bf16 v[176:191], a[220:223], v[136:139], v[176:191]
    v_mfma_f32_32x32x16_bf16 v[240:255], a[192:195], v[112:115], v[240:255]
    v_mfma_f32_32x32x16_bf16 v[240:255], a[200:203], v[120:123], v[240:255]
    s_nop 9
    ds_write_b128 v228, v[176:179]
    ds_write_b128 v229, v[180:183]
    v_mfma_f32_32x32x16_bf16 v[240:255], a[208:211], v[128:131], v[240:255]
    ds_write_b128 v230, v[184:187]
    ds_write_b128 v231, v[188:191]
    v_mfma_f32_32x32x16_bf16 v[240:255], a[216:219], v[136:139], v[240:255]
    s_nop 11
    ds_write_b128 v224, v[240:243]
    ds_write_b128 v225, v[244:247]
    ds_write_b128 v226, v[248:251]
    ds_write_b128 v227, v[252:255]
    s_waitcnt lgkmcnt(0)
    s_barrier
    ds_read_b128 v[48:51], v6 offset:0
    ds_read_b128 v[52:55], v7 offset:0
    ds_read_b128 v[56:59], v6 offset:16384
    ds_read_b128 v[60:63], v7 offset:16384
    ds_read_b128 v[64:67], v6 offset:32768
    ds_read_b128 v[68:71], v7 offset:32768
    ds_read_b128 v[72:75], v6 offset:49152
    ds_read_b128 v[76:79], v7 offset:49152
    ds_read_b128 v[80:83], v6 offset:2048
    ds_read_b128 v[84:87], v7 offset:2048
    ds_read_b128 v[88:91], v6 offset:18432
    ds_read_b128 v[92:95], v7 offset:18432
    ds_read_b128 v[96:99], v6 offset:34816
    ds_read_b128 v[100:103], v7 offset:34816
    ds_read_b128 v[104:107], v6 offset:51200
    ds_read_b128 v[108:111], v7 offset:51200
    s_waitcnt lgkmcnt(13)
    v_pk_add_f32 v[48:49], v[48:49], v[56:57]
    s_waitcnt lgkmcnt(9)
    v_pk_add_f32 v[64:65], v[64:65], v[72:73]
    v_pk_add_f32 v[50:51], v[50:51], v[58:59]
    v_pk_add_f32 v[66:67], v[66:67], v[74:75]
    v_pk_add_f32 v[52:53], v[52:53], v[60:61]
    s_waitcnt lgkmcnt(8)
    v_pk_add_f32 v[68:69], v[68:69], v[76:77]
    v_pk_add_f32 v[54:55], v[54:55], v[62:63]
    v_pk_add_f32 v[70:71], v[70:71], v[78:79]
    v_pk_add_f32 v[48:49], v[48:49], v[64:65]
    v_pk_add_f32 v[50:51], v[50:51], v[66:67]
    v_pk_add_f32 v[52:53], v[52:53], v[68:69]
    v_pk_add_f32 v[54:55], v[54:55], v[70:71]
    v_cvt_pk_bf16_f32 v56, v48, v49
    v_cvt_pk_bf16_f32 v57, v50, v51
    v_cvt_pk_bf16_f32 v58, v52, v53
    v_cvt_pk_bf16_f32 v59, v54, v55
    buffer_store_dwordx4 v[56:59], v15, s[28:31], 0 offen sc1
    s_waitcnt lgkmcnt(5)
    v_pk_add_f32 v[80:81], v[80:81], v[88:89]
    s_waitcnt lgkmcnt(1)
    v_pk_add_f32 v[96:97], v[96:97], v[104:105]
    v_pk_add_f32 v[82:83], v[82:83], v[90:91]
    v_pk_add_f32 v[98:99], v[98:99], v[106:107]
    v_pk_add_f32 v[84:85], v[84:85], v[92:93]
    s_waitcnt lgkmcnt(0)
    v_pk_add_f32 v[100:101], v[100:101], v[108:109]
    v_pk_add_f32 v[86:87], v[86:87], v[94:95]
    v_pk_add_f32 v[102:103], v[102:103], v[110:111]
    v_pk_add_f32 v[80:81], v[80:81], v[96:97]
    v_pk_add_f32 v[82:83], v[82:83], v[98:99]
    v_pk_add_f32 v[84:85], v[84:85], v[100:101]
    v_pk_add_f32 v[86:87], v[86:87], v[102:103]
    v_cvt_pk_bf16_f32 v88, v80, v81
    v_cvt_pk_bf16_f32 v89, v82, v83
    v_cvt_pk_bf16_f32 v90, v84, v85
    v_cvt_pk_bf16_f32 v91, v86, v87
    buffer_store_dwordx4 v[88:91], v15, s[28:31], s98 offen sc1
    s_cmp_gt_u32 s96, s97
    s_cbranch_scc0 L_end
    v_mov_b32 v4, 16
    v_mov_b32 v5, 0xdead
    global_store_dword v4, v5, s[36:37]
L_end:
    s_endpgm
L_tagsrc:
    s_add_u32 s6, s6, 0x7F4A7C15
    s_cmp_lt_u32 s6, 16
    s_cselect_b32 s6, 0x2545F491, s6
    v_mov_b32 v8, s6
    v_mov_b32 v9, 0
    s_mov_b64 exec, 1
    global_store_dword v9, v8, s[36:37] sc1
    buffer_store_dword v8, v9, s[32:35], 0 offen sc1
    s_mov_b64 exec, -1
    s_branch L_tagsrc_done
L_tagspin:
    global_load_dword v12, v17, s[36:37] sc1
    s_add_u32 s96, s96, 1
    s_cmp_gt_u32 s96, s97
    s_waitcnt vmcnt(0)
    s_cbranch_scc1 L_tagok
    v_cmp_eq_u32 vcc, 0, v12
    s_nop 1
    s_cbranch_vccnz L_tagspin
    s_branch L_tagok
L_xccspin:
    buffer_load_dword v11, v9, s[32:35], s87 offen sc1
    s_add_u32 s96, s96, 1
    s_cmp_gt_u32 s96, s97
    s_waitcnt vmcnt(0)
    v_xor_b32 v11, s6, v11
    s_cbranch_scc1 L_xccok
    v_cmp_le_u32 vcc, 16, v11
    s_nop 1
    s_cbranch_vccnz L_xccspin
    s_branch L_xccok
L_slow0:
    s_nop 4
    buffer_store_dword v12, v3, s[32:35], s49 offen sc1
    s_nop 1
    s_branch L_back0
L_aspin0:
    buffer_load_dword v25, v24, s[32:35], s51 offen offset:0 sc1
    s_add_u32 s96, s96, 1
    s_cmp_gt_u32 s96, s97
    s_waitcnt vmcnt(0)
    s_cbranch_scc1 L_aok0
    v_cmp_ne_u32 vcc, s6, v25
    s_nop 1
    s_cbranch_vccnz L_aspin0
    s_branch L_aok0
L_slow1:
    s_nop 4
    buffer_store_dword v12, v3, s[32:35], s55 offen sc1
    s_nop 1
    s_branch L_back1
L_csspin:
    buffer_load_dwordx2 v[120:121], v23, s[32:35], s47 offen offset:0 sc1
    buffer_load_dwordx2 v[122:123], v23, s[32:35], s47 offen offset:512 sc1
    buffer_load_dwordx2 v[124:125], v23, s[32:35], s47 offen offset:1024 sc1
    buffer_load_dwordx2 v[126:127], v23, s[32:35], s47 offen offset:1536 sc1
    s_add_u32 s96, s96, 1
    s_cmp_gt_u32 s96, s97
    s_waitcnt vmcnt(0)
    s_cbranch_scc1 L_csok
    v_min3_u32 v8, v121, v123, v125
    v_max3_u32 v9, v121, v123, v125
    v_min3_u32 v8, v127, v127, v8
    v_max3_u32 v9, v127, v127, v9
    v_xor_b32 v8, s6, v8
    v_xor_b32 v9, s6, v9
    v_or_b32 v8, v8, v9
    v_cmp_ne_u32 vcc, 0, v8
    s_nop 0
    s_cbranch_vccnz L_csspin
    s_branch L_csok
L_slow2:
    s_nop 4
    buffer_store_dword v12, v3, s[32:35], s80 offen offset:0 sc1
    s_nop 1
    s_branch L_back2
L_idle:
    s_waitcnt vmcnt(0) lgkmcnt(0)
    v_and_b32 v4, 31, v1
    v_lshlrev_b32 v4, 7, v4
    v_mul_u32_u24 v7, 229376, v13
    v_add_u32 v4, v4, v7
L_idle_go:
    s_mov_b32 s98, s3
L_idle_t:
    s_mul_i32 s99, s98, 4682
    s_lshr_b32 s99, s99, 16
    s_mul_i32 s100, s99, 14
    s_sub_u32 s100, s98, s100
    s_lshl2_add_u32 s99, s100, s99
    s_lshl_b32 s99, s99, 12
    s_add_u32 s99, s99, s81
    buffer_load_dword v6, v4, s[32:35], s99 offen sc1
    s_add_u32 s98, s98, 4
    s_cmp_lt_u32 s98, 56
    s_cbranch_scc1 L_idle_t
    s_lshl1_add_u32 s43, s58, s52
    buffer_load_dwordx4 a[40:43], v16, s[32:35], s43 offen offset:2048 sc1
    buffer_load_dwordx4 a[44:47], v17, s[32:35], s43 offen offset:2048 sc1
    s_lshl1_add_u32 s43, s59, s52
    buffer_load_dwordx4 a[48:51], v16, s[32:35], s43 offen offset:0 sc1
    buffer_load_dwordx4 a[52:55], v17, s[32:35], s43 offen offset:0 sc1
    buffer_load_dwordx4 a[56:59], v16, s[32:35], s43 offen offset:2048 sc1
    buffer_load_dwordx4 a[60:63], v17, s[32:35], s43 offen offset:2048 sc1
    s_lshl1_add_u32 s43, s60, s52
    buffer_load_dwordx4 a[64:67], v16, s[32:35], s43 offen offset:0 sc1
    buffer_load_dwordx4 a[68:71], v17, s[32:35], s43 offen offset:0 sc1
    buffer_load_dwordx4 a[72:75], v16, s[32:35], s43 offen offset:2048 sc1
    buffer_load_dwordx4 a[76:79], v17, s[32:35], s43 offen offset:2048 sc1
    s_lshl1_add_u32 s43, s61, s52
    buffer_load_dwordx4 a[80:83], v16, s[32:35], s43 offen offset:0 sc1
    buffer_load_dwordx4 a[84:87], v17, s[32:35], s43 offen offset:0 sc1
    buffer_load_dwordx4 a[88:91], v16, s[32:35], s43 offen offset:2048 sc1
    buffer_load_dwordx4 a[92:95], v17, s[32:35], s43 offen offset:2048 sc1
    s_lshl1_add_u32 s43, s62, s52
    buffer_load_dwordx4 a[96:99], v16, s[32:35], s43 offen offset:0 sc1
    buffer_load_dwordx4 a[100:103], v17, s[32:35], s43 offen offset:0 sc1
    buffer_load_dwordx4 a[104:107], v16, s[32:35], s43 offen offset:2048 sc1
    buffer_load_dwordx4 a[108:111], v17, s[32:35], s43 offen offset:2048 sc1
    s_lshl1_add_u32 s43, s63, s52
    buffer_load_dwordx4 a[112:115], v16, s[32:35], s43 offen offset:0 sc1
    buffer_load_dwordx4 a[116:119], v17, s[32:35], s43 offen offset:0 sc1
    buffer_load_dwordx4 a[120:123], v16, s[32:35], s43 offen offset:2048 sc1
    buffer_load_dwordx4 a[124:127], v17, s[32:35], s43 offen offset:2048 sc1
    s_lshl1_add_u32 s43, s64, s52
    buffer_load_dwordx4 a[128:131], v16, s[32:35], s43 offen offset:0 sc1
    buffer_load_dwordx4 a[132:135], v17, s[32:35], s43 offen offset:0 sc1
    buffer_load_dwordx4 a[136:139], v16, s[32:35], s43 offen offset:2048 sc1
    buffer_load_dwordx4 a[140:143], v17, s[32:35], s43 offen offset:2048 sc1
    s_lshl1_add_u32 s43, s65, s52
    buffer_load_dwordx4 a[144:147], v16, s[32:35], s43 offen offset:0 sc1
    buffer_load_dwordx4 a[148:151], v17, s[32:35], s43 offen offset:0 sc1
    buffer_load_dwordx4 a[152:155], v16, s[32:35], s43 offen offset:2048 sc1
    buffer_load_dwordx4 a[156:159], v17, s[32:35], s43 offen offset:2048 sc1
    s_lshl1_add_u32 s43, s66, s52
    buffer_load_dwordx4 a[160:163], v16, s[32:35], s43 offen offset:0 sc1
    buffer_load_dwordx4 a[164:167], v17, s[32:35], s43 offen offset:0 sc1
    buffer_load_dwordx4 a[168:171], v16, s[32:35], s43 offen offset:2048 sc1
    buffer_load_dwordx4 a[172:175], v17, s[32:35], s43 offen offset:2048 sc1
    s_lshl1_add_u32 s43, s67, s52
    buffer_load_dwordx4 a[176:179], v16, s[32:35], s43 offen offset:0 sc1
    buffer_load_dwordx4 a[180:183], v17, s[32:35], s43 offen offset:0 sc1
    buffer_load_dwordx4 a[184:187], v16, s[32:35], s43 offen offset:2048 sc1
    buffer_load_dwordx4 a[188:191], v17, s[32:35], s43 offen offset:2048 sc1
    s_lshl1_add_u32 s43, s68, s52
    buffer_load_dwordx4 a[192:195], v16, s[32:35], s43 offen offset:0 sc1
    buffer_load_dwordx4 a[196:199], v17, s[32:35], s43 offen offset:0 sc1
    buffer_load_dwordx4 a[200:203], v16, s[32:35], s43 offen offset:2048 sc1
    buffer_load_dwordx4 a[204:207], v17, s[32:35], s43 offen offset:2048 sc1
    s_lshl1_add_u32 s43, s69, s52
    buffer_load_dwordx4 a[208:211], v16, s[32:35], s43 offen offset:0 sc1
    buffer_load_dwordx4 a[212:215], v17, s[32:35], s43 offen offset:0 sc1
    buffer_load_dwordx4 a[216:219], v16, s[32:35], s43 offen offset:2048 sc1
    buffer_load_dwordx4 a[220:223], v17, s[32:35], s43 offen offset:2048 sc1
L_idle_a:
    buffer_load_dword v10, v5, s[32:35], s82 offen sc1
    s_add_u32 s96, s96, 1
    s_cmp_gt_u32 s96, s97
    s_waitcnt vmcnt(0)
    s_cbranch_scc1 L_idle_b
    v_cmp_ne_u32 vcc, s6, v10
    s_nop 0
    s_cbranch_vccnz L_idle_a
L_idle_b:
    s_waitcnt vmcnt(0)
    s_branch L_aok
L_codeend:
L_fallback:
    s_nop 15
    v_mov_b32 v4, 0xff800000
    v_mfma_f32_32x32x16_bf16 v[48:63], a[224:227], a[248:251], v[160:175]
    s_nop 11
    v_max3_f32 v4, v48, v49, v4
    v_max3_f32 v4, v50, v51, v4
    v_max3_f32 v4, v52, v53, v4
    v_max3_f32 v4, v54, v55, v4
    v_max3_f32 v4, v56, v57, v4
    v_max3_f32 v4, v58, v59, v4
    v_max3_f32 v4, v60, v61, v4
    v_max3_f32 v4, v62, v63, v4
    s_nop 7
L_fb_a0_8:
    s_cmp_lt_u32 s4, 1
    s_cbranch_scc1 L_fb_a0_7
    v_mfma_f32_32x32x16_bf16 v[48:63], v[156:159], a[248:251], 0
    s_nop 11
    v_max3_f32 v4, v48, v49, v4
    v_max3_f32 v4, v50, v51, v4
    v_max3_f32 v4, v52, v53, v4
    v_max3_f32 v4, v54, v55, v4
    v_max3_f32 v4, v56, v57, v4
    v_max3_f32 v4, v58, v59, v4
    v_max3_f32 v4, v60, v61, v4
    v_max3_f32 v4, v62, v63, v4
    s_nop 7
L_fb_a0_7:
    s_cmp_lt_u32 s4, 1
    s_cbranch_scc1 L_fb_a0_6
    v_mfma_f32_32x32x16_bf16 v[48:63], v[152:155], a[248:251], 0
    s_nop 11
    v_max3_f32 v4, v48, v49, v4
    v_max3_f32 v4, v50, v51, v4
    v_max3_f32 v4, v52, v53, v4
    v_max3_f32 v4, v54, v55, v4
    v_max3_f32 v4, v56, v57, v4
    v_max3_f32 v4, v58, v59, v4
    v_max3_f32 v4, v60, v61, v4
    v_max3_f32 v4, v62, v63, v4
    s_nop 7
L_fb_a0_6:
    s_cmp_lt_u32 s4, 2
    s_cbranch_scc1 L_fb_a0_5
    v_mfma_f32_32x32x16_bf16 v[48:63], v[148:151], a[248:251], 0
    s_nop 11
    v_max3_f32 v4, v48, v49, v4
    v_max3_f32 v4, v50, v51, v4
    v_max3_f32 v4, v52, v53, v4
    v_max3_f32 v4, v54, v55, v4
    v_max3_f32 v4, v56, v57, v4
    v_max3_f32 v4, v58, v59, v4
    v_max3_f32 v4, v60, v61, v4
    v_max3_f32 v4, v62, v63, v4
    s_nop 7
L_fb_a0_5:
    s_cmp_lt_u32 s4, 2
    s_cbranch_scc1 L_fb_a0_4
    v_mfma_f32_32x32x16_bf16 v[48:63], v[144:147], a[248:251], 0
    s_nop 11
    v_max3_f32 v4, v48, v49, v4
    v_max3_f32 v4, v50, v51, v4
    v_max3_f32 v4, v52, v53, v4
    v_max3_f32 v4, v54, v55, v4
    v_max3_f32 v4, v56, v57, v4
    v_max3_f32 v4, v58, v59, v4
    v_max3_f32 v4, v60, v61, v4
    v_max3_f32 v4, v62, v63, v4
    s_nop 7
L_fb_a0_4:
    s_cmp_lt_u32 s4, 3
    s_cbranch_scc1 L_fb_a0_3
    v_mfma_f32_32x32x16_bf16 v[48:63], v[140:143], a[248:251], 0
    s_nop 11
    v_max3_f32 v4, v48, v49, v4
    v_max3_f32 v4, v50, v51, v4
    v_max3_f32 v4, v52, v53, v4
    v_max3_f32 v4, v54, v55, v4
    v_max3_f32 v4, v56, v57, v4
    v_max3_f32 v4, v58, v59, v4
    v_max3_f32 v4, v60, v61, v4
    v_max3_f32 v4, v62, v63, v4
    s_nop 7
L_fb_a0_3:
    s_cmp_lt_u32 s4, 3
    s_cbranch_scc1 L_fb_a0_2
    v_mfma_f32_32x32x16_bf16 v[48:63], v[136:139], a[248:251], 0
    s_nop 11
    v_max3_f32 v4, v48, v49, v4
    v_max3_f32 v4, v50, v51, v4
    v_max3_f32 v4, v52, v53, v4
    v_max3_f32 v4, v54, v55, v4
    v_max3_f32 v4, v56, v57, v4
    v_max3_f32 v4, v58, v59, v4
    v_max3_f32 v4, v60, v61, v4
    v_max3_f32 v4, v62, v63, v4
    s_nop 7
L_fb_a0_2:
    s_cmp_lt_u32 s4, 4
    s_cbranch_scc1 L_fb_a0_1
    v_mfma_f32_32x32x16_bf16 v[48:63], v[132:135], a[248:251], 0
    s_nop 11
    v_max3_f32 v4, v48, v49, v4
    v_max3_f32 v4, v50, v51, v4
    v_max3_f32 v4, v52, v53, v4
    v_max3_f32 v4, v54, v55, v4
    v_max3_f32 v4, v56, v57, v4
    v_max3_f32 v4, v58, v59, v4
    v_max3_f32 v4, v60, v61, v4
    v_max3_f32 v4, v62, v63, v4
    s_nop 7
L_fb_a0_1:
    s_cmp_lt_u32 s4, 4
    s_cbranch_scc1 L_fb_a0_0
    v_mfma_f32_32x32x16_bf16 v[48:63], v[128:131], a[248:251], v[176:191]
    s_nop 11
    v_max3_f32 v4, v48, v49, v4
    v_max3_f32 v4, v50, v51, v4
    v_max3_f32 v4, v52, v53, v4
    v_max3_f32 v4, v54, v55, v4
    v_max3_f32 v4, v56, v57, v4
    v_max3_f32 v4, v58, v59, v4
    v_max3_f32 v4, v60, v61, v4
    v_max3_f32 v4, v62, v63, v4
    s_nop 7
L_fb_a0_0:
    v_mov_b32 v5, v4
    s_nop 1
    v_permlane32_swap_b32 v4, v5
    v_max_f32 v4, v4, v5
    v_mov_b32 v80, 0
    v_mov_b32 v81, 0
    v_mov_b32 v82, 0
    v_mov_b32 v83, 0
    v_mov_b32 v84, 0
    v_mov_b32 v85, 0
    v_mov_b32 v86, 0
    v_mov_b32 v87, 0
    v_mov_b32 v88, 0
    v_mov_b32 v89, 0
    v_mov_b32 v90, 0
    v_mov_b32 v91, 0
    v_mov_b32 v92, 0
    v_mov_b32 v93, 0
    v_mov_b32 v94, 0
    v_mov_b32 v95, 0
    v_mfma_f32_32x32x16_bf16 v[48:63], a[224:227], a[248:251], v[160:175]
    s_nop 11
    v_sub_f32 v48, v48, v4
    v_sub_f32 v49, v49, v4
    v_sub_f32 v50, v50, v4
    v_sub_f32 v51, v51, v4
    v_sub_f32 v52, v52, v4
    v_sub_f32 v53, v53, v4
    v_sub_f32 v54, v54, v4
    v_sub_f32 v55, v55, v4
    v_sub_f32 v56, v56, v4
    v_sub_f32 v57, v57, v4
    v_sub_f32 v58, v58, v4
    v_sub_f32 v59, v59, v4
    v_sub_f32 v60, v60, v4
    v_sub_f32 v61, v61, v4
    v_sub_f32 v62, v62, v4
    v_sub_f32 v63, v63, v4
    v_exp_f32 v48, v48
    v_exp_f32 v49, v49
    v_exp_f32 v50, v50
    v_exp_f32 v51, v51
    v_exp_f32 v52, v52
    v_exp_f32 v53, v53
    v_exp_f32 v54, v54
    v_exp_f32 v55, v55
    v_exp_f32 v56, v56
    v_exp_f32 v57, v57
    v_exp_f32 v58, v58
    v_exp_f32 v59, v59
    v_exp_f32 v60, v60
    v_exp_f32 v61, v61
    v_exp_f32 v62, v62
    v_exp_f32 v63, v63
    v_cvt_pk_bf16_f32 v112, v48, v49
    v_cvt_pk_bf16_f32 v113, v50, v51
    v_cvt_pk_bf16_f32 v114, v52, v53
    v_cvt_pk_bf16_f32 v115, v54, v55
    v_cvt_pk_bf16_f32 v116, v56, v57
    v_cvt_pk_bf16_f32 v117, v58, v59
    v_cvt_pk_bf16_f32 v118, v60, v61
    v_cvt_pk_bf16_f32 v119, v62, v63
    v_mfma_f32_32x32x16_bf16 v[80:95], a[232:235], v[112:115], v[80:95]
    s_nop 0
    v_mfma_f32_32x32x16_bf16 v[80:95], a[236:239], v[116:119], v[80:95]
    s_nop 15
L_fb_b0_8:
    s_cmp_lt_u32 s4, 1
    s_cbranch_scc1 L_fb_b0_7
    v_mfma_f32_32x32x16_bf16 v[48:63], v[156:159], a[248:251], 0
    s_nop 11
    v_sub_f32 v48, v48, v4
    v_sub_f32 v49, v49, v4
    v_sub_f32 v50, v50, v4
    v_sub_f32 v51, v51, v4
    v_sub_f32 v52, v52, v4
    v_sub_f32 v53, v53, v4
    v_sub_f32 v54, v54, v4
    v_sub_f32 v55, v55, v4
    v_sub_f32 v56, v56, v4
    v_sub_f32 v57, v57, v4
    v_sub_f32 v58, v58, v4
    v_sub_f32 v59, v59, v4
    v_sub_f32 v60, v60, v4
    v_sub_f32 v61, v61, v4
    v_sub_f32 v62, v62, v4
    v_sub_f32 v63, v63, v4
    v_exp_f32 v48, v48
    v_exp_f32 v49, v49
    v_exp_f32 v50, v50
    v_exp_f32 v51, v51
    v_exp_f32 v52, v52
    v_exp_f32 v53, v53
    v_exp_f32 v54, v54
    v_exp_f32 v55, v55
    v_exp_f32 v56, v56
    v_exp_f32 v57, v57
    v_exp_f32 v58, v58
    v_exp_f32 v59, v59
    v_exp_f32 v60, v60
    v_exp_f32 v61, v61
    v_exp_f32 v62, v62
    v_exp_f32 v63, v63
    v_cvt_pk_bf16_f32 v112, v48, v49
    v_cvt_pk_bf16_f32 v113, v50, v51
    v_cvt_pk_bf16_f32 v114, v52, v53
    v_cvt_pk_bf16_f32 v115, v54, v55
    v_cvt_pk_bf16_f32 v116, v56, v57
    v_cvt_pk_bf16_f32 v117, v58, v59
    v_cvt_pk_bf16_f32 v118, v60, v61
    v_cvt_pk_bf16_f32 v119, v62, v63
    v_mfma_f32_32x32x16_bf16 v[80:95], v[248:251], v[112:115], v[80:95]
    s_nop 0
    v_mfma_f32_32x32x16_bf16 v[80:95], v[252:255], v[116:119], v[80:95]
    s_nop 15
L_fb_b0_7:
    s_cmp_lt_u32 s4, 1
    s_cbranch_scc1 L_fb_b0_6
    v_mfma_f32_32x32x16_bf16 v[48:63], v[152:155], a[248:251], 0
    s_nop 11
    v_sub_f32 v48, v48, v4
    v_sub_f32 v49, v49, v4
    v_sub_f32 v50, v50, v4
    v_sub_f32 v51, v51, v4
    v_sub_f32 v52, v52, v4
    v_sub_f32 v53, v53, v4
    v_sub_f32 v54, v54, v4
    v_sub_f32 v55, v55, v4
    v_sub_f32 v56, v56, v4
    v_sub_f32 v57, v57, v4
    v_sub_f32 v58, v58, v4
    v_sub_f32 v59, v59, v4
    v_sub_f32 v60, v60, v4
    v_sub_f32 v61, v61, v4
    v_sub_f32 v62, v62, v4
    v_sub_f32 v63, v63, v4
    v_exp_f32 v48, v48
    v_exp_f32 v49, v49
    v_exp_f32 v50, v50
    v_exp_f32 v51, v51
    v_exp_f32 v52, v52
    v_exp_f32 v53, v53
    v_exp_f32 v54, v54
    v_exp_f32 v55, v55
    v_exp_f32 v56, v56
    v_exp_f32 v57, v57
    v_exp_f32 v58, v58
    v_exp_f32 v59, v59
    v_exp_f32 v60, v60
    v_exp_f32 v61, v61
    v_exp_f32 v62, v62
    v_exp_f32 v63, v63
    v_cvt_pk_bf16_f32 v112, v48, v49
    v_cvt_pk_bf16_f32 v113, v50, v51
    v_cvt_pk_bf16_f32 v114, v52, v53
    v_cvt_pk_bf16_f32 v115, v54, v55
    v_cvt_pk_bf16_f32 v116, v56, v57
    v_cvt_pk_bf16_f32 v117, v58, v59
    v_cvt_pk_bf16_f32 v118, v60, v61
    v_cvt_pk_bf16_f32 v119, v62, v63
    v_mfma_f32_32x32x16_bf16 v[80:95], v[240:243], v[112:115], v[80:95]
    s_nop 0
    v_mfma_f32_32x32x16_bf16 v[80:95], v[244:247], v[116:119], v[80:95]
    s_nop 15
L_fb_b0_6:
    s_cmp_lt_u32 s4, 2
    s_cbranch_scc1 L_fb_b0_5
    v_mfma_f32_32x32x16_bf16 v[48:63], v[148:151], a[248:251], 0
    s_nop 11
    v_sub_f32 v48, v48, v4
    v_sub_f32 v49, v49, v4
    v_sub_f32 v50, v50, v4
    v_sub_f32 v51, v51, v4
    v_sub_f32 v52, v52, v4
    v_sub_f32 v53, v53, v4
    v_sub_f32 v54, v54, v4
    v_sub_f32 v55, v55, v4
    v_sub_f32 v56, v56, v4
    v_sub_f32 v57, v57, v4
    v_sub_f32 v58, v58, v4
    v_sub_f32 v59, v59, v4
    v_sub_f32 v60, v60, v4
    v_sub_f32 v61, v61, v4
    v_sub_f32 v62, v62, v4
    v_sub_f32 v63, v63, v4
    v_exp_f32 v48, v48
    v_exp_f32 v49, v49
    v_exp_f32 v50, v50
    v_exp_f32 v51, v51
    v_exp_f32 v52, v52
    v_exp_f32 v53, v53
    v_exp_f32 v54, v54
    v_exp_f32 v55, v55
    v_exp_f32 v56, v56
    v_exp_f32 v57, v57
    v_exp_f32 v58, v58
    v_exp_f32 v59, v59
    v_exp_f32 v60, v60
    v_exp_f32 v61, v61
    v_exp_f32 v62, v62
    v_exp_f32 v63, v63
    v_cvt_pk_bf16_f32 v112, v48, v49
    v_cvt_pk_bf16_f32 v113, v50, v51
    v_cvt_pk_bf16_f32 v114, v52, v53
    v_cvt_pk_bf16_f32 v115, v54, v55
    v_cvt_pk_bf16_f32 v116, v56, v57
    v_cvt_pk_bf16_f32 v117, v58, v59
    v_cvt_pk_bf16_f32 v118, v60, v61
    v_cvt_pk_bf16_f32 v119, v62, v63
    v_mfma_f32_32x32x16_bf16 v[80:95], v[232:235], v[112:115], v[80:95]
    s_nop 0
    v_mfma_f32_32x32x16_bf16 v[80:95], v[236:239], v[116:119], v[80:95]
    s_nop 15
L_fb_b0_5:
    s_cmp_lt_u32 s4, 2
    s_cbranch_scc1 L_fb_b0_4
    v_mfma_f32_32x32x16_bf16 v[48:63], v[144:147], a[248:251], 0
    s_nop 11
    v_sub_f32 v48, v48, v4
    v_sub_f32 v49, v49, v4
    v_sub_f32 v50, v50, v4
    v_sub_f32 v51, v51, v4
    v_sub_f32 v52, v52, v4
    v_sub_f32 v53, v53, v4
    v_sub_f32 v54, v54, v4
    v_sub_f32 v55, v55, v4
    v_sub_f32 v56, v56, v4
    v_sub_f32 v57, v57, v4
    v_sub_f32 v58, v58, v4
    v_sub_f32 v59, v59, v4
    v_sub_f32 v60, v60, v4
    v_sub_f32 v61, v61, v4
    v_sub_f32 v62, v62, v4
    v_sub_f32 v63, v63, v4
    v_exp_f32 v48, v48
    v_exp_f32 v49, v49
    v_exp_f32 v50, v50
    v_exp_f32 v51, v51
    v_exp_f32 v52, v52
    v_exp_f32 v53, v53
    v_exp_f32 v54, v54
    v_exp_f32 v55, v55
    v_exp_f32 v56, v56
    v_exp_f32 v57, v57
    v_exp_f32 v58, v58
    v_exp_f32 v59, v59
    v_exp_f32 v60, v60
    v_exp_f32 v61, v61
    v_exp_f32 v62, v62
    v_exp_f32 v63, v63
    v_cvt_pk_bf16_f32 v112, v48, v49
    v_cvt_pk_bf16_f32 v113, v50, v51
    v_cvt_pk_bf16_f32 v114, v52, v53
    v_cvt_pk_bf16_f32 v115, v54, v55
    v_cvt_pk_bf16_f32 v116, v56, v57
    v_cvt_pk_bf16_f32 v117, v58, v59
    v_cvt_pk_bf16_f32 v118, v60, v61
    v_cvt_pk_bf16_f32 v119, v62, v63
    v_mfma_f32_32x32x16_bf16 v[80:95], v[224:227], v[112:115], v[80:95]
    s_nop 0
    v_mfma_f32_32x32x16_bf16 v[80:95], v[228:231], v[116:119], v[80:95]
    s_nop 15
L_fb_b0_4:
    s_cmp_lt_u32 s4, 3
    s_cbranch_scc1 L_fb_b0_3
    v_mfma_f32_32x32x16_bf16 v[48:63], v[140:143], a[248:251], 0
    s_nop 11
    v_sub_f32 v48, v48, v4
    v_sub_f32 v49, v49, v4
    v_sub_f32 v50, v50, v4
    v_sub_f32 v51, v51, v4
    v_sub_f32 v52, v52, v4
    v_sub_f32 v53, v53, v4
    v_sub_f32 v54, v54, v4
    v_sub_f32 v55, v55, v4
    v_sub_f32 v56, v56, v4
    v_sub_f32 v57, v57, v4
    v_sub_f32 v58, v58, v4
    v_sub_f32 v59, v59, v4
    v_sub_f32 v60, v60, v4
    v_sub_f32 v61, v61, v4
    v_sub_f32 v62, v62, v4
    v_sub_f32 v63, v63, v4
    v_exp_f32 v48, v48
    v_exp_f32 v49, v49
    v_exp_f32 v50, v50
    v_exp_f32 v51, v51
    v_exp_f32 v52, v52
    v_exp_f32 v53, v53
    v_exp_f32 v54, v54
    v_exp_f32 v55, v55
    v_exp_f32 v56, v56
    v_exp_f32 v57, v57
    v_exp_f32 v58, v58
    v_exp_f32 v59, v59
    v_exp_f32 v60, v60
    v_exp_f32 v61, v61
    v_exp_f32 v62, v62
    v_exp_f32 v63, v63
    v_cvt_pk_bf16_f32 v112, v48, v49
    v_cvt_pk_bf16_f32 v113, v50, v51
    v_cvt_pk_bf16_f32 v114, v52, v53
    v_cvt_pk_bf16_f32 v115, v54, v55
    v_cvt_pk_bf16_f32 v116, v56, v57
    v_cvt_pk_bf16_f32 v117, v58, v59
    v_cvt_pk_bf16_f32 v118, v60, v61
    v_cvt_pk_bf16_f32 v119, v62, v63
    v_mfma_f32_32x32x16_bf16 v[80:95], v[216:219], v[112:115], v[80:95]
    s_nop 0
    v_mfma_f32_32x32x16_bf16 v[80:95], v[220:223], v[116:119], v[80:95]
    s_nop 15
L_fb_b0_3:
    s_cmp_lt_u32 s4, 3
    s_cbranch_scc1 L_fb_b0_2
    v_mfma_f32_32x32x16_bf16 v[48:63], v[136:139], a[248:251], 0
    s_nop 11
    v_sub_f32 v48, v48, v4
    v_sub_f32 v49, v49, v4
    v_sub_f32 v50, v50, v4
    v_sub_f32 v51, v51, v4
    v_sub_f32 v52, v52, v4
    v_sub_f32 v53, v53, v4
    v_sub_f32 v54, v54, v4
    v_sub_f32 v55, v55, v4
    v_sub_f32 v56, v56, v4
    v_sub_f32 v57, v57, v4
    v_sub_f32 v58, v58, v4
    v_sub_f32 v59, v59, v4
    v_sub_f32 v60, v60, v4
    v_sub_f32 v61, v61, v4
    v_sub_f32 v62, v62, v4
    v_sub_f32 v63, v63, v4
    v_exp_f32 v48, v48
    v_exp_f32 v49, v49
    v_exp_f32 v50, v50
    v_exp_f32 v51, v51
    v_exp_f32 v52, v52
    v_exp_f32 v53, v53
    v_exp_f32 v54, v54
    v_exp_f32 v55, v55
    v_exp_f32 v56, v56
    v_exp_f32 v57, v57
    v_exp_f32 v58, v58
    v_exp_f32 v59, v59
    v_exp_f32 v60, v60
    v_exp_f32 v61, v61
    v_exp_f32 v62, v62
    v_exp_f32 v63, v63
    v_cvt_pk_bf16_f32 v112, v48, v49
    v_cvt_pk_bf16_f32 v113, v50, v51
    v_cvt_pk_bf16_f32 v114, v52, v53
    v_cvt_pk_bf16_f32 v115, v54, v55
    v_cvt_pk_bf16_f32 v116, v56, v57
    v_cvt_pk_bf16_f32 v117, v58, v59
    v_cvt_pk_bf16_f32 v118, v60, v61
    v_cvt_pk_bf16_f32 v119, v62, v63
    v_mfma_f32_32x32x16_bf16 v[80:95], v[208:211], v[112:115], v[80:95]
    s_nop 0
    v_mfma_f32_32x32x16_bf16 v[80:95], v[212:215], v[116:119], v[80:95]
    s_nop 15
L_fb_b0_2:
    s_cmp_lt_u32 s4, 4
    s_cbranch_scc1 L_fb_b0_1
    v_mfma_f32_32x32x16_bf16 v[48:63], v[132:135], a[248:251], 0
    s_nop 11
    v_sub_f32 v48, v48, v4
    v_sub_f32 v49, v49, v4
    v_sub_f32 v50, v50, v4
    v_sub_f32 v51, v51, v4
    v_sub_f32 v52, v52, v4
    v_sub_f32 v53, v53, v4
    v_sub_f32 v54, v54, v4
    v_sub_f32 v55, v55, v4
    v_sub_f32 v56, v56, v4
    v_sub_f32 v57, v57, v4
    v_sub_f32 v58, v58, v4
    v_sub_f32 v59, v59, v4
    v_sub_f32 v60, v60, v4
    v_sub_f32 v61, v61, v4
    v_sub_f32 v62, v62, v4
    v_sub_f32 v63, v63, v4
    v_exp_f32 v48, v48
    v_exp_f32 v49, v49
    v_exp_f32 v50, v50
    v_exp_f32 v51, v51
    v_exp_f32 v52, v52
    v_exp_f32 v53, v53
    v_exp_f32 v54, v54
    v_exp_f32 v55, v55
    v_exp_f32 v56, v56
    v_exp_f32 v57, v57
    v_exp_f32 v58, v58
    v_exp_f32 v59, v59
    v_exp_f32 v60, v60
    v_exp_f32 v61, v61
    v_exp_f32 v62, v62
    v_exp_f32 v63, v63
    v_cvt_pk_bf16_f32 v112, v48, v49
    v_cvt_pk_bf16_f32 v113, v50, v51
    v_cvt_pk_bf16_f32 v114, v52, v53
    v_cvt_pk_bf16_f32 v115, v54, v55
    v_cvt_pk_bf16_f32 v116, v56, v57
    v_cvt_pk_bf16_f32 v117, v58, v59
    v_cvt_pk_bf16_f32 v118, v60, v61
    v_cvt_pk_bf16_f32 v119, v62, v63
    v_mfma_f32_32x32x16_bf16 v[80:95], v[200:203], v[112:115], v[80:95]
    s_nop 0
    v_mfma_f32_32x32x16_bf16 v[80:95], v[204:207], v[116:119], v[80:95]
    s_nop 15
L_fb_b0_1:
    s_cmp_lt_u32 s4, 4
    s_cbranch_scc1 L_fb_b0_0
    v_mfma_f32_32x32x16_bf16 v[48:63], v[128:131], a[248:251], v[176:191]
    s_nop 11
    v_sub_f32 v48, v48, v4
    v_sub_f32 v49, v49, v4
    v_sub_f32 v50, v50, v4
    v_sub_f32 v51, v51, v4
    v_sub_f32 v52, v52, v4
    v_sub_f32 v53, v53, v4
    v_sub_f32 v54, v54, v4
    v_sub_f32 v55, v55, v4
    v_sub_f32 v56, v56, v4
    v_sub_f32 v57, v57, v4
    v_sub_f32 v58, v58, v4
    v_sub_f32 v59, v59, v4
    v_sub_f32 v60, v60, v4
    v_sub_f32 v61, v61, v4
    v_sub_f32 v62, v62, v4
    v_sub_f32 v63, v63, v4
    v_exp_f32 v48, v48
    v_exp_f32 v49, v49
    v_exp_f32 v50, v50
    v_exp_f32 v51, v51
    v_exp_f32 v52, v52
    v_exp_f32 v53, v53
    v_exp_f32 v54, v54
    v_exp_f32 v55, v55
    v_exp_f32 v56, v56
    v_exp_f32 v57, v57
    v_exp_f32 v58, v58
    v_exp_f32 v59, v59
    v_exp_f32 v60, v60
    v_exp_f32 v61, v61
    v_exp_f32 v62, v62
    v_exp_f32 v63, v63
    v_cvt_pk_bf16_f32 v112, v48, v49
    v_cvt_pk_bf16_f32 v113, v50, v51
    v_cvt_pk_bf16_f32 v114, v52, v53
    v_cvt_pk_bf16_f32 v115, v54, v55
    v_cvt_pk_bf16_f32 v116, v56, v57
    v_cvt_pk_bf16_f32 v117, v58, v59
    v_cvt_pk_bf16_f32 v118, v60, v61
    v_cvt_pk_bf16_f32 v119, v62, v63
    v_mfma_f32_32x32x16_bf16 v[80:95], v[192:195], v[112:115], v[80:95]
    s_nop 0
    v_mfma_f32_32x32x16_bf16 v[80:95], v[196:199], v[116:119], v[80:95]
    s_nop 15
L_fb_b0_0:
    v_mov_b32 v4, 0xff800000
    v_mfma_f32_32x32x16_bf16 v[48:63], a[228:231], a[252:255], v[160:175]
    s_nop 11
    v_max3_f32 v4, v48, v49, v4
    v_max3_f32 v4, v50, v51, v4
    v_max3_f32 v4, v52, v53, v4
    v_max3_f32 v4, v54, v55, v4
    v_max3_f32 v4, v56, v57, v4
    v_max3_f32 v4, v58, v59, v4
    v_max3_f32 v4, v60, v61, v4
    v_max3_f32 v4, v62, v63, v4
    s_nop 7
L_fb_a1_9:
    v_mfma_f32_32x32x16_bf16 v[48:63], a[224:227], a[252:255], 0
    s_nop 11
    v_max3_f32 v4, v48, v49, v4
    v_max3_f32 v4, v50, v51, v4
    v_max3_f32 v4, v52, v53, v4
    v_max3_f32 v4, v54, v55, v4
    v_max3_f32 v4, v56, v57, v4
    v_max3_f32 v4, v58, v59, v4
    v_max3_f32 v4, v60, v61, v4
    v_max3_f32 v4, v62, v63, v4
    s_nop 7
L_fb_a1_8:
    s_cmp_lt_u32 s4, 1
    s_cbranch_scc1 L_fb_a1_7
    v_mfma_f32_32x32x16_bf16 v[48:63], v[156:159], a[252:255], 0
    s_nop 11
    v_max3_f32 v4, v48, v49, v4
    v_max3_f32 v4, v50, v51, v4
    v_max3_f32 v4, v52, v53, v4
    v_max3_f32 v4, v54, v55, v4
    v_max3_f32 v4, v56, v57, v4
    v_max3_f32 v4, v58, v59, v4
    v_max3_f32 v4, v60, v61, v4
    v_max3_f32 v4, v62, v63, v4
    s_nop 7
L_fb_a1_7:
    s_cmp_lt_u32 s4, 1
    s_cbranch_scc1 L_fb_a1_6
    v_mfma_f32_32x32x16_bf16 v[48:63], v[152:155], a[252:255], 0
    s_nop 11
    v_max3_f32 v4, v48, v49, v4
    v_max3_f32 v4, v50, v51, v4
    v_max3_f32 v4, v52, v53, v4
    v_max3_f32 v4, v54, v55, v4
    v_max3_f32 v4, v56, v57, v4
    v_max3_f32 v4, v58, v59, v4
    v_max3_f32 v4, v60, v61, v4
    v_max3_f32 v4, v62, v63, v4
    s_nop 7
L_fb_a1_6:
    s_cmp_lt_u32 s4, 2
    s_cbranch_scc1 L_fb_a1_5
    v_mfma_f32_32x32x16_bf16 v[48:63], v[148:151], a[252:255], 0
    s_nop 11
    v_max3_f32 v4, v48, v49, v4
    v_max3_f32 v4, v50, v51, v4
    v_max3_f32 v4, v52, v53, v4
    v_max3_f32 v4, v54, v55, v4
    v_max3_f32 v4, v56, v57, v4
    v_max3_f32 v4, v58, v59, v4
    v_max3_f32 v4, v60, v61, v4
    v_max3_f32 v4, v62, v63, v4
    s_nop 7
L_fb_a1_5:
    s_cmp_lt_u32 s4, 2
    s_cbranch_scc1 L_fb_a1_4
    v_mfma_f32_32x32x16_bf16 v[48:63], v[144:147], a[252:255], 0
    s_nop 11
    v_max3_f32 v4, v48, v49, v4
    v_max3_f32 v4, v50, v51, v4
    v_max3_f32 v4, v52, v53, v4
    v_max3_f32 v4, v54, v55, v4
    v_max3_f32 v4, v56, v57, v4
    v_max3_f32 v4, v58, v59, v4
    v_max3_f32 v4, v60, v61, v4
    v_max3_f32 v4, v62, v63, v4
    s_nop 7
L_fb_a1_4:
    s_cmp_lt_u32 s4, 3
    s_cbranch_scc1 L_fb_a1_3
    v_mfma_f32_32x32x16_bf16 v[48:63], v[140:143], a[252:255], 0
    s_nop 11
    v_max3_f32 v4, v48, v49, v4
    v_max3_f32 v4, v50, v51, v4
    v_max3_f32 v4, v52, v53, v4
    v_max3_f32 v4, v54, v55, v4
    v_max3_f32 v4, v56, v57, v4
    v_max3_f32 v4, v58, v59, v4
    v_max3_f32 v4, v60, v61, v4
    v_max3_f32 v4, v62, v63, v4
    s_nop 7
L_fb_a1_3:
    s_cmp_lt_u32 s4, 3
    s_cbranch_scc1 L_fb_a1_2
    v_mfma_f32_32x32x16_bf16 v[48:63], v[136:139], a[252:255], 0
    s_nop 11
    v_max3_f32 v4, v48, v49, v4
    v_max3_f32 v4, v50, v51, v4
    v_max3_f32 v4, v52, v53, v4
    v_max3_f32 v4, v54, v55, v4
    v_max3_f32 v4, v56, v57, v4
    v_max3_f32 v4, v58, v59, v4
    v_max3_f32 v4, v60, v61, v4
    v_max3_f32 v4, v62, v63, v4
    s_nop 7
L_fb_a1_2:
    s_cmp_lt_u32 s4, 4
    s_cbranch_scc1 L_fb_a1_1
    v_mfma_f32_32x32x16_bf16 v[48:63], v[132:135], a[252:255], v[176:191]
    s_nop 11
    v_max3_f32 v4, v48, v49, v4
    v_max3_f32 v4, v50, v51, v4
    v_max3_f32 v4, v52, v53, v4
    v_max3_f32 v4, v54, v55, v4
    v_max3_f32 v4, v56, v57, v4
    v_max3_f32 v4, v58, v59, v4
    v_max3_f32 v4, v60, v61, v4
    v_max3_f32 v4, v62, v63, v4
    s_nop 7
L_fb_a1_1:
    v_mov_b32 v5, v4
    s_nop 1
    v_permlane32_swap_b32 v4, v5
    v_max_f32 v4, v4, v5
    v_mov_b32 v96, 0
    v_mov_b32 v97, 0
    v_mov_b32 v98, 0
    v_mov_b32 v99, 0
    v_mov_b32 v100, 0
    v_mov_b32 v101, 0
    v_mov_b32 v102, 0
    v_mov_b32 v103, 0
    v_mov_b32 v104, 0
    v_mov_b32 v105, 0
    v_mov_b32 v106, 0
    v_mov_b32 v107, 0
    v_mov_b32 v108, 0
    v_mov_b32 v109, 0
    v_mov_b32 v110, 0
    v_mov_b32 v111, 0
    v_mfma_f32_32x32x16_bf16 v[48:63], a[228:231], a[252:255], v[160:175]
    s_nop 11
    v_sub_f32 v48, v48, v4
    v_sub_f32 v49, v49, v4
    v_sub_f32 v50, v50, v4
    v_sub_f32 v51, v51, v4
    v_sub_f32 v52, v52, v4
    v_sub_f32 v53, v53, v4
    v_sub_f32 v54, v54, v4
    v_sub_f32 v55, v55, v4
    v_sub_f32 v56, v56, v4
    v_sub_f32 v57, v57, v4
    v_sub_f32 v58, v58, v4
    v_sub_f32 v59, v59, v4
    v_sub_f32 v60, v60, v4
    v_sub_f32 v61, v61, v4
    v_sub_f32 v62, v62, v4
    v_sub_f32 v63, v63, v4
    v_exp_f32 v48, v48
    v_exp_f32 v49, v49
    v_exp_f32 v50, v50
    v_exp_f32 v51, v51
    v_exp_f32 v52, v52
    v_exp_f32 v53, v53
    v_exp_f32 v54, v54
    v_exp_f32 v55, v55
    v_exp_f32 v56, v56
    v_exp_f32 v57, v57
    v_exp_f32 v58, v58
    v_exp_f32 v59, v59
    v_exp_f32 v60, v60
    v_exp_f32 v61, v61
    v_exp_f32 v62, v62
    v_exp_f32 v63, v63
    v_cvt_pk_bf16_f32 v112, v48, v49
    v_cvt_pk_bf16_f32 v113, v50, v51
    v_cvt_pk_bf16_f32 v114, v52, v53
    v_cvt_pk_bf16_f32 v115, v54, v55
    v_cvt_pk_bf16_f32 v116, v56, v57
    v_cvt_pk_bf16_f32 v117, v58, v59
    v_cvt_pk_bf16_f32 v118, v60, v61
    v_cvt_pk_bf16_f32 v119, v62, v63
    v_mfma_f32_32x32x16_bf16 v[96:111], a[240:243], v[112:115], v[96:111]
    s_nop 0
    v_mfma_f32_32x32x16_bf16 v[96:111], a[244:247], v[116:119], v[96:111]
    s_nop 15
L_fb_b1_9:
    v_mfma_f32_32x32x16_bf16 v[48:63], a[224:227], a[252:255], 0
    s_nop 11
    v_sub_f32 v48, v48, v4
    v_sub_f32 v49, v49, v4
    v_sub_f32 v50, v50, v4
    v_sub_f32 v51, v51, v4
    v_sub_f32 v52, v52, v4
    v_sub_f32 v53, v53, v4
    v_sub_f32 v54, v54, v4
    v_sub_f32 v55, v55, v4
    v_sub_f32 v56, v56, v4
    v_sub_f32 v57, v57, v4
    v_sub_f32 v58, v58, v4
    v_sub_f32 v59, v59, v4
    v_sub_f32 v60, v60, v4
    v_sub_f32 v61, v61, v4
    v_sub_f32 v62, v62, v4
    v_sub_f32 v63, v63, v4
    v_exp_f32 v48, v48
    v_exp_f32 v49, v49
    v_exp_f32 v50, v50
    v_exp_f32 v51, v51
    v_exp_f32 v52, v52
    v_exp_f32 v53, v53
    v_exp_f32 v54, v54
    v_exp_f32 v55, v55
    v_exp_f32 v56, v56
    v_exp_f32 v57, v57
    v_exp_f32 v58, v58
    v_exp_f32 v59, v59
    v_exp_f32 v60, v60
    v_exp_f32 v61, v61
    v_exp_f32 v62, v62
    v_exp_f32 v63, v63
    v_cvt_pk_bf16_f32 v112, v48, v49
    v_cvt_pk_bf16_f32 v113, v50, v51
    v_cvt_pk_bf16_f32 v114, v52, v53
    v_cvt_pk_bf16_f32 v115, v54, v55
    v_cvt_pk_bf16_f32 v116, v56, v57
    v_cvt_pk_bf16_f32 v117, v58, v59
    v_cvt_pk_bf16_f32 v118, v60, v61
    v_cvt_pk_bf16_f32 v119, v62, v63
    v_mfma_f32_32x32x16_bf16 v[96:111], a[232:235], v[112:115], v[96:111]
    s_nop 0
    v_mfma_f32_32x32x16_bf16 v[96:111], a[236:239], v[116:119], v[96:111]
    s_nop 15
L_fb_b1_8:
    s_cmp_lt_u32 s4, 1
    s_cbranch_scc1 L_fb_b1_7
    v_mfma_f32_32x32x16_bf16 v[48:63], v[156:159], a[252:255], 0
    s_nop 11
    v_sub_f32 v48, v48, v4
    v_sub_f32 v49, v49, v4
    v_sub_f32 v50, v50, v4
    v_sub_f32 v51, v51, v4
    v_sub_f32 v52, v52, v4
    v_sub_f32 v53, v53, v4
    v_sub_f32 v54, v54, v4
    v_sub_f32 v55, v55, v4
    v_sub_f32 v56, v56, v4
    v_sub_f32 v57, v57, v4
    v_sub_f32 v58, v58, v4
    v_sub_f32 v59, v59, v4
    v_sub_f32 v60, v60, v4
    v_sub_f32 v61, v61, v4
    v_sub_f32 v62, v62, v4
    v_sub_f32 v63, v63, v4
    v_exp_f32 v48, v48
    v_exp_f32 v49, v49
    v_exp_f32 v50, v50
    v_exp_f32 v51, v51
    v_exp_f32 v52, v52
    v_exp_f32 v53, v53
    v_exp_f32 v54, v54
    v_exp_f32 v55, v55
    v_exp_f32 v56, v56
    v_exp_f32 v57, v57
    v_exp_f32 v58, v58
    v_exp_f32 v59, v59
    v_exp_f32 v60, v60
    v_exp_f32 v61, v61
    v_exp_f32 v62, v62
    v_exp_f32 v63, v63
    v_cvt_pk_bf16_f32 v112, v48, v49
    v_cvt_pk_bf16_f32 v113, v50, v51
    v_cvt_pk_bf16_f32 v114, v52, v53
    v_cvt_pk_bf16_f32 v115, v54, v55
    v_cvt_pk_bf16_f32 v116, v56, v57
    v_cvt_pk_bf16_f32 v117, v58, v59
    v_cvt_pk_bf16_f32 v118, v60, v61
    v_cvt_pk_bf16_f32 v119, v62, v63
    v_mfma_f32_32x32x16_bf16 v[96:111], v[248:251], v[112:115], v[96:111]
    s_nop 0
    v_mfma_f32_32x32x16_bf16 v[96:111], v[252:255], v[116:119], v[96:111]
    s_nop 15
L_fb_b1_7:
    s_cmp_lt_u32 s4, 1
    s_cbranch_scc1 L_fb_b1_6
    v_mfma_f32_32x32x16_bf16 v[48:63], v[152:155], a[252:255], 0
    s_nop 11
    v_sub_f32 v48, v48, v4
    v_sub_f32 v49, v49, v4
    v_sub_f32 v50, v50, v4
    v_sub_f32 v51, v51, v4
    v_sub_f32 v52, v52, v4
    v_sub_f32 v53, v53, v4
    v_sub_f32 v54, v54, v4
    v_sub_f32 v55, v55, v4
    v_sub_f32 v56, v56, v4
    v_sub_f32 v57, v57, v4
    v_sub_f32 v58, v58, v4
    v_sub_f32 v59, v59, v4
    v_sub_f32 v60, v60, v4
    v_sub_f32 v61, v61, v4
    v_sub_f32 v62, v62, v4
    v_sub_f32 v63, v63, v4
    v_exp_f32 v48, v48
    v_exp_f32 v49, v49
    v_exp_f32 v50, v50
    v_exp_f32 v51, v51
    v_exp_f32 v52, v52
    v_exp_f32 v53, v53
    v_exp_f32 v54, v54
    v_exp_f32 v55, v55
    v_exp_f32 v56, v56
    v_exp_f32 v57, v57
    v_exp_f32 v58, v58
    v_exp_f32 v59, v59
    v_exp_f32 v60, v60
    v_exp_f32 v61, v61
    v_exp_f32 v62, v62
    v_exp_f32 v63, v63
    v_cvt_pk_bf16_f32 v112, v48, v49
    v_cvt_pk_bf16_f32 v113, v50, v51
    v_cvt_pk_bf16_f32 v114, v52, v53
    v_cvt_pk_bf16_f32 v115, v54, v55
    v_cvt_pk_bf16_f32 v116, v56, v57
    v_cvt_pk_bf16_f32 v117, v58, v59
    v_cvt_pk_bf16_f32 v118, v60, v61
    v_cvt_pk_bf16_f32 v119, v62, v63
    v_mfma_f32_32x32x16_bf16 v[96:111], v[240:243], v[112:115], v[96:111]
    s_nop 0
    v_mfma_f32_32x32x16_bf16 v[96:111], v[244:247], v[116:119], v[96:111]
    s_nop 15
L_fb_b1_6:
    s_cmp_lt_u32 s4, 2
    s_cbranch_scc1 L_fb_b1_5
    v_mfma_f32_32x32x16_bf16 v[48:63], v[148:151], a[252:255], 0
    s_nop 11
    v_sub_f32 v48, v48, v4
    v_sub_f32 v49, v49, v4
    v_sub_f32 v50, v50, v4
    v_sub_f32 v51, v51, v4
    v_sub_f32 v52, v52, v4
    v_sub_f32 v53, v53, v4
    v_sub_f32 v54, v54, v4
    v_sub_f32 v55, v55, v4
    v_sub_f32 v56, v56, v4
    v_sub_f32 v57, v57, v4
    v_sub_f32 v58, v58, v4
    v_sub_f32 v59, v59, v4
    v_sub_f32 v60, v60, v4
    v_sub_f32 v61, v61, v4
    v_sub_f32 v62, v62, v4
    v_sub_f32 v63, v63, v4
    v_exp_f32 v48, v48
    v_exp_f32 v49, v49
    v_exp_f32 v50, v50
    v_exp_f32 v51, v51
    v_exp_f32 v52, v52
    v_exp_f32 v53, v53
    v_exp_f32 v54, v54
    v_exp_f32 v55, v55
    v_exp_f32 v56, v56
    v_exp_f32 v57, v57
    v_exp_f32 v58, v58
    v_exp_f32 v59, v59
    v_exp_f32 v60, v60
    v_exp_f32 v61, v61
    v_exp_f32 v62, v62
    v_exp_f32 v63, v63
    v_cvt_pk_bf16_f32 v112, v48, v49
    v_cvt_pk_bf16_f32 v113, v50, v51
    v_cvt_pk_bf16_f32 v114, v52, v53
    v_cvt_pk_bf16_f32 v115, v54, v55
    v_cvt_pk_bf16_f32 v116, v56, v57
    v_cvt_pk_bf16_f32 v117, v58, v59
    v_cvt_pk_bf16_f32 v118, v60, v61
    v_cvt_pk_bf16_f32 v119, v62, v63
    v_mfma_f32_32x32x16_bf16 v[96:111], v[232:235], v[112:115], v[96:111]
    s_nop 0
    v_mfma_f32_32x32x16_bf16 v[96:111], v[236:239], v[116:119], v[96:111]
    s_nop 15
L_fb_b1_5:
    s_cmp_lt_u32 s4, 2
    s_cbranch_scc1 L_fb_b1_4
    v_mfma_f32_32x32x16_bf16 v[48:63], v[144:147], a[252:255], 0
    s_nop 11
    v_sub_f32 v48, v48, v4
    v_sub_f32 v49, v49, v4
    v_sub_f32 v50, v50, v4
    v_sub_f32 v51, v51, v4
    v_sub_f32 v52, v52, v4
    v_sub_f32 v53, v53, v4
    v_sub_f32 v54, v54, v4
    v_sub_f32 v55, v55, v4
    v_sub_f32 v56, v56, v4
    v_sub_f32 v57, v57, v4
    v_sub_f32 v58, v58, v4
    v_sub_f32 v59, v59, v4
    v_sub_f32 v60, v60, v4
    v_sub_f32 v61, v61, v4
    v_sub_f32 v62, v62, v4
    v_sub_f32 v63, v63, v4
    v_exp_f32 v48, v48
    v_exp_f32 v49, v49
    v_exp_f32 v50, v50
    v_exp_f32 v51, v51
    v_exp_f32 v52, v52
    v_exp_f32 v53, v53
    v_exp_f32 v54, v54
    v_exp_f32 v55, v55
    v_exp_f32 v56, v56
    v_exp_f32 v57, v57
    v_exp_f32 v58, v58
    v_exp_f32 v59, v59
    v_exp_f32 v60, v60
    v_exp_f32 v61, v61
    v_exp_f32 v62, v62
    v_exp_f32 v63, v63
    v_cvt_pk_bf16_f32 v112, v48, v49
    v_cvt_pk_bf16_f32 v113, v50, v51
    v_cvt_pk_bf16_f32 v114, v52, v53
    v_cvt_pk_bf16_f32 v115, v54, v55
    v_cvt_pk_bf16_f32 v116, v56, v57
    v_cvt_pk_bf16_f32 v117, v58, v59
    v_cvt_pk_bf16_f32 v118, v60, v61
    v_cvt_pk_bf16_f32 v119, v62, v63
    v_mfma_f32_32x32x16_bf16 v[96:111], v[224:227], v[112:115], v[96:111]
    s_nop 0
    v_mfma_f32_32x32x16_bf16 v[96:111], v[228:231], v[116:119], v[96:111]
    s_nop 15
L_fb_b1_4:
    s_cmp_lt_u32 s4, 3
    s_cbranch_scc1 L_fb_b1_3
    v_mfma_f32_32x32x16_bf16 v[48:63], v[140:143], a[252:255], 0
    s_nop 11
    v_sub_f32 v48, v48, v4
    v_sub_f32 v49, v49, v4
    v_sub_f32 v50, v50, v4
    v_sub_f32 v51, v51, v4
    v_sub_f32 v52, v52, v4
    v_sub_f32 v53, v53, v4
    v_sub_f32 v54, v54, v4
    v_sub_f32 v55, v55, v4
    v_sub_f32 v56, v56, v4
    v_sub_f32 v57, v57, v4
    v_sub_f32 v58, v58, v4
    v_sub_f32 v59, v59, v4
    v_sub_f32 v60, v60, v4
    v_sub_f32 v61, v61, v4
    v_sub_f32 v62, v62, v4
    v_sub_f32 v63, v63, v4
    v_exp_f32 v48, v48
    v_exp_f32 v49, v49
    v_exp_f32 v50, v50
    v_exp_f32 v51, v51
    v_exp_f32 v52, v52
    v_exp_f32 v53, v53
    v_exp_f32 v54, v54
    v_exp_f32 v55, v55
    v_exp_f32 v56, v56
    v_exp_f32 v57, v57
    v_exp_f32 v58, v58
    v_exp_f32 v59, v59
    v_exp_f32 v60, v60
    v_exp_f32 v61, v61
    v_exp_f32 v62, v62
    v_exp_f32 v63, v63
    v_cvt_pk_bf16_f32 v112, v48, v49
    v_cvt_pk_bf16_f32 v113, v50, v51
    v_cvt_pk_bf16_f32 v114, v52, v53
    v_cvt_pk_bf16_f32 v115, v54, v55
    v_cvt_pk_bf16_f32 v116, v56, v57
    v_cvt_pk_bf16_f32 v117, v58, v59
    v_cvt_pk_bf16_f32 v118, v60, v61
    v_cvt_pk_bf16_f32 v119, v62, v63
    v_mfma_f32_32x32x16_bf16 v[96:111], v[216:219], v[112:115], v[96:111]
    s_nop 0
    v_mfma_f32_32x32x16_bf16 v[96:111], v[220:223], v[116:119], v[96:111]
    s_nop 15
L_fb_b1_3:
    s_cmp_lt_u32 s4, 3
    s_cbranch_scc1 L_fb_b1_2
    v_mfma_f32_32x32x16_bf16 v[48:63], v[136:139], a[252:255], 0
    s_nop 11
    v_sub_f32 v48, v48, v4
    v_sub_f32 v49, v49, v4
    v_sub_f32 v50, v50, v4
    v_sub_f32 v51, v51, v4
    v_sub_f32 v52, v52, v4
    v_sub_f32 v53, v53, v4
    v_sub_f32 v54, v54, v4
    v_sub_f32 v55, v55, v4
    v_sub_f32 v56, v56, v4
    v_sub_f32 v57, v57, v4
    v_sub_f32 v58, v58, v4
    v_sub_f32 v59, v59, v4
    v_sub_f32 v60, v60, v4
    v_sub_f32 v61, v61, v4
    v_sub_f32 v62, v62, v4
    v_sub_f32 v63, v63, v4
    v_exp_f32 v48, v48
    v_exp_f32 v49, v49
    v_exp_f32 v50, v50
    v_exp_f32 v51, v51
    v_exp_f32 v52, v52
    v_exp_f32 v53, v53
    v_exp_f32 v54, v54
    v_exp_f32 v55, v55
    v_exp_f32 v56, v56
    v_exp_f32 v57, v57
    v_exp_f32 v58, v58
    v_exp_f32 v59, v59
    v_exp_f32 v60, v60
    v_exp_f32 v61, v61
    v_exp_f32 v62, v62
    v_exp_f32 v63, v63
    v_cvt_pk_bf16_f32 v112, v48, v49
    v_cvt_pk_bf16_f32 v113, v50, v51
    v_cvt_pk_bf16_f32 v114, v52, v53
    v_cvt_pk_bf16_f32 v115, v54, v55
    v_cvt_pk_bf16_f32 v116, v56, v57
    v_cvt_pk_bf16_f32 v117, v58, v59
    v_cvt_pk_bf16_f32 v118, v60, v61
    v_cvt_pk_bf16_f32 v119, v62, v63
    v_mfma_f32_32x32x16_bf16 v[96:111], v[208:211], v[112:115], v[96:111]
    s_nop 0
    v_mfma_f32_32x32x16_bf16 v[96:111], v[212:215], v[116:119], v[96:111]
    s_nop 15
L_fb_b1_2:
    s_cmp_lt_u32 s4, 4
    s_cbranch_scc1 L_fb_b1_1
    v_mfma_f32_32x32x16_bf16 v[48:63], v[132:135], a[252:255], v[176:191]
    s_nop 11
    v_sub_f32 v48, v48, v4
    v_sub_f32 v49, v49, v4
    v_sub_f32 v50, v50, v4
    v_sub_f32 v51, v51, v4
    v_sub_f32 v52, v52, v4
    v_sub_f32 v53, v53, v4
    v_sub_f32 v54, v54, v4
    v_sub_f32 v55, v55, v4
    v_sub_f32 v56, v56, v4
    v_sub_f32 v57, v57, v4
    v_sub_f32 v58, v58, v4
    v_sub_f32 v59, v59, v4
    v_sub_f32 v60, v60, v4
    v_sub_f32 v61, v61, v4
    v_sub_f32 v62, v62, v4
    v_sub_f32 v63, v63, v4
    v_exp_f32 v48, v48
    v_exp_f32 v49, v49
    v_exp_f32 v50, v50
    v_exp_f32 v51, v51
    v_exp_f32 v52, v52
    v_exp_f32 v53, v53
    v_exp_f32 v54, v54
    v_exp_f32 v55, v55
    v_exp_f32 v56, v56
    v_exp_f32 v57, v57
    v_exp_f32 v58, v58
    v_exp_f32 v59, v59
    v_exp_f32 v60, v60
    v_exp_f32 v61, v61
    v_exp_f32 v62, v62
    v_exp_f32 v63, v63
    v_cvt_pk_bf16_f32 v112, v48, v49
    v_cvt_pk_bf16_f32 v113, v50, v51
    v_cvt_pk_bf16_f32 v114, v52, v53
    v_cvt_pk_bf16_f32 v115, v54, v55
    v_cvt_pk_bf16_f32 v116, v56, v57
    v_cvt_pk_bf16_f32 v117, v58, v59
    v_cvt_pk_bf16_f32 v118, v60, v61
    v_cvt_pk_bf16_f32 v119, v62, v63
    v_mfma_f32_32x32x16_bf16 v[96:111], v[200:203], v[112:115], v[96:111]
    s_nop 0
    v_mfma_f32_32x32x16_bf16 v[96:111], v[204:207], v[116:119], v[96:111]
    s_nop 15
L_fb_b1_1:
    s_nop 15
    v_rcp_f32 v4, v104
    s_nop 0
    v_pk_mul_f32 v[96:97], v[96:97], v[4:5] op_sel_hi:[1,0]
    v_pk_mul_f32 v[98:99], v[98:99], v[4:5] op_sel_hi:[1,0]
    v_pk_mul_f32 v[100:101], v[100:101], v[4:5] op_sel_hi:[1,0]
    v_pk_mul_f32 v[102:103], v[102:103], v[4:5] op_sel_hi:[1,0]
    v_cvt_pk_bf16_f32 v112, v96, v97
    v_cvt_pk_bf16_f32 v113, v98, v99
    v_cvt_pk_bf16_f32 v114, v100, v101
    v_cvt_pk_bf16_f32 v115, v102, v103
    buffer_store_dwordx4 v[112:115], v8, s[32:35], s91 offen sc1
    v_rcp_f32 v4, v88
    s_nop 0
    v_pk_mul_f32 v[80:81], v[80:81], v[4:5] op_sel_hi:[1,0]
    v_pk_mul_f32 v[82:83], v[82:83], v[4:5] op_sel_hi:[1,0]
    v_pk_mul_f32 v[84:85], v[84:85], v[4:5] op_sel_hi:[1,0]
    v_pk_mul_f32 v[86:87], v[86:87], v[4:5] op_sel_hi:[1,0]
    v_cvt_pk_bf16_f32 v116, v80, v81
    v_cvt_pk_bf16_f32 v117, v82, v83
    v_cvt_pk_bf16_f32 v118, v84, v85
    v_cvt_pk_bf16_f32 v119, v86, v87
    buffer_store_dwordx4 v[116:119], v2, s[32:35], s91 offen sc1
    s_nop 1
    s_branch L_attn_ok
.p2align 6
.type L_tab,@object
L_tab:
.long 536870912,536870912,536870912,536870912,0,0,49152,5242880,1048576,65536,4096,4096,0,0,16384,7340032,655360,262144,0,262144,7340032,196608,196608,655360,4285530112,0,393216,200704,0,200704,393216,7340032,208896,0,208896,0,7340032,7372800,7405568,7438336,7350272,7383040,7415808,7360512,7393280,7426048,7448576,7370752,7403520,7436288,0,0
.long 536870912,536870912,536870912,536870912,0,0,49152,5244928,1050624,65664,536870912,4096,57344,16384,16384,7341056,655488,536870912,114688,262400,7356416,196612,196672,655360,4285530112,2048,393472,200708,32768,200832,397312,7454720,209280,0,208896,16384,7364608,7397376,7430144,7342080,7374848,7407616,7352320,7385088,7417856,7450624,7440384,7362560,7395328,7428096,0,0
.long 536870912,536870912,536870912,536870912,0,0,49408,5246976,1056768,65792,536870912,4096,114688,32768,20480,7342080,655616,536870912,229376,266240,7454720,196616,196608,655360,4285530112,32768,397312,200832,65536,200960,401408,7569408,209664,0,208896,32768,7356416,7389184,7421952,7366656,7399424,7432192,7344128,7376896,7409664,7442432,7354368,7387136,7419904,7452672,0,0
.long 536870912,536870912,536870912,536870912,0,0,49408,5249024,1058816,65920,536870912,4096,172032,49152,20480,7343104,655744,536870912,344064,266496,7471104,196620,196672,655360,4285530112,34816,397568,200836,98304,201088,405504,7684096,210048,0,208896,49152,7348224,7380992,7413760,7446528,7358464,7391232,7424000,7368704,7401472,7434240,7346176,7378944,7411712,7444480,0,0
.long 536870912,536870912,536870912,536870912,0,0,49664,5251072,1064960,66048,4224,4096,128,65536,24576,7344128,655872,266240,256,270336,7340032,196624,196608,669696,4285759488,4096,393728,200712,0,200704,393216,7348224,208900,0,208896,128,7405568,7438336,7350272,7383040,7340032,7372800,7360512,7393280,7426048,7415808,7370752,7403520,7436288,7448576,0,0
.long 536870912,536870912,536870912,536870912,0,0,49664,5253120,1067008,66176,536870912,4096,57472,81920,24576,7345152,656000,536870912,114944,270592,7356416,196628,196672,669696,4285759488,6144,393984,200716,32768,200832,397312,7462912,209284,0,208896,16512,7430144,7342080,7374848,7407616,7364608,7397376,7385088,7417856,7450624,7352320,7362560,7395328,7428096,7440384,0,0
.long 536870912,536870912,536870912,536870912,0,0,49920,5255168,1073152,66304,536870912,4096,114816,98304,28672,7346176,656128,536870912,229632,274432,7454720,196632,196608,669696,4285759488,36864,397824,200840,65536,200960,401408,7577600,209668,0,208896,32896,7421952,7366656,7399424,7432192,7356416,7389184,7376896,7409664,7442432,7344128,7387136,7419904,7452672,7354368,0,0
.long 536870912,536870912,536870912,536870912,0,0,49920,5257216,1075200,66432,536870912,4096,172160,114688,28672,7347200,656256,536870912,344320,274688,7471104,196636,196672,669696,4285759488,38912,398080,200844,98304,201088,405504,7692288,210052,0,208896,49280,7413760,7446528,7358464,7391232,7348224,7380992,7368704,7401472,7434240,7424000,7378944,7411712,7444480,7346176,0,0
.long 536870912,536870912,536870912,536870912,0,0,50176,5259264,1081344,66560,4352,4096,256,131072,32768,7348224,656384,270336,512,278528,7340032,196640,196608,684032,4285988864,8192,394240,200720,0,200704,393216,7356416,208904,0,208896,256,7438336,7350272,7383040,7340032,7372800,7405568,7393280,7426048,7415808,7360512,7403520,7436288,7448576,7370752,0,0
.long 536870912,536870912,536870912,536870912,0,0,50176,5261312,1083392,66688,536870912,4096,57600,147456,32768,7349248,656512,536870912,115200,278784,7356416,196644,196672,684032,4285988864,10240,394496,200724,32768,200832,397312,7471104,209288,0,208896,16640,7342080,7374848,7407616,7364608,7397376,7430144,7417856,7450624,7352320,7385088,7395328,7428096,7440384,7362560,0,0
.long 536870912,536870912,536870912,536870912,0,0,50432,5263360,1089536,66816,536870912,4096,114944,163840,36864,7350272,656640,536870912,229888,282624,7454720,196648,196608,684032,4285988864,40960,398336,200848,65536,200960,401408,7585792,209672,0,208896,33024,7366656,7399424,7432192,7356416,7389184,7421952,7409664,7442432,7344128,7376896,7419904,7452672,7354368,7387136,0,0
.long 536870912,536870912,536870912,536870912,0,0,50432,5265408,1091584,66944,536870912,4096,172288,180224,36864,7351296,656768,536870912,344576,282880,7471104,196652,196672,684032,4285988864,43008,398592,200852,98304,201088,405504,7700480,210056,0,208896,49408,7446528,7358464,7391232,7348224,7380992,7413760,7401472,7434240,7424000,7368704,7411712,7444480,7346176,7378944,0,0
.long 536870912,536870912,536870912,536870912,0,0,50688,5267456,1097728,67072,4480,4096,384,196608,40960,7352320,656896,274432,768,286720,7340032,196656,196608,698368,4286218240,12288,394752,200728,0,200704,393216,7364608,208908,0,208896,384,7383040,7340032,7372800,7405568,7438336,7350272,7426048,7415808,7360512,7393280,7436288,7448576,7370752,7403520,0,0
.long 536870912,536870912,536870912,536870912,0,0,50688,5269504,1099776,67200,536870912,4096,57728,212992,40960,7353344,657024,536870912,115456,286976,7356416,196660,196672,698368,4286218240,14336,395008,200732,32768,200832,397312,7479296,209292,0,208896,16768,7407616,7364608,7397376,7430144,7342080,7374848,7450624,7352320,7385088,7417856,7428096,7440384,7362560,7395328,0,0
.long 536870912,536870912,536870912,536870912,0,0,50944,5271552,1105920,67328,536870912,4096,115072,229376,45056,7354368,657152,536870912,230144,290816,7454720,196664,196608,698368,4286218240,45056,398848,200856,65536,200960,401408,7593984,209676,0,208896,33152,7432192,7356416,7389184,7421952,7366656,7399424,7442432,7344128,7376896,7409664,7452672,7354368,7387136,7419904,0,0
.long 536870912,536870912,536870912,536870912,0,0,50944,5273600,1107968,67456,536870912,4096,172416,245760,45056,7355392,657280,536870912,344832,291072,7471104,196668,196672,698368,4286218240,47104,399104,200860,98304,201088,405504,7708672,210060,0,208896,49536,7391232,7348224,7380992,7413760,7446528,7358464,7434240,7424000,7368704,7401472,7444480,7346176,7378944,7411712,0,0
.long 536870912,536870912,536870912,536870912,0,0,51200,5275648,1114112,67584,4608,4096,512,262144,49152,7356416,657408,278528,1024,294912,7340032,196672,196608,712704,4286447616,16384,395264,200736,0,200704,393216,7372800,208912,0,208896,512,7340032,7372800,7405568,7438336,7350272,7383040,7415808,7360512,7393280,7426048,7448576,7370752,7403520,7436288,0,0
.long 536870912,536870912,536870912,536870912,0,0,51200,5277696,1116160,67712,536870912,4096,57856,278528,49152,7357440,657536,536870912,115712,295168,7356416,196676,196672,712704,4286447616,18432,395520,200740,32768,200832,397312,7487488,209296,0,208896,16896,7364608,7397376,7430144,7342080,7374848,7407616,7352320,7385088,7417856,7450624,7440384,7362560,7395328,7428096,0,0
.long 536870912,536870912,536870912,536870912,0,0,51456,5279744,1122304,67840,536870912,4096,115200,294912,53248,7358464,657664,536870912,230400,299008,7454720,196680,196608,712704,4286447616,49152,399360,200864,65536,200960,401408,7602176,209680,0,208896,33280,7356416,7389184,7421952,7366656,7399424,7432192,7344128,7376896,7409664,7442432,7354368,7387136,7419904,7452672,0,0
.long 536870912,536870912,536870912,536870912,0,0,51456,5281792,1124352,67968,536870912,4096,172544,311296,53248,7359488,657792,536870912,345088,299264,7471104,196684,196672,712704,4286447616,51200,399616,200868,98304,201088,405504,7716864,210064,0,208896,49664,7348224,7380992,7413760,7446528,7358464,7391232,7424000,7368704,7401472,7434240,7346176,7378944,7411712,7444480,0,0
.long 536870912,536870912,536870912,536870912,0,0,51712,5283840,1130496,68096,4736,4096,640,327680,57344,7360512,657920,282624,1280,303104,7340032,196688,196608,727040,4286676992,20480,395776,200744,0,200704,393216,7380992,208916,0,208896,640,7405568,7438336,7350272,7383040,7340032,7372800,7360512,7393280,7426048,7415808,7370752,7403520,7436288,7448576,0,0
.long 536870912,536870912,536870912,536870912,0,0,51712,5285888,1132544,68224,536870912,4096,57984,344064,57344,7361536,658048,536870912,115968,303360,7356416,196692,196672,727040,4286676992,22528,396032,200748,32768,200832,397312,7495680,209300,0,208896,17024,7430144,7342080,7374848,7407616,7364608,7397376,7385088,7417856,7450624,7352320,7362560,7395328,7428096,7440384,0,0
.long 536870912,536870912,536870912,536870912,0,0,51968,5287936,1138688,68352,536870912,4096,115328,360448,61440,7362560,658176,536870912,230656,307200,7454720,196696,196608,727040,4286676992,53248,399872,200872,65536,200960,401408,7610368,209684,0,208896,33408,7421952,7366656,7399424,7432192,7356416,7389184,7376896,7409664,7442432,7344128,7387136,7419904,7452672,7354368,0,0
.long 536870912,536870912,536870912,536870912,0,0,51968,5289984,1140736,68480,536870912,4096,172672,376832,61440,7363584,658304,536870912,345344,307456,7471104,196700,196672,727040,4286676992,55296,400128,200876,98304,201088,405504,7725056,210068,0,208896,49792,7413760,7446528,7358464,7391232,7348224,7380992,7368704,7401472,7434240,7424000,7378944,7411712,7444480,7346176,0,0
.long 536870912,536870912,536870912,536870912,0,0,52224,5292032,1146880,68608,4864,4096,768,393216,65536,7364608,658432,286720,1536,311296,7340032,196704,196608,741376,4286906368,24576,396288,200752,0,200704,393216,7389184,208920,0,208896,768,7438336,7350272,7383040,7340032,7372800,7405568,7393280,7426048,7415808,7360512,7403520,7436288,7448576,7370752,0,0
.long 536870912,536870912,536870912,536870912,0,0,52224,5294080,1148928,68736,536870912,4096,58112,409600,65536,7365632,658560,536870912,116224,311552,7356416,196708,196672,741376,4286906368,26624,396544,200756,32768,200832,397312,7503872,209304,0,208896,17152,7342080,7374848,7407616,7364608,7397376,7430144,7417856,7450624,7352320,7385088,7395328,7428096,7440384,7362560,0,0
.long 536870912,536870912,536870912,536870912,0,0,52480,5296128,1155072,68864,536870912,4096,115456,425984,69632,7366656,658688,536870912,230912,315392,7454720,196712,196608,741376,4286906368,57344,400384,200880,65536,200960,401408,7618560,209688,0,208896,33536,7366656,7399424,7432192,7356416,7389184,7421952,7409664,7442432,7344128,7376896,7419904,7452672,7354368,7387136,0,0
.long 536870912,536870912,536870912,536870912,0,0,52480,5298176,1157120,68992,536870912,4096,172800,442368,69632,7367680,658816,536870912,345600,315648,7471104,196716,196672,741376,4286906368,59392,400640,200884,98304,201088,405504,7733248,210072,0,208896,49920,7446528,7358464,7391232,7348224,7380992,7413760,7401472,7434240,7424000,7368704,7411712,7444480,7346176,7378944,0,0
.long 536870912,536870912,536870912,536870912,0,0,52736,5300224,1163264,69120,4992,4096,896,458752,73728,7368704,658944,290816,1792,319488,7340032,196720,196608,755712,4287135744,28672,396800,200760,0,200704,393216,7397376,208924,0,208896,896,7383040,7340032,7372800,7405568,7438336,7350272,7426048,7415808,7360512,7393280,7436288,7448576,7370752,7403520,0,0
.long 536870912,536870912,536870912,536870912,0,0,52736,5302272,1165312,69248,536870912,4096,58240,475136,73728,7369728,659072,536870912,116480,319744,7356416,196724,196672,755712,4287135744,30720,397056,200764,32768,200832,397312,7512064,209308,0,208896,17280,7407616,7364608,7397376,7430144,7342080,7374848,7450624,7352320,7385088,7417856,7428096,7440384,7362560,7395328,0,0
.long 536870912,536870912,536870912,536870912,0,0,52992,5304320,1171456,69376,536870912,4096,115584,491520,77824,7370752,659200,536870912,231168,323584,7454720,196728,196608,755712,4287135744,61440,400896,200888,65536,200960,401408,7626752,209692,0,208896,33664,7432192,7356416,7389184,7421952,7366656,7399424,7442432,7344128,7376896,7409664,7452672,7354368,7387136,7419904,0,0
.long 536870912,536870912,536870912,536870912,0,0,52992,5306368,1173504,69504,536870912,4096,172928,507904,77824,7371776,659328,536870912,345856,323840,7471104,196732,196672,755712,4287135744,63488,401152,200892,98304,201088,405504,7741440,210076,0,208896,50048,7391232,7348224,7380992,7413760,7446528,7358464,7434240,7424000,7368704,7401472,7444480,7346176,7378944,7411712,0,0
.long 536870912,536870912,536870912,1048576,3233857728,3233857728,53248,5308416,1179648,69632,5120,4096,1024,524288,73728,7569408,659456,294912,2048,327680,7569408,196736,196736,655360,4285071360,65536,401408,200960,0,200704,393216,7405568,208928,0,209664,65536,7634944,7667712,7579648,7612416,7569408,7602176,7589888,7622656,7655424,7645184,7600128,7632896,7665664,7677952,0,0
.long 536870912,536870912,536870912,1052672,3233857728,3233857728,53248,5310464,1181696,69760,536870912,4096,58368,540672,73728,7570432,659584,536870912,116736,327936,7585792,196740,196800,655360,4285071360,67584,401664,200964,32768,200832,397312,7520256,209312,0,209664,81920,7659520,7571456,7604224,7636992,7593984,7626752,7614464,7647232,7680000,7581696,7591936,7624704,7657472,7669760,0,0
.long 536870912,536870912,536870912,1056768,3233857728,3233857728,53504,5312512,1187840,69888,536870912,4096,115712,557056,77824,7571456,659712,536870912,231424,331776,7684096,196744,196736,655360,4285071360,98304,405504,201088,65536,200960,401408,7634944,209696,0,209664,98304,7651328,7596032,7628800,7661568,7585792,7618560,7606272,7639040,7671808,7573504,7616512,7649280,7682048,7583744,0,0
.long 536870912,536870912,536870912,1060864,3233857728,3233857728,53504,5314560,1189888,70016,536870912,4096,173056,573440,77824,7572480,659840,536870912,346112,332032,7700480,196748,196800,655360,4285071360,100352,405760,201092,98304,201088,405504,7749632,210080,0,209664,114688,7643136,7675904,7587840,7620608,7577600,7610368,7598080,7630848,7663616,7653376,7608320,7641088,7673856,7575552,0,0
.long 536870912,536870912,536870912,1064960,3233857728,3233857728,53760,5316608,1196032,70144,5248,4096,1152,589824,16384,7573504,659968,299008,2304,335872,7569408,196752,196736,669696,4285300736,69632,401920,200968,0,200704,393216,7413760,208932,0,209664,65664,7667712,7579648,7612416,7569408,7602176,7634944,7622656,7655424,7645184,7589888,7632896,7665664,7677952,7600128,0,0
.long 536870912,536870912,536870912,1069056,3233857728,3233857728,53760,5318656,1198080,70272,536870912,4096,58496,606208,16384,7574528,660096,536870912,116992,336128,7585792,196756,196800,669696,4285300736,71680,402176,200972,32768,200832,397312,7528448,209316,0,209664,82048,7571456,7604224,7636992,7593984,7626752,7659520,7647232,7680000,7581696,7614464,7624704,7657472,7669760,7591936,0,0
.long 536870912,536870912,536870912,1073152,3233857728,3233857728,54016,5320704,1204224,70400,536870912,4096,115840,622592,20480,7575552,660224,536870912,231680,339968,7684096,196760,196736,669696,4285300736,102400,406016,201096,65536,200960,401408,7643136,209700,0,209664,98432,7596032,7628800,7661568,7585792,7618560,7651328,7639040,7671808,7573504,7606272,7649280,7682048,7583744,7616512,0,0
.long 536870912,536870912,536870912,1077248,3233857728,3233857728,54016,5322752,1206272,70528,536870912,4096,173184,638976,20480,7576576,660352,536870912,346368,340224,7700480,196764,196800,669696,4285300736,104448,406272,201100,98304,201088,405504,7757824,210084,0,209664,114816,7675904,7587840,7620608,7577600,7610368,7643136,7630848,7663616,7653376,7598080,7641088,7673856,7575552,7608320,0,0
.long 536870912,536870912,536870912,1081344,3233857728,3233857728,54272,5324800,1212416,70656,5376,4096,1280,655360,24576,7577600,660480,303104,2560,344064,7569408,196768,196736,684032,4285530112,73728,402432,200976,0,200704,393216,7421952,208936,0,209664,65792,7612416,7569408,7602176,7634944,7667712,7579648,7655424,7645184,7589888,7622656,7665664,7677952,7600128,7632896,0,0
.long 536870912,536870912,536870912,1085440,3233857728,3233857728,54272,5326848,1214464,70784,536870912,4096,58624,671744,24576,7578624,660608,536870912,117248,344320,7585792,196772,196800,684032,4285530112,75776,402688,200980,32768,200832,397312,7536640,209320,0,209664,82176,7636992,7593984,7626752,7659520,7571456,7604224,7680000,7581696,7614464,7647232,7657472,7669760,7591936,7624704,0,0
.long 536870912,536870912,536870912,1089536,3233857728,3233857728,54528,5328896,1220608,70912,536870912,4096,115968,688128,28672,7579648,660736,536870912,231936,348160,7684096,196776,196736,684032,4285530112,106496,406528,201104,65536,200960,401408,7651328,209704,0,209664,98560,7661568,7585792,7618560,7651328,7596032,7628800,7671808,7573504,7606272,7639040,7682048,7583744,7616512,7649280,0,0
.long 536870912,536870912,536870912,1093632,3233857728,3233857728,54528,5330944,1222656,71040,536870912,4096,173312,704512,28672,7580672,660864,536870912,346624,348416,7700480,196780,196800,684032,4285530112,108544,406784,201108,98304,201088,405504,7766016,210088,0,209664,114944,7620608,7577600,7610368,7643136,7675904,7587840,7663616,7653376,7598080,7630848,7673856,7575552,7608320,7641088,0,0
.long 536870912,536870912,536870912,1097728,3233857728,3233857728,54784,5332992,1228800,71168,5504,4096,1408,720896,32768,7581696,660992,307200,2816,352256,7569408,196784,196736,698368,4285759488,77824,402944,200984,0,200704,393216,7430144,208940,0,209664,65920,7569408,7602176,7634944,7667712,7579648,7612416,7645184,7589888,7622656,7655424,7677952,7600128,7632896,7665664,0,0
.long 536870912,536870912,536870912,1101824,3233857728,3233857728,54784,5335040,1230848,71296,536870912,4096,58752,737280,32768,7582720,661120,536870912,117504,352512,7585792,196788,196800,698368,4285759488,79872,403200,200988,32768,200832,397312,7544832,209324,0,209664,82304,7593984,7626752,7659520,7571456,7604224,7636992,7581696,7614464,7647232,7680000,7669760,7591936,7624704,7657472,0,0
.long 536870912,536870912,536870912,1105920,3233857728,3233857728,55040,5337088,1236992,71424,536870912,4096,116096,753664,36864,7583744,661248,536870912,232192,356352,7684096,196792,196736,698368,4285759488,110592,407040,201112,65536,200960,401408,7659520,209708,0,209664,98688,7585792,7618560,7651328,7596032,7628800,7661568,7573504,7606272,7639040,7671808,7583744,7616512,7649280,7682048,0,0
.long 536870912,536870912,536870912,1110016,3233857728,3233857728,55040,5339136,1239040,71552,536870912,4096,173440,770048,36864,7584768,661376,536870912,346880,356608,7700480,196796,196800,698368,4285759488,112640,407296,201116,98304,201088,405504,7774208,210092,0,209664,115072,7577600,7610368,7643136,7675904,7587840,7620608,7653376,7598080,7630848,7663616,7575552,7608320,7641088,7673856,0,0
.long 536870912,536870912,536870912,1114112,3233857728,3233857728,55296,5341184,1245184,71680,5632,4096,1536,786432,40960,7585792,661504,311296,3072,360448,7569408,196800,196736,712704,4285988864,81920,403456,200992,0,200704,393216,7438336,208944,0,209664,66048,7634944,7667712,7579648,7612416,7569408,7602176,7589888,7622656,7655424,7645184,7600128,7632896,7665664,7677952,0,0
.long 536870912,536870912,536870912,1118208,3233857728,3233857728,55296,5343232,1247232,71808,536870912,4096,58880,802816,40960,7586816,661632,536870912,117760,360704,7585792,196804,196800,712704,4285988864,83968,403712,200996,32768,200832,397312,7553024,209328,0,209664,82432,7659520,7571456,7604224,7636992,7593984,7626752,7614464,7647232,7680000,7581696,7591936,7624704,7657472,7669760,0,0
.long 536870912,536870912,536870912,1122304,3233857728,3233857728,55552,5345280,1253376,71936,536870912,4096,116224,819200,45056,7587840,661760,536870912,232448,364544,7684096,196808,196736,712704,4285988864,114688,407552,201120,65536,200960,401408,7667712,209712,0,209664,98816,7651328,7596032,7628800,7661568,7585792,7618560,7606272,7639040,7671808,7573504,7616512,7649280,7682048,7583744,0,0
.long 536870912,536870912,536870912,1126400,3233857728,3233857728,55552,5347328,1255424,72064,536870912,4096,173568,835584,45056,7588864,661888,536870912,347136,364800,7700480,196812,196800,712704,4285988864,116736,407808,201124,98304,201088,405504,7782400,210096,0,209664,115200,7643136,7675904,7587840,7620608,7577600,7610368,7598080,7630848,7663616,7653376,7608320,7641088,7673856,7575552,0,0
.long 536870912,536870912,536870912,1130496,3233857728,3233857728,55808,5349376,1261568,72192,5760,4096,1664,851968,49152,7589888,662016,315392,3328,368640,7569408,196816,196736,727040,4286218240,86016,403968,201000,0,200704,393216,7446528,208948,0,209664,66176,7667712,7579648,7612416,7569408,7602176,7634944,7622656,7655424,7645184,7589888,7632896,7665664,7677952,7600128,0,0
.long 536870912,536870912,536870912,1134592,3233857728,3233857728,55808,5351424,1263616,72320,536870912,4096,59008,868352,49152,7590912,662144,536870912,118016,368896,7585792,196820,196800,727040,4286218240,88064,404224,201004,32768,200832,397312,7561216,209332,0,209664,82560,7571456,7604224,7636992,7593984,7626752,7659520,7647232,7680000,7581696,7614464,7624704,7657472,7669760,7591936,0,0
.long 536870912,536870912,536870912,1138688,3233857728,3233857728,56064,5353472,1269760,72448,536870912,4096,116352,884736,53248,7591936,662272,536870912,232704,372736,7684096,196824,196736,727040,4286218240,118784,408064,201128,65536,200960,401408,7675904,209716,0,209664,98944,7596032,7628800,7661568,7585792,7618560,7651328,7639040,7671808,7573504,7606272,7649280,7682048,7583744,7616512,0,0
.long 536870912,536870912,536870912,1142784,3233857728,3233857728,56064,5355520,1271808,72576,536870912,4096,173696,901120,53248,7592960,662400,536870912,347392,372992,7700480,196828,196800,727040,4286218240,120832,408320,201132,98304,201088,405504,7790592,210100,0,209664,115328,7675904,7587840,7620608,7577600,7610368,7643136,7630848,7663616,7653376,7598080,7641088,7673856,7575552,7608320,0,0
.long 536870912,536870912,536870912,1146880,3233857728,3233857728,56320,5357568,1277952,72704,5888,4096,1792,917504,57344,7593984,662528,319488,3328,368640,7569408,196832,196736,741376,4286447616,90112,404480,201008,0,200704,393216,536870912,536870912,5242880,209664,66304,7612416,7569408,7602176,7634944,7667712,7579648,7655424,7645184,7589888,7622656,7665664,7677952,7600128,7632896,0,0
.long 536870912,536870912,536870912,1150976,3233857728,3233857728,56320,5359616,1280000,72832,536870912,4096,59136,933888,57344,7595008,662656,536870912,118016,368896,7585792,196836,196800,741376,4286447616,92160,404736,201012,32768,200832,397312,536870912,536870912,5242880,209664,82688,7636992,7593984,7626752,7659520,7571456,7604224,7680000,7581696,7614464,7647232,7657472,7669760,7591936,7624704,0,0
.long 536870912,536870912,536870912,1155072,3233857728,3233857728,56576,5361664,1286144,72960,536870912,4096,116480,950272,61440,7596032,662784,536870912,232704,372736,7684096,196840,196736,741376,4286447616,122880,408576,201136,65536,200960,401408,536870912,536870912,5242880,209664,99072,7661568,7585792,7618560,7651328,7596032,7628800,7671808,7573504,7606272,7639040,7682048,7583744,7616512,7649280,0,0
.long 536870912,536870912,536870912,1159168,3233857728,3233857728,56576,5363712,1288192,73088,536870912,4096,173824,966656,61440,7597056,662912,536870912,347392,372992,7700480,196844,196800,741376,4286447616,124928,408832,201140,98304,201088,405504,536870912,536870912,5242880,209664,115456,7620608,7577600,7610368,7643136,7675904,7587840,7663616,7653376,7598080,7630848,7673856,7575552,7608320,7641088,0,0
.long 536870912,536870912,536870912,1163264,3233857728,3233857728,56832,5365760,1294336,73216,6016,4096,1920,983040,65536,7598080,663040,323584,3328,368640,7569408,196848,196736,755712,4286676992,94208,404992,201016,0,200704,393216,536870912,536870912,5701632,209664,66432,7569408,7602176,7634944,7667712,7579648,7612416,7645184,7589888,7622656,7655424,7677952,7600128,7632896,7665664,0,0
.long 536870912,536870912,536870912,1167360,3233857728,3233857728,56832,5367808,1296384,73344,536870912,4096,59264,999424,65536,7599104,663168,536870912,118016,368896,7585792,196852,196800,755712,4286676992,96256,405248,201020,32768,200832,397312,536870912,536870912,5701632,209664,82816,7593984,7626752,7659520,7571456,7604224,7636992,7581696,7614464,7647232,7680000,7669760,7591936,7624704,7657472,0,0
.long 536870912,536870912,536870912,1171456,3233857728,3233857728,57088,5369856,1302528,73472,536870912,4096,116608,1015808,69632,7600128,663296,536870912,232704,372736,7684096,196856,196736,755712,4286676992,126976,409088,201144,65536,200960,401408,536870912,536870912,5701632,209664,99200,7585792,7618560,7651328,7596032,7628800,7661568,7573504,7606272,7639040,7671808,7583744,7616512,7649280,7682048,0,0
.long 536870912,536870912,536870912,1175552,3233857728,3233857728,57088,5371904,1304576,73600,536870912,4096,173952,1032192,69632,7601152,663424,536870912,347392,372992,7700480,196860,196800,755712,4286676992,129024,409344,201148,98304,201088,405504,536870912,536870912,5701632,209664,115584,7577600,7610368,7643136,7675904,7587840,7620608,7653376,7598080,7630848,7663616,7575552,7608320,7641088,7673856,0,0
.long 536870912,536870912,1048576,1179648,4042322160,4042322160,57344,5373952,1310720,73728,6144,6144,2048,1048576,65536,7798784,663552,327680,0,262144,7798784,196864,196864,655360,4284612608,131072,409600,201216,131072,201216,409600,7798784,210432,0,210432,131072,7897088,7809024,7841792,7798784,7831552,7864320,7852032,7884800,7874560,7819264,7862272,7895040,7907328,7829504,0,0
.long 536870912,536870912,1052672,1183744,4042322160,4042322160,57344,5376000,1312768,73856,536870912,6144,59392,1064960,65536,7799808,663680,536870912,114688,262400,7815168,196868,196928,655360,4284612608,133120,409856,201220,163840,201344,413696,7913472,210816,0,210432,147456,7800832,7833600,7866368,7823360,7856128,7888896,7876608,7909376,7811072,7843840,7854080,7886848,7899136,7821312,0,0
.long 536870912,536870912,1056768,1187840,4042322160,4042322160,57600,5378048,1318912,73984,536870912,6144,116736,1081344,69632,7800832,663808,536870912,229376,266240,7913472,196872,196864,655360,4284612608,163840,413696,201344,196608,201472,417792,8028160,211200,0,210432,163840,7825408,7858176,7890944,7815168,7847936,7880704,7868416,7901184,7802880,7835648,7878656,7911424,7813120,7845888,0,0
.long 536870912,536870912,1060864,1191936,4042322160,4042322160,57600,5380096,1320960,74112,536870912,6144,174080,1097728,69632,7801856,663936,536870912,344064,266496,7929856,196876,196928,655360,4284612608,165888,413952,201348,229376,201600,421888,8142848,211584,0,210432,180224,7905280,7817216,7849984,7806976,7839744,7872512,7860224,7892992,7882752,7827456,7870464,7903232,7804928,7837696,0,0
.long 536870912,536870912,1064960,1196032,4042322160,4042322160,57856,5382144,1327104,74240,6272,6144,2176,1114112,73728,7802880,664064,331776,256,270336,7798784,196880,196864,669696,4284841984,135168,410112,201224,131072,201216,409600,7806976,210436,0,210432,131200,7841792,7798784,7831552,7864320,7897088,7809024,7884800,7874560,7819264,7852032,7895040,7907328,7829504,7862272,0,0
.long 536870912,536870912,1069056,1200128,4042322160,4042322160,57856,5384192,1329152,74368,536870912,6144,59520,1130496,73728,7803904,664192,536870912,114944,270592,7815168,196884,196928,669696,4284841984,137216,410368,201228,163840,201344,413696,7921664,210820,0,210432,147584,7866368,7823360,7856128,7888896,7800832,7833600,7909376,7811072,7843840,7876608,7886848,7899136,7821312,7854080,0,0
.long 536870912,536870912,1073152,1204224,4042322160,4042322160,58112,5386240,1335296,74496,536870912,6144,116864,1146880,77824,7804928,664320,536870912,229632,274432,7913472,196888,196864,669696,4284841984,167936,414208,201352,196608,201472,417792,8036352,211204,0,210432,163968,7890944,7815168,7847936,7880704,7825408,7858176,7901184,7802880,7835648,7868416,7911424,7813120,7845888,7878656,0,0
.long 536870912,536870912,1077248,1208320,4042322160,4042322160,58112,5388288,1337344,74624,536870912,6144,174208,1163264,77824,7805952,664448,536870912,344320,274688,7929856,196892,196928,669696,4284841984,169984,414464,201356,229376,201600,421888,8151040,211588,0,210432,180352,7849984,7806976,7839744,7872512,7905280,7817216,7892992,7882752,7827456,7860224,7903232,7804928,7837696,7870464,0,0
.long 536870912,536870912,1081344,1212416,4042322160,4042322160,58368,5390336,1343488,74752,6400,6144,2304,1179648,16384,7806976,664576,335872,512,278528,7798784,196896,196864,684032,4285071360,139264,410624,201232,131072,201216,409600,7815168,210440,0,210432,131328,7798784,7831552,7864320,7897088,7809024,7841792,7874560,7819264,7852032,7884800,7907328,7829504,7862272,7895040,0,0
.long 536870912,536870912,1085440,1216512,4042322160,4042322160,58368,5392384,1345536,74880,536870912,6144,59648,1196032,16384,7808000,664704,536870912,115200,278784,7815168,196900,196928,684032,4285071360,141312,410880,201236,163840,201344,413696,7929856,210824,0,210432,147712,7823360,7856128,7888896,7800832,7833600,7866368,7811072,7843840,7876608,7909376,7899136,7821312,7854080,7886848,0,0
.long 536870912,536870912,1089536,1220608,4042322160,4042322160,58624,5394432,1351680,75008,536870912,6144,116992,1212416,20480,7809024,664832,536870912,229888,282624,7913472,196904,196864,684032,4285071360,172032,414720,201360,196608,201472,417792,8044544,211208,0,210432,164096,7815168,7847936,7880704,7825408,7858176,7890944,7802880,7835648,7868416,7901184,7813120,7845888,7878656,7911424,0,0
.long 536870912,536870912,1093632,1224704,4042322160,4042322160,58624,5396480,1353728,75136,536870912,6144,174336,1228800,20480,7810048,664960,536870912,344576,282880,7929856,196908,196928,684032,4285071360,174080,414976,201364,229376,201600,421888,8159232,211592,0,210432,180480,7806976,7839744,7872512,7905280,7817216,7849984,7882752,7827456,7860224,7892992,7804928,7837696,7870464,7903232,0,0
.long 536870912,536870912,1097728,1228800,4042322160,4042322160,58880,5398528,1359872,75264,6528,6144,2432,1245184,24576,7811072,665088,339968,768,286720,7798784,196912,196864,698368,4285300736,143360,411136,201240,131072,201216,409600,7823360,210444,0,210432,131456,7864320,7897088,7809024,7841792,7798784,7831552,7819264,7852032,7884800,7874560,7829504,7862272,7895040,7907328,0,0
.long 536870912,536870912,1101824,1232896,4042322160,4042322160,58880,5400576,1361920,75392,536870912,6144,59776,1261568,24576,7812096,665216,536870912,115456,286976,7815168,196916,196928,698368,4285300736,145408,411392,201244,163840,201344,413696,7938048,210828,0,210432,147840,7888896,7800832,7833600,7866368,7823360,7856128,7843840,7876608,7909376,7811072,7821312,7854080,7886848,7899136,0,0
.long 536870912,536870912,1105920,1236992,4042322160,4042322160,59136,5402624,1368064,75520,536870912,6144,117120,1277952,28672,7813120,665344,536870912,230144,290816,7913472,196920,196864,698368,4285300736,176128,415232,201368,196608,201472,417792,8052736,211212,0,210432,164224,7880704,7825408,7858176,7890944,7815168,7847936,7835648,7868416,7901184,7802880,7845888,7878656,7911424,7813120,0,0
.long 536870912,536870912,1110016,1241088,4042322160,4042322160,59136,5404672,1370112,75648,536870912,6144,174464,1294336,28672,7814144,665472,536870912,344832,291072,7929856,196924,196928,698368,4285300736,178176,415488,201372,229376,201600,421888,8167424,211596,0,210432,180608,7872512,7905280,7817216,7849984,7806976,7839744,7827456,7860224,7892992,7882752,7837696,7870464,7903232,7804928,0,0
.long 536870912,536870912,1114112,1245184,4042322160,4042322160,59392,5406720,1376256,75776,6656,6144,2560,1310720,32768,7815168,665600,344064,1024,294912,7798784,196928,196864,712704,4285530112,147456,411648,201248,131072,201216,409600,7831552,210448,0,210432,131584,7897088,7809024,7841792,7798784,7831552,7864320,7852032,7884800,7874560,7819264,7862272,7895040,7907328,7829504,0,0
.long 536870912,536870912,1118208,1249280,4042322160,4042322160,59392,5408768,1378304,75904,536870912,6144,59904,1327104,32768,7816192,665728,536870912,115712,295168,7815168,196932,196928,712704,4285530112,149504,411904,201252,163840,201344,413696,7946240,210832,0,210432,147968,7800832,7833600,7866368,7823360,7856128,7888896,7876608,7909376,7811072,7843840,7854080,7886848,7899136,7821312,0,0
.long 536870912,536870912,1122304,1253376,4042322160,4042322160,59648,5410816,1384448,76032,536870912,6144,117248,1343488,36864,7817216,665856,536870912,230400,299008,7913472,196936,196864,712704,4285530112,180224,415744,201376,196608,201472,417792,8060928,211216,0,210432,164352,7825408,7858176,7890944,7815168,7847936,7880704,7868416,7901184,7802880,7835648,7878656,7911424,7813120,7845888,0,0
.long 536870912,536870912,1126400,1257472,4042322160,4042322160,59648,5412864,1386496,76160,536870912,6144,174592,1359872,36864,7818240,665984,536870912,345088,299264,7929856,196940,196928,712704,4285530112,182272,416000,201380,229376,201600,421888,8175616,211600,0,210432,180736,7905280,7817216,7849984,7806976,7839744,7872512,7860224,7892992,7882752,7827456,7870464,7903232,7804928,7837696,0,0
.long 536870912,536870912,1130496,1261568,4042322160,4042322160,59904,5414912,1392640,76288,6784,6144,2688,1376256,40960,7819264,666112,348160,1280,303104,7798784,196944,196864,727040,4285759488,151552,412160,201256,131072,201216,409600,7839744,210452,0,210432,131712,7841792,7798784,7831552,7864320,7897088,7809024,7884800,7874560,7819264,7852032,7895040,7907328,7829504,7862272,0,0
.long 536870912,536870912,1134592,1265664,4042322160,4042322160,59904,5416960,1394688,76416,536870912,6144,60032,1392640,40960,7820288,666240,536870912,115968,303360,7815168,196948,196928,727040,4285759488,153600,412416,201260,163840,201344,413696,7954432,210836,0,210432,148096,7866368,7823360,7856128,7888896,7800832,7833600,7909376,7811072,7843840,7876608,7886848,7899136,7821312,7854080,0,0
.long 536870912,536870912,1138688,1269760,4042322160,4042322160,60160,5419008,1400832,76544,536870912,6144,117376,1409024,45056,7821312,666368,536870912,230656,307200,7913472,196952,196864,727040,4285759488,184320,416256,201384,196608,201472,417792,8069120,211220,0,210432,164480,7890944,7815168,7847936,7880704,7825408,7858176,7901184,7802880,7835648,7868416,7911424,7813120,7845888,7878656,0,0
.long 536870912,536870912,1142784,1273856,4042322160,4042322160,60160,5421056,1402880,76672,536870912,6144,174720,1425408,45056,7822336,666496,536870912,345344,307456,7929856,196956,196928,727040,4285759488,186368,416512,201388,229376,201600,421888,8183808,211604,0,210432,180864,7849984,7806976,7839744,7872512,7905280,7817216,7892992,7882752,7827456,7860224,7903232,7804928,7837696,7870464,0,0
.long 536870912,536870912,1146880,1277952,4042322160,4042322160,60416,5423104,1409024,76800,6912,6144,2816,1441792,49152,7823360,666624,352256,1536,311296,7798784,196960,196864,741376,4285988864,155648,412672,201264,131072,201216,409600,7847936,210456,0,210432,131840,7798784,7831552,7864320,7897088,7809024,7841792,7874560,7819264,7852032,7884800,7907328,7829504,7862272,7895040,0,0
.long 536870912,536870912,1150976,1282048,4042322160,4042322160,60416,5425152,1411072,76928,536870912,6144,60160,1458176,49152,7824384,666752,536870912,116224,311552,7815168,196964,196928,741376,4285988864,157696,412928,201268,163840,201344,413696,7962624,210840,0,210432,148224,7823360,7856128,7888896,7800832,7833600,7866368,7811072,7843840,7876608,7909376,7899136,7821312,7854080,7886848,0,0
.long 536870912,536870912,1155072,1286144,4042322160,4042322160,60672,5427200,1417216,77056,536870912,6144,117504,1474560,53248,7825408,666880,536870912,230912,315392,7913472,196968,196864,741376,4285988864,188416,416768,201392,196608,201472,417792,8077312,211224,0,210432,164608,7815168,7847936,7880704,7825408,7858176,7890944,7802880,7835648,7868416,7901184,7813120,7845888,7878656,7911424,0,0
.long 536870912,536870912,1159168,1290240,4042322160,4042322160,60672,5429248,1419264,77184,536870912,6144,174848,1490944,53248,7826432,667008,536870912,345600,315648,7929856,196972,196928,741376,4285988864,190464,417024,201396,229376,201600,421888,8192000,211608,0,210432,180992,7806976,7839744,7872512,7905280,7817216,7849984,7882752,7827456,7860224,7892992,7804928,7837696,7870464,7903232,0,0
.long 536870912,536870912,1163264,1294336,4042322160,4042322160,60928,5431296,1425408,77312,7040,6144,2944,1507328,57344,7827456,667136,356352,1792,319488,7798784,196976,196864,755712,4286218240,159744,413184,201272,131072,201216,409600,7856128,210460,0,210432,131968,7864320,7897088,7809024,7841792,7798784,7831552,7819264,7852032,7884800,7874560,7829504,7862272,7895040,7907328,0,0
.long 536870912,536870912,1167360,1298432,4042322160,4042322160,60928,5433344,1427456,77440,536870912,6144,60288,1523712,57344,7828480,667264,536870912,116480,319744,7815168,196980,196928,755712,4286218240,161792,413440,201276,163840,201344,413696,7970816,210844,0,210432,148352,7888896,7800832,7833600,7866368,7823360,7856128,7843840,7876608,7909376,7811072,7821312,7854080,7886848,7899136,0,0
.long 536870912,536870912,1171456,1302528,4042322160,4042322160,61184,5435392,1433600,77568,536870912,6144,117632,1540096,61440,7829504,667392,536870912,231168,323584,7913472,196984,196864,755712,4286218240,192512,417280,201400,196608,201472,417792,8085504,211228,0,210432,164736,7880704,7825408,7858176,7890944,7815168,7847936,7835648,7868416,7901184,7802880,7845888,7878656,7911424,7813120,0,0
.long 536870912,536870912,1175552,1306624,4042322160,4042322160,61184,5437440,1435648,77696,536870912,6144,174976,1556480,61440,7830528,667520,536870912,345856,323840,7929856,196988,196928,755712,4286218240,194560,417536,201404,229376,201600,421888,8200192,211612,0,210432,181120,7872512,7905280,7817216,7849984,7806976,7839744,7827456,7860224,7892992,7882752,7837696,7870464,7903232,7804928,0,0
.long 536870912,1048576,1179648,1310720,4244438268,4244438268,61440,5439488,1441792,77824,7168,6144,3072,1572864,57344,8028160,667648,360448,2048,327680,8028160,196992,196992,655360,4284153856,196608,417792,201472,131072,201216,409600,7864320,210464,0,211200,196608,8071168,8028160,8060928,8093696,8126464,8038400,8114176,8103936,8048640,8081408,8124416,8136704,8058880,8091648,0,0
.long 536870912,1052672,1183744,1314816,4244438268,4244438268,61440,5441536,1443840,77952,536870912,6144,60416,1589248,57344,8029184,667776,536870912,116736,327936,8044544,196996,197056,655360,4284153856,198656,418048,201476,163840,201344,413696,7979008,210848,0,211200,212992,8095744,8052736,8085504,8118272,8030208,8062976,8138752,8040448,8073216,8105984,8116224,8128512,8050688,8083456,0,0
.long 536870912,1056768,1187840,1318912,4244438268,4244438268,61696,5443584,1449984,78080,536870912,6144,117760,1605632,61440,8030208,667904,536870912,231424,331776,8142848,197000,196992,655360,4284153856,229376,421888,201600,196608,201472,417792,8093696,211232,0,211200,229376,8120320,8044544,8077312,8110080,8054784,8087552,8130560,8032256,8065024,8097792,8140800,8042496,8075264,8108032,0,0
.long 536870912,1060864,1191936,1323008,4244438268,4244438268,61696,5445632,1452032,78208,536870912,6144,175104,1622016,61440,8031232,668032,536870912,346112,332032,8159232,197004,197056,655360,4284153856,231424,422144,201604,229376,201600,421888,8208384,211616,0,211200,245760,8079360,8036352,8069120,8101888,8134656,8046592,8122368,8112128,8056832,8089600,8132608,8034304,8067072,8099840,0,0
.long 536870912,1064960,1196032,1327104,4244438268,4244438268,61952,5447680,1458176,78336,7296,6144,3200,1638400,65536,8032256,668160,364544,2304,335872,8028160,197008,196992,669696,4284383232,200704,418304,201480,131072,201216,409600,7872512,210468,0,211200,196736,8028160,8060928,8093696,8126464,8038400,8071168,8103936,8048640,8081408,8114176,8136704,8058880,8091648,8124416,0,0
.long 536870912,1069056,1200128,1331200,4244438268,4244438268,61952,5449728,1460224,78464,536870912,6144,60544,1654784,65536,8033280,668288,536870912,116992,336128,8044544,197012,197056,669696,4284383232,202752,418560,201484,163840,201344,413696,7987200,210852,0,211200,213120,8052736,8085504,8118272,8030208,8062976,8095744,8040448,8073216,8105984,8138752,8128512,8050688,8083456,8116224,0,0
.long 536870912,1073152,1204224,1335296,4244438268,4244438268,62208,5451776,1466368,78592,536870912,6144,117888,1671168,69632,8034304,668416,536870912,231680,339968,8142848,197016,196992,669696,4284383232,233472,422400,201608,196608,201472,417792,8101888,211236,0,211200,229504,8044544,8077312,8110080,8054784,8087552,8120320,8032256,8065024,8097792,8130560,8042496,8075264,8108032,8140800,0,0
.long 536870912,1077248,1208320,1339392,4244438268,4244438268,62208,5453824,1468416,78720,536870912,6144,175232,1687552,69632,8035328,668544,536870912,346368,340224,8159232,197020,197056,669696,4284383232,235520,422656,201612,229376,201600,421888,8216576,211620,0,211200,245888,8036352,8069120,8101888,8134656,8046592,8079360,8112128,8056832,8089600,8122368,8034304,8067072,8099840,8132608,0,0
.long 536870912,1081344,1212416,1343488,4244438268,4244438268,62464,5455872,1474560,78848,7424,6144,3328,1703936,73728,8036352,668672,368640,2560,344064,8028160,197024,196992,684032,4284612608,204800,418816,201488,131072,201216,409600,7880704,210472,0,211200,196864,8093696,8126464,8038400,8071168,8028160,8060928,8048640,8081408,8114176,8103936,8058880,8091648,8124416,8136704,0,0
.long 536870912,1085440,1216512,1347584,4244438268,4244438268,62464,5457920,1476608,78976,536870912,6144,60672,1720320,73728,8037376,668800,536870912,117248,344320,8044544,197028,197056,684032,4284612608,206848,419072,201492,163840,201344,413696,7995392,210856,0,211200,213248,8118272,8030208,8062976,8095744,8052736,8085504,8073216,8105984,8138752,8040448,8050688,8083456,8116224,8128512,0,0
.long 536870912,1089536,1220608,1351680,4244438268,4244438268,62720,5459968,1482752,79104,536870912,6144,118016,1736704,77824,8038400,668928,536870912,231936,348160,8142848,197032,196992,684032,4284612608,237568,422912,201616,196608,201472,417792,8110080,211240,0,211200,229632,8110080,8054784,8087552,8120320,8044544,8077312,8065024,8097792,8130560,8032256,8075264,8108032,8140800,8042496,0,0
.long 536870912,1093632,1224704,1355776,4244438268,4244438268,62720,5462016,1484800,79232,536870912,6144,175360,1753088,77824,8039424,669056,536870912,346624,348416,8159232,197036,197056,684032,4284612608,239616,423168,201620,229376,201600,421888,8224768,211624,0,211200,246016,8101888,8134656,8046592,8079360,8036352,8069120,8056832,8089600,8122368,8112128,8067072,8099840,8132608,8034304,0,0
.long 536870912,1097728,1228800,1359872,4244438268,4244438268,62976,5464064,1490944,79360,7552,6144,3456,1769472,16384,8040448,669184,372736,2816,352256,8028160,197040,196992,698368,4284841984,208896,419328,201496,131072,201216,409600,7888896,210476,0,211200,196992,8126464,8038400,8071168,8028160,8060928,8093696,8081408,8114176,8103936,8048640,8091648,8124416,8136704,8058880,0,0
.long 536870912,1101824,1232896,1363968,4244438268,4244438268,62976,5466112,1492992,79488,536870912,6144,60800,1785856,16384,8041472,669312,536870912,117504,352512,8044544,197044,197056,698368,4284841984,210944,419584,201500,163840,201344,413696,8003584,210860,0,211200,213376,8030208,8062976,8095744,8052736,8085504,8118272,8105984,8138752,8040448,8073216,8083456,8116224,8128512,8050688,0,0
.long 536870912,1105920,1236992,1368064,4244438268,4244438268,63232,5468160,1499136,79616,536870912,6144,118144,1802240,20480,8042496,669440,536870912,232192,356352,8142848,197048,196992,698368,4284841984,241664,423424,201624,196608,201472,417792,8118272,211244,0,211200,229760,8054784,8087552,8120320,8044544,8077312,8110080,8097792,8130560,8032256,8065024,8108032,8140800,8042496,8075264,0,0
.long 536870912,1110016,1241088,1372160,4244438268,4244438268,63232,5470208,1501184,79744,536870912,6144,175488,1818624,20480,8043520,669568,536870912,346880,356608,8159232,197052,197056,698368,4284841984,243712,423680,201628,229376,201600,421888,8232960,211628,0,211200,246144,8134656,8046592,8079360,8036352,8069120,8101888,8089600,8122368,8112128,8056832,8099840,8132608,8034304,8067072,0,0
.long 536870912,1114112,1245184,1376256,4244438268,4244438268,63488,5472256,1507328,79872,7680,6144,229376,128,24576,8044544,669696,262656,3072,360448,8028160,197056,196992,712704,4285071360,212992,419840,201504,131072,201216,409600,7897088,210480,0,211200,197120,8071168,8028160,8060928,8093696,8126464,8038400,8114176,8103936,8048640,8081408,8124416,8136704,8058880,8091648,0,0
.long 536870912,1118208,1249280,1380352,4244438268,4244438268,63488,5474304,1509376,80000,536870912,6144,286720,16512,24576,8045568,669824,536870912,117760,360704,8044544,197060,197056,712704,4285071360,215040,420096,201508,163840,201344,413696,8011776,210864,0,211200,213504,8095744,8052736,8085504,8118272,8030208,8062976,8138752,8040448,8073216,8105984,8116224,8128512,8050688,8083456,0,0
.long 536870912,1122304,1253376,1384448,4244438268,4244438268,63744,5476352,1515520,80128,536870912,6144,344064,32896,28672,8046592,669952,536870912,232448,364544,8142848,197064,196992,712704,4285071360,245760,423936,201632,196608,201472,417792,8126464,211248,0,211200,229888,8120320,8044544,8077312,8110080,8054784,8087552,8130560,8032256,8065024,8097792,8140800,8042496,8075264,8108032,0,0
.long 536870912,1126400,1257472,1388544,4244438268,4244438268,63744,5478400,1517568,80256,536870912,6144,401408,49280,28672,8047616,670080,536870912,347136,364800,8159232,197068,197056,712704,4285071360,247808,424192,201636,229376,201600,421888,8241152,211632,0,211200,246272,8079360,8036352,8069120,8101888,8134656,8046592,8122368,8112128,8056832,8089600,8132608,8034304,8067072,8099840,0,0
.long 536870912,1130496,1261568,1392640,4244438268,4244438268,64000,5480448,1523712,80384,7808,6144,229504,65664,32768,8048640,670208,266752,3328,368640,8028160,197072,196992,727040,4285300736,217088,420352,201512,131072,201216,409600,7905280,210484,0,211200,197248,8028160,8060928,8093696,8126464,8038400,8071168,8103936,8048640,8081408,8114176,8136704,8058880,8091648,8124416,0,0
.long 536870912,1134592,1265664,1396736,4244438268,4244438268,64000,5482496,1525760,80512,536870912,6144,286848,82048,32768,8049664,670336,536870912,118016,368896,8044544,197076,197056,727040,4285300736,219136,420608,201516,163840,201344,413696,8019968,210868,0,211200,213632,8052736,8085504,8118272,8030208,8062976,8095744,8040448,8073216,8105984,8138752,8128512,8050688,8083456,8116224,0,0
.long 536870912,1138688,1269760,1400832,4244438268,4244438268,64256,5484544,1531904,80640,536870912,6144,344192,98432,36864,8050688,670464,536870912,232704,372736,8142848,197080,196992,727040,4285300736,249856,424448,201640,196608,201472,417792,8134656,211252,0,211200,230016,8044544,8077312,8110080,8054784,8087552,8120320,8032256,8065024,8097792,8130560,8042496,8075264,8108032,8140800,0,0
.long 536870912,1142784,1273856,1404928,4244438268,4244438268,64256,5486592,1533952,80768,536870912,6144,401536,114816,36864,8051712,670592,536870912,347392,372992,8159232,197084,197056,727040,4285300736,251904,424704,201644,229376,201600,421888,8249344,211636,0,211200,246400,8036352,8069120,8101888,8134656,8046592,8079360,8112128,8056832,8089600,8122368,8034304,8067072,8099840,8132608,0,0
.long 536870912,1146880,1277952,1409024,4244438268,4244438268,64512,5488640,1540096,80896,7936,6144,229632,131200,40960,8052736,670720,270848,3328,368640,8028160,197088,196992,741376,4285530112,221184,420864,201520,131072,201216,409600,536870912,536870912,6160384,211200,197376,8093696,8126464,8038400,8071168,8028160,8060928,8048640,8081408,8114176,8103936,8058880,8091648,8124416,8136704,0,0
.long 536870912,1150976,1282048,1413120,4244438268,4244438268,64512,5490688,1542144,81024,536870912,6144,286976,147584,40960,8053760,670848,536870912,118016,368896,8044544,197092,197056,741376,4285530112,223232,421120,201524,163840,201344,413696,536870912,536870912,6160384,211200,213760,8118272,8030208,8062976,8095744,8052736,8085504,8073216,8105984,8138752,8040448,8050688,8083456,8116224,8128512,0,0
.long 536870912,1155072,1286144,1417216,4244438268,4244438268,64768,5492736,1548288,81152,536870912,6144,344320,163968,45056,8054784,670976,536870912,232704,372736,8142848,197096,196992,741376,4285530112,253952,424960,201648,196608,201472,417792,536870912,536870912,6160384,211200,230144,8110080,8054784,8087552,8120320,8044544,8077312,8065024,8097792,8130560,8032256,8075264,8108032,8140800,8042496,0,0
.long 536870912,1159168,1290240,1421312,4244438268,4244438268,64768,5494784,1550336,81280,536870912,6144,401664,180352,45056,8055808,671104,536870912,347392,372992,8159232,197100,197056,741376,4285530112,256000,425216,201652,229376,201600,421888,536870912,536870912,6160384,211200,246528,8101888,8134656,8046592,8079360,8036352,8069120,8056832,8089600,8122368,8112128,8067072,8099840,8132608,8034304,0,0
.long 536870912,1163264,1294336,1425408,4244438268,4244438268,65024,5496832,1556480,81408,8064,6144,229760,196736,49152,8056832,671232,274944,3328,368640,8028160,197104,196992,755712,4285759488,225280,421376,201528,131072,201216,409600,536870912,536870912,6619136,211200,197504,8126464,8038400,8071168,8028160,8060928,8093696,8081408,8114176,8103936,8048640,8091648,8124416,8136704,8058880,0,0
.long 536870912,1167360,1298432,1429504,4244438268,4244438268,65024,5498880,1558528,81536,536870912,6144,287104,213120,49152,8057856,671360,536870912,118016,368896,8044544,197108,197056,755712,4285759488,227328,421632,201532,163840,201344,413696,536870912,536870912,6619136,211200,213888,8030208,8062976,8095744,8052736,8085504,8118272,8105984,8138752,8040448,8073216,8083456,8116224,8128512,8050688,0,0
.long 536870912,1171456,1302528,1433600,4244438268,4244438268,65280,5500928,1564672,81664,536870912,6144,344448,229504,53248,8058880,671488,536870912,232704,372736,8142848,197112,196992,755712,4285759488,258048,425472,201656,196608,201472,417792,536870912,536870912,6619136,211200,230272,8054784,8087552,8120320,8044544,8077312,8110080,8097792,8130560,8032256,8065024,8108032,8140800,8042496,8075264,0,0
.long 536870912,1175552,1306624,1437696,4244438268,4244438268,65280,5502976,1566720,81792,536870912,6144,401792,245888,53248,8059904,671616,536870912,347392,372992,8159232,197116,197056,755712,4285759488,260096,425728,201660,229376,201600,421888,536870912,536870912,6619136,211200,246656,8134656,8046592,8079360,8036352,8069120,8101888,8089600,8122368,8112128,8056832,8099840,8132608,8034304,8067072,0,0
.long 1048576,1179648,1310720,1441792,4294967295,4294967295,65536,5505024,1572864,81920,8192,8192,229888,262272,49152,8257536,671744,279040,0,262144,8257536,197120,197120,655360,4283695104,262144,425984,201728,262144,201728,425984,8257536,211968,0,211968,262144,8257536,8290304,8323072,8355840,8267776,8300544,8333312,8278016,8310784,8343552,8366080,8288256,8321024,8353792,0,0
.long 1052672,1183744,1314816,1445888,4294967295,4294967295,65536,5507072,1574912,82048,536870912,8192,287232,278656,49152,8258560,671872,536870912,114688,262400,8273920,197124,197184,655360,4283695104,264192,426240,201732,294912,201856,430080,8372224,212352,0,211968,278528,8282112,8314880,8347648,8259584,8292352,8325120,8269824,8302592,8335360,8368128,8357888,8280064,8312832,8345600,0,0
.long 1056768,1187840,1318912,1449984,4294967295,4294967295,65792,5509120,1581056,82176,536870912,8192,344576,295040,53248,8259584,672000,536870912,229376,266240,8372224,197128,197120,655360,4283695104,294912,430080,201856,327680,201984,434176,8486912,212736,0,211968,294912,8273920,8306688,8339456,8284160,8316928,8349696,8261632,8294400,8327168,8359936,8271872,8304640,8337408,8370176,0,0
.long 1060864,1191936,1323008,1454080,4294967295,4294967295,65792,5511168,1583104,82304,536870912,8192,401920,311424,53248,8260608,672128,536870912,344064,266496,8388608,197132,197184,655360,4283695104,296960,430336,201860,360448,202112,438272,8601600,213120,0,211968,311296,8265728,8298496,8331264,8364032,8275968,8308736,8341504,8286208,8318976,8351744,8263680,8296448,8329216,8361984,0,0
.long 1064960,1196032,1327104,1458176,4294967295,4294967295,66048,5513216,1589248,82432,8320,8192,230016,327808,57344,8261632,672256,283136,256,270336,8257536,197136,197120,669696,4283924480,266240,426496,201736,262144,201728,425984,8265728,211972,0,211968,262272,8323072,8355840,8267776,8300544,8257536,8290304,8278016,8310784,8343552,8333312,8288256,8321024,8353792,8366080,0,0
.long 1069056,1200128,1331200,1462272,4294967295,4294967295,66048,5515264,1591296,82560,536870912,8192,287360,344192,57344,8262656,672384,536870912,114944,270592,8273920,197140,197184,669696,4283924480,268288,426752,201740,294912,201856,430080,8380416,212356,0,211968,278656,8347648,8259584,8292352,8325120,8282112,8314880,8302592,8335360,8368128,8269824,8280064,8312832,8345600,8357888,0,0
.long 1073152,1204224,1335296,1466368,4294967295,4294967295,66304,5517312,1597440,82688,536870912,8192,344704,360576,61440,8263680,672512,536870912,229632,274432,8372224,197144,197120,669696,4283924480,299008,430592,201864,327680,201984,434176,8495104,212740,0,211968,295040,8339456,8284160,8316928,8349696,8273920,8306688,8294400,8327168,8359936,8261632,8304640,8337408,8370176,8271872,0,0
.long 1077248,1208320,1339392,1470464,4294967295,4294967295,66304,5519360,1599488,82816,536870912,8192,402048,376960,61440,8264704,672640,536870912,344320,274688,8388608,197148,197184,669696,4283924480,301056,430848,201868,360448,202112,438272,8609792,213124,0,211968,311424,8331264,8364032,8275968,8308736,8265728,8298496,8286208,8318976,8351744,8341504,8296448,8329216,8361984,8263680,0,0
.long 1081344,1212416,1343488,1474560,4294967295,4294967295,66560,5521408,1605632,82944,8448,8192,230144,393344,65536,8265728,672768,287232,512,278528,8257536,197152,197120,684032,4284153856,270336,427008,201744,262144,201728,425984,8273920,211976,0,211968,262400,8355840,8267776,8300544,8257536,8290304,8323072,8310784,8343552,8333312,8278016,8321024,8353792,8366080,8288256,0,0
.long 1085440,1216512,1347584,1478656,4294967295,4294967295,66560,5523456,1607680,83072,536870912,8192,287488,409728,65536,8266752,672896,536870912,115200,278784,8273920,197156,197184,684032,4284153856,272384,427264,201748,294912,201856,430080,8388608,212360,0,211968,278784,8259584,8292352,8325120,8282112,8314880,8347648,8335360,8368128,8269824,8302592,8312832,8345600,8357888,8280064,0,0
.long 1089536,1220608,1351680,1482752,4294967295,4294967295,66816,5525504,1613824,83200,536870912,8192,344832,426112,69632,8267776,673024,536870912,229888,282624,8372224,197160,197120,684032,4284153856,303104,431104,201872,327680,201984,434176,8503296,212744,0,211968,295168,8284160,8316928,8349696,8273920,8306688,8339456,8327168,8359936,8261632,8294400,8337408,8370176,8271872,8304640,0,0
.long 1093632,1224704,1355776,1486848,4294967295,4294967295,66816,5527552,1615872,83328,536870912,8192,402176,442496,69632,8268800,673152,536870912,344576,282880,8388608,197164,197184,684032,4284153856,305152,431360,201876,360448,202112,438272,8617984,213128,0,211968,311552,8364032,8275968,8308736,8265728,8298496,8331264,8318976,8351744,8341504,8286208,8329216,8361984,8263680,8296448,0,0
.long 1097728,1228800,1359872,1490944,4294967295,4294967295,67072,5529600,1622016,83456,8576,8192,230272,458880,73728,8269824,673280,291328,768,286720,8257536,197168,197120,698368,4284383232,274432,427520,201752,262144,201728,425984,8282112,211980,0,211968,262528,8300544,8257536,8290304,8323072,8355840,8267776,8343552,8333312,8278016,8310784,8353792,8366080,8288256,8321024,0,0
.long 1101824,1232896,1363968,1495040,4294967295,4294967295,67072,5531648,1624064,83584,536870912,8192,287616,475264,73728,8270848,673408,536870912,115456,286976,8273920,197172,197184,698368,4284383232,276480,427776,201756,294912,201856,430080,8396800,212364,0,211968,278912,8325120,8282112,8314880,8347648,8259584,8292352,8368128,8269824,8302592,8335360,8345600,8357888,8280064,8312832,0,0
.long 1105920,1236992,1368064,1499136,4294967295,4294967295,67328,5533696,1630208,83712,536870912,8192,344960,491648,77824,8271872,673536,536870912,230144,290816,8372224,197176,197120,698368,4284383232,307200,431616,201880,327680,201984,434176,8511488,212748,0,211968,295296,8349696,8273920,8306688,8339456,8284160,8316928,8359936,8261632,8294400,8327168,8370176,8271872,8304640,8337408,0,0
.long 1110016,1241088,1372160,1503232,4294967295,4294967295,67328,5535744,1632256,83840,536870912,8192,402304,508032,77824,8272896,673664,536870912,344832,291072,8388608,197180,197184,698368,4284383232,309248,431872,201884,360448,202112,438272,8626176,213132,0,211968,311680,8308736,8265728,8298496,8331264,8364032,8275968,8351744,8341504,8286208,8318976,8361984,8263680,8296448,8329216,0,0
.long 1114112,1245184,1376256,1507328,4294967295,4294967295,67584,5537792,1638400,83968,8704,8192,230400,524416,16384,8273920,673792,295424,1024,294912,8257536,197184,197120,712704,4284612608,278528,428032,201760,262144,201728,425984,8290304,211984,0,211968,262656,8257536,8290304,8323072,8355840,8267776,8300544,8333312,8278016,8310784,8343552,8366080,8288256,8321024,8353792,0,0
.long 1118208,1249280,1380352,1511424,4294967295,4294967295,67584,5539840,1640448,84096,536870912,8192,287744,540800,16384,8274944,673920,536870912,115712,295168,8273920,197188,197184,712704,4284612608,280576,428288,201764,294912,201856,430080,8404992,212368,0,211968,279040,8282112,8314880,8347648,8259584,8292352,8325120,8269824,8302592,8335360,8368128,8357888,8280064,8312832,8345600,0,0
.long 1122304,1253376,1384448,1515520,4294967295,4294967295,67840,5541888,1646592,84224,536870912,8192,345088,557184,20480,8275968,674048,536870912,230400,299008,8372224,197192,197120,712704,4284612608,311296,432128,201888,327680,201984,434176,8519680,212752,0,211968,295424,8273920,8306688,8339456,8284160,8316928,8349696,8261632,8294400,8327168,8359936,8271872,8304640,8337408,8370176,0,0
.long 1126400,1257472,1388544,1519616,4294967295,4294967295,67840,5543936,1648640,84352,536870912,8192,402432,573568,20480,8276992,674176,536870912,345088,299264,8388608,197196,197184,712704,4284612608,313344,432384,201892,360448,202112,438272,8634368,213136,0,211968,311808,8265728,8298496,8331264,8364032,8275968,8308736,8341504,8286208,8318976,8351744,8263680,8296448,8329216,8361984,0,0
.long 1130496,1261568,1392640,1523712,4294967295,4294967295,68096,5545984,1654784,84480,8832,8192,230528,589952,24576,8278016,674304,299520,1280,303104,8257536,197200,197120,727040,4284841984,282624,428544,201768,262144,201728,425984,8298496,211988,0,211968,262784,8323072,8355840,8267776,8300544,8257536,8290304,8278016,8310784,8343552,8333312,8288256,8321024,8353792,8366080,0,0
.long 1134592,1265664,1396736,1527808,4294967295,4294967295,68096,5548032,1656832,84608,536870912,8192,287872,606336,24576,8279040,674432,536870912,115968,303360,8273920,197204,197184,727040,4284841984,284672,428800,201772,294912,201856,430080,8413184,212372,0,211968,279168,8347648,8259584,8292352,8325120,8282112,8314880,8302592,8335360,8368128,8269824,8280064,8312832,8345600,8357888,0,0
.long 1138688,1269760,1400832,1531904,4294967295,4294967295,68352,5550080,1662976,84736,536870912,8192,345216,622720,28672,8280064,674560,536870912,230656,307200,8372224,197208,197120,727040,4284841984,315392,432640,201896,327680,201984,434176,8527872,212756,0,211968,295552,8339456,8284160,8316928,8349696,8273920,8306688,8294400,8327168,8359936,8261632,8304640,8337408,8370176,8271872,0,0
.long 1142784,1273856,1404928,1536000,4294967295,4294967295,68352,5552128,1665024,84864,536870912,8192,402560,639104,28672,8281088,674688,536870912,345344,307456,8388608,197212,197184,727040,4284841984,317440,432896,201900,360448,202112,438272,8642560,213140,0,211968,311936,8331264,8364032,8275968,8308736,8265728,8298496,8286208,8318976,8351744,8341504,8296448,8329216,8361984,8263680,0,0
.long 1146880,1277952,1409024,1540096,4294967295,4294967295,68608,5554176,1671168,84992,8960,8192,230656,655488,32768,8282112,674816,303616,1536,311296,8257536,197216,197120,741376,4285071360,286720,429056,201776,262144,201728,425984,8306688,211992,0,211968,262912,8355840,8267776,8300544,8257536,8290304,8323072,8310784,8343552,8333312,8278016,8321024,8353792,8366080,8288256,0,0
.long 1150976,1282048,1413120,1544192,4294967295,4294967295,68608,5556224,1673216,85120,536870912,8192,288000,671872,32768,8283136,674944,536870912,116224,311552,8273920,197220,197184,741376,4285071360,288768,429312,201780,294912,201856,430080,8421376,212376,0,211968,279296,8259584,8292352,8325120,8282112,8314880,8347648,8335360,8368128,8269824,8302592,8312832,8345600,8357888,8280064,0,0
.long 1155072,1286144,1417216,1548288,4294967295,4294967295,68864,5558272,1679360,85248,536870912,8192,345344,688256,36864,8284160,675072,536870912,230912,315392,8372224,197224,197120,741376,4285071360,319488,433152,201904,327680,201984,434176,8536064,212760,0,211968,295680,8284160,8316928,8349696,8273920,8306688,8339456,8327168,8359936,8261632,8294400,8337408,8370176,8271872,8304640,0,0
.long 1159168,1290240,1421312,1552384,4294967295,4294967295,68864,5560320,1681408,85376,536870912,8192,402688,704640,36864,8285184,675200,536870912,345600,315648,8388608,197228,197184,741376,4285071360,321536,433408,201908,360448,202112,438272,8650752,213144,0,211968,312064,8364032,8275968,8308736,8265728,8298496,8331264,8318976,8351744,8341504,8286208,8329216,8361984,8263680,8296448,0,0
.long 1163264,1294336,1425408,1556480,4294967295,4294967295,69120,5562368,1687552,85504,9088,8192,230784,721024,40960,8286208,675328,307712,1792,319488,8257536,197232,197120,755712,4285300736,290816,429568,201784,262144,201728,425984,8314880,211996,0,211968,263040,8300544,8257536,8290304,8323072,8355840,8267776,8343552,8333312,8278016,8310784,8353792,8366080,8288256,8321024,0,0
.long 1167360,1298432,1429504,1560576,4294967295,4294967295,69120,5564416,1689600,85632,536870912,8192,288128,737408,40960,8287232,675456,536870912,116480,319744,8273920,197236,197184,755712,4285300736,292864,429824,201788,294912,201856,430080,8429568,212380,0,211968,279424,8325120,8282112,8314880,8347648,8259584,8292352,8368128,8269824,8302592,8335360,8345600,8357888,8280064,8312832,0,0
.long 1171456,1302528,1433600,1564672,4294967295,4294967295,69376,5566464,1695744,85760,536870912,8192,345472,753792,45056,8288256,675584,536870912,231168,323584,8372224,197240,197120,755712,4285300736,323584,433664,201912,327680,201984,434176,8544256,212764,0,211968,295808,8349696,8273920,8306688,8339456,8284160,8316928,8359936,8261632,8294400,8327168,8370176,8271872,8304640,8337408,0,0
.long 1175552,1306624,1437696,1568768,4294967295,4294967295,69376,5568512,1697792,85888,536870912,8192,402816,770176,45056,8289280,675712,536870912,345856,323840,8388608,197244,197184,755712,4285300736,325632,433920,201916,360448,202112,438272,8658944,213148,0,211968,312192,8308736,8265728,8298496,8331264,8364032,8275968,8351744,8341504,8286208,8318976,8361984,8263680,8296448,8329216,0,0
.long 1179648,1310720,1441792,1572864,4294967295,4294967295,69632,5570560,1703936,86016,9216,8192,230912,786560,40960,8486912,675840,311808,2048,327680,8486912,197248,197248,655360,4283236352,327680,434176,201984,262144,201728,425984,8323072,212000,0,212736,327680,8552448,8585216,8497152,8529920,8486912,8519680,8507392,8540160,8572928,8562688,8517632,8550400,8583168,8595456,0,0
.long 1183744,1314816,1445888,1576960,4294967295,4294967295,69632,5572608,1705984,86144,536870912,8192,288256,802944,40960,8487936,675968,536870912,116736,327936,8503296,197252,197312,655360,4283236352,329728,434432,201988,294912,201856,430080,8437760,212384,0,212736,344064,8577024,8488960,8521728,8554496,8511488,8544256,8531968,8564736,8597504,8499200,8509440,8542208,8574976,8587264,0,0
.long 1187840,1318912,1449984,1581056,4294967295,4294967295,69888,5574656,1712128,86272,536870912,8192,345600,819328,45056,8488960,676096,536870912,231424,331776,8601600,197256,197248,655360,4283236352,360448,438272,202112,327680,201984,434176,8552448,212768,0,212736,360448,8568832,8513536,8546304,8579072,8503296,8536064,8523776,8556544,8589312,8491008,8534016,8566784,8599552,8501248,0,0
.long 1191936,1323008,1454080,1585152,4294967295,4294967295,69888,5576704,1714176,86400,536870912,8192,402944,835712,45056,8489984,676224,536870912,346112,332032,8617984,197260,197312,655360,4283236352,362496,438528,202116,360448,202112,438272,8667136,213152,0,212736,376832,8560640,8593408,8505344,8538112,8495104,8527872,8515584,8548352,8581120,8570880,8525824,8558592,8591360,8493056,0,0
.long 1196032,1327104,1458176,1589248,4294967295,4294967295,70144,5578752,1720320,86528,9344,8192,231040,852096,49152,8491008,676352,315904,2304,335872,8486912,197264,197248,669696,4283465728,331776,434688,201992,262144,201728,425984,8331264,212004,0,212736,327808,8585216,8497152,8529920,8486912,8519680,8552448,8540160,8572928,8562688,8507392,8550400,8583168,8595456,8517632,0,0
.long 1200128,1331200,1462272,1593344,4294967295,4294967295,70144,5580800,1722368,86656,536870912,8192,288384,868480,49152,8492032,676480,536870912,116992,336128,8503296,197268,197312,669696,4283465728,333824,434944,201996,294912,201856,430080,8445952,212388,0,212736,344192,8488960,8521728,8554496,8511488,8544256,8577024,8564736,8597504,8499200,8531968,8542208,8574976,8587264,8509440,0,0
.long 1204224,1335296,1466368,1597440,4294967295,4294967295,70400,5582848,1728512,86784,536870912,8192,345728,884864,53248,8493056,676608,536870912,231680,339968,8601600,197272,197248,669696,4283465728,364544,438784,202120,327680,201984,434176,8560640,212772,0,212736,360576,8513536,8546304,8579072,8503296,8536064,8568832,8556544,8589312,8491008,8523776,8566784,8599552,8501248,8534016,0,0
.long 1208320,1339392,1470464,1601536,4294967295,4294967295,70400,5584896,1730560,86912,536870912,8192,403072,901248,53248,8494080,676736,536870912,346368,340224,8617984,197276,197312,669696,4283465728,366592,439040,202124,360448,202112,438272,8675328,213156,0,212736,376960,8593408,8505344,8538112,8495104,8527872,8560640,8548352,8581120,8570880,8515584,8558592,8591360,8493056,8525824,0,0
.long 1212416,1343488,1474560,1605632,4294967295,4294967295,70656,5586944,1736704,87040,9472,8192,231168,917632,57344,8495104,676864,320000,2560,344064,8486912,197280,197248,684032,4283695104,335872,435200,202000,262144,201728,425984,8339456,212008,0,212736,327936,8529920,8486912,8519680,8552448,8585216,8497152,8572928,8562688,8507392,8540160,8583168,8595456,8517632,8550400,0,0
.long 1216512,1347584,1478656,1609728,4294967295,4294967295,70656,5588992,1738752,87168,536870912,8192,288512,934016,57344,8496128,676992,536870912,117248,344320,8503296,197284,197312,684032,4283695104,337920,435456,202004,294912,201856,430080,8454144,212392,0,212736,344320,8554496,8511488,8544256,8577024,8488960,8521728,8597504,8499200,8531968,8564736,8574976,8587264,8509440,8542208,0,0
.long 1220608,1351680,1482752,1613824,4294967295,4294967295,70912,5591040,1744896,87296,536870912,8192,345856,950400,61440,8497152,677120,536870912,231936,348160,8601600,197288,197248,684032,4283695104,368640,439296,202128,327680,201984,434176,8568832,212776,0,212736,360704,8579072,8503296,8536064,8568832,8513536,8546304,8589312,8491008,8523776,8556544,8599552,8501248,8534016,8566784,0,0
.long 1224704,1355776,1486848,1617920,4294967295,4294967295,70912,5593088,1746944,87424,536870912,8192,403200,966784,61440,8498176,677248,536870912,346624,348416,8617984,197292,197312,684032,4283695104,370688,439552,202132,360448,202112,438272,8683520,213160,0,212736,377088,8538112,8495104,8527872,8560640,8593408,8505344,8581120,8570880,8515584,8548352,8591360,8493056,8525824,8558592,0,0
.long 1228800,1359872,1490944,1622016,4294967295,4294967295,71168,5595136,1753088,87552,9600,8192,231296,983168,65536,8499200,677376,324096,2816,352256,8486912,197296,197248,698368,4283924480,339968,435712,202008,262144,201728,425984,8347648,212012,0,212736,328064,8486912,8519680,8552448,8585216,8497152,8529920,8562688,8507392,8540160,8572928,8595456,8517632,8550400,8583168,0,0
.long 1232896,1363968,1495040,1626112,4294967295,4294967295,71168,5597184,1755136,87680,536870912,8192,288640,999552,65536,8500224,677504,536870912,117504,352512,8503296,197300,197312,698368,4283924480,342016,435968,202012,294912,201856,430080,8462336,212396,0,212736,344448,8511488,8544256,8577024,8488960,8521728,8554496,8499200,8531968,8564736,8597504,8587264,8509440,8542208,8574976,0,0
.long 1236992,1368064,1499136,1630208,4294967295,4294967295,71424,5599232,1761280,87808,536870912,8192,345984,1015936,69632,8501248,677632,536870912,232192,356352,8601600,197304,197248,698368,4283924480,372736,439808,202136,327680,201984,434176,8577024,212780,0,212736,360832,8503296,8536064,8568832,8513536,8546304,8579072,8491008,8523776,8556544,8589312,8501248,8534016,8566784,8599552,0,0
.long 1241088,1372160,1503232,1634304,4294967295,4294967295,71424,5601280,1763328,87936,536870912,8192,403328,1032320,69632,8502272,677760,536870912,346880,356608,8617984,197308,197312,698368,4283924480,374784,440064,202140,360448,202112,438272,8691712,213164,0,212736,377216,8495104,8527872,8560640,8593408,8505344,8538112,8570880,8515584,8548352,8581120,8493056,8525824,8558592,8591360,0,0
.long 1245184,1376256,1507328,1638400,4294967295,4294967295,71680,5603328,1769472,88064,9728,8192,231424,1048704,73728,8503296,677888,328192,3072,360448,8486912,197312,197248,712704,4284153856,344064,436224,202016,262144,201728,425984,8355840,212016,0,212736,328192,8552448,8585216,8497152,8529920,8486912,8519680,8507392,8540160,8572928,8562688,8517632,8550400,8583168,8595456,0,0
.long 1249280,1380352,1511424,1642496,4294967295,4294967295,71680,5605376,1771520,88192,536870912,8192,288768,1065088,73728,8504320,678016,536870912,117760,360704,8503296,197316,197312,712704,4284153856,346112,436480,202020,294912,201856,430080,8470528,212400,0,212736,344576,8577024,8488960,8521728,8554496,8511488,8544256,8531968,8564736,8597504,8499200,8509440,8542208,8574976,8587264,0,0
.long 1253376,1384448,1515520,1646592,4294967295,4294967295,71936,5607424,1777664,88320,536870912,8192,346112,1081472,77824,8505344,678144,536870912,232448,364544,8601600,197320,197248,712704,4284153856,376832,440320,202144,327680,201984,434176,8585216,212784,0,212736,360960,8568832,8513536,8546304,8579072,8503296,8536064,8523776,8556544,8589312,8491008,8534016,8566784,8599552,8501248,0,0
.long 1257472,1388544,1519616,1650688,4294967295,4294967295,71936,5609472,1779712,88448,536870912,8192,403456,1097856,77824,8506368,678272,536870912,347136,364800,8617984,197324,197312,712704,4284153856,378880,440576,202148,360448,202112,438272,8699904,213168,0,212736,377344,8560640,8593408,8505344,8538112,8495104,8527872,8515584,8548352,8581120,8570880,8525824,8558592,8591360,8493056,0,0
.long 1261568,1392640,1523712,1654784,4294967295,4294967295,72192,5611520,1785856,88576,9856,8192,231552,1114240,16384,8507392,678400,332288,3328,368640,8486912,197328,197248,727040,4284383232,348160,436736,202024,262144,201728,425984,8364032,212020,0,212736,328320,8585216,8497152,8529920,8486912,8519680,8552448,8540160,8572928,8562688,8507392,8550400,8583168,8595456,8517632,0,0
.long 1265664,1396736,1527808,1658880,4294967295,4294967295,72192,5613568,1787904,88704,536870912,8192,288896,1130624,16384,8508416,678528,536870912,118016,368896,8503296,197332,197312,727040,4284383232,350208,436992,202028,294912,201856,430080,8478720,212404,0,212736,344704,8488960,8521728,8554496,8511488,8544256,8577024,8564736,8597504,8499200,8531968,8542208,8574976,8587264,8509440,0,0
.long 1269760,1400832,1531904,1662976,4294967295,4294967295,72448,5615616,1794048,88832,536870912,8192,346240,1147008,20480,8509440,678656,536870912,232704,372736,8601600,197336,197248,727040,4284383232,380928,440832,202152,327680,201984,434176,8593408,212788,0,212736,361088,8513536,8546304,8579072,8503296,8536064,8568832,8556544,8589312,8491008,8523776,8566784,8599552,8501248,8534016,0,0
.long 1273856,1404928,1536000,1667072,4294967295,4294967295,72448,5617664,1796096,88960,536870912,8192,403584,1163392,20480,8510464,678784,536870912,347392,372992,8617984,197340,197312,727040,4284383232,382976,441088,202156,360448,202112,438272,8708096,213172,0,212736,377472,8593408,8505344,8538112,8495104,8527872,8560640,8548352,8581120,8570880,8515584,8558592,8591360,8493056,8525824,0,0
.long 1277952,1409024,1540096,1671168,4294967295,4294967295,72704,5619712,1802240,89088,9984,8192,231680,1179776,24576,8511488,678912,336384,3328,368640,8486912,197344,197248,741376,4284612608,352256,437248,202032,262144,201728,425984,536870912,536870912,5242880,212736,328448,8529920,8486912,8519680,8552448,8585216,8497152,8572928,8562688,8507392,8540160,8583168,8595456,8517632,8550400,0,0
.long 1282048,1413120,1544192,1675264,4294967295,4294967295,72704,5621760,1804288,89216,536870912,8192,289024,1196160,24576,8512512,679040,536870912,118016,368896,8503296,197348,197312,741376,4284612608,354304,437504,202036,294912,201856,430080,536870912,536870912,5242880,212736,344832,8554496,8511488,8544256,8577024,8488960,8521728,8597504,8499200,8531968,8564736,8574976,8587264,8509440,8542208,0,0
.long 1286144,1417216,1548288,1679360,4294967295,4294967295,72960,5623808,1810432,89344,536870912,8192,346368,1212544,28672,8513536,679168,536870912,232704,372736,8601600,197352,197248,741376,4284612608,385024,441344,202160,327680,201984,434176,536870912,536870912,5242880,212736,361216,8579072,8503296,8536064,8568832,8513536,8546304,8589312,8491008,8523776,8556544,8599552,8501248,8534016,8566784,0,0
.long 1290240,1421312,1552384,1683456,4294967295,4294967295,72960,5625856,1812480,89472,536870912,8192,403712,1228928,28672,8514560,679296,536870912,347392,372992,8617984,197356,197312,741376,4284612608,387072,441600,202164,360448,202112,438272,536870912,536870912,5242880,212736,377600,8538112,8495104,8527872,8560640,8593408,8505344,8581120,8570880,8515584,8548352,8591360,8493056,8525824,8558592,0,0
.long 1294336,1425408,1556480,1687552,4294967295,4294967295,73216,5627904,1818624,89600,10112,8192,231808,1245312,32768,8515584,679424,340480,3328,368640,8486912,197360,197248,755712,4284841984,356352,437760,202040,262144,201728,425984,536870912,536870912,5701632,212736,328576,8486912,8519680,8552448,8585216,8497152,8529920,8562688,8507392,8540160,8572928,8595456,8517632,8550400,8583168,0,0
.long 1298432,1429504,1560576,1691648,4294967295,4294967295,73216,5629952,1820672,89728,536870912,8192,289152,1261696,32768,8516608,679552,536870912,118016,368896,8503296,197364,197312,755712,4284841984,358400,438016,202044,294912,201856,430080,536870912,536870912,5701632,212736,344960,8511488,8544256,8577024,8488960,8521728,8554496,8499200,8531968,8564736,8597504,8587264,8509440,8542208,8574976,0,0
.long 1302528,1433600,1564672,1695744,4294967295,4294967295,73472,5632000,1826816,89856,536870912,8192,346496,1278080,36864,8517632,679680,536870912,232704,372736,8601600,197368,197248,755712,4284841984,389120,441856,202168,327680,201984,434176,536870912,536870912,5701632,212736,361344,8503296,8536064,8568832,8513536,8546304,8579072,8491008,8523776,8556544,8589312,8501248,8534016,8566784,8599552,0,0
.long 1306624,1437696,1568768,1699840,4294967295,4294967295,73472,5634048,1828864,89984,536870912,8192,403840,1294464,36864,8518656,679808,536870912,347392,372992,8617984,197372,197312,755712,4284841984,391168,442112,202172,360448,202112,438272,536870912,536870912,5701632,212736,377728,8495104,8527872,8560640,8593408,8505344,8538112,8570880,8515584,8548352,8581120,8493056,8525824,8558592,8591360,0,0
.long 1310720,1441792,1572864,1703936,4294967295,4294967295,73728,5636096,1835008,90112,10240,10240,231936,1310848,32768,8716288,679936,344576,0,262144,8716288,197376,197376,655360,4282777600,393216,442368,202240,393216,202240,442368,8716288,213504,0,213504,393216,8814592,8726528,8759296,8716288,8749056,8781824,8769536,8802304,8792064,8736768,8779776,8812544,8824832,8747008,0,0
.long 1314816,1445888,1576960,1708032,4294967295,4294967295,73728,5638144,1837056,90240,536870912,10240,289280,1327232,32768,8717312,680064,536870912,114688,262400,8732672,197380,197440,655360,4282777600,395264,442624,202244,425984,202368,446464,8830976,213888,0,213504,409600,8718336,8751104,8783872,8740864,8773632,8806400,8794112,8826880,8728576,8761344,8771584,8804352,8816640,8738816,0,0
.long 1318912,1449984,1581056,1712128,4294967295,4294967295,73984,5640192,1843200,90368,536870912,10240,346624,1343616,36864,8718336,680192,536870912,229376,266240,8830976,197384,197376,655360,4282777600,425984,446464,202368,458752,202496,450560,8945664,214272,0,213504,425984,8742912,8775680,8808448,8732672,8765440,8798208,8785920,8818688,8720384,8753152,8796160,8828928,8730624,8763392,0,0
.long 1323008,1454080,1585152,1716224,4294967295,4294967295,73984,5642240,1845248,90496,536870912,10240,403968,1360000,36864,8719360,680320,536870912,344064,266496,8847360,197388,197440,655360,4282777600,428032,446720,202372,491520,202624,454656,9060352,214656,0,213504,442368,8822784,8734720,8767488,8724480,8757248,8790016,8777728,8810496,8800256,8744960,8787968,8820736,8722432,8755200,0,0
.long 1327104,1458176,1589248,1720320,4294967295,4294967295,74240,5644288,1851392,90624,10368,10240,232064,1376384,40960,8720384,680448,348672,256,270336,8716288,197392,197376,669696,4283006976,397312,442880,202248,393216,202240,442368,8724480,213508,0,213504,393344,8759296,8716288,8749056,8781824,8814592,8726528,8802304,8792064,8736768,8769536,8812544,8824832,8747008,8779776,0,0
.long 1331200,1462272,1593344,1724416,4294967295,4294967295,74240,5646336,1853440,90752,536870912,10240,289408,1392768,40960,8721408,680576,536870912,114944,270592,8732672,197396,197440,669696,4283006976,399360,443136,202252,425984,202368,446464,8839168,213892,0,213504,409728,8783872,8740864,8773632,8806400,8718336,8751104,8826880,8728576,8761344,8794112,8804352,8816640,8738816,8771584,0,0
.long 1335296,1466368,1597440,1728512,4294967295,4294967295,74496,5648384,1859584,90880,536870912,10240,346752,1409152,45056,8722432,680704,536870912,229632,274432,8830976,197400,197376,669696,4283006976,430080,446976,202376,458752,202496,450560,8953856,214276,0,213504,426112,8808448,8732672,8765440,8798208,8742912,8775680,8818688,8720384,8753152,8785920,8828928,8730624,8763392,8796160,0,0
.long 1339392,1470464,1601536,1732608,4294967295,4294967295,74496,5650432,1861632,91008,536870912,10240,404096,1425536,45056,8723456,680832,536870912,344320,274688,8847360,197404,197440,669696,4283006976,432128,447232,202380,491520,202624,454656,9068544,214660,0,213504,442496,8767488,8724480,8757248,8790016,8822784,8734720,8810496,8800256,8744960,8777728,8820736,8722432,8755200,8787968,0,0
.long 1343488,1474560,1605632,1736704,4294967295,4294967295,74752,5652480,1867776,91136,10496,10240,232192,1441920,49152,8724480,680960,352768,512,278528,8716288,197408,197376,684032,4283236352,401408,443392,202256,393216,202240,442368,8732672,213512,0,213504,393472,8716288,8749056,8781824,8814592,8726528,8759296,8792064,8736768,8769536,8802304,8824832,8747008,8779776,8812544,0,0
.long 1347584,1478656,1609728,1740800,4294967295,4294967295,74752,5654528,1869824,91264,536870912,10240,289536,1458304,49152,8725504,681088,536870912,115200,278784,8732672,197412,197440,684032,4283236352,403456,443648,202260,425984,202368,446464,8847360,213896,0,213504,409856,8740864,8773632,8806400,8718336,8751104,8783872,8728576,8761344,8794112,8826880,8816640,8738816,8771584,8804352,0,0
.long 1351680,1482752,1613824,1744896,4294967295,4294967295,75008,5656576,1875968,91392,536870912,10240,346880,1474688,53248,8726528,681216,536870912,229888,282624,8830976,197416,197376,684032,4283236352,434176,447488,202384,458752,202496,450560,8962048,214280,0,213504,426240,8732672,8765440,8798208,8742912,8775680,8808448,8720384,8753152,8785920,8818688,8730624,8763392,8796160,8828928,0,0
.long 1355776,1486848,1617920,1748992,4294967295,4294967295,75008,5658624,1878016,91520,536870912,10240,404224,1491072,53248,8727552,681344,536870912,344576,282880,8847360,197420,197440,684032,4283236352,436224,447744,202388,491520,202624,454656,9076736,214664,0,213504,442624,8724480,8757248,8790016,8822784,8734720,8767488,8800256,8744960,8777728,8810496,8722432,8755200,8787968,8820736,0,0
.long 1359872,1490944,1622016,1753088,4294967295,4294967295,75264,5660672,1884160,91648,10624,10240,232320,1507456,57344,8728576,681472,356864,768,286720,8716288,197424,197376,698368,4283465728,405504,443904,202264,393216,202240,442368,8740864,213516,0,213504,393600,8781824,8814592,8726528,8759296,8716288,8749056,8736768,8769536,8802304,8792064,8747008,8779776,8812544,8824832,0,0
.long 1363968,1495040,1626112,1757184,4294967295,4294967295,75264,5662720,1886208,91776,536870912,10240,289664,1523840,57344,8729600,681600,536870912,115456,286976,8732672,197428,197440,698368,4283465728,407552,444160,202268,425984,202368,446464,8855552,213900,0,213504,409984,8806400,8718336,8751104,8783872,8740864,8773632,8761344,8794112,8826880,8728576,8738816,8771584,8804352,8816640,0,0
.long 1368064,1499136,1630208,1761280,4294967295,4294967295,75520,5664768,1892352,91904,536870912,10240,347008,1540224,61440,8730624,681728,536870912,230144,290816,8830976,197432,197376,698368,4283465728,438272,448000,202392,458752,202496,450560,8970240,214284,0,213504,426368,8798208,8742912,8775680,8808448,8732672,8765440,8753152,8785920,8818688,8720384,8763392,8796160,8828928,8730624,0,0
.long 1372160,1503232,1634304,1765376,4294967295,4294967295,75520,5666816,1894400,92032,536870912,10240,404352,1556608,61440,8731648,681856,536870912,344832,291072,8847360,197436,197440,698368,4283465728,440320,448256,202396,491520,202624,454656,9084928,214668,0,213504,442752,8790016,8822784,8734720,8767488,8724480,8757248,8744960,8777728,8810496,8800256,8755200,8787968,8820736,8722432,0,0
.long 1376256,1507328,1638400,1769472,4294967295,4294967295,75776,5668864,1900544,92160,10752,10240,232448,1572992,65536,8732672,681984,360960,1024,294912,8716288,197440,197376,712704,4283695104,409600,444416,202272,393216,202240,442368,8749056,213520,0,213504,393728,8814592,8726528,8759296,8716288,8749056,8781824,8769536,8802304,8792064,8736768,8779776,8812544,8824832,8747008,0,0
.long 1380352,1511424,1642496,1773568,4294967295,4294967295,75776,5670912,1902592,92288,536870912,10240,289792,1589376,65536,8733696,682112,536870912,115712,295168,8732672,197444,197440,712704,4283695104,411648,444672,202276,425984,202368,446464,8863744,213904,0,213504,410112,8718336,8751104,8783872,8740864,8773632,8806400,8794112,8826880,8728576,8761344,8771584,8804352,8816640,8738816,0,0
.long 1384448,1515520,1646592,1777664,4294967295,4294967295,76032,5672960,1908736,92416,536870912,10240,347136,1605760,69632,8734720,682240,536870912,230400,299008,8830976,197448,197376,712704,4283695104,442368,448512,202400,458752,202496,450560,8978432,214288,0,213504,426496,8742912,8775680,8808448,8732672,8765440,8798208,8785920,8818688,8720384,8753152,8796160,8828928,8730624,8763392,0,0
.long 1388544,1519616,1650688,1781760,4294967295,4294967295,76032,5675008,1910784,92544,536870912,10240,404480,1622144,69632,8735744,682368,536870912,345088,299264,8847360,197452,197440,712704,4283695104,444416,448768,202404,491520,202624,454656,9093120,214672,0,213504,442880,8822784,8734720,8767488,8724480,8757248,8790016,8777728,8810496,8800256,8744960,8787968,8820736,8722432,8755200,0,0
.long 1392640,1523712,1654784,1785856,4294967295,4294967295,76288,5677056,1916928,92672,10880,10240,232576,1638528,73728,8736768,682496,365056,1280,303104,8716288,197456,197376,727040,4283924480,413696,444928,202280,393216,202240,442368,8757248,213524,0,213504,393856,8759296,8716288,8749056,8781824,8814592,8726528,8802304,8792064,8736768,8769536,8812544,8824832,8747008,8779776,0,0
.long 1396736,1527808,1658880,1789952,4294967295,4294967295,76288,5679104,1918976,92800,536870912,10240,289920,1654912,73728,8737792,682624,536870912,115968,303360,8732672,197460,197440,727040,4283924480,415744,445184,202284,425984,202368,446464,8871936,213908,0,213504,410240,8783872,8740864,8773632,8806400,8718336,8751104,8826880,8728576,8761344,8794112,8804352,8816640,8738816,8771584,0,0
.long 1400832,1531904,1662976,1794048,4294967295,4294967295,76544,5681152,1925120,92928,536870912,10240,347264,1671296,77824,8738816,682752,536870912,230656,307200,8830976,197464,197376,727040,4283924480,446464,449024,202408,458752,202496,450560,8986624,214292,0,213504,426624,8808448,8732672,8765440,8798208,8742912,8775680,8818688,8720384,8753152,8785920,8828928,8730624,8763392,8796160,0,0
.long 1404928,1536000,1667072,1798144,4294967295,4294967295,76544,5683200,1927168,93056,536870912,10240,404608,1687680,77824,8739840,682880,536870912,345344,307456,8847360,197468,197440,727040,4283924480,448512,449280,202412,491520,202624,454656,9101312,214676,0,213504,443008,8767488,8724480,8757248,8790016,8822784,8734720,8810496,8800256,8744960,8777728,8820736,8722432,8755200,8787968,0,0
.long 1409024,1540096,1671168,1802240,4294967295,4294967295,76800,5685248,1933312,93184,11008,10240,232704,1704064,16384,8740864,683008,369152,1536,311296,8716288,197472,197376,741376,4284153856,417792,445440,202288,393216,202240,442368,8765440,213528,0,213504,393984,8716288,8749056,8781824,8814592,8726528,8759296,8792064,8736768,8769536,8802304,8824832,8747008,8779776,8812544,0,0
.long 1413120,1544192,1675264,1806336,4294967295,4294967295,76800,5687296,1935360,93312,536870912,10240,290048,1720448,16384,8741888,683136,536870912,116224,311552,8732672,197476,197440,741376,4284153856,419840,445696,202292,425984,202368,446464,8880128,213912,0,213504,410368,8740864,8773632,8806400,8718336,8751104,8783872,8728576,8761344,8794112,8826880,8816640,8738816,8771584,8804352,0,0
.long 1417216,1548288,1679360,1810432,4294967295,4294967295,77056,5689344,1941504,93440,536870912,10240,347392,1736832,20480,8742912,683264,536870912,230912,315392,8830976,197480,197376,741376,4284153856,450560,449536,202416,458752,202496,450560,8994816,214296,0,213504,426752,8732672,8765440,8798208,8742912,8775680,8808448,8720384,8753152,8785920,8818688,8730624,8763392,8796160,8828928,0,0
.long 1421312,1552384,1683456,1814528,4294967295,4294967295,77056,5691392,1943552,93568,536870912,10240,404736,1753216,20480,8743936,683392,536870912,345600,315648,8847360,197484,197440,741376,4284153856,452608,449792,202420,491520,202624,454656,9109504,214680,0,213504,443136,8724480,8757248,8790016,8822784,8734720,8767488,8800256,8744960,8777728,8810496,8722432,8755200,8787968,8820736,0,0
.long 1425408,1556480,1687552,1818624,4294967295,4294967295,77312,5693440,1949696,93696,11136,10240,232832,1769600,24576,8744960,683520,373248,1792,319488,8716288,197488,197376,755712,4284383232,421888,445952,202296,393216,202240,442368,8773632,213532,0,213504,394112,8781824,8814592,8726528,8759296,8716288,8749056,8736768,8769536,8802304,8792064,8747008,8779776,8812544,8824832,0,0
.long 1429504,1560576,1691648,1822720,4294967295,4294967295,77312,5695488,1951744,93824,536870912,10240,290176,1785984,24576,8745984,683648,536870912,116480,319744,8732672,197492,197440,755712,4284383232,423936,446208,202300,425984,202368,446464,8888320,213916,0,213504,410496,8806400,8718336,8751104,8783872,8740864,8773632,8761344,8794112,8826880,8728576,8738816,8771584,8804352,8816640,0,0
.long 1433600,1564672,1695744,1826816,4294967295,4294967295,77568,5697536,1957888,93952,536870912,10240,347520,1802368,28672,8747008,683776,536870912,231168,323584,8830976,197496,197376,755712,4284383232,454656,450048,202424,458752,202496,450560,9003008,214300,0,213504,426880,8798208,8742912,8775680,8808448,8732672,8765440,8753152,8785920,8818688,8720384,8763392,8796160,8828928,8730624,0,0
.long 1437696,1568768,1699840,1830912,4294967295,4294967295,77568,5699584,1959936,94080,536870912,10240,404864,1818752,28672,8748032,683904,536870912,345856,323840,8847360,197500,197440,755712,4284383232,456704,450304,202428,491520,202624,454656,9117696,214684,0,213504,443264,8790016,8822784,8734720,8767488,8724480,8757248,8744960,8777728,8810496,8800256,8755200,8787968,8820736,8722432,0,0
.long 1441792,1572864,1703936,1835008,4294967295,4294967295,77824,5701632,1966080,94208,11264,10240,458752,256,24576,8945664,684032,263168,2048,327680,8945664,197504,197504,655360,4282318848,458752,450560,202496,393216,202240,442368,8781824,213536,0,214272,458752,8988672,8945664,8978432,9011200,9043968,8955904,9031680,9021440,8966144,8998912,9041920,9054208,8976384,9009152,0,0
.long 1445888,1576960,1708032,1839104,4294967295,4294967295,77824,5703680,1968128,94336,536870912,10240,516096,16640,24576,8946688,684160,536870912,116736,327936,8962048,197508,197568,655360,4282318848,460800,450816,202500,425984,202368,446464,8896512,213920,0,214272,475136,9013248,8970240,9003008,9035776,8947712,8980480,9056256,8957952,8990720,9023488,9033728,9046016,8968192,9000960,0,0
.long 1449984,1581056,1712128,1843200,4294967295,4294967295,78080,5705728,1974272,94464,536870912,10240,573440,33024,28672,8947712,684288,536870912,231424,331776,9060352,197512,197504,655360,4282318848,491520,454656,202624,458752,202496,450560,9011200,214304,0,214272,491520,9037824,8962048,8994816,9027584,8972288,9005056,9048064,8949760,8982528,9015296,9058304,8960000,8992768,9025536,0,0
.long 1454080,1585152,1716224,1847296,4294967295,4294967295,78080,5707776,1976320,94592,536870912,10240,630784,49408,28672,8948736,684416,536870912,346112,332032,9076736,197516,197568,655360,4282318848,493568,454912,202628,491520,202624,454656,9125888,214688,0,214272,507904,8996864,8953856,8986624,9019392,9052160,8964096,9039872,9029632,8974336,9007104,9050112,8951808,8984576,9017344,0,0
.long 1458176,1589248,1720320,1851392,4294967295,4294967295,78336,5709824,1982464,94720,11392,10240,458880,65792,32768,8949760,684544,267264,2304,335872,8945664,197520,197504,669696,4282548224,462848,451072,202504,393216,202240,442368,8790016,213540,0,214272,458880,8945664,8978432,9011200,9043968,8955904,8988672,9021440,8966144,8998912,9031680,9054208,8976384,9009152,9041920,0,0
.long 1462272,1593344,1724416,1855488,4294967295,4294967295,78336,5711872,1984512,94848,536870912,10240,516224,82176,32768,8950784,684672,536870912,116992,336128,8962048,197524,197568,669696,4282548224,464896,451328,202508,425984,202368,446464,8904704,213924,0,214272,475264,8970240,9003008,9035776,8947712,8980480,9013248,8957952,8990720,9023488,9056256,9046016,8968192,9000960,9033728,0,0
.long 1466368,1597440,1728512,1859584,4294967295,4294967295,78592,5713920,1990656,94976,536870912,10240,573568,98560,36864,8951808,684800,536870912,231680,339968,9060352,197528,197504,669696,4282548224,495616,455168,202632,458752,202496,450560,9019392,214308,0,214272,491648,8962048,8994816,9027584,8972288,9005056,9037824,8949760,8982528,9015296,9048064,8960000,8992768,9025536,9058304,0,0
.long 1470464,1601536,1732608,1863680,4294967295,4294967295,78592,5715968,1992704,95104,536870912,10240,630912,114944,36864,8952832,684928,536870912,346368,340224,9076736,197532,197568,669696,4282548224,497664,455424,202636,491520,202624,454656,9134080,214692,0,214272,508032,8953856,8986624,9019392,9052160,8964096,8996864,9029632,8974336,9007104,9039872,8951808,8984576,9017344,9050112,0,0
.long 1474560,1605632,1736704,1867776,4294967295,4294967295,78848,5718016,1998848,95232,11520,10240,459008,131328,40960,8953856,685056,271360,2560,344064,8945664,197536,197504,684032,4282777600,466944,451584,202512,393216,202240,442368,8798208,213544,0,214272,459008,9011200,9043968,8955904,8988672,8945664,8978432,8966144,8998912,9031680,9021440,8976384,9009152,9041920,9054208,0,0
.long 1478656,1609728,1740800,1871872,4294967295,4294967295,78848,5720064,2000896,95360,536870912,10240,516352,147712,40960,8954880,685184,536870912,117248,344320,8962048,197540,197568,684032,4282777600,468992,451840,202516,425984,202368,446464,8912896,213928,0,214272,475392,9035776,8947712,8980480,9013248,8970240,9003008,8990720,9023488,9056256,8957952,8968192,9000960,9033728,9046016,0,0
.long 1482752,1613824,1744896,1875968,4294967295,4294967295,79104,5722112,2007040,95488,536870912,10240,573696,164096,45056,8955904,685312,536870912,231936,348160,9060352,197544,197504,684032,4282777600,499712,455680,202640,458752,202496,450560,9027584,214312,0,214272,491776,9027584,8972288,9005056,9037824,8962048,8994816,8982528,9015296,9048064,8949760,8992768,9025536,9058304,8960000,0,0
.long 1486848,1617920,1748992,1880064,4294967295,4294967295,79104,5724160,2009088,95616,536870912,10240,631040,180480,45056,8956928,685440,536870912,346624,348416,9076736,197548,197568,684032,4282777600,501760,455936,202644,491520,202624,454656,9142272,214696,0,214272,508160,9019392,9052160,8964096,8996864,8953856,8986624,8974336,9007104,9039872,9029632,8984576,9017344,9050112,8951808,0,0
.long 1490944,1622016,1753088,1884160,4294967295,4294967295,79360,5726208,2015232,95744,11648,10240,459136,196864,49152,8957952,685568,275456,2816,352256,8945664,197552,197504,698368,4283006976,471040,452096,202520,393216,202240,442368,8806400,213548,0,214272,459136,9043968,8955904,8988672,8945664,8978432,9011200,8998912,9031680,9021440,8966144,9009152,9041920,9054208,8976384,0,0
.long 1495040,1626112,1757184,1888256,4294967295,4294967295,79360,5728256,2017280,95872,536870912,10240,516480,213248,49152,8958976,685696,536870912,117504,352512,8962048,197556,197568,698368,4283006976,473088,452352,202524,425984,202368,446464,8921088,213932,0,214272,475520,8947712,8980480,9013248,8970240,9003008,9035776,9023488,9056256,8957952,8990720,9000960,9033728,9046016,8968192,0,0
.long 1499136,1630208,1761280,1892352,4294967295,4294967295,79616,5730304,2023424,96000,536870912,10240,573824,229632,53248,8960000,685824,536870912,232192,356352,9060352,197560,197504,698368,4283006976,503808,456192,202648,458752,202496,450560,9035776,214316,0,214272,491904,8972288,9005056,9037824,8962048,8994816,9027584,9015296,9048064,8949760,8982528,9025536,9058304,8960000,8992768,0,0
.long 1503232,1634304,1765376,1896448,4294967295,4294967295,79616,5732352,2025472,96128,536870912,10240,631168,246016,53248,8961024,685952,536870912,346880,356608,9076736,197564,197568,698368,4283006976,505856,456448,202652,491520,202624,454656,9150464,214700,0,214272,508288,9052160,8964096,8996864,8953856,8986624,9019392,9007104,9039872,9029632,8974336,9017344,9050112,8951808,8984576,0,0
.long 1507328,1638400,1769472,1900544,4294967295,4294967295,79872,5734400,2031616,96256,11776,10240,459264,262400,57344,8962048,686080,279552,3072,360448,8945664,197568,197504,712704,4283236352,475136,452608,202528,393216,202240,442368,8814592,213552,0,214272,459264,8988672,8945664,8978432,9011200,9043968,8955904,9031680,9021440,8966144,8998912,9041920,9054208,8976384,9009152,0,0
.long 1511424,1642496,1773568,1904640,4294967295,4294967295,79872,5736448,2033664,96384,536870912,10240,516608,278784,57344,8963072,686208,536870912,117760,360704,8962048,197572,197568,712704,4283236352,477184,452864,202532,425984,202368,446464,8929280,213936,0,214272,475648,9013248,8970240,9003008,9035776,8947712,8980480,9056256,8957952,8990720,9023488,9033728,9046016,8968192,9000960,0,0
.long 1515520,1646592,1777664,1908736,4294967295,4294967295,80128,5738496,2039808,96512,536870912,10240,573952,295168,61440,8964096,686336,536870912,232448,364544,9060352,197576,197504,712704,4283236352,507904,456704,202656,458752,202496,450560,9043968,214320,0,214272,492032,9037824,8962048,8994816,9027584,8972288,9005056,9048064,8949760,8982528,9015296,9058304,8960000,8992768,9025536,0,0
.long 1519616,1650688,1781760,1912832,4294967295,4294967295,80128,5740544,2041856,96640,536870912,10240,631296,311552,61440,8965120,686464,536870912,347136,364800,9076736,197580,197568,712704,4283236352,509952,456960,202660,491520,202624,454656,9158656,214704,0,214272,508416,8996864,8953856,8986624,9019392,9052160,8964096,9039872,9029632,8974336,9007104,9050112,8951808,8984576,9017344,0,0
.long 1523712,1654784,1785856,1916928,4294967295,4294967295,80384,5742592,2048000,96768,11904,10240,459392,327936,65536,8966144,686592,283648,3328,368640,8945664,197584,197504,727040,4283465728,479232,453120,202536,393216,202240,442368,8822784,213556,0,214272,459392,8945664,8978432,9011200,9043968,8955904,8988672,9021440,8966144,8998912,9031680,9054208,8976384,9009152,9041920,0,0
.long 1527808,1658880,1789952,1921024,4294967295,4294967295,80384,5744640,2050048,96896,536870912,10240,516736,344320,65536,8967168,686720,536870912,118016,368896,8962048,197588,197568,727040,4283465728,481280,453376,202540,425984,202368,446464,8937472,213940,0,214272,475776,8970240,9003008,9035776,8947712,8980480,9013248,8957952,8990720,9023488,9056256,9046016,8968192,9000960,9033728,0,0
.long 1531904,1662976,1794048,1925120,4294967295,4294967295,80640,5746688,2056192,97024,536870912,10240,574080,360704,69632,8968192,686848,536870912,232704,372736,9060352,197592,197504,727040,4283465728,512000,457216,202664,458752,202496,450560,9052160,214324,0,214272,492160,8962048,8994816,9027584,8972288,9005056,9037824,8949760,8982528,9015296,9048064,8960000,8992768,9025536,9058304,0,0
.long 1536000,1667072,1798144,1929216,4294967295,4294967295,80640,5748736,2058240,97152,536870912,10240,631424,377088,69632,8969216,686976,536870912,347392,372992,9076736,197596,197568,727040,4283465728,514048,457472,202668,491520,202624,454656,9166848,214708,0,214272,508544,8953856,8986624,9019392,9052160,8964096,8996864,9029632,8974336,9007104,9039872,8951808,8984576,9017344,9050112,0,0
.long 1540096,1671168,1802240,1933312,4294967295,4294967295,80896,5750784,2064384,97280,12032,10240,459520,393472,73728,8970240,687104,287744,3328,368640,8945664,197600,197504,741376,4283695104,483328,453632,202544,393216,202240,442368,536870912,536870912,6160384,214272,459520,9011200,9043968,8955904,8988672,8945664,8978432,8966144,8998912,9031680,9021440,8976384,9009152,9041920,9054208,0,0
.long 1544192,1675264,1806336,1937408,4294967295,4294967295,80896,5752832,2066432,97408,536870912,10240,516864,409856,73728,8971264,687232,536870912,118016,368896,8962048,197604,197568,741376,4283695104,485376,453888,202548,425984,202368,446464,536870912,536870912,6160384,214272,475904,9035776,8947712,8980480,9013248,8970240,9003008,8990720,9023488,9056256,8957952,8968192,9000960,9033728,9046016,0,0
.long 1548288,1679360,1810432,1941504,4294967295,4294967295,81152,5754880,2072576,97536,536870912,10240,574208,426240,77824,8972288,687360,536870912,232704,372736,9060352,197608,197504,741376,4283695104,516096,457728,202672,458752,202496,450560,536870912,536870912,6160384,214272,492288,9027584,8972288,9005056,9037824,8962048,8994816,8982528,9015296,9048064,8949760,8992768,9025536,9058304,8960000,0,0
.long 1552384,1683456,1814528,1945600,4294967295,4294967295,81152,5756928,2074624,97664,536870912,10240,631552,442624,77824,8973312,687488,536870912,347392,372992,9076736,197612,197568,741376,4283695104,518144,457984,202676,491520,202624,454656,536870912,536870912,6160384,214272,508672,9019392,9052160,8964096,8996864,8953856,8986624,8974336,9007104,9039872,9029632,8984576,9017344,9050112,8951808,0,0
.long 1556480,1687552,1818624,1949696,4294967295,4294967295,81408,5758976,2080768,97792,12160,10240,459648,459008,16384,8974336,687616,291840,3328,368640,8945664,197616,197504,755712,4283924480,487424,454144,202552,393216,202240,442368,536870912,536870912,6619136,214272,459648,9043968,8955904,8988672,8945664,8978432,9011200,8998912,9031680,9021440,8966144,9009152,9041920,9054208,8976384,0,0
.long 1560576,1691648,1822720,1953792,4294967295,4294967295,81408,5761024,2082816,97920,536870912,10240,516992,475392,16384,8975360,687744,536870912,118016,368896,8962048,197620,197568,755712,4283924480,489472,454400,202556,425984,202368,446464,536870912,536870912,6619136,214272,476032,8947712,8980480,9013248,8970240,9003008,9035776,9023488,9056256,8957952,8990720,9000960,9033728,9046016,8968192,0,0
.long 1564672,1695744,1826816,1957888,4294967295,4294967295,81664,5763072,2088960,98048,536870912,10240,574336,491776,20480,8976384,687872,536870912,232704,372736,9060352,197624,197504,755712,4283924480,520192,458240,202680,458752,202496,450560,536870912,536870912,6619136,214272,492416,8972288,9005056,9037824,8962048,8994816,9027584,9015296,9048064,8949760,8982528,9025536,9058304,8960000,8992768,0,0
.long 1568768,1699840,1830912,1961984,4294967295,4294967295,81664,5765120,2091008,98176,536870912,10240,631680,508160,20480,8977408,688000,536870912,347392,372992,9076736,197628,197568,755712,4283924480,522240,458496,202684,491520,202624,454656,536870912,536870912,6619136,214272,508800,9052160,8964096,8996864,8953856,8986624,9019392,9007104,9039872,9029632,8974336,9017344,9050112,8951808,8984576,0,0
.long 1572864,1703936,1835008,1966080,4294967295,4294967295,81920,5767168,2097152,98304,12288,12288,459776,524544,16384,9175040,688128,295936,0,262144,9175040,197632,197632,655360,4281860096,524288,458752,202752,524288,202752,458752,9175040,215040,0,215040,524288,9175040,9207808,9240576,9273344,9185280,9218048,9250816,9195520,9228288,9261056,9283584,9205760,9238528,9271296,0,0
.long 1576960,1708032,1839104,1970176,4294967295,4294967295,81920,5769216,2099200,98432,536870912,12288,517120,540928,16384,9176064,688256,536870912,114688,262400,9191424,197636,197696,655360,4281860096,526336,459008,202756,557056,202880,462848,9289728,215424,0,215040,540672,9199616,9232384,9265152,9177088,9209856,9242624,9187328,9220096,9252864,9285632,9275392,9197568,9230336,9263104,0,0
.long 1581056,1712128,1843200,1974272,4294967295,4294967295,82176,5771264,2105344,98560,536870912,12288,574464,557312,20480,9177088,688384,536870912,229376,266240,9289728,197640,197632,655360,4281860096,557056,462848,202880,589824,203008,466944,9404416,215808,0,215040,557056,9191424,9224192,9256960,9201664,9234432,9267200,9179136,9211904,9244672,9277440,9189376,9222144,9254912,9287680,0,0
.long 1585152,1716224,1847296,1978368,4294967295,4294967295,82176,5773312,2107392,98688,536870912,12288,631808,573696,20480,9178112,688512,536870912,344064,266496,9306112,197644,197696,655360,4281860096,559104,463104,202884,622592,203136,471040,9519104,216192,0,215040,573440,9183232,9216000,9248768,9281536,9193472,9226240,9259008,9203712,9236480,9269248,9181184,9213952,9246720,9279488,0,0
.long 1589248,1720320,1851392,1982464,4294967295,4294967295,82432,5775360,2113536,98816,12416,12288,459904,590080,24576,9179136,688640,300032,256,270336,9175040,197648,197632,669696,4282089472,528384,459264,202760,524288,202752,458752,9183232,215044,0,215040,524416,9240576,9273344,9185280,9218048,9175040,9207808,9195520,9228288,9261056,9250816,9205760,9238528,9271296,9283584,0,0
.long 1593344,1724416,1855488,1986560,4294967295,4294967295,82432,5777408,2115584,98944,536870912,12288,517248,606464,24576,9180160,688768,536870912,114944,270592,9191424,197652,197696,669696,4282089472,530432,459520,202764,557056,202880,462848,9297920,215428,0,215040,540800,9265152,9177088,9209856,9242624,9199616,9232384,9220096,9252864,9285632,9187328,9197568,9230336,9263104,9275392,0,0
.long 1597440,1728512,1859584,1990656,4294967295,4294967295,82688,5779456,2121728,99072,536870912,12288,574592,622848,28672,9181184,688896,536870912,229632,274432,9289728,197656,197632,669696,4282089472,561152,463360,202888,589824,203008,466944,9412608,215812,0,215040,557184,9256960,9201664,9234432,9267200,9191424,9224192,9211904,9244672,9277440,9179136,9222144,9254912,9287680,9189376,0,0
.long 1601536,1732608,1863680,1994752,4294967295,4294967295,82688,5781504,2123776,99200,536870912,12288,631936,639232,28672,9182208,689024,536870912,344320,274688,9306112,197660,197696,669696,4282089472,563200,463616,202892,622592,203136,471040,9527296,216196,0,215040,573568,9248768,9281536,9193472,9226240,9183232,9216000,9203712,9236480,9269248,9259008,9213952,9246720,9279488,9181184,0,0
.long 1605632,1736704,1867776,1998848,4294967295,4294967295,82944,5783552,2129920,99328,12544,12288,460032,655616,32768,9183232,689152,304128,512,278528,9175040,197664,197632,684032,4282318848,532480,459776,202768,524288,202752,458752,9191424,215048,0,215040,524544,9273344,9185280,9218048,9175040,9207808,9240576,9228288,9261056,9250816,9195520,9238528,9271296,9283584,9205760,0,0
.long 1609728,1740800,1871872,2002944,4294967295,4294967295,82944,5785600,2131968,99456,536870912,12288,517376,672000,32768,9184256,689280,536870912,115200,278784,9191424,197668,197696,684032,4282318848,534528,460032,202772,557056,202880,462848,9306112,215432,0,215040,540928,9177088,9209856,9242624,9199616,9232384,9265152,9252864,9285632,9187328,9220096,9230336,9263104,9275392,9197568,0,0
.long 1613824,1744896,1875968,2007040,4294967295,4294967295,83200,5787648,2138112,99584,536870912,12288,574720,688384,36864,9185280,689408,536870912,229888,282624,9289728,197672,197632,684032,4282318848,565248,463872,202896,589824,203008,466944,9420800,215816,0,215040,557312,9201664,9234432,9267200,9191424,9224192,9256960,9244672,9277440,9179136,9211904,9254912,9287680,9189376,9222144,0,0
.long 1617920,1748992,1880064,2011136,4294967295,4294967295,83200,5789696,2140160,99712,536870912,12288,632064,704768,36864,9186304,689536,536870912,344576,282880,9306112,197676,197696,684032,4282318848,567296,464128,202900,622592,203136,471040,9535488,216200,0,215040,573696,9281536,9193472,9226240,9183232,9216000,9248768,9236480,9269248,9259008,9203712,9246720,9279488,9181184,9213952,0,0
.long 1622016,1753088,1884160,2015232,4294967295,4294967295,83456,5791744,2146304,99840,12672,12288,460160,721152,40960,9187328,689664,308224,768,286720,9175040,197680,197632,698368,4282548224,536576,460288,202776,524288,202752,458752,9199616,215052,0,215040,524672,9218048,9175040,9207808,9240576,9273344,9185280,9261056,9250816,9195520,9228288,9271296,9283584,9205760,9238528,0,0
.long 1626112,1757184,1888256,2019328,4294967295,4294967295,83456,5793792,2148352,99968,536870912,12288,517504,737536,40960,9188352,689792,536870912,115456,286976,9191424,197684,197696,698368,4282548224,538624,460544,202780,557056,202880,462848,9314304,215436,0,215040,541056,9242624,9199616,9232384,9265152,9177088,9209856,9285632,9187328,9220096,9252864,9263104,9275392,9197568,9230336,0,0
.long 1630208,1761280,1892352,2023424,4294967295,4294967295,83712,5795840,2154496,100096,536870912,12288,574848,753920,45056,9189376,689920,536870912,230144,290816,9289728,197688,197632,698368,4282548224,569344,464384,202904,589824,203008,466944,9428992,215820,0,215040,557440,9267200,9191424,9224192,9256960,9201664,9234432,9277440,9179136,9211904,9244672,9287680,9189376,9222144,9254912,0,0
.long 1634304,1765376,1896448,2027520,4294967295,4294967295,83712,5797888,2156544,100224,536870912,12288,632192,770304,45056,9190400,690048,536870912,344832,291072,9306112,197692,197696,698368,4282548224,571392,464640,202908,622592,203136,471040,9543680,216204,0,215040,573824,9226240,9183232,9216000,9248768,9281536,9193472,9269248,9259008,9203712,9236480,9279488,9181184,9213952,9246720,0,0
.long 1638400,1769472,1900544,2031616,4294967295,4294967295,83968,5799936,2162688,100352,12800,12288,460288,786688,49152,9191424,690176,312320,1024,294912,9175040,197696,197632,712704,4282777600,540672,460800,202784,524288,202752,458752,9207808,215056,0,215040,524800,9175040,9207808,9240576,9273344,9185280,9218048,9250816,9195520,9228288,9261056,9283584,9205760,9238528,9271296,0,0
.long 1642496,1773568,1904640,2035712,4294967295,4294967295,83968,5801984,2164736,100480,536870912,12288,517632,803072,49152,9192448,690304,536870912,115712,295168,9191424,197700,197696,712704,4282777600,542720,461056,202788,557056,202880,462848,9322496,215440,0,215040,541184,9199616,9232384,9265152,9177088,9209856,9242624,9187328,9220096,9252864,9285632,9275392,9197568,9230336,9263104,0,0
.long 1646592,1777664,1908736,2039808,4294967295,4294967295,84224,5804032,2170880,100608,536870912,12288,574976,819456,53248,9193472,690432,536870912,230400,299008,9289728,197704,197632,712704,4282777600,573440,464896,202912,589824,203008,466944,9437184,215824,0,215040,557568,9191424,9224192,9256960,9201664,9234432,9267200,9179136,9211904,9244672,9277440,9189376,9222144,9254912,9287680,0,0
.long 1650688,1781760,1912832,2043904,4294967295,4294967295,84224,5806080,2172928,100736,536870912,12288,632320,835840,53248,9194496,690560,536870912,345088,299264,9306112,197708,197696,712704,4282777600,575488,465152,202916,622592,203136,471040,9551872,216208,0,215040,573952,9183232,9216000,9248768,9281536,9193472,9226240,9259008,9203712,9236480,9269248,9181184,9213952,9246720,9279488,0,0
.long 1654784,1785856,1916928,2048000,4294967295,4294967295,84480,5808128,2179072,100864,12928,12288,460416,852224,57344,9195520,690688,316416,1280,303104,9175040,197712,197632,727040,4283006976,544768,461312,202792,524288,202752,458752,9216000,215060,0,215040,524928,9240576,9273344,9185280,9218048,9175040,9207808,9195520,9228288,9261056,9250816,9205760,9238528,9271296,9283584,0,0
.long 1658880,1789952,1921024,2052096,4294967295,4294967295,84480,5810176,2181120,100992,536870912,12288,517760,868608,57344,9196544,690816,536870912,115968,303360,9191424,197716,197696,727040,4283006976,546816,461568,202796,557056,202880,462848,9330688,215444,0,215040,541312,9265152,9177088,9209856,9242624,9199616,9232384,9220096,9252864,9285632,9187328,9197568,9230336,9263104,9275392,0,0
.long 1662976,1794048,1925120,2056192,4294967295,4294967295,84736,5812224,2187264,101120,536870912,12288,575104,884992,61440,9197568,690944,536870912,230656,307200,9289728,197720,197632,727040,4283006976,577536,465408,202920,589824,203008,466944,9445376,215828,0,215040,557696,9256960,9201664,9234432,9267200,9191424,9224192,9211904,9244672,9277440,9179136,9222144,9254912,9287680,9189376,0,0
.long 1667072,1798144,1929216,2060288,4294967295,4294967295,84736,5814272,2189312,101248,536870912,12288,632448,901376,61440,9198592,691072,536870912,345344,307456,9306112,197724,197696,727040,4283006976,579584,465664,202924,622592,203136,471040,9560064,216212,0,215040,574080,9248768,9281536,9193472,9226240,9183232,9216000,9203712,9236480,9269248,9259008,9213952,9246720,9279488,9181184,0,0
.long 1671168,1802240,1933312,2064384,4294967295,4294967295,84992,5816320,2195456,101376,13056,12288,460544,917760,65536,9199616,691200,320512,1536,311296,9175040,197728,197632,741376,4283236352,548864,461824,202800,524288,202752,458752,9224192,215064,0,215040,525056,9273344,9185280,9218048,9175040,9207808,9240576,9228288,9261056,9250816,9195520,9238528,9271296,9283584,9205760,0,0
.long 1675264,1806336,1937408,2068480,4294967295,4294967295,84992,5818368,2197504,101504,536870912,12288,517888,934144,65536,9200640,691328,536870912,116224,311552,9191424,197732,197696,741376,4283236352,550912,462080,202804,557056,202880,462848,9338880,215448,0,215040,541440,9177088,9209856,9242624,9199616,9232384,9265152,9252864,9285632,9187328,9220096,9230336,9263104,9275392,9197568,0,0
.long 1679360,1810432,1941504,2072576,4294967295,4294967295,85248,5820416,2203648,101632,536870912,12288,575232,950528,69632,9201664,691456,536870912,230912,315392,9289728,197736,197632,741376,4283236352,581632,465920,202928,589824,203008,466944,9453568,215832,0,215040,557824,9201664,9234432,9267200,9191424,9224192,9256960,9244672,9277440,9179136,9211904,9254912,9287680,9189376,9222144,0,0
.long 1683456,1814528,1945600,2076672,4294967295,4294967295,85248,5822464,2205696,101760,536870912,12288,632576,966912,69632,9202688,691584,536870912,345600,315648,9306112,197740,197696,741376,4283236352,583680,466176,202932,622592,203136,471040,9568256,216216,0,215040,574208,9281536,9193472,9226240,9183232,9216000,9248768,9236480,9269248,9259008,9203712,9246720,9279488,9181184,9213952,0,0
.long 1687552,1818624,1949696,2080768,4294967295,4294967295,85504,5824512,2211840,101888,13184,12288,460672,983296,73728,9203712,691712,324608,1792,319488,9175040,197744,197632,755712,4283465728,552960,462336,202808,524288,202752,458752,9232384,215068,0,215040,525184,9218048,9175040,9207808,9240576,9273344,9185280,9261056,9250816,9195520,9228288,9271296,9283584,9205760,9238528,0,0
.long 1691648,1822720,1953792,2084864,4294967295,4294967295,85504,5826560,2213888,102016,536870912,12288,518016,999680,73728,9204736,691840,536870912,116480,319744,9191424,197748,197696,755712,4283465728,555008,462592,202812,557056,202880,462848,9347072,215452,0,215040,541568,9242624,9199616,9232384,9265152,9177088,9209856,9285632,9187328,9220096,9252864,9263104,9275392,9197568,9230336,0,0
.long 1695744,1826816,1957888,2088960,4294967295,4294967295,85760,5828608,2220032,102144,536870912,12288,575360,1016064,77824,9205760,691968,536870912,231168,323584,9289728,197752,197632,755712,4283465728,585728,466432,202936,589824,203008,466944,9461760,215836,0,215040,557952,9267200,9191424,9224192,9256960,9201664,9234432,9277440,9179136,9211904,9244672,9287680,9189376,9222144,9254912,0,0
.long 1699840,1830912,1961984,2093056,4294967295,4294967295,85760,5830656,2222080,102272,536870912,12288,632704,1032448,77824,9206784,692096,536870912,345856,323840,9306112,197756,197696,755712,4283465728,587776,466688,202940,622592,203136,471040,9576448,216220,0,215040,574336,9226240,9183232,9216000,9248768,9281536,9193472,9269248,9259008,9203712,9236480,9279488,9181184,9213952,9246720,0,0
.long 1703936,1835008,1966080,2097152,4294967295,4294967295,86016,5832704,2228224,102400,13312,12288,460800,1048832,73728,9404416,692224,328704,2048,327680,9404416,197760,197760,655360,4281401344,589824,466944,203008,524288,202752,458752,9240576,215072,0,215808,589824,9469952,9502720,9414656,9447424,9404416,9437184,9424896,9457664,9490432,9480192,9435136,9467904,9500672,9512960,0,0
.long 1708032,1839104,1970176,2101248,4294967295,4294967295,86016,5834752,2230272,102528,536870912,12288,518144,1065216,73728,9405440,692352,536870912,116736,327936,9420800,197764,197824,655360,4281401344,591872,467200,203012,557056,202880,462848,9355264,215456,0,215808,606208,9494528,9406464,9439232,9472000,9428992,9461760,9449472,9482240,9515008,9416704,9426944,9459712,9492480,9504768,0,0
.long 1712128,1843200,1974272,2105344,4294967295,4294967295,86272,5836800,2236416,102656,536870912,12288,575488,1081600,77824,9406464,692480,536870912,231424,331776,9519104,197768,197760,655360,4281401344,622592,471040,203136,589824,203008,466944,9469952,215840,0,215808,622592,9486336,9431040,9463808,9496576,9420800,9453568,9441280,9474048,9506816,9408512,9451520,9484288,9517056,9418752,0,0
.long 1716224,1847296,1978368,2109440,4294967295,4294967295,86272,5838848,2238464,102784,536870912,12288,632832,1097984,77824,9407488,692608,536870912,346112,332032,9535488,197772,197824,655360,4281401344,624640,471296,203140,622592,203136,471040,9584640,216224,0,215808,638976,9478144,9510912,9422848,9455616,9412608,9445376,9433088,9465856,9498624,9488384,9443328,9476096,9508864,9410560,0,0
.long 1720320,1851392,1982464,2113536,4294967295,4294967295,86528,5840896,2244608,102912,13440,12288,460928,1114368,16384,9408512,692736,332800,2304,335872,9404416,197776,197760,669696,4281630720,593920,467456,203016,524288,202752,458752,9248768,215076,0,215808,589952,9502720,9414656,9447424,9404416,9437184,9469952,9457664,9490432,9480192,9424896,9467904,9500672,9512960,9435136,0,0
.long 1724416,1855488,1986560,2117632,4294967295,4294967295,86528,5842944,2246656,103040,536870912,12288,518272,1130752,16384,9409536,692864,536870912,116992,336128,9420800,197780,197824,669696,4281630720,595968,467712,203020,557056,202880,462848,9363456,215460,0,215808,606336,9406464,9439232,9472000,9428992,9461760,9494528,9482240,9515008,9416704,9449472,9459712,9492480,9504768,9426944,0,0
.long 1728512,1859584,1990656,2121728,4294967295,4294967295,86784,5844992,2252800,103168,536870912,12288,575616,1147136,20480,9410560,692992,536870912,231680,339968,9519104,197784,197760,669696,4281630720,626688,471552,203144,589824,203008,466944,9478144,215844,0,215808,622720,9431040,9463808,9496576,9420800,9453568,9486336,9474048,9506816,9408512,9441280,9484288,9517056,9418752,9451520,0,0
.long 1732608,1863680,1994752,2125824,4294967295,4294967295,86784,5847040,2254848,103296,536870912,12288,632960,1163520,20480,9411584,693120,536870912,346368,340224,9535488,197788,197824,669696,4281630720,628736,471808,203148,622592,203136,471040,9592832,216228,0,215808,639104,9510912,9422848,9455616,9412608,9445376,9478144,9465856,9498624,9488384,9433088,9476096,9508864,9410560,9443328,0,0
.long 1736704,1867776,1998848,2129920,4294967295,4294967295,87040,5849088,2260992,103424,13568,12288,461056,1179904,24576,9412608,693248,336896,2560,344064,9404416,197792,197760,684032,4281860096,598016,467968,203024,524288,202752,458752,9256960,215080,0,215808,590080,9447424,9404416,9437184,9469952,9502720,9414656,9490432,9480192,9424896,9457664,9500672,9512960,9435136,9467904,0,0
.long 1740800,1871872,2002944,2134016,4294967295,4294967295,87040,5851136,2263040,103552,536870912,12288,518400,1196288,24576,9413632,693376,536870912,117248,344320,9420800,197796,197824,684032,4281860096,600064,468224,203028,557056,202880,462848,9371648,215464,0,215808,606464,9472000,9428992,9461760,9494528,9406464,9439232,9515008,9416704,9449472,9482240,9492480,9504768,9426944,9459712,0,0
.long 1744896,1875968,2007040,2138112,4294967295,4294967295,87296,5853184,2269184,103680,536870912,12288,575744,1212672,28672,9414656,693504,536870912,231936,348160,9519104,197800,197760,684032,4281860096,630784,472064,203152,589824,203008,466944,9486336,215848,0,215808,622848,9496576,9420800,9453568,9486336,9431040,9463808,9506816,9408512,9441280,9474048,9517056,9418752,9451520,9484288,0,0
.long 1748992,1880064,2011136,2142208,4294967295,4294967295,87296,5855232,2271232,103808,536870912,12288,633088,1229056,28672,9415680,693632,536870912,346624,348416,9535488,197804,197824,684032,4281860096,632832,472320,203156,622592,203136,471040,9601024,216232,0,215808,639232,9455616,9412608,9445376,9478144,9510912,9422848,9498624,9488384,9433088,9465856,9508864,9410560,9443328,9476096,0,0
.long 1753088,1884160,2015232,2146304,4294967295,4294967295,87552,5857280,2277376,103936,13696,12288,461184,1245440,32768,9416704,693760,340992,2816,352256,9404416,197808,197760,698368,4282089472,602112,468480,203032,524288,202752,458752,9265152,215084,0,215808,590208,9404416,9437184,9469952,9502720,9414656,9447424,9480192,9424896,9457664,9490432,9512960,9435136,9467904,9500672,0,0
.long 1757184,1888256,2019328,2150400,4294967295,4294967295,87552,5859328,2279424,104064,536870912,12288,518528,1261824,32768,9417728,693888,536870912,117504,352512,9420800,197812,197824,698368,4282089472,604160,468736,203036,557056,202880,462848,9379840,215468,0,215808,606592,9428992,9461760,9494528,9406464,9439232,9472000,9416704,9449472,9482240,9515008,9504768,9426944,9459712,9492480,0,0
.long 1761280,1892352,2023424,2154496,4294967295,4294967295,87808,5861376,2285568,104192,536870912,12288,575872,1278208,36864,9418752,694016,536870912,232192,356352,9519104,197816,197760,698368,4282089472,634880,472576,203160,589824,203008,466944,9494528,215852,0,215808,622976,9420800,9453568,9486336,9431040,9463808,9496576,9408512,9441280,9474048,9506816,9418752,9451520,9484288,9517056,0,0
.long 1765376,1896448,2027520,2158592,4294967295,4294967295,87808,5863424,2287616,104320,536870912,12288,633216,1294592,36864,9419776,694144,536870912,346880,356608,9535488,197820,197824,698368,4282089472,636928,472832,203164,622592,203136,471040,9609216,216236,0,215808,639360,9412608,9445376,9478144,9510912,9422848,9455616,9488384,9433088,9465856,9498624,9410560,9443328,9476096,9508864,0,0
.long 1769472,1900544,2031616,2162688,4294967295,4294967295,88064,5865472,2293760,104448,13824,12288,461312,1310976,40960,9420800,694272,345088,3072,360448,9404416,197824,197760,712704,4282318848,606208,468992,203040,524288,202752,458752,9273344,215088,0,215808,590336,9469952,9502720,9414656,9447424,9404416,9437184,9424896,9457664,9490432,9480192,9435136,9467904,9500672,9512960,0,0
.long 1773568,1904640,2035712,2166784,4294967295,4294967295,88064,5867520,2295808,104576,536870912,12288,518656,1327360,40960,9421824,694400,536870912,117760,360704,9420800,197828,197824,712704,4282318848,608256,469248,203044,557056,202880,462848,9388032,215472,0,215808,606720,9494528,9406464,9439232,9472000,9428992,9461760,9449472,9482240,9515008,9416704,9426944,9459712,9492480,9504768,0,0
.long 1777664,1908736,2039808,2170880,4294967295,4294967295,88320,5869568,2301952,104704,536870912,12288,576000,1343744,45056,9422848,694528,536870912,232448,364544,9519104,197832,197760,712704,4282318848,638976,473088,203168,589824,203008,466944,9502720,215856,0,215808,623104,9486336,9431040,9463808,9496576,9420800,9453568,9441280,9474048,9506816,9408512,9451520,9484288,9517056,9418752,0,0
.long 1781760,1912832,2043904,2174976,4294967295,4294967295,88320,5871616,2304000,104832,536870912,12288,633344,1360128,45056,9423872,694656,536870912,347136,364800,9535488,197836,197824,712704,4282318848,641024,473344,203172,622592,203136,471040,9617408,216240,0,215808,639488,9478144,9510912,9422848,9455616,9412608,9445376,9433088,9465856,9498624,9488384,9443328,9476096,9508864,9410560,0,0
.long 1785856,1916928,2048000,2179072,4294967295,4294967295,88576,5873664,2310144,104960,13952,12288,461440,1376512,49152,9424896,694784,349184,3328,368640,9404416,197840,197760,727040,4282548224,610304,469504,203048,524288,202752,458752,9281536,215092,0,215808,590464,9502720,9414656,9447424,9404416,9437184,9469952,9457664,9490432,9480192,9424896,9467904,9500672,9512960,9435136,0,0
.long 1789952,1921024,2052096,2183168,4294967295,4294967295,88576,5875712,2312192,105088,536870912,12288,518784,1392896,49152,9425920,694912,536870912,118016,368896,9420800,197844,197824,727040,4282548224,612352,469760,203052,557056,202880,462848,9396224,215476,0,215808,606848,9406464,9439232,9472000,9428992,9461760,9494528,9482240,9515008,9416704,9449472,9459712,9492480,9504768,9426944,0,0
.long 1794048,1925120,2056192,2187264,4294967295,4294967295,88832,5877760,2318336,105216,536870912,12288,576128,1409280,53248,9426944,695040,536870912,232704,372736,9519104,197848,197760,727040,4282548224,643072,473600,203176,589824,203008,466944,9510912,215860,0,215808,623232,9431040,9463808,9496576,9420800,9453568,9486336,9474048,9506816,9408512,9441280,9484288,9517056,9418752,9451520,0,0
.long 1798144,1929216,2060288,2191360,4294967295,4294967295,88832,5879808,2320384,105344,536870912,12288,633472,1425664,53248,9427968,695168,536870912,347392,372992,9535488,197852,197824,727040,4282548224,645120,473856,203180,622592,203136,471040,9625600,216244,0,215808,639616,9510912,9422848,9455616,9412608,9445376,9478144,9465856,9498624,9488384,9433088,9476096,9508864,9410560,9443328,0,0
.long 1802240,1933312,2064384,2195456,4294967295,4294967295,89088,5881856,2326528,105472,14080,12288,461568,1442048,57344,9428992,695296,353280,3328,368640,9404416,197856,197760,741376,4282777600,614400,470016,203056,524288,202752,458752,536870912,536870912,5242880,215808,590592,9447424,9404416,9437184,9469952,9502720,9414656,9490432,9480192,9424896,9457664,9500672,9512960,9435136,9467904,0,0
.long 1806336,1937408,2068480,2199552,4294967295,4294967295,89088,5883904,2328576,105600,536870912,12288,518912,1458432,57344,9430016,695424,536870912,118016,368896,9420800,197860,197824,741376,4282777600,616448,470272,203060,557056,202880,462848,536870912,536870912,5242880,215808,606976,9472000,9428992,9461760,9494528,9406464,9439232,9515008,9416704,9449472,9482240,9492480,9504768,9426944,9459712,0,0
.long 1810432,1941504,2072576,2203648,4294967295,4294967295,89344,5885952,2334720,105728,536870912,12288,576256,1474816,61440,9431040,695552,536870912,232704,372736,9519104,197864,197760,741376,4282777600,647168,474112,203184,589824,203008,466944,536870912,536870912,5242880,215808,623360,9496576,9420800,9453568,9486336,9431040,9463808,9506816,9408512,9441280,9474048,9517056,9418752,9451520,9484288,0,0
.long 1814528,1945600,2076672,2207744,4294967295,4294967295,89344,5888000,2336768,105856,536870912,12288,633600,1491200,61440,9432064,695680,536870912,347392,372992,9535488,197868,197824,741376,4282777600,649216,474368,203188,622592,203136,471040,536870912,536870912,5242880,215808,639744,9455616,9412608,9445376,9478144,9510912,9422848,9498624,9488384,9433088,9465856,9508864,9410560,9443328,9476096,0,0
.long 1818624,1949696,2080768,2211840,4294967295,4294967295,89600,5890048,2342912,105984,14208,12288,461696,1507584,65536,9433088,695808,357376,3328,368640,9404416,197872,197760,755712,4283006976,618496,470528,203064,524288,202752,458752,536870912,536870912,5701632,215808,590720,9404416,9437184,9469952,9502720,9414656,9447424,9480192,9424896,9457664,9490432,9512960,9435136,9467904,9500672,0,0
.long 1822720,1953792,2084864,2215936,4294967295,4294967295,89600,5892096,2344960,106112,536870912,12288,519040,1523968,65536,9434112,695936,536870912,118016,368896,9420800,197876,197824,755712,4283006976,620544,470784,203068,557056,202880,462848,536870912,536870912,5701632,215808,607104,9428992,9461760,9494528,9406464,9439232,9472000,9416704,9449472,9482240,9515008,9504768,9426944,9459712,9492480,0,0
.long 1826816,1957888,2088960,2220032,4294967295,4294967295,89856,5894144,2351104,106240,536870912,12288,576384,1540352,69632,9435136,696064,536870912,232704,372736,9519104,197880,197760,755712,4283006976,651264,474624,203192,589824,203008,466944,536870912,536870912,5701632,215808,623488,9420800,9453568,9486336,9431040,9463808,9496576,9408512,9441280,9474048,9506816,9418752,9451520,9484288,9517056,0,0
.long 1830912,1961984,2093056,2224128,4294967295,4294967295,89856,5896192,2353152,106368,536870912,12288,633728,1556736,69632,9436160,696192,536870912,347392,372992,9535488,197884,197824,755712,4283006976,653312,474880,203196,622592,203136,471040,536870912,536870912,5701632,215808,639872,9412608,9445376,9478144,9510912,9422848,9455616,9488384,9433088,9465856,9498624,9410560,9443328,9476096,9508864,0,0
.long 1835008,1966080,2097152,2228224,4294967295,4294967295,90112,5898240,2359296,106496,14336,14336,461824,1573120,65536,9633792,696320,361472,0,262144,9633792,197888,197888,655360,4280942592,655360,475136,203264,655360,203264,475136,9633792,216576,0,216576,655360,9732096,9644032,9676800,9633792,9666560,9699328,9687040,9719808,9709568,9654272,9697280,9730048,9742336,9664512,0,0
.long 1839104,1970176,2101248,2232320,4294967295,4294967295,90112,5900288,2361344,106624,536870912,14336,519168,1589504,65536,9634816,696448,536870912,114688,262400,9650176,197892,197952,655360,4280942592,657408,475392,203268,688128,203392,479232,9748480,216960,0,216576,671744,9635840,9668608,9701376,9658368,9691136,9723904,9711616,9744384,9646080,9678848,9689088,9721856,9734144,9656320,0,0
.long 1843200,1974272,2105344,2236416,4294967295,4294967295,90368,5902336,2367488,106752,536870912,14336,576512,1605888,69632,9635840,696576,536870912,229376,266240,9748480,197896,197888,655360,4280942592,688128,479232,203392,720896,203520,483328,9863168,217344,0,216576,688128,9660416,9693184,9725952,9650176,9682944,9715712,9703424,9736192,9637888,9670656,9713664,9746432,9648128,9680896,0,0
.long 1847296,1978368,2109440,2240512,4294967295,4294967295,90368,5904384,2369536,106880,536870912,14336,633856,1622272,69632,9636864,696704,536870912,344064,266496,9764864,197900,197952,655360,4280942592,690176,479488,203396,753664,203648,487424,9977856,217728,0,216576,704512,9740288,9652224,9684992,9641984,9674752,9707520,9695232,9728000,9717760,9662464,9705472,9738240,9639936,9672704,0,0
.long 1851392,1982464,2113536,2244608,4294967295,4294967295,90624,5906432,2375680,107008,14464,14336,461952,1638656,73728,9637888,696832,365568,256,270336,9633792,197904,197888,669696,4281171968,659456,475648,203272,655360,203264,475136,9641984,216580,0,216576,655488,9676800,9633792,9666560,9699328,9732096,9644032,9719808,9709568,9654272,9687040,9730048,9742336,9664512,9697280,0,0
.long 1855488,1986560,2117632,2248704,4294967295,4294967295,90624,5908480,2377728,107136,536870912,14336,519296,1655040,73728,9638912,696960,536870912,114944,270592,9650176,197908,197952,669696,4281171968,661504,475904,203276,688128,203392,479232,9756672,216964,0,216576,671872,9701376,9658368,9691136,9723904,9635840,9668608,9744384,9646080,9678848,9711616,9721856,9734144,9656320,9689088,0,0
.long 1859584,1990656,2121728,2252800,4294967295,4294967295,90880,5910528,2383872,107264,536870912,14336,576640,1671424,77824,9639936,697088,536870912,229632,274432,9748480,197912,197888,669696,4281171968,692224,479744,203400,720896,203520,483328,9871360,217348,0,216576,688256,9725952,9650176,9682944,9715712,9660416,9693184,9736192,9637888,9670656,9703424,9746432,9648128,9680896,9713664,0,0
.long 1863680,1994752,2125824,2256896,4294967295,4294967295,90880,5912576,2385920,107392,536870912,14336,633984,1687808,77824,9640960,697216,536870912,344320,274688,9764864,197916,197952,669696,4281171968,694272,480000,203404,753664,203648,487424,9986048,217732,0,216576,704640,9684992,9641984,9674752,9707520,9740288,9652224,9728000,9717760,9662464,9695232,9738240,9639936,9672704,9705472,0,0
.long 1867776,1998848,2129920,2260992,4294967295,4294967295,91136,5914624,2392064,107520,14592,14336,462080,1704192,16384,9641984,697344,369664,512,278528,9633792,197920,197888,684032,4281401344,663552,476160,203280,655360,203264,475136,9650176,216584,0,216576,655616,9633792,9666560,9699328,9732096,9644032,9676800,9709568,9654272,9687040,9719808,9742336,9664512,9697280,9730048,0,0
.long 1871872,2002944,2134016,2265088,4294967295,4294967295,91136,5916672,2394112,107648,536870912,14336,519424,1720576,16384,9643008,697472,536870912,115200,278784,9650176,197924,197952,684032,4281401344,665600,476416,203284,688128,203392,479232,9764864,216968,0,216576,672000,9658368,9691136,9723904,9635840,9668608,9701376,9646080,9678848,9711616,9744384,9734144,9656320,9689088,9721856,0,0
.long 1875968,2007040,2138112,2269184,4294967295,4294967295,91392,5918720,2400256,107776,536870912,14336,576768,1736960,20480,9644032,697600,536870912,229888,282624,9748480,197928,197888,684032,4281401344,696320,480256,203408,720896,203520,483328,9879552,217352,0,216576,688384,9650176,9682944,9715712,9660416,9693184,9725952,9637888,9670656,9703424,9736192,9648128,9680896,9713664,9746432,0,0
.long 1880064,2011136,2142208,2273280,4294967295,4294967295,91392,5920768,2402304,107904,536870912,14336,634112,1753344,20480,9645056,697728,536870912,344576,282880,9764864,197932,197952,684032,4281401344,698368,480512,203412,753664,203648,487424,9994240,217736,0,216576,704768,9641984,9674752,9707520,9740288,9652224,9684992,9717760,9662464,9695232,9728000,9639936,9672704,9705472,9738240,0,0
.long 1884160,2015232,2146304,2277376,4294967295,4294967295,91648,5922816,2408448,108032,14720,14336,462208,1769728,24576,9646080,697856,373760,768,286720,9633792,197936,197888,698368,4281630720,667648,476672,203288,655360,203264,475136,9658368,216588,0,216576,655744,9699328,9732096,9644032,9676800,9633792,9666560,9654272,9687040,9719808,9709568,9664512,9697280,9730048,9742336,0,0
.long 1888256,2019328,2150400,2281472,4294967295,4294967295,91648,5924864,2410496,108160,536870912,14336,519552,1786112,24576,9647104,697984,536870912,115456,286976,9650176,197940,197952,698368,4281630720,669696,476928,203292,688128,203392,479232,9773056,216972,0,216576,672128,9723904,9635840,9668608,9701376,9658368,9691136,9678848,9711616,9744384,9646080,9656320,9689088,9721856,9734144,0,0
.long 1892352,2023424,2154496,2285568,4294967295,4294967295,91904,5926912,2416640,108288,536870912,14336,576896,1802496,28672,9648128,698112,536870912,230144,290816,9748480,197944,197888,698368,4281630720,700416,480768,203416,720896,203520,483328,9887744,217356,0,216576,688512,9715712,9660416,9693184,9725952,9650176,9682944,9670656,9703424,9736192,9637888,9680896,9713664,9746432,9648128,0,0
.long 1896448,2027520,2158592,2289664,4294967295,4294967295,91904,5928960,2418688,108416,536870912,14336,634240,1818880,28672,9649152,698240,536870912,344832,291072,9764864,197948,197952,698368,4281630720,702464,481024,203420,753664,203648,487424,10002432,217740,0,216576,704896,9707520,9740288,9652224,9684992,9641984,9674752,9662464,9695232,9728000,9717760,9672704,9705472,9738240,9639936,0,0
.long 1900544,2031616,2162688,2293760,4294967295,4294967295,92160,5931008,2424832,108544,14848,14336,688128,384,32768,9650176,698368,263680,1024,294912,9633792,197952,197888,712704,4281860096,671744,477184,203296,655360,203264,475136,9666560,216592,0,216576,655872,9732096,9644032,9676800,9633792,9666560,9699328,9687040,9719808,9709568,9654272,9697280,9730048,9742336,9664512,0,0
.long 1904640,2035712,2166784,2297856,4294967295,4294967295,92160,5933056,2426880,108672,536870912,14336,745472,16768,32768,9651200,698496,536870912,115712,295168,9650176,197956,197952,712704,4281860096,673792,477440,203300,688128,203392,479232,9781248,216976,0,216576,672256,9635840,9668608,9701376,9658368,9691136,9723904,9711616,9744384,9646080,9678848,9689088,9721856,9734144,9656320,0,0
.long 1908736,2039808,2170880,2301952,4294967295,4294967295,92416,5935104,2433024,108800,536870912,14336,802816,33152,36864,9652224,698624,536870912,230400,299008,9748480,197960,197888,712704,4281860096,704512,481280,203424,720896,203520,483328,9895936,217360,0,216576,688640,9660416,9693184,9725952,9650176,9682944,9715712,9703424,9736192,9637888,9670656,9713664,9746432,9648128,9680896,0,0
.long 1912832,2043904,2174976,2306048,4294967295,4294967295,92416,5937152,2435072,108928,536870912,14336,860160,49536,36864,9653248,698752,536870912,345088,299264,9764864,197964,197952,712704,4281860096,706560,481536,203428,753664,203648,487424,10010624,217744,0,216576,705024,9740288,9652224,9684992,9641984,9674752,9707520,9695232,9728000,9717760,9662464,9705472,9738240,9639936,9672704,0,0
.long 1916928,2048000,2179072,2310144,4294967295,4294967295,92672,5939200,2441216,109056,14976,14336,688256,65920,40960,9654272,698880,267776,1280,303104,9633792,197968,197888,727040,4282089472,675840,477696,203304,655360,203264,475136,9674752,216596,0,216576,656000,9676800,9633792,9666560,9699328,9732096,9644032,9719808,9709568,9654272,9687040,9730048,9742336,9664512,9697280,0,0
.long 1921024,2052096,2183168,2314240,4294967295,4294967295,92672,5941248,2443264,109184,536870912,14336,745600,82304,40960,9655296,699008,536870912,115968,303360,9650176,197972,197952,727040,4282089472,677888,477952,203308,688128,203392,479232,9789440,216980,0,216576,672384,9701376,9658368,9691136,9723904,9635840,9668608,9744384,9646080,9678848,9711616,9721856,9734144,9656320,9689088,0,0
.long 1925120,2056192,2187264,2318336,4294967295,4294967295,92928,5943296,2449408,109312,536870912,14336,802944,98688,45056,9656320,699136,536870912,230656,307200,9748480,197976,197888,727040,4282089472,708608,481792,203432,720896,203520,483328,9904128,217364,0,216576,688768,9725952,9650176,9682944,9715712,9660416,9693184,9736192,9637888,9670656,9703424,9746432,9648128,9680896,9713664,0,0
.long 1929216,2060288,2191360,2322432,4294967295,4294967295,92928,5945344,2451456,109440,536870912,14336,860288,115072,45056,9657344,699264,536870912,345344,307456,9764864,197980,197952,727040,4282089472,710656,482048,203436,753664,203648,487424,10018816,217748,0,216576,705152,9684992,9641984,9674752,9707520,9740288,9652224,9728000,9717760,9662464,9695232,9738240,9639936,9672704,9705472,0,0
.long 1933312,2064384,2195456,2326528,4294967295,4294967295,93184,5947392,2457600,109568,15104,14336,688384,131456,49152,9658368,699392,271872,1536,311296,9633792,197984,197888,741376,4282318848,679936,478208,203312,655360,203264,475136,9682944,216600,0,216576,656128,9633792,9666560,9699328,9732096,9644032,9676800,9709568,9654272,9687040,9719808,9742336,9664512,9697280,9730048,0,0
.long 1937408,2068480,2199552,2330624,4294967295,4294967295,93184,5949440,2459648,109696,536870912,14336,745728,147840,49152,9659392,699520,536870912,116224,311552,9650176,197988,197952,741376,4282318848,681984,478464,203316,688128,203392,479232,9797632,216984,0,216576,672512,9658368,9691136,9723904,9635840,9668608,9701376,9646080,9678848,9711616,9744384,9734144,9656320,9689088,9721856,0,0
.long 1941504,2072576,2203648,2334720,4294967295,4294967295,93440,5951488,2465792,109824,536870912,14336,803072,164224,53248,9660416,699648,536870912,230912,315392,9748480,197992,197888,741376,4282318848,712704,482304,203440,720896,203520,483328,9912320,217368,0,216576,688896,9650176,9682944,9715712,9660416,9693184,9725952,9637888,9670656,9703424,9736192,9648128,9680896,9713664,9746432,0,0
.long 1945600,2076672,2207744,2338816,4294967295,4294967295,93440,5953536,2467840,109952,536870912,14336,860416,180608,53248,9661440,699776,536870912,345600,315648,9764864,197996,197952,741376,4282318848,714752,482560,203444,753664,203648,487424,10027008,217752,0,216576,705280,9641984,9674752,9707520,9740288,9652224,9684992,9717760,9662464,9695232,9728000,9639936,9672704,9705472,9738240,0,0
.long 1949696,2080768,2211840,2342912,4294967295,4294967295,93696,5955584,2473984,110080,15232,14336,688512,196992,57344,9662464,699904,275968,1792,319488,9633792,198000,197888,755712,4282548224,684032,478720,203320,655360,203264,475136,9691136,216604,0,216576,656256,9699328,9732096,9644032,9676800,9633792,9666560,9654272,9687040,9719808,9709568,9664512,9697280,9730048,9742336,0,0
.long 1953792,2084864,2215936,2347008,4294967295,4294967295,93696,5957632,2476032,110208,536870912,14336,745856,213376,57344,9663488,700032,536870912,116480,319744,9650176,198004,197952,755712,4282548224,686080,478976,203324,688128,203392,479232,9805824,216988,0,216576,672640,9723904,9635840,9668608,9701376,9658368,9691136,9678848,9711616,9744384,9646080,9656320,9689088,9721856,9734144,0,0
.long 1957888,2088960,2220032,2351104,4294967295,4294967295,93952,5959680,2482176,110336,536870912,14336,803200,229760,61440,9664512,700160,536870912,231168,323584,9748480,198008,197888,755712,4282548224,716800,482816,203448,720896,203520,483328,9920512,217372,0,216576,689024,9715712,9660416,9693184,9725952,9650176,9682944,9670656,9703424,9736192,9637888,9680896,9713664,9746432,9648128,0,0
.long 1961984,2093056,2224128,2355200,4294967295,4294967295,93952,5961728,2484224,110464,536870912,14336,860544,246144,61440,9665536,700288,536870912,345856,323840,9764864,198012,197952,755712,4282548224,718848,483072,203452,753664,203648,487424,10035200,217756,0,216576,705408,9707520,9740288,9652224,9684992,9641984,9674752,9662464,9695232,9728000,9717760,9672704,9705472,9738240,9639936,0,0
.long 1966080,2097152,2228224,2359296,4294967295,4294967295,94208,5963776,2490368,110592,15360,14336,688640,262528,57344,9863168,700416,280064,2048,327680,9863168,198016,198016,655360,4280483840,720896,483328,203520,655360,203264,475136,9699328,216608,0,217344,720896,9906176,9863168,9895936,9928704,9961472,9873408,9949184,9938944,9883648,9916416,9959424,9971712,9893888,9926656,0,0
.long 1970176,2101248,2232320,2363392,4294967295,4294967295,94208,5965824,2492416,110720,536870912,14336,745984,278912,57344,9864192,700544,536870912,116736,327936,9879552,198020,198080,655360,4280483840,722944,483584,203524,688128,203392,479232,9814016,216992,0,217344,737280,9930752,9887744,9920512,9953280,9865216,9897984,9973760,9875456,9908224,9940992,9951232,9963520,9885696,9918464,0,0
.long 1974272,2105344,2236416,2367488,4294967295,4294967295,94464,5967872,2498560,110848,536870912,14336,803328,295296,61440,9865216,700672,536870912,231424,331776,9977856,198024,198016,655360,4280483840,753664,487424,203648,720896,203520,483328,9928704,217376,0,217344,753664,9955328,9879552,9912320,9945088,9889792,9922560,9965568,9867264,9900032,9932800,9975808,9877504,9910272,9943040,0,0
.long 1978368,2109440,2240512,2371584,4294967295,4294967295,94464,5969920,2500608,110976,536870912,14336,860672,311680,61440,9866240,700800,536870912,346112,332032,9994240,198028,198080,655360,4280483840,755712,487680,203652,753664,203648,487424,10043392,217760,0,217344,770048,9914368,9871360,9904128,9936896,9969664,9881600,9957376,9947136,9891840,9924608,9967616,9869312,9902080,9934848,0,0
.long 1982464,2113536,2244608,2375680,4294967295,4294967295,94720,5971968,2506752,111104,15488,14336,688768,328064,65536,9867264,700928,284160,2304,335872,9863168,198032,198016,669696,4280713216,724992,483840,203528,655360,203264,475136,9707520,216612,0,217344,721024,9863168,9895936,9928704,9961472,9873408,9906176,9938944,9883648,9916416,9949184,9971712,9893888,9926656,9959424,0,0
.long 1986560,2117632,2248704,2379776,4294967295,4294967295,94720,5974016,2508800,111232,536870912,14336,746112,344448,65536,9868288,701056,536870912,116992,336128,9879552,198036,198080,669696,4280713216,727040,484096,203532,688128,203392,479232,9822208,216996,0,217344,737408,9887744,9920512,9953280,9865216,9897984,9930752,9875456,9908224,9940992,9973760,9963520,9885696,9918464,9951232,0,0
.long 1990656,2121728,2252800,2383872,4294967295,4294967295,94976,5976064,2514944,111360,536870912,14336,803456,360832,69632,9869312,701184,536870912,231680,339968,9977856,198040,198016,669696,4280713216,757760,487936,203656,720896,203520,483328,9936896,217380,0,217344,753792,9879552,9912320,9945088,9889792,9922560,9955328,9867264,9900032,9932800,9965568,9877504,9910272,9943040,9975808,0,0
.long 1994752,2125824,2256896,2387968,4294967295,4294967295,94976,5978112,2516992,111488,536870912,14336,860800,377216,69632,9870336,701312,536870912,346368,340224,9994240,198044,198080,669696,4280713216,759808,488192,203660,753664,203648,487424,10051584,217764,0,217344,770176,9871360,9904128,9936896,9969664,9881600,9914368,9947136,9891840,9924608,9957376,9869312,9902080,9934848,9967616,0,0
.long 1998848,2129920,2260992,2392064,4294967295,4294967295,95232,5980160,2523136,111616,15616,14336,688896,393600,73728,9871360,701440,288256,2560,344064,9863168,198048,198016,684032,4280942592,729088,484352,203536,655360,203264,475136,9715712,216616,0,217344,721152,9928704,9961472,9873408,9906176,9863168,9895936,9883648,9916416,9949184,9938944,9893888,9926656,9959424,9971712,0,0
.long 2002944,2134016,2265088,2396160,4294967295,4294967295,95232,5982208,2525184,111744,536870912,14336,746240,409984,73728,9872384,701568,536870912,117248,344320,9879552,198052,198080,684032,4280942592,731136,484608,203540,688128,203392,479232,9830400,217000,0,217344,737536,9953280,9865216,9897984,9930752,9887744,9920512,9908224,9940992,9973760,9875456,9885696,9918464,9951232,9963520,0,0
.long 2007040,2138112,2269184,2400256,4294967295,4294967295,95488,5984256,2531328,111872,536870912,14336,803584,426368,77824,9873408,701696,536870912,231936,348160,9977856,198056,198016,684032,4280942592,761856,488448,203664,720896,203520,483328,9945088,217384,0,217344,753920,9945088,9889792,9922560,9955328,9879552,9912320,9900032,9932800,9965568,9867264,9910272,9943040,9975808,9877504,0,0
.long 2011136,2142208,2273280,2404352,4294967295,4294967295,95488,5986304,2533376,112000,536870912,14336,860928,442752,77824,9874432,701824,536870912,346624,348416,9994240,198060,198080,684032,4280942592,763904,488704,203668,753664,203648,487424,10059776,217768,0,217344,770304,9936896,9969664,9881600,9914368,9871360,9904128,9891840,9924608,9957376,9947136,9902080,9934848,9967616,9869312,0,0
.long 2015232,2146304,2277376,2408448,4294967295,4294967295,95744,5988352,2539520,112128,15744,14336,689024,459136,16384,9875456,701952,292352,2816,352256,9863168,198064,198016,698368,4281171968,733184,484864,203544,655360,203264,475136,9723904,216620,0,217344,721280,9961472,9873408,9906176,9863168,9895936,9928704,9916416,9949184,9938944,9883648,9926656,9959424,9971712,9893888,0,0
.long 2019328,2150400,2281472,2412544,4294967295,4294967295,95744,5990400,2541568,112256,536870912,14336,746368,475520,16384,9876480,702080,536870912,117504,352512,9879552,198068,198080,698368,4281171968,735232,485120,203548,688128,203392,479232,9838592,217004,0,217344,737664,9865216,9897984,9930752,9887744,9920512,9953280,9940992,9973760,9875456,9908224,9918464,9951232,9963520,9885696,0,0
.long 2023424,2154496,2285568,2416640,4294967295,4294967295,96000,5992448,2547712,112384,536870912,14336,803712,491904,20480,9877504,702208,536870912,232192,356352,9977856,198072,198016,698368,4281171968,765952,488960,203672,720896,203520,483328,9953280,217388,0,217344,754048,9889792,9922560,9955328,9879552,9912320,9945088,9932800,9965568,9867264,9900032,9943040,9975808,9877504,9910272,0,0
.long 2027520,2158592,2289664,2420736,4294967295,4294967295,96000,5994496,2549760,112512,536870912,14336,861056,508288,20480,9878528,702336,536870912,346880,356608,9994240,198076,198080,698368,4281171968,768000,489216,203676,753664,203648,487424,10067968,217772,0,217344,770432,9969664,9881600,9914368,9871360,9904128,9936896,9924608,9957376,9947136,9891840,9934848,9967616,9869312,9902080,0,0
.long 2031616,2162688,2293760,2424832,4294967295,4294967295,96256,5996544,2555904,112640,15872,14336,689152,524672,24576,9879552,702464,296448,3072,360448,9863168,198080,198016,712704,4281401344,737280,485376,203552,655360,203264,475136,9732096,216624,0,217344,721408,9906176,9863168,9895936,9928704,9961472,9873408,9949184,9938944,9883648,9916416,9959424,9971712,9893888,9926656,0,0
.long 2035712,2166784,2297856,2428928,4294967295,4294967295,96256,5998592,2557952,112768,536870912,14336,746496,541056,24576,9880576,702592,536870912,117760,360704,9879552,198084,198080,712704,4281401344,739328,485632,203556,688128,203392,479232,9846784,217008,0,217344,737792,9930752,9887744,9920512,9953280,9865216,9897984,9973760,9875456,9908224,9940992,9951232,9963520,9885696,9918464,0,0
.long 2039808,2170880,2301952,2433024,4294967295,4294967295,96512,6000640,2564096,112896,536870912,14336,803840,557440,28672,9881600,702720,536870912,232448,364544,9977856,198088,198016,712704,4281401344,770048,489472,203680,720896,203520,483328,9961472,217392,0,217344,754176,9955328,9879552,9912320,9945088,9889792,9922560,9965568,9867264,9900032,9932800,9975808,9877504,9910272,9943040,0,0
.long 2043904,2174976,2306048,2437120,4294967295,4294967295,96512,6002688,2566144,113024,536870912,14336,861184,573824,28672,9882624,702848,536870912,347136,364800,9994240,198092,198080,712704,4281401344,772096,489728,203684,753664,203648,487424,10076160,217776,0,217344,770560,9914368,9871360,9904128,9936896,9969664,9881600,9957376,9947136,9891840,9924608,9967616,9869312,9902080,9934848,0,0
.long 2048000,2179072,2310144,2441216,4294967295,4294967295,96768,6004736,2572288,113152,16000,14336,689280,590208,32768,9883648,702976,300544,3328,368640,9863168,198096,198016,727040,4281630720,741376,485888,203560,655360,203264,475136,9740288,216628,0,217344,721536,9863168,9895936,9928704,9961472,9873408,9906176,9938944,9883648,9916416,9949184,9971712,9893888,9926656,9959424,0,0
.long 2052096,2183168,2314240,2445312,4294967295,4294967295,96768,6006784,2574336,113280,536870912,14336,746624,606592,32768,9884672,703104,536870912,118016,368896,9879552,198100,198080,727040,4281630720,743424,486144,203564,688128,203392,479232,9854976,217012,0,217344,737920,9887744,9920512,9953280,9865216,9897984,9930752,9875456,9908224,9940992,9973760,9963520,9885696,9918464,9951232,0,0
.long 2056192,2187264,2318336,2449408,4294967295,4294967295,97024,6008832,2580480,113408,536870912,14336,803968,622976,36864,9885696,703232,536870912,232704,372736,9977856,198104,198016,727040,4281630720,774144,489984,203688,720896,203520,483328,9969664,217396,0,217344,754304,9879552,9912320,9945088,9889792,9922560,9955328,9867264,9900032,9932800,9965568,9877504,9910272,9943040,9975808,0,0
.long 2060288,2191360,2322432,2453504,4294967295,4294967295,97024,6010880,2582528,113536,536870912,14336,861312,639360,36864,9886720,703360,536870912,347392,372992,9994240,198108,198080,727040,4281630720,776192,490240,203692,753664,203648,487424,10084352,217780,0,217344,770688,9871360,9904128,9936896,9969664,9881600,9914368,9947136,9891840,9924608,9957376,9869312,9902080,9934848,9967616,0,0
.long 2064384,2195456,2326528,2457600,4294967295,4294967295,97280,6012928,2588672,113664,16128,14336,689408,655744,40960,9887744,703488,304640,3328,368640,9863168,198112,198016,741376,4281860096,745472,486400,203568,655360,203264,475136,536870912,536870912,6160384,217344,721664,9928704,9961472,9873408,9906176,9863168,9895936,9883648,9916416,9949184,9938944,9893888,9926656,9959424,9971712,0,0
.long 2068480,2199552,2330624,2461696,4294967295,4294967295,97280,6014976,2590720,113792,536870912,14336,746752,672128,40960,9888768,703616,536870912,118016,368896,9879552,198116,198080,741376,4281860096,747520,486656,203572,688128,203392,479232,536870912,536870912,6160384,217344,738048,9953280,9865216,9897984,9930752,9887744,9920512,9908224,9940992,9973760,9875456,9885696,9918464,9951232,9963520,0,0
.long 2072576,2203648,2334720,2465792,4294967295,4294967295,97536,6017024,2596864,113920,536870912,14336,804096,688512,45056,9889792,703744,536870912,232704,372736,9977856,198120,198016,741376,4281860096,778240,490496,203696,720896,203520,483328,536870912,536870912,6160384,217344,754432,9945088,9889792,9922560,9955328,9879552,9912320,9900032,9932800,9965568,9867264,9910272,9943040,9975808,9877504,0,0
.long 2076672,2207744,2338816,2469888,4294967295,4294967295,97536,6019072,2598912,114048,536870912,14336,861440,704896,45056,9890816,703872,536870912,347392,372992,9994240,198124,198080,741376,4281860096,780288,490752,203700,753664,203648,487424,536870912,536870912,6160384,217344,770816,9936896,9969664,9881600,9914368,9871360,9904128,9891840,9924608,9957376,9947136,9902080,9934848,9967616,9869312,0,0
.long 2080768,2211840,2342912,2473984,4294967295,4294967295,97792,6021120,2605056,114176,16256,14336,689536,721280,49152,9891840,704000,308736,3328,368640,9863168,198128,198016,755712,4282089472,749568,486912,203576,655360,203264,475136,536870912,536870912,6619136,217344,721792,9961472,9873408,9906176,9863168,9895936,9928704,9916416,9949184,9938944,9883648,9926656,9959424,9971712,9893888,0,0
.long 2084864,2215936,2347008,2478080,4294967295,4294967295,97792,6023168,2607104,114304,536870912,14336,746880,737664,49152,9892864,704128,536870912,118016,368896,9879552,198132,198080,755712,4282089472,751616,487168,203580,688128,203392,479232,536870912,536870912,6619136,217344,738176,9865216,9897984,9930752,9887744,9920512,9953280,9940992,9973760,9875456,9908224,9918464,9951232,9963520,9885696,0,0
.long 2088960,2220032,2351104,2482176,4294967295,4294967295,98048,6025216,2613248,114432,536870912,14336,804224,754048,53248,9893888,704256,536870912,232704,372736,9977856,198136,198016,755712,4282089472,782336,491008,203704,720896,203520,483328,536870912,536870912,6619136,217344,754560,9889792,9922560,9955328,9879552,9912320,9945088,9932800,9965568,9867264,9900032,9943040,9975808,9877504,9910272,0,0
.long 2093056,2224128,2355200,2486272,4294967295,4294967295,98048,6027264,2615296,114560,536870912,14336,861568,770432,53248,9894912,704384,536870912,347392,372992,9994240,198140,198080,755712,4282089472,784384,491264,203708,753664,203648,487424,536870912,536870912,6619136,217344,770944,9969664,9881600,9914368,9871360,9904128,9936896,9924608,9957376,9947136,9891840,9934848,9967616,9869312,9902080,0,0
.long 2097152,2228224,2359296,2490368,4294967295,4294967295,98304,6029312,2621440,114688,16384,16384,689664,786816,49152,10092544,704512,312832,0,262144,10092544,198144,198144,655360,4280025088,786432,491520,203776,786432,203776,491520,10092544,218112,0,218112,786432,10092544,10125312,10158080,10190848,10102784,10135552,10168320,10113024,10145792,10178560,10201088,10123264,10156032,10188800,0,0
.long 2101248,2232320,2363392,2494464,4294967295,4294967295,98304,6031360,2623488,114816,536870912,16384,747008,803200,49152,10093568,704640,536870912,114688,262400,10108928,198148,198208,655360,4280025088,788480,491776,203780,819200,203904,495616,10207232,218496,0,218112,802816,10117120,10149888,10182656,10094592,10127360,10160128,10104832,10137600,10170368,10203136,10192896,10115072,10147840,10180608,0,0
.long 2105344,2236416,2367488,2498560,4294967295,4294967295,98560,6033408,2629632,114944,536870912,16384,804352,819584,53248,10094592,704768,536870912,229376,266240,10207232,198152,198144,655360,4280025088,819200,495616,203904,851968,204032,499712,10321920,218880,0,218112,819200,10108928,10141696,10174464,10119168,10151936,10184704,10096640,10129408,10162176,10194944,10106880,10139648,10172416,10205184,0,0
.long 2109440,2240512,2371584,2502656,4294967295,4294967295,98560,6035456,2631680,115072,536870912,16384,861696,835968,53248,10095616,704896,536870912,344064,266496,10223616,198156,198208,655360,4280025088,821248,495872,203908,884736,204160,503808,10436608,219264,0,218112,835584,10100736,10133504,10166272,10199040,10110976,10143744,10176512,10121216,10153984,10186752,10098688,10131456,10164224,10196992,0,0
.long 2113536,2244608,2375680,2506752,4294967295,4294967295,98816,6037504,2637824,115200,16512,16384,689792,852352,57344,10096640,705024,316928,256,270336,10092544,198160,198144,669696,4280254464,790528,492032,203784,786432,203776,491520,10100736,218116,0,218112,786560,10158080,10190848,10102784,10135552,10092544,10125312,10113024,10145792,10178560,10168320,10123264,10156032,10188800,10201088,0,0
.long 2117632,2248704,2379776,2510848,4294967295,4294967295,98816,6039552,2639872,115328,536870912,16384,747136,868736,57344,10097664,705152,536870912,114944,270592,10108928,198164,198208,669696,4280254464,792576,492288,203788,819200,203904,495616,10215424,218500,0,218112,802944,10182656,10094592,10127360,10160128,10117120,10149888,10137600,10170368,10203136,10104832,10115072,10147840,10180608,10192896,0,0
.long 2121728,2252800,2383872,2514944,4294967295,4294967295,99072,6041600,2646016,115456,536870912,16384,804480,885120,61440,10098688,705280,536870912,229632,274432,10207232,198168,198144,669696,4280254464,823296,496128,203912,851968,204032,499712,10330112,218884,0,218112,819328,10174464,10119168,10151936,10184704,10108928,10141696,10129408,10162176,10194944,10096640,10139648,10172416,10205184,10106880,0,0
.long 2125824,2256896,2387968,2519040,4294967295,4294967295,99072,6043648,2648064,115584,536870912,16384,861824,901504,61440,10099712,705408,536870912,344320,274688,10223616,198172,198208,669696,4280254464,825344,496384,203916,884736,204160,503808,10444800,219268,0,218112,835712,10166272,10199040,10110976,10143744,10100736,10133504,10121216,10153984,10186752,10176512,10131456,10164224,10196992,10098688,0,0
.long 2129920,2260992,2392064,2523136,4294967295,4294967295,99328,6045696,2654208,115712,16640,16384,689920,917888,65536,10100736,705536,321024,512,278528,10092544,198176,198144,684032,4280483840,794624,492544,203792,786432,203776,491520,10108928,218120,0,218112,786688,10190848,10102784,10135552,10092544,10125312,10158080,10145792,10178560,10168320,10113024,10156032,10188800,10201088,10123264,0,0
.long 2134016,2265088,2396160,2527232,4294967295,4294967295,99328,6047744,2656256,115840,536870912,16384,747264,934272,65536,10101760,705664,536870912,115200,278784,10108928,198180,198208,684032,4280483840,796672,492800,203796,819200,203904,495616,10223616,218504,0,218112,803072,10094592,10127360,10160128,10117120,10149888,10182656,10170368,10203136,10104832,10137600,10147840,10180608,10192896,10115072,0,0
.long 2138112,2269184,2400256,2531328,4294967295,4294967295,99584,6049792,2662400,115968,536870912,16384,804608,950656,69632,10102784,705792,536870912,229888,282624,10207232,198184,198144,684032,4280483840,827392,496640,203920,851968,204032,499712,10338304,218888,0,218112,819456,10119168,10151936,10184704,10108928,10141696,10174464,10162176,10194944,10096640,10129408,10172416,10205184,10106880,10139648,0,0
.long 2142208,2273280,2404352,2535424,4294967295,4294967295,99584,6051840,2664448,116096,536870912,16384,861952,967040,69632,10103808,705920,536870912,344576,282880,10223616,198188,198208,684032,4280483840,829440,496896,203924,884736,204160,503808,10452992,219272,0,218112,835840,10199040,10110976,10143744,10100736,10133504,10166272,10153984,10186752,10176512,10121216,10164224,10196992,10098688,10131456,0,0
.long 2146304,2277376,2408448,2539520,4294967295,4294967295,99840,6053888,2670592,116224,16768,16384,690048,983424,73728,10104832,706048,325120,768,286720,10092544,198192,198144,698368,4280713216,798720,493056,203800,786432,203776,491520,10117120,218124,0,218112,786816,10135552,10092544,10125312,10158080,10190848,10102784,10178560,10168320,10113024,10145792,10188800,10201088,10123264,10156032,0,0
.long 2150400,2281472,2412544,2543616,4294967295,4294967295,99840,6055936,2672640,116352,536870912,16384,747392,999808,73728,10105856,706176,536870912,115456,286976,10108928,198196,198208,698368,4280713216,800768,493312,203804,819200,203904,495616,10231808,218508,0,218112,803200,10160128,10117120,10149888,10182656,10094592,10127360,10203136,10104832,10137600,10170368,10180608,10192896,10115072,10147840,0,0
.long 2154496,2285568,2416640,2547712,4294967295,4294967295,100096,6057984,2678784,116480,536870912,16384,804736,1016192,77824,10106880,706304,536870912,230144,290816,10207232,198200,198144,698368,4280713216,831488,497152,203928,851968,204032,499712,10346496,218892,0,218112,819584,10184704,10108928,10141696,10174464,10119168,10151936,10194944,10096640,10129408,10162176,10205184,10106880,10139648,10172416,0,0
.long 2158592,2289664,2420736,2551808,4294967295,4294967295,100096,6060032,2680832,116608,536870912,16384,862080,1032576,77824,10107904,706432,536870912,344832,291072,10223616,198204,198208,698368,4280713216,833536,497408,203932,884736,204160,503808,10461184,219276,0,218112,835968,10143744,10100736,10133504,10166272,10199040,10110976,10186752,10176512,10121216,10153984,10196992,10098688,10131456,10164224,0,0
.long 2162688,2293760,2424832,2555904,4294967295,4294967295,100352,6062080,2686976,116736,16896,16384,690176,1048960,16384,10108928,706560,329216,1024,294912,10092544,198208,198144,712704,4280942592,802816,493568,203808,786432,203776,491520,10125312,218128,0,218112,786944,10092544,10125312,10158080,10190848,10102784,10135552,10168320,10113024,10145792,10178560,10201088,10123264,10156032,10188800,0,0
.long 2166784,2297856,2428928,2560000,4294967295,4294967295,100352,6064128,2689024,116864,536870912,16384,747520,1065344,16384,10109952,706688,536870912,115712,295168,10108928,198212,198208,712704,4280942592,804864,493824,203812,819200,203904,495616,10240000,218512,0,218112,803328,10117120,10149888,10182656,10094592,10127360,10160128,10104832,10137600,10170368,10203136,10192896,10115072,10147840,10180608,0,0
.long 2170880,2301952,2433024,2564096,4294967295,4294967295,100608,6066176,2695168,116992,536870912,16384,804864,1081728,20480,10110976,706816,536870912,230400,299008,10207232,198216,198144,712704,4280942592,835584,497664,203936,851968,204032,499712,10354688,218896,0,218112,819712,10108928,10141696,10174464,10119168,10151936,10184704,10096640,10129408,10162176,10194944,10106880,10139648,10172416,10205184,0,0
.long 2174976,2306048,2437120,2568192,4294967295,4294967295,100608,6068224,2697216,117120,536870912,16384,862208,1098112,20480,10112000,706944,536870912,345088,299264,10223616,198220,198208,712704,4280942592,837632,497920,203940,884736,204160,503808,10469376,219280,0,218112,836096,10100736,10133504,10166272,10199040,10110976,10143744,10176512,10121216,10153984,10186752,10098688,10131456,10164224,10196992,0,0
.long 2179072,2310144,2441216,2572288,4294967295,4294967295,100864,6070272,2703360,117248,17024,16384,690304,1114496,24576,10113024,707072,333312,1280,303104,10092544,198224,198144,727040,4281171968,806912,494080,203816,786432,203776,491520,10133504,218132,0,218112,787072,10158080,10190848,10102784,10135552,10092544,10125312,10113024,10145792,10178560,10168320,10123264,10156032,10188800,10201088,0,0
.long 2183168,2314240,2445312,2576384,4294967295,4294967295,100864,6072320,2705408,117376,536870912,16384,747648,1130880,24576,10114048,707200,536870912,115968,303360,10108928,198228,198208,727040,4281171968,808960,494336,203820,819200,203904,495616,10248192,218516,0,218112,803456,10182656,10094592,10127360,10160128,10117120,10149888,10137600,10170368,10203136,10104832,10115072,10147840,10180608,10192896,0,0
.long 2187264,2318336,2449408,2580480,4294967295,4294967295,101120,6074368,2711552,117504,536870912,16384,804992,1147264,28672,10115072,707328,536870912,230656,307200,10207232,198232,198144,727040,4281171968,839680,498176,203944,851968,204032,499712,10362880,218900,0,218112,819840,10174464,10119168,10151936,10184704,10108928,10141696,10129408,10162176,10194944,10096640,10139648,10172416,10205184,10106880,0,0
.long 2191360,2322432,2453504,2584576,4294967295,4294967295,101120,6076416,2713600,117632,536870912,16384,862336,1163648,28672,10116096,707456,536870912,345344,307456,10223616,198236,198208,727040,4281171968,841728,498432,203948,884736,204160,503808,10477568,219284,0,218112,836224,10166272,10199040,10110976,10143744,10100736,10133504,10121216,10153984,10186752,10176512,10131456,10164224,10196992,10098688,0,0
.long 2195456,2326528,2457600,2588672,4294967295,4294967295,101376,6078464,2719744,117760,17152,16384,690432,1180032,32768,10117120,707584,337408,1536,311296,10092544,198240,198144,741376,4281401344,811008,494592,203824,786432,203776,491520,10141696,218136,0,218112,787200,10190848,10102784,10135552,10092544,10125312,10158080,10145792,10178560,10168320,10113024,10156032,10188800,10201088,10123264,0,0
.long 2199552,2330624,2461696,2592768,4294967295,4294967295,101376,6080512,2721792,117888,536870912,16384,747776,1196416,32768,10118144,707712,536870912,116224,311552,10108928,198244,198208,741376,4281401344,813056,494848,203828,819200,203904,495616,10256384,218520,0,218112,803584,10094592,10127360,10160128,10117120,10149888,10182656,10170368,10203136,10104832,10137600,10147840,10180608,10192896,10115072,0,0
.long 2203648,2334720,2465792,2596864,4294967295,4294967295,101632,6082560,2727936,118016,536870912,16384,805120,1212800,36864,10119168,707840,536870912,230912,315392,10207232,198248,198144,741376,4281401344,843776,498688,203952,851968,204032,499712,10371072,218904,0,218112,819968,10119168,10151936,10184704,10108928,10141696,10174464,10162176,10194944,10096640,10129408,10172416,10205184,10106880,10139648,0,0
.long 2207744,2338816,2469888,2600960,4294967295,4294967295,101632,6084608,2729984,118144,536870912,16384,862464,1229184,36864,10120192,707968,536870912,345600,315648,10223616,198252,198208,741376,4281401344,845824,498944,203956,884736,204160,503808,10485760,219288,0,218112,836352,10199040,10110976,10143744,10100736,10133504,10166272,10153984,10186752,10176512,10121216,10164224,10196992,10098688,10131456,0,0
.long 2211840,2342912,2473984,2605056,4294967295,4294967295,101888,6086656,2736128,118272,17280,16384,690560,1245568,40960,10121216,708096,341504,1792,319488,10092544,198256,198144,755712,4281630720,815104,495104,203832,786432,203776,491520,10149888,218140,0,218112,787328,10135552,10092544,10125312,10158080,10190848,10102784,10178560,10168320,10113024,10145792,10188800,10201088,10123264,10156032,0,0
.long 2215936,2347008,2478080,2609152,4294967295,4294967295,101888,6088704,2738176,118400,536870912,16384,747904,1261952,40960,10122240,708224,536870912,116480,319744,10108928,198260,198208,755712,4281630720,817152,495360,203836,819200,203904,495616,10264576,218524,0,218112,803712,10160128,10117120,10149888,10182656,10094592,10127360,10203136,10104832,10137600,10170368,10180608,10192896,10115072,10147840,0,0
.long 2220032,2351104,2482176,2613248,4294967295,4294967295,102144,6090752,2744320,118528,536870912,16384,805248,1278336,45056,10123264,708352,536870912,231168,323584,10207232,198264,198144,755712,4281630720,847872,499200,203960,851968,204032,499712,10379264,218908,0,218112,820096,10184704,10108928,10141696,10174464,10119168,10151936,10194944,10096640,10129408,10162176,10205184,10106880,10139648,10172416,0,0
.long 2224128,2355200,2486272,2617344,4294967295,4294967295,102144,6092800,2746368,118656,536870912,16384,862592,1294720,45056,10124288,708480,536870912,345856,323840,10223616,198268,198208,755712,4281630720,849920,499456,203964,884736,204160,503808,10493952,219292,0,218112,836480,10143744,10100736,10133504,10166272,10199040,10110976,10186752,10176512,10121216,10153984,10196992,10098688,10131456,10164224,0,0
.long 2228224,2359296,2490368,2621440,4294967295,4294967295,102400,6094848,2752512,118784,17408,16384,690688,1311104,40960,10321920,708608,345600,2048,327680,10321920,198272,198272,655360,4279566336,851968,499712,204032,786432,203776,491520,10158080,218144,0,218880,851968,10387456,10420224,10332160,10364928,10321920,10354688,10342400,10375168,10407936,10397696,10352640,10385408,10418176,10430464,0,0
.long 2232320,2363392,2494464,2625536,4294967295,4294967295,102400,6096896,2754560,118912,536870912,16384,748032,1327488,40960,10322944,708736,536870912,116736,327936,10338304,198276,198336,655360,4279566336,854016,499968,204036,819200,203904,495616,10272768,218528,0,218880,868352,10412032,10323968,10356736,10389504,10346496,10379264,10366976,10399744,10432512,10334208,10344448,10377216,10409984,10422272,0,0
.long 2236416,2367488,2498560,2629632,4294967295,4294967295,102656,6098944,2760704,119040,536870912,16384,805376,1343872,45056,10323968,708864,536870912,231424,331776,10436608,198280,198272,655360,4279566336,884736,503808,204160,851968,204032,499712,10387456,218912,0,218880,884736,10403840,10348544,10381312,10414080,10338304,10371072,10358784,10391552,10424320,10326016,10369024,10401792,10434560,10336256,0,0
.long 2240512,2371584,2502656,2633728,4294967295,4294967295,102656,6100992,2762752,119168,536870912,16384,862720,1360256,45056,10324992,708992,536870912,346112,332032,10452992,198284,198336,655360,4279566336,886784,504064,204164,884736,204160,503808,10502144,219296,0,218880,901120,10395648,10428416,10340352,10373120,10330112,10362880,10350592,10383360,10416128,10405888,10360832,10393600,10426368,10328064,0,0
.long 2244608,2375680,2506752,2637824,4294967295,4294967295,102912,6103040,2768896,119296,17536,16384,690816,1376640,49152,10326016,709120,349696,2304,335872,10321920,198288,198272,669696,4279795712,856064,500224,204040,786432,203776,491520,10166272,218148,0,218880,852096,10420224,10332160,10364928,10321920,10354688,10387456,10375168,10407936,10397696,10342400,10385408,10418176,10430464,10352640,0,0
.long 2248704,2379776,2510848,2641920,4294967295,4294967295,102912,6105088,2770944,119424,536870912,16384,748160,1393024,49152,10327040,709248,536870912,116992,336128,10338304,198292,198336,669696,4279795712,858112,500480,204044,819200,203904,495616,10280960,218532,0,218880,868480,10323968,10356736,10389504,10346496,10379264,10412032,10399744,10432512,10334208,10366976,10377216,10409984,10422272,10344448,0,0
.long 2252800,2383872,2514944,2646016,4294967295,4294967295,103168,6107136,2777088,119552,536870912,16384,805504,1409408,53248,10328064,709376,536870912,231680,339968,10436608,198296,198272,669696,4279795712,888832,504320,204168,851968,204032,499712,10395648,218916,0,218880,884864,10348544,10381312,10414080,10338304,10371072,10403840,10391552,10424320,10326016,10358784,10401792,10434560,10336256,10369024,0,0
.long 2256896,2387968,2519040,2650112,4294967295,4294967295,103168,6109184,2779136,119680,536870912,16384,862848,1425792,53248,10329088,709504,536870912,346368,340224,10452992,198300,198336,669696,4279795712,890880,504576,204172,884736,204160,503808,10510336,219300,0,218880,901248,10428416,10340352,10373120,10330112,10362880,10395648,10383360,10416128,10405888,10350592,10393600,10426368,10328064,10360832,0,0
.long 2260992,2392064,2523136,2654208,4294967295,4294967295,103424,6111232,2785280,119808,17664,16384,690944,1442176,57344,10330112,709632,353792,2560,344064,10321920,198304,198272,684032,4280025088,860160,500736,204048,786432,203776,491520,10174464,218152,0,218880,852224,10364928,10321920,10354688,10387456,10420224,10332160,10407936,10397696,10342400,10375168,10418176,10430464,10352640,10385408,0,0
.long 2265088,2396160,2527232,2658304,4294967295,4294967295,103424,6113280,2787328,119936,536870912,16384,748288,1458560,57344,10331136,709760,536870912,117248,344320,10338304,198308,198336,684032,4280025088,862208,500992,204052,819200,203904,495616,10289152,218536,0,218880,868608,10389504,10346496,10379264,10412032,10323968,10356736,10432512,10334208,10366976,10399744,10409984,10422272,10344448,10377216,0,0
.long 2269184,2400256,2531328,2662400,4294967295,4294967295,103680,6115328,2793472,120064,536870912,16384,805632,1474944,61440,10332160,709888,536870912,231936,348160,10436608,198312,198272,684032,4280025088,892928,504832,204176,851968,204032,499712,10403840,218920,0,218880,884992,10414080,10338304,10371072,10403840,10348544,10381312,10424320,10326016,10358784,10391552,10434560,10336256,10369024,10401792,0,0
.long 2273280,2404352,2535424,2666496,4294967295,4294967295,103680,6117376,2795520,120192,536870912,16384,862976,1491328,61440,10333184,710016,536870912,346624,348416,10452992,198316,198336,684032,4280025088,894976,505088,204180,884736,204160,503808,10518528,219304,0,218880,901376,10373120,10330112,10362880,10395648,10428416,10340352,10416128,10405888,10350592,10383360,10426368,10328064,10360832,10393600,0,0
.long 2277376,2408448,2539520,2670592,4294967295,4294967295,103936,6119424,2801664,120320,17792,16384,691072,1507712,65536,10334208,710144,357888,2816,352256,10321920,198320,198272,698368,4280254464,864256,501248,204056,786432,203776,491520,10182656,218156,0,218880,852352,10321920,10354688,10387456,10420224,10332160,10364928,10397696,10342400,10375168,10407936,10430464,10352640,10385408,10418176,0,0
.long 2281472,2412544,2543616,2674688,4294967295,4294967295,103936,6121472,2803712,120448,536870912,16384,748416,1524096,65536,10335232,710272,536870912,117504,352512,10338304,198324,198336,698368,4280254464,866304,501504,204060,819200,203904,495616,10297344,218540,0,218880,868736,10346496,10379264,10412032,10323968,10356736,10389504,10334208,10366976,10399744,10432512,10422272,10344448,10377216,10409984,0,0
.long 2285568,2416640,2547712,2678784,4294967295,4294967295,104192,6123520,2809856,120576,536870912,16384,805760,1540480,69632,10336256,710400,536870912,232192,356352,10436608,198328,198272,698368,4280254464,897024,505344,204184,851968,204032,499712,10412032,218924,0,218880,885120,10338304,10371072,10403840,10348544,10381312,10414080,10326016,10358784,10391552,10424320,10336256,10369024,10401792,10434560,0,0
.long 2289664,2420736,2551808,2682880,4294967295,4294967295,104192,6125568,2811904,120704,536870912,16384,863104,1556864,69632,10337280,710528,536870912,346880,356608,10452992,198332,198336,698368,4280254464,899072,505600,204188,884736,204160,503808,10526720,219308,0,218880,901504,10330112,10362880,10395648,10428416,10340352,10373120,10405888,10350592,10383360,10416128,10328064,10360832,10393600,10426368,0,0
.long 2293760,2424832,2555904,2686976,4294967295,4294967295,104448,6127616,2818048,120832,17920,16384,691200,1573248,73728,10338304,710656,361984,3072,360448,10321920,198336,198272,712704,4280483840,868352,501760,204064,786432,203776,491520,10190848,218160,0,218880,852480,10387456,10420224,10332160,10364928,10321920,10354688,10342400,10375168,10407936,10397696,10352640,10385408,10418176,10430464,0,0
.long 2297856,2428928,2560000,2691072,4294967295,4294967295,104448,6129664,2820096,120960,536870912,16384,748544,1589632,73728,10339328,710784,536870912,117760,360704,10338304,198340,198336,712704,4280483840,870400,502016,204068,819200,203904,495616,10305536,218544,0,218880,868864,10412032,10323968,10356736,10389504,10346496,10379264,10366976,10399744,10432512,10334208,10344448,10377216,10409984,10422272,0,0
.long 2301952,2433024,2564096,2695168,4294967295,4294967295,104704,6131712,2826240,121088,536870912,16384,805888,1606016,77824,10340352,710912,536870912,232448,364544,10436608,198344,198272,712704,4280483840,901120,505856,204192,851968,204032,499712,10420224,218928,0,218880,885248,10403840,10348544,10381312,10414080,10338304,10371072,10358784,10391552,10424320,10326016,10369024,10401792,10434560,10336256,0,0
.long 2306048,2437120,2568192,2699264,4294967295,4294967295,104704,6133760,2828288,121216,536870912,16384,863232,1622400,77824,10341376,711040,536870912,347136,364800,10452992,198348,198336,712704,4280483840,903168,506112,204196,884736,204160,503808,10534912,219312,0,218880,901632,10395648,10428416,10340352,10373120,10330112,10362880,10350592,10383360,10416128,10405888,10360832,10393600,10426368,10328064,0,0
.long 2310144,2441216,2572288,2703360,4294967295,4294967295,104960,6135808,2834432,121344,18048,16384,691328,1638784,16384,10342400,711168,366080,3328,368640,10321920,198352,198272,727040,4280713216,872448,502272,204072,786432,203776,491520,10199040,218164,0,218880,852608,10420224,10332160,10364928,10321920,10354688,10387456,10375168,10407936,10397696,10342400,10385408,10418176,10430464,10352640,0,0
.long 2314240,2445312,2576384,2707456,4294967295,4294967295,104960,6137856,2836480,121472,536870912,16384,748672,1655168,16384,10343424,711296,536870912,118016,368896,10338304,198356,198336,727040,4280713216,874496,502528,204076,819200,203904,495616,10313728,218548,0,218880,868992,10323968,10356736,10389504,10346496,10379264,10412032,10399744,10432512,10334208,10366976,10377216,10409984,10422272,10344448,0,0
.long 2318336,2449408,2580480,2711552,4294967295,4294967295,105216,6139904,2842624,121600,536870912,16384,806016,1671552,20480,10344448,711424,536870912,232704,372736,10436608,198360,198272,727040,4280713216,905216,506368,204200,851968,204032,499712,10428416,218932,0,218880,885376,10348544,10381312,10414080,10338304,10371072,10403840,10391552,10424320,10326016,10358784,10401792,10434560,10336256,10369024,0,0
.long 2322432,2453504,2584576,2715648,4294967295,4294967295,105216,6141952,2844672,121728,536870912,16384,863360,1687936,20480,10345472,711552,536870912,347392,372992,10452992,198364,198336,727040,4280713216,907264,506624,204204,884736,204160,503808,10543104,219316,0,218880,901760,10428416,10340352,10373120,10330112,10362880,10395648,10383360,10416128,10405888,10350592,10393600,10426368,10328064,10360832,0,0
.long 2326528,2457600,2588672,2719744,4294967295,4294967295,105472,6144000,2850816,121856,18176,16384,691456,1704320,24576,10346496,711680,370176,3328,368640,10321920,198368,198272,741376,4280942592,876544,502784,204080,786432,203776,491520,536870912,536870912,5242880,218880,852736,10364928,10321920,10354688,10387456,10420224,10332160,10407936,10397696,10342400,10375168,10418176,10430464,10352640,10385408,0,0
.long 2330624,2461696,2592768,2723840,4294967295,4294967295,105472,6146048,2852864,121984,536870912,16384,748800,1720704,24576,10347520,711808,536870912,118016,368896,10338304,198372,198336,741376,4280942592,878592,503040,204084,819200,203904,495616,536870912,536870912,5242880,218880,869120,10389504,10346496,10379264,10412032,10323968,10356736,10432512,10334208,10366976,10399744,10409984,10422272,10344448,10377216,0,0
.long 2334720,2465792,2596864,2727936,4294967295,4294967295,105728,6148096,2859008,122112,536870912,16384,806144,1737088,28672,10348544,711936,536870912,232704,372736,10436608,198376,198272,741376,4280942592,909312,506880,204208,851968,204032,499712,536870912,536870912,5242880,218880,885504,10414080,10338304,10371072,10403840,10348544,10381312,10424320,10326016,10358784,10391552,10434560,10336256,10369024,10401792,0,0
.long 2338816,2469888,2600960,2732032,4294967295,4294967295,105728,6150144,2861056,122240,536870912,16384,863488,1753472,28672,10349568,712064,536870912,347392,372992,10452992,198380,198336,741376,4280942592,911360,507136,204212,884736,204160,503808,536870912,536870912,5242880,218880,901888,10373120,10330112,10362880,10395648,10428416,10340352,10416128,10405888,10350592,10383360,10426368,10328064,10360832,10393600,0,0
.long 2342912,2473984,2605056,2736128,4294967295,4294967295,105984,6152192,2867200,122368,18304,16384,691584,1769856,32768,10350592,712192,374272,3328,368640,10321920,198384,198272,755712,4281171968,880640,503296,204088,786432,203776,491520,536870912,536870912,5701632,218880,852864,10321920,10354688,10387456,10420224,10332160,10364928,10397696,10342400,10375168,10407936,10430464,10352640,10385408,10418176,0,0
.long 2347008,2478080,2609152,2740224,4294967295,4294967295,105984,6154240,2869248,122496,536870912,16384,748928,1786240,32768,10351616,712320,536870912,118016,368896,10338304,198388,198336,755712,4281171968,882688,503552,204092,819200,203904,495616,536870912,536870912,5701632,218880,869248,10346496,10379264,10412032,10323968,10356736,10389504,10334208,10366976,10399744,10432512,10422272,10344448,10377216,10409984,0,0
.long 2351104,2482176,2613248,2744320,4294967295,4294967295,106240,6156288,2875392,122624,536870912,16384,806272,1802624,36864,10352640,712448,536870912,232704,372736,10436608,198392,198272,755712,4281171968,913408,507392,204216,851968,204032,499712,536870912,536870912,5701632,218880,885632,10338304,10371072,10403840,10348544,10381312,10414080,10326016,10358784,10391552,10424320,10336256,10369024,10401792,10434560,0,0
.long 2355200,2486272,2617344,2748416,4294967295,4294967295,106240,6158336,2877440,122752,536870912,16384,863616,1819008,36864,10353664,712576,536870912,347392,372992,10452992,198396,198336,755712,4281171968,915456,507648,204220,884736,204160,503808,536870912,536870912,5701632,218880,902016,10330112,10362880,10395648,10428416,10340352,10373120,10405888,10350592,10383360,10416128,10328064,10360832,10393600,10426368,0,0
.long 2359296,2490368,2621440,2752512,4294967295,4294967295,106496,6160384,2883584,122880,18432,18432,917504,512,32768,10551296,712704,264192,0,262144,10551296,198400,198400,655360,4279107584,917504,507904,204288,917504,204288,507904,10551296,219648,0,219648,917504,10649600,10561536,10594304,10551296,10584064,10616832,10604544,10637312,10627072,10571776,10614784,10647552,10659840,10582016,0,0
.long 2363392,2494464,2625536,2756608,4294967295,4294967295,106496,6162432,2885632,123008,536870912,18432,974848,16896,32768,10552320,712832,536870912,114688,262400,10567680,198404,198464,655360,4279107584,919552,508160,204292,950272,204416,512000,10665984,220032,0,219648,933888,10553344,10586112,10618880,10575872,10608640,10641408,10629120,10661888,10563584,10596352,10606592,10639360,10651648,10573824,0,0
.long 2367488,2498560,2629632,2760704,4294967295,4294967295,106752,6164480,2891776,123136,536870912,18432,1032192,33280,36864,10553344,712960,536870912,229376,266240,10665984,198408,198400,655360,4279107584,950272,512000,204416,983040,204544,516096,10780672,220416,0,219648,950272,10577920,10610688,10643456,10567680,10600448,10633216,10620928,10653696,10555392,10588160,10631168,10663936,10565632,10598400,0,0
.long 2371584,2502656,2633728,2764800,4294967295,4294967295,106752,6166528,2893824,123264,536870912,18432,1089536,49664,36864,10554368,713088,536870912,344064,266496,10682368,198412,198464,655360,4279107584,952320,512256,204420,1015808,204672,520192,10895360,220800,0,219648,966656,10657792,10569728,10602496,10559488,10592256,10625024,10612736,10645504,10635264,10579968,10622976,10655744,10557440,10590208,0,0
.long 2375680,2506752,2637824,2768896,4294967295,4294967295,107008,6168576,2899968,123392,18560,18432,917632,66048,40960,10555392,713216,268288,256,270336,10551296,198416,198400,669696,4279336960,921600,508416,204296,917504,204288,507904,10559488,219652,0,219648,917632,10594304,10551296,10584064,10616832,10649600,10561536,10637312,10627072,10571776,10604544,10647552,10659840,10582016,10614784,0,0
.long 2379776,2510848,2641920,2772992,4294967295,4294967295,107008,6170624,2902016,123520,536870912,18432,974976,82432,40960,10556416,713344,536870912,114944,270592,10567680,198420,198464,669696,4279336960,923648,508672,204300,950272,204416,512000,10674176,220036,0,219648,934016,10618880,10575872,10608640,10641408,10553344,10586112,10661888,10563584,10596352,10629120,10639360,10651648,10573824,10606592,0,0
.long 2383872,2514944,2646016,2777088,4294967295,4294967295,107264,6172672,2908160,123648,536870912,18432,1032320,98816,45056,10557440,713472,536870912,229632,274432,10665984,198424,198400,669696,4279336960,954368,512512,204424,983040,204544,516096,10788864,220420,0,219648,950400,10643456,10567680,10600448,10633216,10577920,10610688,10653696,10555392,10588160,10620928,10663936,10565632,10598400,10631168,0,0
.long 2387968,2519040,2650112,2781184,4294967295,4294967295,107264,6174720,2910208,123776,536870912,18432,1089664,115200,45056,10558464,713600,536870912,344320,274688,10682368,198428,198464,669696,4279336960,956416,512768,204428,1015808,204672,520192,10903552,220804,0,219648,966784,10602496,10559488,10592256,10625024,10657792,10569728,10645504,10635264,10579968,10612736,10655744,10557440,10590208,10622976,0,0
.long 2392064,2523136,2654208,2785280,4294967295,4294967295,107520,6176768,2916352,123904,18688,18432,917760,131584,49152,10559488,713728,272384,512,278528,10551296,198432,198400,684032,4279566336,925696,508928,204304,917504,204288,507904,10567680,219656,0,219648,917760,10551296,10584064,10616832,10649600,10561536,10594304,10627072,10571776,10604544,10637312,10659840,10582016,10614784,10647552,0,0
.long 2396160,2527232,2658304,2789376,4294967295,4294967295,107520,6178816,2918400,124032,536870912,18432,975104,147968,49152,10560512,713856,536870912,115200,278784,10567680,198436,198464,684032,4279566336,927744,509184,204308,950272,204416,512000,10682368,220040,0,219648,934144,10575872,10608640,10641408,10553344,10586112,10618880,10563584,10596352,10629120,10661888,10651648,10573824,10606592,10639360,0,0
.long 2400256,2531328,2662400,2793472,4294967295,4294967295,107776,6180864,2924544,124160,536870912,18432,1032448,164352,53248,10561536,713984,536870912,229888,282624,10665984,198440,198400,684032,4279566336,958464,513024,204432,983040,204544,516096,10797056,220424,0,219648,950528,10567680,10600448,10633216,10577920,10610688,10643456,10555392,10588160,10620928,10653696,10565632,10598400,10631168,10663936,0,0
.long 2404352,2535424,2666496,2797568,4294967295,4294967295,107776,6182912,2926592,124288,536870912,18432,1089792,180736,53248,10562560,714112,536870912,344576,282880,10682368,198444,198464,684032,4279566336,960512,513280,204436,1015808,204672,520192,10911744,220808,0,219648,966912,10559488,10592256,10625024,10657792,10569728,10602496,10635264,10579968,10612736,10645504,10557440,10590208,10622976,10655744,0,0
.long 2408448,2539520,2670592,2801664,4294967295,4294967295,108032,6184960,2932736,124416,18816,18432,917888,197120,57344,10563584,714240,276480,768,286720,10551296,198448,198400,698368,4279795712,929792,509440,204312,917504,204288,507904,10575872,219660,0,219648,917888,10616832,10649600,10561536,10594304,10551296,10584064,10571776,10604544,10637312,10627072,10582016,10614784,10647552,10659840,0,0
.long 2412544,2543616,2674688,2805760,4294967295,4294967295,108032,6187008,2934784,124544,536870912,18432,975232,213504,57344,10564608,714368,536870912,115456,286976,10567680,198452,198464,698368,4279795712,931840,509696,204316,950272,204416,512000,10690560,220044,0,219648,934272,10641408,10553344,10586112,10618880,10575872,10608640,10596352,10629120,10661888,10563584,10573824,10606592,10639360,10651648,0,0
.long 2416640,2547712,2678784,2809856,4294967295,4294967295,108288,6189056,2940928,124672,536870912,18432,1032576,229888,61440,10565632,714496,536870912,230144,290816,10665984,198456,198400,698368,4279795712,962560,513536,204440,983040,204544,516096,10805248,220428,0,219648,950656,10633216,10577920,10610688,10643456,10567680,10600448,10588160,10620928,10653696,10555392,10598400,10631168,10663936,10565632,0,0
.long 2420736,2551808,2682880,2813952,4294967295,4294967295,108288,6191104,2942976,124800,536870912,18432,1089920,246272,61440,10566656,714624,536870912,344832,291072,10682368,198460,198464,698368,4279795712,964608,513792,204444,1015808,204672,520192,10919936,220812,0,219648,967040,10625024,10657792,10569728,10602496,10559488,10592256,10579968,10612736,10645504,10635264,10590208,10622976,10655744,10557440,0,0
.long 2424832,2555904,2686976,2818048,4294967295,4294967295,108544,6193152,2949120,124928,18944,18432,918016,262656,65536,10567680,714752,280576,1024,294912,10551296,198464,198400,712704,4280025088,933888,509952,204320,917504,204288,507904,10584064,219664,0,219648,918016,10649600,10561536,10594304,10551296,10584064,10616832,10604544,10637312,10627072,10571776,10614784,10647552,10659840,10582016,0,0
.long 2428928,2560000,2691072,2822144,4294967295,4294967295,108544,6195200,2951168,125056,536870912,18432,975360,279040,65536,10568704,714880,536870912,115712,295168,10567680,198468,198464,712704,4280025088,935936,510208,204324,950272,204416,512000,10698752,220048,0,219648,934400,10553344,10586112,10618880,10575872,10608640,10641408,10629120,10661888,10563584,10596352,10606592,10639360,10651648,10573824,0,0
.long 2433024,2564096,2695168,2826240,4294967295,4294967295,108800,6197248,2957312,125184,536870912,18432,1032704,295424,69632,10569728,715008,536870912,230400,299008,10665984,198472,198400,712704,4280025088,966656,514048,204448,983040,204544,516096,10813440,220432,0,219648,950784,10577920,10610688,10643456,10567680,10600448,10633216,10620928,10653696,10555392,10588160,10631168,10663936,10565632,10598400,0,0
.long 2437120,2568192,2699264,2830336,4294967295,4294967295,108800,6199296,2959360,125312,536870912,18432,1090048,311808,69632,10570752,715136,536870912,345088,299264,10682368,198476,198464,712704,4280025088,968704,514304,204452,1015808,204672,520192,10928128,220816,0,219648,967168,10657792,10569728,10602496,10559488,10592256,10625024,10612736,10645504,10635264,10579968,10622976,10655744,10557440,10590208,0,0
.long 2441216,2572288,2703360,2834432,4294967295,4294967295,109056,6201344,2965504,125440,19072,18432,918144,328192,73728,10571776,715264,284672,1280,303104,10551296,198480,198400,727040,4280254464,937984,510464,204328,917504,204288,507904,10592256,219668,0,219648,918144,10594304,10551296,10584064,10616832,10649600,10561536,10637312,10627072,10571776,10604544,10647552,10659840,10582016,10614784,0,0
.long 2445312,2576384,2707456,2838528,4294967295,4294967295,109056,6203392,2967552,125568,536870912,18432,975488,344576,73728,10572800,715392,536870912,115968,303360,10567680,198484,198464,727040,4280254464,940032,510720,204332,950272,204416,512000,10706944,220052,0,219648,934528,10618880,10575872,10608640,10641408,10553344,10586112,10661888,10563584,10596352,10629120,10639360,10651648,10573824,10606592,0,0
.long 2449408,2580480,2711552,2842624,4294967295,4294967295,109312,6205440,2973696,125696,536870912,18432,1032832,360960,77824,10573824,715520,536870912,230656,307200,10665984,198488,198400,727040,4280254464,970752,514560,204456,983040,204544,516096,10821632,220436,0,219648,950912,10643456,10567680,10600448,10633216,10577920,10610688,10653696,10555392,10588160,10620928,10663936,10565632,10598400,10631168,0,0
.long 2453504,2584576,2715648,2846720,4294967295,4294967295,109312,6207488,2975744,125824,536870912,18432,1090176,377344,77824,10574848,715648,536870912,345344,307456,10682368,198492,198464,727040,4280254464,972800,514816,204460,1015808,204672,520192,10936320,220820,0,219648,967296,10602496,10559488,10592256,10625024,10657792,10569728,10645504,10635264,10579968,10612736,10655744,10557440,10590208,10622976,0,0
.long 2457600,2588672,2719744,2850816,4294967295,4294967295,109568,6209536,2981888,125952,19200,18432,918272,393728,16384,10575872,715776,288768,1536,311296,10551296,198496,198400,741376,4280483840,942080,510976,204336,917504,204288,507904,10600448,219672,0,219648,918272,10551296,10584064,10616832,10649600,10561536,10594304,10627072,10571776,10604544,10637312,10659840,10582016,10614784,10647552,0,0
.long 2461696,2592768,2723840,2854912,4294967295,4294967295,109568,6211584,2983936,126080,536870912,18432,975616,410112,16384,10576896,715904,536870912,116224,311552,10567680,198500,198464,741376,4280483840,944128,511232,204340,950272,204416,512000,10715136,220056,0,219648,934656,10575872,10608640,10641408,10553344,10586112,10618880,10563584,10596352,10629120,10661888,10651648,10573824,10606592,10639360,0,0
.long 2465792,2596864,2727936,2859008,4294967295,4294967295,109824,6213632,2990080,126208,536870912,18432,1032960,426496,20480,10577920,716032,536870912,230912,315392,10665984,198504,198400,741376,4280483840,974848,515072,204464,983040,204544,516096,10829824,220440,0,219648,951040,10567680,10600448,10633216,10577920,10610688,10643456,10555392,10588160,10620928,10653696,10565632,10598400,10631168,10663936,0,0
.long 2469888,2600960,2732032,2863104,4294967295,4294967295,109824,6215680,2992128,126336,536870912,18432,1090304,442880,20480,10578944,716160,536870912,345600,315648,10682368,198508,198464,741376,4280483840,976896,515328,204468,1015808,204672,520192,10944512,220824,0,219648,967424,10559488,10592256,10625024,10657792,10569728,10602496,10635264,10579968,10612736,10645504,10557440,10590208,10622976,10655744,0,0
.long 2473984,2605056,2736128,2867200,4294967295,4294967295,110080,6217728,2998272,126464,19328,18432,918400,459264,24576,10579968,716288,292864,1792,319488,10551296,198512,198400,755712,4280713216,946176,511488,204344,917504,204288,507904,10608640,219676,0,219648,918400,10616832,10649600,10561536,10594304,10551296,10584064,10571776,10604544,10637312,10627072,10582016,10614784,10647552,10659840,0,0
.long 2478080,2609152,2740224,2871296,4294967295,4294967295,110080,6219776,3000320,126592,536870912,18432,975744,475648,24576,10580992,716416,536870912,116480,319744,10567680,198516,198464,755712,4280713216,948224,511744,204348,950272,204416,512000,10723328,220060,0,219648,934784,10641408,10553344,10586112,10618880,10575872,10608640,10596352,10629120,10661888,10563584,10573824,10606592,10639360,10651648,0,0
.long 2482176,2613248,2744320,2875392,4294967295,4294967295,110336,6221824,3006464,126720,536870912,18432,1033088,492032,28672,10582016,716544,536870912,231168,323584,10665984,198520,198400,755712,4280713216,978944,515584,204472,983040,204544,516096,10838016,220444,0,219648,951168,10633216,10577920,10610688,10643456,10567680,10600448,10588160,10620928,10653696,10555392,10598400,10631168,10663936,10565632,0,0
.long 2486272,2617344,2748416,2879488,4294967295,4294967295,110336,6223872,3008512,126848,536870912,18432,1090432,508416,28672,10583040,716672,536870912,345856,323840,10682368,198524,198464,755712,4280713216,980992,515840,204476,1015808,204672,520192,10952704,220828,0,219648,967552,10625024,10657792,10569728,10602496,10559488,10592256,10579968,10612736,10645504,10635264,10590208,10622976,10655744,10557440,0,0
.long 2490368,2621440,2752512,2883584,4294967295,4294967295,110592,6225920,3014656,126976,19456,18432,918528,524800,24576,10780672,716800,296960,2048,327680,10780672,198528,198528,655360,4278648832,983040,516096,204544,917504,204288,507904,10616832,219680,0,220416,983040,10823680,10780672,10813440,10846208,10878976,10790912,10866688,10856448,10801152,10833920,10876928,10889216,10811392,10844160,0,0
.long 2494464,2625536,2756608,2887680,4294967295,4294967295,110592,6227968,3016704,127104,536870912,18432,975872,541184,24576,10781696,716928,536870912,116736,327936,10797056,198532,198592,655360,4278648832,985088,516352,204548,950272,204416,512000,10731520,220064,0,220416,999424,10848256,10805248,10838016,10870784,10782720,10815488,10891264,10792960,10825728,10858496,10868736,10881024,10803200,10835968,0,0
.long 2498560,2629632,2760704,2891776,4294967295,4294967295,110848,6230016,3022848,127232,536870912,18432,1033216,557568,28672,10782720,717056,536870912,231424,331776,10895360,198536,198528,655360,4278648832,1015808,520192,204672,983040,204544,516096,10846208,220448,0,220416,1015808,10872832,10797056,10829824,10862592,10807296,10840064,10883072,10784768,10817536,10850304,10893312,10795008,10827776,10860544,0,0
.long 2502656,2633728,2764800,2895872,4294967295,4294967295,110848,6232064,3024896,127360,536870912,18432,1090560,573952,28672,10783744,717184,536870912,346112,332032,10911744,198540,198592,655360,4278648832,1017856,520448,204676,1015808,204672,520192,10960896,220832,0,220416,1032192,10831872,10788864,10821632,10854400,10887168,10799104,10874880,10864640,10809344,10842112,10885120,10786816,10819584,10852352,0,0
.long 2506752,2637824,2768896,2899968,4294967295,4294967295,111104,6234112,3031040,127488,19584,18432,918656,590336,32768,10784768,717312,301056,2304,335872,10780672,198544,198528,669696,4278878208,987136,516608,204552,917504,204288,507904,10625024,219684,0,220416,983168,10780672,10813440,10846208,10878976,10790912,10823680,10856448,10801152,10833920,10866688,10889216,10811392,10844160,10876928,0,0
.long 2510848,2641920,2772992,2904064,4294967295,4294967295,111104,6236160,3033088,127616,536870912,18432,976000,606720,32768,10785792,717440,536870912,116992,336128,10797056,198548,198592,669696,4278878208,989184,516864,204556,950272,204416,512000,10739712,220068,0,220416,999552,10805248,10838016,10870784,10782720,10815488,10848256,10792960,10825728,10858496,10891264,10881024,10803200,10835968,10868736,0,0
.long 2514944,2646016,2777088,2908160,4294967295,4294967295,111360,6238208,3039232,127744,536870912,18432,1033344,623104,36864,10786816,717568,536870912,231680,339968,10895360,198552,198528,669696,4278878208,1019904,520704,204680,983040,204544,516096,10854400,220452,0,220416,1015936,10797056,10829824,10862592,10807296,10840064,10872832,10784768,10817536,10850304,10883072,10795008,10827776,10860544,10893312,0,0
.long 2519040,2650112,2781184,2912256,4294967295,4294967295,111360,6240256,3041280,127872,536870912,18432,1090688,639488,36864,10787840,717696,536870912,346368,340224,10911744,198556,198592,669696,4278878208,1021952,520960,204684,1015808,204672,520192,10969088,220836,0,220416,1032320,10788864,10821632,10854400,10887168,10799104,10831872,10864640,10809344,10842112,10874880,10786816,10819584,10852352,10885120,0,0
.long 2523136,2654208,2785280,2916352,4294967295,4294967295,111616,6242304,3047424,128000,19712,18432,918784,655872,40960,10788864,717824,305152,2560,344064,10780672,198560,198528,684032,4279107584,991232,517120,204560,917504,204288,507904,10633216,219688,0,220416,983296,10846208,10878976,10790912,10823680,10780672,10813440,10801152,10833920,10866688,10856448,10811392,10844160,10876928,10889216,0,0
.long 2527232,2658304,2789376,2920448,4294967295,4294967295,111616,6244352,3049472,128128,536870912,18432,976128,672256,40960,10789888,717952,536870912,117248,344320,10797056,198564,198592,684032,4279107584,993280,517376,204564,950272,204416,512000,10747904,220072,0,220416,999680,10870784,10782720,10815488,10848256,10805248,10838016,10825728,10858496,10891264,10792960,10803200,10835968,10868736,10881024,0,0
.long 2531328,2662400,2793472,2924544,4294967295,4294967295,111872,6246400,3055616,128256,536870912,18432,1033472,688640,45056,10790912,718080,536870912,231936,348160,10895360,198568,198528,684032,4279107584,1024000,521216,204688,983040,204544,516096,10862592,220456,0,220416,1016064,10862592,10807296,10840064,10872832,10797056,10829824,10817536,10850304,10883072,10784768,10827776,10860544,10893312,10795008,0,0
.long 2535424,2666496,2797568,2928640,4294967295,4294967295,111872,6248448,3057664,128384,536870912,18432,1090816,705024,45056,10791936,718208,536870912,346624,348416,10911744,198572,198592,684032,4279107584,1026048,521472,204692,1015808,204672,520192,10977280,220840,0,220416,1032448,10854400,10887168,10799104,10831872,10788864,10821632,10809344,10842112,10874880,10864640,10819584,10852352,10885120,10786816,0,0
.long 2539520,2670592,2801664,2932736,4294967295,4294967295,112128,6250496,3063808,128512,19840,18432,918912,721408,49152,10792960,718336,309248,2816,352256,10780672,198576,198528,698368,4279336960,995328,517632,204568,917504,204288,507904,10641408,219692,0,220416,983424,10878976,10790912,10823680,10780672,10813440,10846208,10833920,10866688,10856448,10801152,10844160,10876928,10889216,10811392,0,0
.long 2543616,2674688,2805760,2936832,4294967295,4294967295,112128,6252544,3065856,128640,536870912,18432,976256,737792,49152,10793984,718464,536870912,117504,352512,10797056,198580,198592,698368,4279336960,997376,517888,204572,950272,204416,512000,10756096,220076,0,220416,999808,10782720,10815488,10848256,10805248,10838016,10870784,10858496,10891264,10792960,10825728,10835968,10868736,10881024,10803200,0,0
.long 2547712,2678784,2809856,2940928,4294967295,4294967295,112384,6254592,3072000,128768,536870912,18432,1033600,754176,53248,10795008,718592,536870912,232192,356352,10895360,198584,198528,698368,4279336960,1028096,521728,204696,983040,204544,516096,10870784,220460,0,220416,1016192,10807296,10840064,10872832,10797056,10829824,10862592,10850304,10883072,10784768,10817536,10860544,10893312,10795008,10827776,0,0
.long 2551808,2682880,2813952,2945024,4294967295,4294967295,112384,6256640,3074048,128896,536870912,18432,1090944,770560,53248,10796032,718720,536870912,346880,356608,10911744,198588,198592,698368,4279336960,1030144,521984,204700,1015808,204672,520192,10985472,220844,0,220416,1032576,10887168,10799104,10831872,10788864,10821632,10854400,10842112,10874880,10864640,10809344,10852352,10885120,10786816,10819584,0,0
.long 2555904,2686976,2818048,2949120,4294967295,4294967295,112640,6258688,3080192,129024,19968,18432,919040,786944,57344,10797056,718848,313344,3072,360448,10780672,198592,198528,712704,4279566336,999424,518144,204576,917504,204288,507904,10649600,219696,0,220416,983552,10823680,10780672,10813440,10846208,10878976,10790912,10866688,10856448,10801152,10833920,10876928,10889216,10811392,10844160,0,0
.long 2560000,2691072,2822144,2953216,4294967295,4294967295,112640,6260736,3082240,129152,536870912,18432,976384,803328,57344,10798080,718976,536870912,117760,360704,10797056,198596,198592,712704,4279566336,1001472,518400,204580,950272,204416,512000,10764288,220080,0,220416,999936,10848256,10805248,10838016,10870784,10782720,10815488,10891264,10792960,10825728,10858496,10868736,10881024,10803200,10835968,0,0
.long 2564096,2695168,2826240,2957312,4294967295,4294967295,112896,6262784,3088384,129280,536870912,18432,1033728,819712,61440,10799104,719104,536870912,232448,364544,10895360,198600,198528,712704,4279566336,1032192,522240,204704,983040,204544,516096,10878976,220464,0,220416,1016320,10872832,10797056,10829824,10862592,10807296,10840064,10883072,10784768,10817536,10850304,10893312,10795008,10827776,10860544,0,0
.long 2568192,2699264,2830336,2961408,4294967295,4294967295,112896,6264832,3090432,129408,536870912,18432,1091072,836096,61440,10800128,719232,536870912,347136,364800,10911744,198604,198592,712704,4279566336,1034240,522496,204708,1015808,204672,520192,10993664,220848,0,220416,1032704,10831872,10788864,10821632,10854400,10887168,10799104,10874880,10864640,10809344,10842112,10885120,10786816,10819584,10852352,0,0
.long 2572288,2703360,2834432,2965504,4294967295,4294967295,113152,6266880,3096576,129536,20096,18432,919168,852480,65536,10801152,719360,317440,3328,368640,10780672,198608,198528,727040,4279795712,1003520,518656,204584,917504,204288,507904,10657792,219700,0,220416,983680,10780672,10813440,10846208,10878976,10790912,10823680,10856448,10801152,10833920,10866688,10889216,10811392,10844160,10876928,0,0
.long 2576384,2707456,2838528,2969600,4294967295,4294967295,113152,6268928,3098624,129664,536870912,18432,976512,868864,65536,10802176,719488,536870912,118016,368896,10797056,198612,198592,727040,4279795712,1005568,518912,204588,950272,204416,512000,10772480,220084,0,220416,1000064,10805248,10838016,10870784,10782720,10815488,10848256,10792960,10825728,10858496,10891264,10881024,10803200,10835968,10868736,0,0
.long 2580480,2711552,2842624,2973696,4294967295,4294967295,113408,6270976,3104768,129792,536870912,18432,1033856,885248,69632,10803200,719616,536870912,232704,372736,10895360,198616,198528,727040,4279795712,1036288,522752,204712,983040,204544,516096,10887168,220468,0,220416,1016448,10797056,10829824,10862592,10807296,10840064,10872832,10784768,10817536,10850304,10883072,10795008,10827776,10860544,10893312,0,0
.long 2584576,2715648,2846720,2977792,4294967295,4294967295,113408,6273024,3106816,129920,536870912,18432,1091200,901632,69632,10804224,719744,536870912,347392,372992,10911744,198620,198592,727040,4279795712,1038336,523008,204716,1015808,204672,520192,11001856,220852,0,220416,1032832,10788864,10821632,10854400,10887168,10799104,10831872,10864640,10809344,10842112,10874880,10786816,10819584,10852352,10885120,0,0
.long 2588672,2719744,2850816,2981888,4294967295,4294967295,113664,6275072,3112960,130048,20224,18432,919296,918016,73728,10805248,719872,321536,3328,368640,10780672,198624,198528,741376,4280025088,1007616,519168,204592,917504,204288,507904,536870912,536870912,6160384,220416,983808,10846208,10878976,10790912,10823680,10780672,10813440,10801152,10833920,10866688,10856448,10811392,10844160,10876928,10889216,0,0
.long 2592768,2723840,2854912,2985984,4294967295,4294967295,113664,6277120,3115008,130176,536870912,18432,976640,934400,73728,10806272,720000,536870912,118016,368896,10797056,198628,198592,741376,4280025088,1009664,519424,204596,950272,204416,512000,536870912,536870912,6160384,220416,1000192,10870784,10782720,10815488,10848256,10805248,10838016,10825728,10858496,10891264,10792960,10803200,10835968,10868736,10881024,0,0
.long 2596864,2727936,2859008,2990080,4294967295,4294967295,113920,6279168,3121152,130304,536870912,18432,1033984,950784,77824,10807296,720128,536870912,232704,372736,10895360,198632,198528,741376,4280025088,1040384,523264,204720,983040,204544,516096,536870912,536870912,6160384,220416,1016576,10862592,10807296,10840064,10872832,10797056,10829824,10817536,10850304,10883072,10784768,10827776,10860544,10893312,10795008,0,0
.long 2600960,2732032,2863104,2994176,4294967295,4294967295,113920,6281216,3123200,130432,536870912,18432,1091328,967168,77824,10808320,720256,536870912,347392,372992,10911744,198636,198592,741376,4280025088,1042432,523520,204724,1015808,204672,520192,536870912,536870912,6160384,220416,1032960,10854400,10887168,10799104,10831872,10788864,10821632,10809344,10842112,10874880,10864640,10819584,10852352,10885120,10786816,0,0
.long 2605056,2736128,2867200,2998272,4294967295,4294967295,114176,6283264,3129344,130560,20352,18432,919424,983552,16384,10809344,720384,325632,3328,368640,10780672,198640,198528,755712,4280254464,1011712,519680,204600,917504,204288,507904,536870912,536870912,6619136,220416,983936,10878976,10790912,10823680,10780672,10813440,10846208,10833920,10866688,10856448,10801152,10844160,10876928,10889216,10811392,0,0
.long 2609152,2740224,2871296,3002368,4294967295,4294967295,114176,6285312,3131392,130688,536870912,18432,976768,999936,16384,10810368,720512,536870912,118016,368896,10797056,198644,198592,755712,4280254464,1013760,519936,204604,950272,204416,512000,536870912,536870912,6619136,220416,1000320,10782720,10815488,10848256,10805248,10838016,10870784,10858496,10891264,10792960,10825728,10835968,10868736,10881024,10803200,0,0
.long 2613248,2744320,2875392,3006464,4294967295,4294967295,114432,6287360,3137536,130816,536870912,18432,1034112,1016320,20480,10811392,720640,536870912,232704,372736,10895360,198648,198528,755712,4280254464,1044480,523776,204728,983040,204544,516096,536870912,536870912,6619136,220416,1016704,10807296,10840064,10872832,10797056,10829824,10862592,10850304,10883072,10784768,10817536,10860544,10893312,10795008,10827776,0,0
.long 2617344,2748416,2879488,3010560,4294967295,4294967295,114432,6289408,3139584,130944,536870912,18432,1091456,1032704,20480,10812416,720768,536870912,347392,372992,10911744,198652,198592,755712,4280254464,1046528,524032,204732,1015808,204672,520192,536870912,536870912,6619136,220416,1033088,10887168,10799104,10831872,10788864,10821632,10854400,10842112,10874880,10864640,10809344,10852352,10885120,10786816,10819584,0,0
.long 2621440,2752512,2883584,3014656,4294967295,4294967295,114688,6291456,3145728,131072,20480,20480,919552,1049088,16384,11010048,720896,329728,0,262144,11010048,198656,198656,655360,4278190080,1048576,524288,204800,1048576,204800,524288,11010048,221184,0,221184,1048576,11010048,11042816,11075584,11108352,11020288,11053056,11085824,11030528,11063296,11096064,11118592,11040768,11073536,11106304,0,0
.long 2625536,2756608,2887680,3018752,4294967295,4294967295,114688,6293504,3147776,131200,536870912,20480,976896,1065472,16384,11011072,721024,536870912,114688,262400,11026432,198660,198720,655360,4278190080,1050624,524544,204804,1081344,204928,528384,11124736,221568,0,221184,1064960,11034624,11067392,11100160,11012096,11044864,11077632,11022336,11055104,11087872,11120640,11110400,11032576,11065344,11098112,0,0
.long 2629632,2760704,2891776,3022848,4294967295,4294967295,114944,6295552,3153920,131328,536870912,20480,1034240,1081856,20480,11012096,721152,536870912,229376,266240,11124736,198664,198656,655360,4278190080,1081344,528384,204928,1114112,205056,532480,11239424,221952,0,221184,1081344,11026432,11059200,11091968,11036672,11069440,11102208,11014144,11046912,11079680,11112448,11024384,11057152,11089920,11122688,0,0
.long 2633728,2764800,2895872,3026944,4294967295,4294967295,114944,6297600,3155968,131456,536870912,20480,1091584,1098240,20480,11013120,721280,536870912,344064,266496,11141120,198668,198720,655360,4278190080,1083392,528640,204932,1146880,205184,536576,11354112,222336,0,221184,1097728,11018240,11051008,11083776,11116544,11028480,11061248,11094016,11038720,11071488,11104256,11016192,11048960,11081728,11114496,0,0
.long 2637824,2768896,2899968,3031040,4294967295,4294967295,115200,6299648,3162112,131584,20608,20480,919680,1114624,24576,11014144,721408,333824,256,270336,11010048,198672,198656,669696,4278419456,1052672,524800,204808,1048576,204800,524288,11018240,221188,0,221184,1048704,11075584,11108352,11020288,11053056,11010048,11042816,11030528,11063296,11096064,11085824,11040768,11073536,11106304,11118592,0,0
.long 2641920,2772992,2904064,3035136,4294967295,4294967295,115200,6301696,3164160,131712,536870912,20480,977024,1131008,24576,11015168,721536,536870912,114944,270592,11026432,198676,198720,669696,4278419456,1054720,525056,204812,1081344,204928,528384,11132928,221572,0,221184,1065088,11100160,11012096,11044864,11077632,11034624,11067392,11055104,11087872,11120640,11022336,11032576,11065344,11098112,11110400,0,0
.long 2646016,2777088,2908160,3039232,4294967295,4294967295,115456,6303744,3170304,131840,536870912,20480,1034368,1147392,28672,11016192,721664,536870912,229632,274432,11124736,198680,198656,669696,4278419456,1085440,528896,204936,1114112,205056,532480,11247616,221956,0,221184,1081472,11091968,11036672,11069440,11102208,11026432,11059200,11046912,11079680,11112448,11014144,11057152,11089920,11122688,11024384,0,0
.long 2650112,2781184,2912256,3043328,4294967295,4294967295,115456,6305792,3172352,131968,536870912,20480,1091712,1163776,28672,11017216,721792,536870912,344320,274688,11141120,198684,198720,669696,4278419456,1087488,529152,204940,1146880,205184,536576,11362304,222340,0,221184,1097856,11083776,11116544,11028480,11061248,11018240,11051008,11038720,11071488,11104256,11094016,11048960,11081728,11114496,11016192,0,0
.long 2654208,2785280,2916352,3047424,4294967295,4294967295,115712,6307840,3178496,132096,20736,20480,919808,1180160,32768,11018240,721920,337920,512,278528,11010048,198688,198656,684032,4278648832,1056768,525312,204816,1048576,204800,524288,11026432,221192,0,221184,1048832,11108352,11020288,11053056,11010048,11042816,11075584,11063296,11096064,11085824,11030528,11073536,11106304,11118592,11040768,0,0
.long 2658304,2789376,2920448,3051520,4294967295,4294967295,115712,6309888,3180544,132224,536870912,20480,977152,1196544,32768,11019264,722048,536870912,115200,278784,11026432,198692,198720,684032,4278648832,1058816,525568,204820,1081344,204928,528384,11141120,221576,0,221184,1065216,11012096,11044864,11077632,11034624,11067392,11100160,11087872,11120640,11022336,11055104,11065344,11098112,11110400,11032576,0,0
.long 2662400,2793472,2924544,3055616,4294967295,4294967295,115968,6311936,3186688,132352,536870912,20480,1034496,1212928,36864,11020288,722176,536870912,229888,282624,11124736,198696,198656,684032,4278648832,1089536,529408,204944,1114112,205056,532480,11255808,221960,0,221184,1081600,11036672,11069440,11102208,11026432,11059200,11091968,11079680,11112448,11014144,11046912,11089920,11122688,11024384,11057152,0,0
.long 2666496,2797568,2928640,3059712,4294967295,4294967295,115968,6313984,3188736,132480,536870912,20480,1091840,1229312,36864,11021312,722304,536870912,344576,282880,11141120,198700,198720,684032,4278648832,1091584,529664,204948,1146880,205184,536576,11370496,222344,0,221184,1097984,11116544,11028480,11061248,11018240,11051008,11083776,11071488,11104256,11094016,11038720,11081728,11114496,11016192,11048960,0,0
.long 2670592,2801664,2932736,3063808,4294967295,4294967295,116224,6316032,3194880,132608,20864,20480,919936,1245696,40960,11022336,722432,342016,768,286720,11010048,198704,198656,698368,4278878208,1060864,525824,204824,1048576,204800,524288,11034624,221196,0,221184,1048960,11053056,11010048,11042816,11075584,11108352,11020288,11096064,11085824,11030528,11063296,11106304,11118592,11040768,11073536,0,0
.long 2674688,2805760,2936832,3067904,4294967295,4294967295,116224,6318080,3196928,132736,536870912,20480,977280,1262080,40960,11023360,722560,536870912,115456,286976,11026432,198708,198720,698368,4278878208,1062912,526080,204828,1081344,204928,528384,11149312,221580,0,221184,1065344,11077632,11034624,11067392,11100160,11012096,11044864,11120640,11022336,11055104,11087872,11098112,11110400,11032576,11065344,0,0
.long 2678784,2809856,2940928,3072000,4294967295,4294967295,116480,6320128,3203072,132864,536870912,20480,1034624,1278464,45056,11024384,722688,536870912,230144,290816,11124736,198712,198656,698368,4278878208,1093632,529920,204952,1114112,205056,532480,11264000,221964,0,221184,1081728,11102208,11026432,11059200,11091968,11036672,11069440,11112448,11014144,11046912,11079680,11122688,11024384,11057152,11089920,0,0
.long 2682880,2813952,2945024,3076096,4294967295,4294967295,116480,6322176,3205120,132992,536870912,20480,1091968,1294848,45056,11025408,722816,536870912,344832,291072,11141120,198716,198720,698368,4278878208,1095680,530176,204956,1146880,205184,536576,11378688,222348,0,221184,1098112,11061248,11018240,11051008,11083776,11116544,11028480,11104256,11094016,11038720,11071488,11114496,11016192,11048960,11081728,0,0
.long 2686976,2818048,2949120,3080192,4294967295,4294967295,116736,6324224,3211264,133120,20992,20480,920064,1311232,49152,11026432,722944,346112,1024,294912,11010048,198720,198656,712704,4279107584,1064960,526336,204832,1048576,204800,524288,11042816,221200,0,221184,1049088,11010048,11042816,11075584,11108352,11020288,11053056,11085824,11030528,11063296,11096064,11118592,11040768,11073536,11106304,0,0
.long 2691072,2822144,2953216,3084288,4294967295,4294967295,116736,6326272,3213312,133248,536870912,20480,977408,1327616,49152,11027456,723072,536870912,115712,295168,11026432,198724,198720,712704,4279107584,1067008,526592,204836,1081344,204928,528384,11157504,221584,0,221184,1065472,11034624,11067392,11100160,11012096,11044864,11077632,11022336,11055104,11087872,11120640,11110400,11032576,11065344,11098112,0,0
.long 2695168,2826240,2957312,3088384,4294967295,4294967295,116992,6328320,3219456,133376,536870912,20480,1034752,1344000,53248,11028480,723200,536870912,230400,299008,11124736,198728,198656,712704,4279107584,1097728,530432,204960,1114112,205056,532480,11272192,221968,0,221184,1081856,11026432,11059200,11091968,11036672,11069440,11102208,11014144,11046912,11079680,11112448,11024384,11057152,11089920,11122688,0,0
.long 2699264,2830336,2961408,3092480,4294967295,4294967295,116992,6330368,3221504,133504,536870912,20480,1092096,1360384,53248,11029504,723328,536870912,345088,299264,11141120,198732,198720,712704,4279107584,1099776,530688,204964,1146880,205184,536576,11386880,222352,0,221184,1098240,11018240,11051008,11083776,11116544,11028480,11061248,11094016,11038720,11071488,11104256,11016192,11048960,11081728,11114496,0,0
.long 2703360,2834432,2965504,3096576,4294967295,4294967295,117248,6332416,3227648,133632,21120,20480,920192,1376768,57344,11030528,723456,350208,1280,303104,11010048,198736,198656,727040,4279336960,1069056,526848,204840,1048576,204800,524288,11051008,221204,0,221184,1049216,11075584,11108352,11020288,11053056,11010048,11042816,11030528,11063296,11096064,11085824,11040768,11073536,11106304,11118592,0,0
.long 2707456,2838528,2969600,3100672,4294967295,4294967295,117248,6334464,3229696,133760,536870912,20480,977536,1393152,57344,11031552,723584,536870912,115968,303360,11026432,198740,198720,727040,4279336960,1071104,527104,204844,1081344,204928,528384,11165696,221588,0,221184,1065600,11100160,11012096,11044864,11077632,11034624,11067392,11055104,11087872,11120640,11022336,11032576,11065344,11098112,11110400,0,0
.long 2711552,2842624,2973696,3104768,4294967295,4294967295,117504,6336512,3235840,133888,536870912,20480,1034880,1409536,61440,11032576,723712,536870912,230656,307200,11124736,198744,198656,727040,4279336960,1101824,530944,204968,1114112,205056,532480,11280384,221972,0,221184,1081984,11091968,11036672,11069440,11102208,11026432,11059200,11046912,11079680,11112448,11014144,11057152,11089920,11122688,11024384,0,0
.long 2715648,2846720,2977792,3108864,4294967295,4294967295,117504,6338560,3237888,134016,536870912,20480,1092224,1425920,61440,11033600,723840,536870912,345344,307456,11141120,198748,198720,727040,4279336960,1103872,531200,204972,1146880,205184,536576,11395072,222356,0,221184,1098368,11083776,11116544,11028480,11061248,11018240,11051008,11038720,11071488,11104256,11094016,11048960,11081728,11114496,11016192,0,0
.long 2719744,2850816,2981888,3112960,4294967295,4294967295,117760,6340608,3244032,134144,21248,20480,920320,1442304,65536,11034624,723968,354304,1536,311296,11010048,198752,198656,741376,4279566336,1073152,527360,204848,1048576,204800,524288,11059200,221208,0,221184,1049344,11108352,11020288,11053056,11010048,11042816,11075584,11063296,11096064,11085824,11030528,11073536,11106304,11118592,11040768,0,0
.long 2723840,2854912,2985984,3117056,4294967295,4294967295,117760,6342656,3246080,134272,536870912,20480,977664,1458688,65536,11035648,724096,536870912,116224,311552,11026432,198756,198720,741376,4279566336,1075200,527616,204852,1081344,204928,528384,11173888,221592,0,221184,1065728,11012096,11044864,11077632,11034624,11067392,11100160,11087872,11120640,11022336,11055104,11065344,11098112,11110400,11032576,0,0
.long 2727936,2859008,2990080,3121152,4294967295,4294967295,118016,6344704,3252224,134400,536870912,20480,1035008,1475072,69632,11036672,724224,536870912,230912,315392,11124736,198760,198656,741376,4279566336,1105920,531456,204976,1114112,205056,532480,11288576,221976,0,221184,1082112,11036672,11069440,11102208,11026432,11059200,11091968,11079680,11112448,11014144,11046912,11089920,11122688,11024384,11057152,0,0
.long 2732032,2863104,2994176,3125248,4294967295,4294967295,118016,6346752,3254272,134528,536870912,20480,1092352,1491456,69632,11037696,724352,536870912,345600,315648,11141120,198764,198720,741376,4279566336,1107968,531712,204980,1146880,205184,536576,11403264,222360,0,221184,1098496,11116544,11028480,11061248,11018240,11051008,11083776,11071488,11104256,11094016,11038720,11081728,11114496,11016192,11048960,0,0
.long 2736128,2867200,2998272,3129344,4294967295,4294967295,118272,6348800,3260416,134656,21376,20480,920448,1507840,73728,11038720,724480,358400,1792,319488,11010048,198768,198656,755712,4279795712,1077248,527872,204856,1048576,204800,524288,11067392,221212,0,221184,1049472,11053056,11010048,11042816,11075584,11108352,11020288,11096064,11085824,11030528,11063296,11106304,11118592,11040768,11073536,0,0
.long 2740224,2871296,3002368,3133440,4294967295,4294967295,118272,6350848,3262464,134784,536870912,20480,977792,1524224,73728,11039744,724608,536870912,116480,319744,11026432,198772,198720,755712,4279795712,1079296,528128,204860,1081344,204928,528384,11182080,221596,0,221184,1065856,11077632,11034624,11067392,11100160,11012096,11044864,11120640,11022336,11055104,11087872,11098112,11110400,11032576,11065344,0,0
.long 2744320,2875392,3006464,3137536,4294967295,4294967295,118528,6352896,3268608,134912,536870912,20480,1035136,1540608,77824,11040768,724736,536870912,231168,323584,11124736,198776,198656,755712,4279795712,1110016,531968,204984,1114112,205056,532480,11296768,221980,0,221184,1082240,11102208,11026432,11059200,11091968,11036672,11069440,11112448,11014144,11046912,11079680,11122688,11024384,11057152,11089920,0,0
.long 2748416,2879488,3010560,3141632,4294967295,4294967295,118528,6354944,3270656,135040,536870912,20480,1092480,1556992,77824,11041792,724864,536870912,345856,323840,11141120,198780,198720,755712,4279795712,1112064,532224,204988,1146880,205184,536576,11411456,222364,0,221184,1098624,11061248,11018240,11051008,11083776,11116544,11028480,11104256,11094016,11038720,11071488,11114496,11016192,11048960,11081728,0,0
.long 2752512,2883584,3014656,3145728,4294967295,4294967295,118784,6356992,3276800,135168,21504,20480,920576,1573376,73728,11239424,724992,362496,2048,327680,11239424,198784,198784,655360,4277731328,1114112,532480,205056,1048576,204800,524288,11075584,221216,0,221952,1114112,11304960,11337728,11249664,11282432,11239424,11272192,11259904,11292672,11325440,11315200,11270144,11302912,11335680,11347968,0,0
.long 2756608,2887680,3018752,3149824,4294967295,4294967295,118784,6359040,3278848,135296,536870912,20480,977920,1589760,73728,11240448,725120,536870912,116736,327936,11255808,198788,198848,655360,4277731328,1116160,532736,205060,1081344,204928,528384,11190272,221600,0,221952,1130496,11329536,11241472,11274240,11307008,11264000,11296768,11284480,11317248,11350016,11251712,11261952,11294720,11327488,11339776,0,0
.long 2760704,2891776,3022848,3153920,4294967295,4294967295,119040,6361088,3284992,135424,536870912,20480,1035264,1606144,77824,11241472,725248,536870912,231424,331776,11354112,198792,198784,655360,4277731328,1146880,536576,205184,1114112,205056,532480,11304960,221984,0,221952,1146880,11321344,11266048,11298816,11331584,11255808,11288576,11276288,11309056,11341824,11243520,11286528,11319296,11352064,11253760,0,0
.long 2764800,2895872,3026944,3158016,4294967295,4294967295,119040,6363136,3287040,135552,536870912,20480,1092608,1622528,77824,11242496,725376,536870912,346112,332032,11370496,198796,198848,655360,4277731328,1148928,536832,205188,1146880,205184,536576,11419648,222368,0,221952,1163264,11313152,11345920,11257856,11290624,11247616,11280384,11268096,11300864,11333632,11323392,11278336,11311104,11343872,11245568,0,0
.long 2768896,2899968,3031040,3162112,4294967295,4294967295,119296,6365184,3293184,135680,21632,20480,920704,1638912,16384,11243520,725504,366592,2304,335872,11239424,198800,198784,669696,4277960704,1118208,532992,205064,1048576,204800,524288,11083776,221220,0,221952,1114240,11337728,11249664,11282432,11239424,11272192,11304960,11292672,11325440,11315200,11259904,11302912,11335680,11347968,11270144,0,0
.long 2772992,2904064,3035136,3166208,4294967295,4294967295,119296,6367232,3295232,135808,536870912,20480,978048,1655296,16384,11244544,725632,536870912,116992,336128,11255808,198804,198848,669696,4277960704,1120256,533248,205068,1081344,204928,528384,11198464,221604,0,221952,1130624,11241472,11274240,11307008,11264000,11296768,11329536,11317248,11350016,11251712,11284480,11294720,11327488,11339776,11261952,0,0
.long 2777088,2908160,3039232,3170304,4294967295,4294967295,119552,6369280,3301376,135936,536870912,20480,1035392,1671680,20480,11245568,725760,536870912,231680,339968,11354112,198808,198784,669696,4277960704,1150976,537088,205192,1114112,205056,532480,11313152,221988,0,221952,1147008,11266048,11298816,11331584,11255808,11288576,11321344,11309056,11341824,11243520,11276288,11319296,11352064,11253760,11286528,0,0
.long 2781184,2912256,3043328,3174400,4294967295,4294967295,119552,6371328,3303424,136064,536870912,20480,1092736,1688064,20480,11246592,725888,536870912,346368,340224,11370496,198812,198848,669696,4277960704,1153024,537344,205196,1146880,205184,536576,11427840,222372,0,221952,1163392,11345920,11257856,11290624,11247616,11280384,11313152,11300864,11333632,11323392,11268096,11311104,11343872,11245568,11278336,0,0
.long 2785280,2916352,3047424,3178496,4294967295,4294967295,119808,6373376,3309568,136192,21760,20480,920832,1704448,24576,11247616,726016,370688,2560,344064,11239424,198816,198784,684032,4278190080,1122304,533504,205072,1048576,204800,524288,11091968,221224,0,221952,1114368,11282432,11239424,11272192,11304960,11337728,11249664,11325440,11315200,11259904,11292672,11335680,11347968,11270144,11302912,0,0
.long 2789376,2920448,3051520,3182592,4294967295,4294967295,119808,6375424,3311616,136320,536870912,20480,978176,1720832,24576,11248640,726144,536870912,117248,344320,11255808,198820,198848,684032,4278190080,1124352,533760,205076,1081344,204928,528384,11206656,221608,0,221952,1130752,11307008,11264000,11296768,11329536,11241472,11274240,11350016,11251712,11284480,11317248,11327488,11339776,11261952,11294720,0,0
.long 2793472,2924544,3055616,3186688,4294967295,4294967295,120064,6377472,3317760,136448,536870912,20480,1035520,1737216,28672,11249664,726272,536870912,231936,348160,11354112,198824,198784,684032,4278190080,1155072,537600,205200,1114112,205056,532480,11321344,221992,0,221952,1147136,11331584,11255808,11288576,11321344,11266048,11298816,11341824,11243520,11276288,11309056,11352064,11253760,11286528,11319296,0,0
.long 2797568,2928640,3059712,3190784,4294967295,4294967295,120064,6379520,3319808,136576,536870912,20480,1092864,1753600,28672,11250688,726400,536870912,346624,348416,11370496,198828,198848,684032,4278190080,1157120,537856,205204,1146880,205184,536576,11436032,222376,0,221952,1163520,11290624,11247616,11280384,11313152,11345920,11257856,11333632,11323392,11268096,11300864,11343872,11245568,11278336,11311104,0,0
.long 2801664,2932736,3063808,3194880,4294967295,4294967295,120320,6381568,3325952,136704,21888,20480,920960,1769984,32768,11251712,726528,374784,2816,352256,11239424,198832,198784,698368,4278419456,1126400,534016,205080,1048576,204800,524288,11100160,221228,0,221952,1114496,11239424,11272192,11304960,11337728,11249664,11282432,11315200,11259904,11292672,11325440,11347968,11270144,11302912,11335680,0,0
.long 2805760,2936832,3067904,3198976,4294967295,4294967295,120320,6383616,3328000,136832,536870912,20480,978304,1786368,32768,11252736,726656,536870912,117504,352512,11255808,198836,198848,698368,4278419456,1128448,534272,205084,1081344,204928,528384,11214848,221612,0,221952,1130880,11264000,11296768,11329536,11241472,11274240,11307008,11251712,11284480,11317248,11350016,11339776,11261952,11294720,11327488,0,0
.long 2809856,2940928,3072000,3203072,4294967295,4294967295,120576,6385664,3334144,136960,536870912,20480,1035648,1802752,36864,11253760,726784,536870912,232192,356352,11354112,198840,198784,698368,4278419456,1159168,538112,205208,1114112,205056,532480,11329536,221996,0,221952,1147264,11255808,11288576,11321344,11266048,11298816,11331584,11243520,11276288,11309056,11341824,11253760,11286528,11319296,11352064,0,0
.long 2813952,2945024,3076096,3207168,4294967295,4294967295,120576,6387712,3336192,137088,536870912,20480,1092992,1819136,36864,11254784,726912,536870912,346880,356608,11370496,198844,198848,698368,4278419456,1161216,538368,205212,1146880,205184,536576,11444224,222380,0,221952,1163648,11247616,11280384,11313152,11345920,11257856,11290624,11323392,11268096,11300864,11333632,11245568,11278336,11311104,11343872,0,0
.long 2818048,2949120,3080192,3211264,4294967295,4294967295,120832,6389760,3342336,137216,22016,20480,1146880,640,40960,11255808,727040,264704,3072,360448,11239424,198848,198784,712704,4278648832,1130496,534528,205088,1048576,204800,524288,11108352,221232,0,221952,1114624,11304960,11337728,11249664,11282432,11239424,11272192,11259904,11292672,11325440,11315200,11270144,11302912,11335680,11347968,0,0
.long 2822144,2953216,3084288,3215360,4294967295,4294967295,120832,6391808,3344384,137344,536870912,20480,1204224,17024,40960,11256832,727168,536870912,117760,360704,11255808,198852,198848,712704,4278648832,1132544,534784,205092,1081344,204928,528384,11223040,221616,0,221952,1131008,11329536,11241472,11274240,11307008,11264000,11296768,11284480,11317248,11350016,11251712,11261952,11294720,11327488,11339776,0,0
.long 2826240,2957312,3088384,3219456,4294967295,4294967295,121088,6393856,3350528,137472,536870912,20480,1261568,33408,45056,11257856,727296,536870912,232448,364544,11354112,198856,198784,712704,4278648832,1163264,538624,205216,1114112,205056,532480,11337728,222000,0,221952,1147392,11321344,11266048,11298816,11331584,11255808,11288576,11276288,11309056,11341824,11243520,11286528,11319296,11352064,11253760,0,0
.long 2830336,2961408,3092480,3223552,4294967295,4294967295,121088,6395904,3352576,137600,536870912,20480,1318912,49792,45056,11258880,727424,536870912,347136,364800,11370496,198860,198848,712704,4278648832,1165312,538880,205220,1146880,205184,536576,11452416,222384,0,221952,1163776,11313152,11345920,11257856,11290624,11247616,11280384,11268096,11300864,11333632,11323392,11278336,11311104,11343872,11245568,0,0
.long 2834432,2965504,3096576,3227648,4294967295,4294967295,121344,6397952,3358720,137728,22144,20480,1147008,66176,49152,11259904,727552,268800,3328,368640,11239424,198864,198784,727040,4278878208,1134592,535040,205096,1048576,204800,524288,11116544,221236,0,221952,1114752,11337728,11249664,11282432,11239424,11272192,11304960,11292672,11325440,11315200,11259904,11302912,11335680,11347968,11270144,0,0
.long 2838528,2969600,3100672,3231744,4294967295,4294967295,121344,6400000,3360768,137856,536870912,20480,1204352,82560,49152,11260928,727680,536870912,118016,368896,11255808,198868,198848,727040,4278878208,1136640,535296,205100,1081344,204928,528384,11231232,221620,0,221952,1131136,11241472,11274240,11307008,11264000,11296768,11329536,11317248,11350016,11251712,11284480,11294720,11327488,11339776,11261952,0,0
.long 2842624,2973696,3104768,3235840,4294967295,4294967295,121600,6402048,3366912,137984,536870912,20480,1261696,98944,53248,11261952,727808,536870912,232704,372736,11354112,198872,198784,727040,4278878208,1167360,539136,205224,1114112,205056,532480,11345920,222004,0,221952,1147520,11266048,11298816,11331584,11255808,11288576,11321344,11309056,11341824,11243520,11276288,11319296,11352064,11253760,11286528,0,0
.long 2846720,2977792,3108864,3239936,4294967295,4294967295,121600,6404096,3368960,138112,536870912,20480,1319040,115328,53248,11262976,727936,536870912,347392,372992,11370496,198876,198848,727040,4278878208,1169408,539392,205228,1146880,205184,536576,11460608,222388,0,221952,1163904,11345920,11257856,11290624,11247616,11280384,11313152,11300864,11333632,11323392,11268096,11311104,11343872,11245568,11278336,0,0
.long 2850816,2981888,3112960,3244032,4294967295,4294967295,121856,6406144,3375104,138240,22272,20480,1147136,131712,57344,11264000,728064,272896,3328,368640,11239424,198880,198784,741376,4279107584,1138688,535552,205104,1048576,204800,524288,536870912,536870912,5242880,221952,1114880,11282432,11239424,11272192,11304960,11337728,11249664,11325440,11315200,11259904,11292672,11335680,11347968,11270144,11302912,0,0
.long 2854912,2985984,3117056,3248128,4294967295,4294967295,121856,6408192,3377152,138368,536870912,20480,1204480,148096,57344,11265024,728192,536870912,118016,368896,11255808,198884,198848,741376,4279107584,1140736,535808,205108,1081344,204928,528384,536870912,536870912,5242880,221952,1131264,11307008,11264000,11296768,11329536,11241472,11274240,11350016,11251712,11284480,11317248,11327488,11339776,11261952,11294720,0,0
.long 2859008,2990080,3121152,3252224,4294967295,4294967295,122112,6410240,3383296,138496,536870912,20480,1261824,164480,61440,11266048,728320,536870912,232704,372736,11354112,198888,198784,741376,4279107584,1171456,539648,205232,1114112,205056,532480,536870912,536870912,5242880,221952,1147648,11331584,11255808,11288576,11321344,11266048,11298816,11341824,11243520,11276288,11309056,11352064,11253760,11286528,11319296,0,0
.long 2863104,2994176,3125248,3256320,4294967295,4294967295,122112,6412288,3385344,138624,536870912,20480,1319168,180864,61440,11267072,728448,536870912,347392,372992,11370496,198892,198848,741376,4279107584,1173504,539904,205236,1146880,205184,536576,536870912,536870912,5242880,221952,1164032,11290624,11247616,11280384,11313152,11345920,11257856,11333632,11323392,11268096,11300864,11343872,11245568,11278336,11311104,0,0
.long 2867200,2998272,3129344,3260416,4294967295,4294967295,122368,6414336,3391488,138752,22400,20480,1147264,197248,65536,11268096,728576,276992,3328,368640,11239424,198896,198784,755712,4279336960,1142784,536064,205112,1048576,204800,524288,536870912,536870912,5701632,221952,1115008,11239424,11272192,11304960,11337728,11249664,11282432,11315200,11259904,11292672,11325440,11347968,11270144,11302912,11335680,0,0
.long 2871296,3002368,3133440,3264512,4294967295,4294967295,122368,6416384,3393536,138880,536870912,20480,1204608,213632,65536,11269120,728704,536870912,118016,368896,11255808,198900,198848,755712,4279336960,1144832,536320,205116,1081344,204928,528384,536870912,536870912,5701632,221952,1131392,11264000,11296768,11329536,11241472,11274240,11307008,11251712,11284480,11317248,11350016,11339776,11261952,11294720,11327488,0,0
.long 2875392,3006464,3137536,3268608,4294967295,4294967295,122624,6418432,3399680,139008,536870912,20480,1261952,230016,69632,11270144,728832,536870912,232704,372736,11354112,198904,198784,755712,4279336960,1175552,540160,205240,1114112,205056,532480,536870912,536870912,5701632,221952,1147776,11255808,11288576,11321344,11266048,11298816,11331584,11243520,11276288,11309056,11341824,11253760,11286528,11319296,11352064,0,0
.long 2879488,3010560,3141632,3272704,4294967295,4294967295,122624,6420480,3401728,139136,536870912,20480,1319296,246400,69632,11271168,728960,536870912,347392,372992,11370496,198908,198848,755712,4279336960,1177600,540416,205244,1146880,205184,536576,536870912,536870912,5701632,221952,1164160,11247616,11280384,11313152,11345920,11257856,11290624,11323392,11268096,11300864,11333632,11245568,11278336,11311104,11343872,0,0
.long 2883584,3014656,3145728,3276800,4294967295,4294967295,122880,6422528,3407872,139264,22528,22528,1147392,262784,65536,11468800,729088,281088,0,262144,11468800,198912,198912,655360,4277272576,1179648,540672,205312,1179648,205312,540672,11468800,222720,0,222720,1179648,11567104,11479040,11511808,11468800,11501568,11534336,11522048,11554816,11544576,11489280,11532288,11565056,11577344,11499520,0,0
.long 2887680,3018752,3149824,3280896,4294967295,4294967295,122880,6424576,3409920,139392,536870912,22528,1204736,279168,65536,11469824,729216,536870912,114688,262400,11485184,198916,198976,655360,4277272576,1181696,540928,205316,1212416,205440,544768,11583488,223104,0,222720,1196032,11470848,11503616,11536384,11493376,11526144,11558912,11546624,11579392,11481088,11513856,11524096,11556864,11569152,11491328,0,0
.long 2891776,3022848,3153920,3284992,4294967295,4294967295,123136,6426624,3416064,139520,536870912,22528,1262080,295552,69632,11470848,729344,536870912,229376,266240,11583488,198920,198912,655360,4277272576,1212416,544768,205440,1245184,205568,548864,11698176,223488,0,222720,1212416,11495424,11528192,11560960,11485184,11517952,11550720,11538432,11571200,11472896,11505664,11548672,11581440,11483136,11515904,0,0
.long 2895872,3026944,3158016,3289088,4294967295,4294967295,123136,6428672,3418112,139648,536870912,22528,1319424,311936,69632,11471872,729472,536870912,344064,266496,11599872,198924,198976,655360,4277272576,1214464,545024,205444,1277952,205696,552960,11812864,223872,0,222720,1228800,11575296,11487232,11520000,11476992,11509760,11542528,11530240,11563008,11552768,11497472,11540480,11573248,11474944,11507712,0,0
.long 2899968,3031040,3162112,3293184,4294967295,4294967295,123392,6430720,3424256,139776,22656,22528,1147520,328320,73728,11472896,729600,285184,256,270336,11468800,198928,198912,669696,4277501952,1183744,541184,205320,1179648,205312,540672,11476992,222724,0,222720,1179776,11511808,11468800,11501568,11534336,11567104,11479040,11554816,11544576,11489280,11522048,11565056,11577344,11499520,11532288,0,0
.long 2904064,3035136,3166208,3297280,4294967295,4294967295,123392,6432768,3426304,139904,536870912,22528,1204864,344704,73728,11473920,729728,536870912,114944,270592,11485184,198932,198976,669696,4277501952,1185792,541440,205324,1212416,205440,544768,11591680,223108,0,222720,1196160,11536384,11493376,11526144,11558912,11470848,11503616,11579392,11481088,11513856,11546624,11556864,11569152,11491328,11524096,0,0
.long 2908160,3039232,3170304,3301376,4294967295,4294967295,123648,6434816,3432448,140032,536870912,22528,1262208,361088,77824,11474944,729856,536870912,229632,274432,11583488,198936,198912,669696,4277501952,1216512,545280,205448,1245184,205568,548864,11706368,223492,0,222720,1212544,11560960,11485184,11517952,11550720,11495424,11528192,11571200,11472896,11505664,11538432,11581440,11483136,11515904,11548672,0,0
.long 2912256,3043328,3174400,3305472,4294967295,4294967295,123648,6436864,3434496,140160,536870912,22528,1319552,377472,77824,11475968,729984,536870912,344320,274688,11599872,198940,198976,669696,4277501952,1218560,545536,205452,1277952,205696,552960,11821056,223876,0,222720,1228928,11520000,11476992,11509760,11542528,11575296,11487232,11563008,11552768,11497472,11530240,11573248,11474944,11507712,11540480,0,0
.long 2916352,3047424,3178496,3309568,4294967295,4294967295,123904,6438912,3440640,140288,22784,22528,1147648,393856,16384,11476992,730112,289280,512,278528,11468800,198944,198912,684032,4277731328,1187840,541696,205328,1179648,205312,540672,11485184,222728,0,222720,1179904,11468800,11501568,11534336,11567104,11479040,11511808,11544576,11489280,11522048,11554816,11577344,11499520,11532288,11565056,0,0
.long 2920448,3051520,3182592,3313664,4294967295,4294967295,123904,6440960,3442688,140416,536870912,22528,1204992,410240,16384,11478016,730240,536870912,115200,278784,11485184,198948,198976,684032,4277731328,1189888,541952,205332,1212416,205440,544768,11599872,223112,0,222720,1196288,11493376,11526144,11558912,11470848,11503616,11536384,11481088,11513856,11546624,11579392,11569152,11491328,11524096,11556864,0,0
.long 2924544,3055616,3186688,3317760,4294967295,4294967295,124160,6443008,3448832,140544,536870912,22528,1262336,426624,20480,11479040,730368,536870912,229888,282624,11583488,198952,198912,684032,4277731328,1220608,545792,205456,1245184,205568,548864,11714560,223496,0,222720,1212672,11485184,11517952,11550720,11495424,11528192,11560960,11472896,11505664,11538432,11571200,11483136,11515904,11548672,11581440,0,0
.long 2928640,3059712,3190784,3321856,4294967295,4294967295,124160,6445056,3450880,140672,536870912,22528,1319680,443008,20480,11480064,730496,536870912,344576,282880,11599872,198956,198976,684032,4277731328,1222656,546048,205460,1277952,205696,552960,11829248,223880,0,222720,1229056,11476992,11509760,11542528,11575296,11487232,11520000,11552768,11497472,11530240,11563008,11474944,11507712,11540480,11573248,0,0
.long 2932736,3063808,3194880,3325952,4294967295,4294967295,124416,6447104,3457024,140800,22912,22528,1147776,459392,24576,11481088,730624,293376,768,286720,11468800,198960,198912,698368,4277960704,1191936,542208,205336,1179648,205312,540672,11493376,222732,0,222720,1180032,11534336,11567104,11479040,11511808,11468800,11501568,11489280,11522048,11554816,11544576,11499520,11532288,11565056,11577344,0,0
.long 2936832,3067904,3198976,3330048,4294967295,4294967295,124416,6449152,3459072,140928,536870912,22528,1205120,475776,24576,11482112,730752,536870912,115456,286976,11485184,198964,198976,698368,4277960704,1193984,542464,205340,1212416,205440,544768,11608064,223116,0,222720,1196416,11558912,11470848,11503616,11536384,11493376,11526144,11513856,11546624,11579392,11481088,11491328,11524096,11556864,11569152,0,0
.long 2940928,3072000,3203072,3334144,4294967295,4294967295,124672,6451200,3465216,141056,536870912,22528,1262464,492160,28672,11483136,730880,536870912,230144,290816,11583488,198968,198912,698368,4277960704,1224704,546304,205464,1245184,205568,548864,11722752,223500,0,222720,1212800,11550720,11495424,11528192,11560960,11485184,11517952,11505664,11538432,11571200,11472896,11515904,11548672,11581440,11483136,0,0
.long 2945024,3076096,3207168,3338240,4294967295,4294967295,124672,6453248,3467264,141184,536870912,22528,1319808,508544,28672,11484160,731008,536870912,344832,291072,11599872,198972,198976,698368,4277960704,1226752,546560,205468,1277952,205696,552960,11837440,223884,0,222720,1229184,11542528,11575296,11487232,11520000,11476992,11509760,11497472,11530240,11563008,11552768,11507712,11540480,11573248,11474944,0,0
.long 2949120,3080192,3211264,3342336,4294967295,4294967295,124928,6455296,3473408,141312,23040,22528,1147904,524928,32768,11485184,731136,297472,1024,294912,11468800,198976,198912,712704,4278190080,1196032,542720,205344,1179648,205312,540672,11501568,222736,0,222720,1180160,11567104,11479040,11511808,11468800,11501568,11534336,11522048,11554816,11544576,11489280,11532288,11565056,11577344,11499520,0,0
.long 2953216,3084288,3215360,3346432,4294967295,4294967295,124928,6457344,3475456,141440,536870912,22528,1205248,541312,32768,11486208,731264,536870912,115712,295168,11485184,198980,198976,712704,4278190080,1198080,542976,205348,1212416,205440,544768,11616256,223120,0,222720,1196544,11470848,11503616,11536384,11493376,11526144,11558912,11546624,11579392,11481088,11513856,11524096,11556864,11569152,11491328,0,0
.long 2957312,3088384,3219456,3350528,4294967295,4294967295,125184,6459392,3481600,141568,536870912,22528,1262592,557696,36864,11487232,731392,536870912,230400,299008,11583488,198984,198912,712704,4278190080,1228800,546816,205472,1245184,205568,548864,11730944,223504,0,222720,1212928,11495424,11528192,11560960,11485184,11517952,11550720,11538432,11571200,11472896,11505664,11548672,11581440,11483136,11515904,0,0
.long 2961408,3092480,3223552,3354624,4294967295,4294967295,125184,6461440,3483648,141696,536870912,22528,1319936,574080,36864,11488256,731520,536870912,345088,299264,11599872,198988,198976,712704,4278190080,1230848,547072,205476,1277952,205696,552960,11845632,223888,0,222720,1229312,11575296,11487232,11520000,11476992,11509760,11542528,11530240,11563008,11552768,11497472,11540480,11573248,11474944,11507712,0,0
.long 2965504,3096576,3227648,3358720,4294967295,4294967295,125440,6463488,3489792,141824,23168,22528,1148032,590464,40960,11489280,731648,301568,1280,303104,11468800,198992,198912,727040,4278419456,1200128,543232,205352,1179648,205312,540672,11509760,222740,0,222720,1180288,11511808,11468800,11501568,11534336,11567104,11479040,11554816,11544576,11489280,11522048,11565056,11577344,11499520,11532288,0,0
.long 2969600,3100672,3231744,3362816,4294967295,4294967295,125440,6465536,3491840,141952,536870912,22528,1205376,606848,40960,11490304,731776,536870912,115968,303360,11485184,198996,198976,727040,4278419456,1202176,543488,205356,1212416,205440,544768,11624448,223124,0,222720,1196672,11536384,11493376,11526144,11558912,11470848,11503616,11579392,11481088,11513856,11546624,11556864,11569152,11491328,11524096,0,0
.long 2973696,3104768,3235840,3366912,4294967295,4294967295,125696,6467584,3497984,142080,536870912,22528,1262720,623232,45056,11491328,731904,536870912,230656,307200,11583488,199000,198912,727040,4278419456,1232896,547328,205480,1245184,205568,548864,11739136,223508,0,222720,1213056,11560960,11485184,11517952,11550720,11495424,11528192,11571200,11472896,11505664,11538432,11581440,11483136,11515904,11548672,0,0
.long 2977792,3108864,3239936,3371008,4294967295,4294967295,125696,6469632,3500032,142208,536870912,22528,1320064,639616,45056,11492352,732032,536870912,345344,307456,11599872,199004,198976,727040,4278419456,1234944,547584,205484,1277952,205696,552960,11853824,223892,0,222720,1229440,11520000,11476992,11509760,11542528,11575296,11487232,11563008,11552768,11497472,11530240,11573248,11474944,11507712,11540480,0,0
.long 2981888,3112960,3244032,3375104,4294967295,4294967295,125952,6471680,3506176,142336,23296,22528,1148160,656000,49152,11493376,732160,305664,1536,311296,11468800,199008,198912,741376,4278648832,1204224,543744,205360,1179648,205312,540672,11517952,222744,0,222720,1180416,11468800,11501568,11534336,11567104,11479040,11511808,11544576,11489280,11522048,11554816,11577344,11499520,11532288,11565056,0,0
.long 2985984,3117056,3248128,3379200,4294967295,4294967295,125952,6473728,3508224,142464,536870912,22528,1205504,672384,49152,11494400,732288,536870912,116224,311552,11485184,199012,198976,741376,4278648832,1206272,544000,205364,1212416,205440,544768,11632640,223128,0,222720,1196800,11493376,11526144,11558912,11470848,11503616,11536384,11481088,11513856,11546624,11579392,11569152,11491328,11524096,11556864,0,0
.long 2990080,3121152,3252224,3383296,4294967295,4294967295,126208,6475776,3514368,142592,536870912,22528,1262848,688768,53248,11495424,732416,536870912,230912,315392,11583488,199016,198912,741376,4278648832,1236992,547840,205488,1245184,205568,548864,11747328,223512,0,222720,1213184,11485184,11517952,11550720,11495424,11528192,11560960,11472896,11505664,11538432,11571200,11483136,11515904,11548672,11581440,0,0
.long 2994176,3125248,3256320,3387392,4294967295,4294967295,126208,6477824,3516416,142720,536870912,22528,1320192,705152,53248,11496448,732544,536870912,345600,315648,11599872,199020,198976,741376,4278648832,1239040,548096,205492,1277952,205696,552960,11862016,223896,0,222720,1229568,11476992,11509760,11542528,11575296,11487232,11520000,11552768,11497472,11530240,11563008,11474944,11507712,11540480,11573248,0,0
.long 2998272,3129344,3260416,3391488,4294967295,4294967295,126464,6479872,3522560,142848,23424,22528,1148288,721536,57344,11497472,732672,309760,1792,319488,11468800,199024,198912,755712,4278878208,1208320,544256,205368,1179648,205312,540672,11526144,222748,0,222720,1180544,11534336,11567104,11479040,11511808,11468800,11501568,11489280,11522048,11554816,11544576,11499520,11532288,11565056,11577344,0,0
.long 3002368,3133440,3264512,3395584,4294967295,4294967295,126464,6481920,3524608,142976,536870912,22528,1205632,737920,57344,11498496,732800,536870912,116480,319744,11485184,199028,198976,755712,4278878208,1210368,544512,205372,1212416,205440,544768,11640832,223132,0,222720,1196928,11558912,11470848,11503616,11536384,11493376,11526144,11513856,11546624,11579392,11481088,11491328,11524096,11556864,11569152,0,0
.long 3006464,3137536,3268608,3399680,4294967295,4294967295,126720,6483968,3530752,143104,536870912,22528,1262976,754304,61440,11499520,732928,536870912,231168,323584,11583488,199032,198912,755712,4278878208,1241088,548352,205496,1245184,205568,548864,11755520,223516,0,222720,1213312,11550720,11495424,11528192,11560960,11485184,11517952,11505664,11538432,11571200,11472896,11515904,11548672,11581440,11483136,0,0
.long 3010560,3141632,3272704,3403776,4294967295,4294967295,126720,6486016,3532800,143232,536870912,22528,1320320,770688,61440,11500544,733056,536870912,345856,323840,11599872,199036,198976,755712,4278878208,1243136,548608,205500,1277952,205696,552960,11870208,223900,0,222720,1229696,11542528,11575296,11487232,11520000,11476992,11509760,11497472,11530240,11563008,11552768,11507712,11540480,11573248,11474944,0,0
.long 3014656,3145728,3276800,3407872,4294967295,4294967295,126976,6488064,3538944,143360,23552,22528,1148416,787072,57344,11698176,733184,313856,2048,327680,11698176,199040,199040,655360,4276813824,1245184,548864,205568,1179648,205312,540672,11534336,222752,0,223488,1245184,11741184,11698176,11730944,11763712,11796480,11708416,11784192,11773952,11718656,11751424,11794432,11806720,11728896,11761664,0,0
.long 3018752,3149824,3280896,3411968,4294967295,4294967295,126976,6490112,3540992,143488,536870912,22528,1205760,803456,57344,11699200,733312,536870912,116736,327936,11714560,199044,199104,655360,4276813824,1247232,549120,205572,1212416,205440,544768,11649024,223136,0,223488,1261568,11765760,11722752,11755520,11788288,11700224,11732992,11808768,11710464,11743232,11776000,11786240,11798528,11720704,11753472,0,0
.long 3022848,3153920,3284992,3416064,4294967295,4294967295,127232,6492160,3547136,143616,536870912,22528,1263104,819840,61440,11700224,733440,536870912,231424,331776,11812864,199048,199040,655360,4276813824,1277952,552960,205696,1245184,205568,548864,11763712,223520,0,223488,1277952,11790336,11714560,11747328,11780096,11724800,11757568,11800576,11702272,11735040,11767808,11810816,11712512,11745280,11778048,0,0
.long 3026944,3158016,3289088,3420160,4294967295,4294967295,127232,6494208,3549184,143744,536870912,22528,1320448,836224,61440,11701248,733568,536870912,346112,332032,11829248,199052,199104,655360,4276813824,1280000,553216,205700,1277952,205696,552960,11878400,223904,0,223488,1294336,11749376,11706368,11739136,11771904,11804672,11716608,11792384,11782144,11726848,11759616,11802624,11704320,11737088,11769856,0,0
.long 3031040,3162112,3293184,3424256,4294967295,4294967295,127488,6496256,3555328,143872,23680,22528,1148544,852608,65536,11702272,733696,317952,2304,335872,11698176,199056,199040,669696,4277043200,1249280,549376,205576,1179648,205312,540672,11542528,222756,0,223488,1245312,11698176,11730944,11763712,11796480,11708416,11741184,11773952,11718656,11751424,11784192,11806720,11728896,11761664,11794432,0,0
.long 3035136,3166208,3297280,3428352,4294967295,4294967295,127488,6498304,3557376,144000,536870912,22528,1205888,868992,65536,11703296,733824,536870912,116992,336128,11714560,199060,199104,669696,4277043200,1251328,549632,205580,1212416,205440,544768,11657216,223140,0,223488,1261696,11722752,11755520,11788288,11700224,11732992,11765760,11710464,11743232,11776000,11808768,11798528,11720704,11753472,11786240,0,0
.long 3039232,3170304,3301376,3432448,4294967295,4294967295,127744,6500352,3563520,144128,536870912,22528,1263232,885376,69632,11704320,733952,536870912,231680,339968,11812864,199064,199040,669696,4277043200,1282048,553472,205704,1245184,205568,548864,11771904,223524,0,223488,1278080,11714560,11747328,11780096,11724800,11757568,11790336,11702272,11735040,11767808,11800576,11712512,11745280,11778048,11810816,0,0
.long 3043328,3174400,3305472,3436544,4294967295,4294967295,127744,6502400,3565568,144256,536870912,22528,1320576,901760,69632,11705344,734080,536870912,346368,340224,11829248,199068,199104,669696,4277043200,1284096,553728,205708,1277952,205696,552960,11886592,223908,0,223488,1294464,11706368,11739136,11771904,11804672,11716608,11749376,11782144,11726848,11759616,11792384,11704320,11737088,11769856,11802624,0,0
.long 3047424,3178496,3309568,3440640,4294967295,4294967295,128000,6504448,3571712,144384,23808,22528,1148672,918144,73728,11706368,734208,322048,2560,344064,11698176,199072,199040,684032,4277272576,1253376,549888,205584,1179648,205312,540672,11550720,222760,0,223488,1245440,11763712,11796480,11708416,11741184,11698176,11730944,11718656,11751424,11784192,11773952,11728896,11761664,11794432,11806720,0,0
.long 3051520,3182592,3313664,3444736,4294967295,4294967295,128000,6506496,3573760,144512,536870912,22528,1206016,934528,73728,11707392,734336,536870912,117248,344320,11714560,199076,199104,684032,4277272576,1255424,550144,205588,1212416,205440,544768,11665408,223144,0,223488,1261824,11788288,11700224,11732992,11765760,11722752,11755520,11743232,11776000,11808768,11710464,11720704,11753472,11786240,11798528,0,0
.long 3055616,3186688,3317760,3448832,4294967295,4294967295,128256,6508544,3579904,144640,536870912,22528,1263360,950912,77824,11708416,734464,536870912,231936,348160,11812864,199080,199040,684032,4277272576,1286144,553984,205712,1245184,205568,548864,11780096,223528,0,223488,1278208,11780096,11724800,11757568,11790336,11714560,11747328,11735040,11767808,11800576,11702272,11745280,11778048,11810816,11712512,0,0
.long 3059712,3190784,3321856,3452928,4294967295,4294967295,128256,6510592,3581952,144768,536870912,22528,1320704,967296,77824,11709440,734592,536870912,346624,348416,11829248,199084,199104,684032,4277272576,1288192,554240,205716,1277952,205696,552960,11894784,223912,0,223488,1294592,11771904,11804672,11716608,11749376,11706368,11739136,11726848,11759616,11792384,11782144,11737088,11769856,11802624,11704320,0,0
.long 3063808,3194880,3325952,3457024,4294967295,4294967295,128512,6512640,3588096,144896,23936,22528,1148800,983680,16384,11710464,734720,326144,2816,352256,11698176,199088,199040,698368,4277501952,1257472,550400,205592,1179648,205312,540672,11558912,222764,0,223488,1245568,11796480,11708416,11741184,11698176,11730944,11763712,11751424,11784192,11773952,11718656,11761664,11794432,11806720,11728896,0,0
.long 3067904,3198976,3330048,3461120,4294967295,4294967295,128512,6514688,3590144,145024,536870912,22528,1206144,1000064,16384,11711488,734848,536870912,117504,352512,11714560,199092,199104,698368,4277501952,1259520,550656,205596,1212416,205440,544768,11673600,223148,0,223488,1261952,11700224,11732992,11765760,11722752,11755520,11788288,11776000,11808768,11710464,11743232,11753472,11786240,11798528,11720704,0,0
.long 3072000,3203072,3334144,3465216,4294967295,4294967295,128768,6516736,3596288,145152,536870912,22528,1263488,1016448,20480,11712512,734976,536870912,232192,356352,11812864,199096,199040,698368,4277501952,1290240,554496,205720,1245184,205568,548864,11788288,223532,0,223488,1278336,11724800,11757568,11790336,11714560,11747328,11780096,11767808,11800576,11702272,11735040,11778048,11810816,11712512,11745280,0,0
.long 3076096,3207168,3338240,3469312,4294967295,4294967295,128768,6518784,3598336,145280,536870912,22528,1320832,1032832,20480,11713536,735104,536870912,346880,356608,11829248,199100,199104,698368,4277501952,1292288,554752,205724,1277952,205696,552960,11902976,223916,0,223488,1294720,11804672,11716608,11749376,11706368,11739136,11771904,11759616,11792384,11782144,11726848,11769856,11802624,11704320,11737088,0,0
.long 3080192,3211264,3342336,3473408,4294967295,4294967295,129024,6520832,3604480,145408,24064,22528,1148928,1049216,24576,11714560,735232,330240,3072,360448,11698176,199104,199040,712704,4277731328,1261568,550912,205600,1179648,205312,540672,11567104,222768,0,223488,1245696,11741184,11698176,11730944,11763712,11796480,11708416,11784192,11773952,11718656,11751424,11794432,11806720,11728896,11761664,0,0
.long 3084288,3215360,3346432,3477504,4294967295,4294967295,129024,6522880,3606528,145536,536870912,22528,1206272,1065600,24576,11715584,735360,536870912,117760,360704,11714560,199108,199104,712704,4277731328,1263616,551168,205604,1212416,205440,544768,11681792,223152,0,223488,1262080,11765760,11722752,11755520,11788288,11700224,11732992,11808768,11710464,11743232,11776000,11786240,11798528,11720704,11753472,0,0
.long 3088384,3219456,3350528,3481600,4294967295,4294967295,129280,6524928,3612672,145664,536870912,22528,1263616,1081984,28672,11716608,735488,536870912,232448,364544,11812864,199112,199040,712704,4277731328,1294336,555008,205728,1245184,205568,548864,11796480,223536,0,223488,1278464,11790336,11714560,11747328,11780096,11724800,11757568,11800576,11702272,11735040,11767808,11810816,11712512,11745280,11778048,0,0
.long 3092480,3223552,3354624,3485696,4294967295,4294967295,129280,6526976,3614720,145792,536870912,22528,1320960,1098368,28672,11717632,735616,536870912,347136,364800,11829248,199116,199104,712704,4277731328,1296384,555264,205732,1277952,205696,552960,11911168,223920,0,223488,1294848,11749376,11706368,11739136,11771904,11804672,11716608,11792384,11782144,11726848,11759616,11802624,11704320,11737088,11769856,0,0
.long 3096576,3227648,3358720,3489792,4294967295,4294967295,129536,6529024,3620864,145920,24192,22528,1149056,1114752,32768,11718656,735744,334336,3328,368640,11698176,199120,199040,727040,4277960704,1265664,551424,205608,1179648,205312,540672,11575296,222772,0,223488,1245824,11698176,11730944,11763712,11796480,11708416,11741184,11773952,11718656,11751424,11784192,11806720,11728896,11761664,11794432,0,0
.long 3100672,3231744,3362816,3493888,4294967295,4294967295,129536,6531072,3622912,146048,536870912,22528,1206400,1131136,32768,11719680,735872,536870912,118016,368896,11714560,199124,199104,727040,4277960704,1267712,551680,205612,1212416,205440,544768,11689984,223156,0,223488,1262208,11722752,11755520,11788288,11700224,11732992,11765760,11710464,11743232,11776000,11808768,11798528,11720704,11753472,11786240,0,0
.long 3104768,3235840,3366912,3497984,4294967295,4294967295,129792,6533120,3629056,146176,536870912,22528,1263744,1147520,36864,11720704,736000,536870912,232704,372736,11812864,199128,199040,727040,4277960704,1298432,555520,205736,1245184,205568,548864,11804672,223540,0,223488,1278592,11714560,11747328,11780096,11724800,11757568,11790336,11702272,11735040,11767808,11800576,11712512,11745280,11778048,11810816,0,0
.long 3108864,3239936,3371008,3502080,4294967295,4294967295,129792,6535168,3631104,146304,536870912,22528,1321088,1163904,36864,11721728,736128,536870912,347392,372992,11829248,199132,199104,727040,4277960704,1300480,555776,205740,1277952,205696,552960,11919360,223924,0,223488,1294976,11706368,11739136,11771904,11804672,11716608,11749376,11782144,11726848,11759616,11792384,11704320,11737088,11769856,11802624,0,0
.long 3112960,3244032,3375104,3506176,4294967295,4294967295,130048,6537216,3637248,146432,24320,22528,1149184,1180288,40960,11722752,736256,338432,3328,368640,11698176,199136,199040,741376,4278190080,1269760,551936,205616,1179648,205312,540672,536870912,536870912,6160384,223488,1245952,11763712,11796480,11708416,11741184,11698176,11730944,11718656,11751424,11784192,11773952,11728896,11761664,11794432,11806720,0,0
.long 3117056,3248128,3379200,3510272,4294967295,4294967295,130048,6539264,3639296,146560,536870912,22528,1206528,1196672,40960,11723776,736384,536870912,118016,368896,11714560,199140,199104,741376,4278190080,1271808,552192,205620,1212416,205440,544768,536870912,536870912,6160384,223488,1262336,11788288,11700224,11732992,11765760,11722752,11755520,11743232,11776000,11808768,11710464,11720704,11753472,11786240,11798528,0,0
.long 3121152,3252224,3383296,3514368,4294967295,4294967295,130304,6541312,3645440,146688,536870912,22528,1263872,1213056,45056,11724800,736512,536870912,232704,372736,11812864,199144,199040,741376,4278190080,1302528,556032,205744,1245184,205568,548864,536870912,536870912,6160384,223488,1278720,11780096,11724800,11757568,11790336,11714560,11747328,11735040,11767808,11800576,11702272,11745280,11778048,11810816,11712512,0,0
.long 3125248,3256320,3387392,3518464,4294967295,4294967295,130304,6543360,3647488,146816,536870912,22528,1321216,1229440,45056,11725824,736640,536870912,347392,372992,11829248,199148,199104,741376,4278190080,1304576,556288,205748,1277952,205696,552960,536870912,536870912,6160384,223488,1295104,11771904,11804672,11716608,11749376,11706368,11739136,11726848,11759616,11792384,11782144,11737088,11769856,11802624,11704320,0,0
.long 3129344,3260416,3391488,3522560,4294967295,4294967295,130560,6545408,3653632,146944,24448,22528,1149312,1245824,49152,11726848,736768,342528,3328,368640,11698176,199152,199040,755712,4278419456,1273856,552448,205624,1179648,205312,540672,536870912,536870912,6619136,223488,1246080,11796480,11708416,11741184,11698176,11730944,11763712,11751424,11784192,11773952,11718656,11761664,11794432,11806720,11728896,0,0
.long 3133440,3264512,3395584,3526656,4294967295,4294967295,130560,6547456,3655680,147072,536870912,22528,1206656,1262208,49152,11727872,736896,536870912,118016,368896,11714560,199156,199104,755712,4278419456,1275904,552704,205628,1212416,205440,544768,536870912,536870912,6619136,223488,1262464,11700224,11732992,11765760,11722752,11755520,11788288,11776000,11808768,11710464,11743232,11753472,11786240,11798528,11720704,0,0
.long 3137536,3268608,3399680,3530752,4294967295,4294967295,130816,6549504,3661824,147200,536870912,22528,1264000,1278592,53248,11728896,737024,536870912,232704,372736,11812864,199160,199040,755712,4278419456,1306624,556544,205752,1245184,205568,548864,536870912,536870912,6619136,223488,1278848,11724800,11757568,11790336,11714560,11747328,11780096,11767808,11800576,11702272,11735040,11778048,11810816,11712512,11745280,0,0
.long 3141632,3272704,3403776,3534848,4294967295,4294967295,130816,6551552,3663872,147328,536870912,22528,1321344,1294976,53248,11729920,737152,536870912,347392,372992,11829248,199164,199104,755712,4278419456,1308672,556800,205756,1277952,205696,552960,536870912,536870912,6619136,223488,1295232,11804672,11716608,11749376,11706368,11739136,11771904,11759616,11792384,11782144,11726848,11769856,11802624,11704320,11737088,0,0
.long 3145728,3276800,3407872,3538944,4294967295,4294967295,131072,6553600,3670016,147456,24576,24576,1149440,1311360,49152,11927552,737280,346624,0,262144,11927552,199168,199168,655360,4276355072,1310720,557056,205824,1310720,205824,557056,11927552,224256,0,224256,1310720,11927552,11960320,11993088,12025856,11937792,11970560,12003328,11948032,11980800,12013568,12036096,11958272,11991040,12023808,0,0
.long 3149824,3280896,3411968,3543040,4294967295,4294967295,131072,6555648,3672064,147584,536870912,24576,1206784,1327744,49152,11928576,737408,536870912,114688,262400,11943936,199172,199232,655360,4276355072,1312768,557312,205828,1343488,205952,561152,12042240,224640,0,224256,1327104,11952128,11984896,12017664,11929600,11962368,11995136,11939840,11972608,12005376,12038144,12027904,11950080,11982848,12015616,0,0
.long 3153920,3284992,3416064,3547136,4294967295,4294967295,131328,6557696,3678208,147712,536870912,24576,1264128,1344128,53248,11929600,737536,536870912,229376,266240,12042240,199176,199168,655360,4276355072,1343488,561152,205952,1376256,206080,565248,12156928,225024,0,224256,1343488,11943936,11976704,12009472,11954176,11986944,12019712,11931648,11964416,11997184,12029952,11941888,11974656,12007424,12040192,0,0
.long 3158016,3289088,3420160,3551232,4294967295,4294967295,131328,6559744,3680256,147840,536870912,24576,1321472,1360512,53248,11930624,737664,536870912,344064,266496,12058624,199180,199232,655360,4276355072,1345536,561408,205956,1409024,206208,569344,12271616,225408,0,224256,1359872,11935744,11968512,12001280,12034048,11945984,11978752,12011520,11956224,11988992,12021760,11933696,11966464,11999232,12032000,0,0
.long 3162112,3293184,3424256,3555328,4294967295,4294967295,131584,6561792,3686400,147968,24704,24576,1149568,1376896,57344,11931648,737792,350720,256,270336,11927552,199184,199168,669696,4276584448,1314816,557568,205832,1310720,205824,557056,11935744,224260,0,224256,1310848,11993088,12025856,11937792,11970560,11927552,11960320,11948032,11980800,12013568,12003328,11958272,11991040,12023808,12036096,0,0
.long 3166208,3297280,3428352,3559424,4294967295,4294967295,131584,6563840,3688448,148096,536870912,24576,1206912,1393280,57344,11932672,737920,536870912,114944,270592,11943936,199188,199232,669696,4276584448,1316864,557824,205836,1343488,205952,561152,12050432,224644,0,224256,1327232,12017664,11929600,11962368,11995136,11952128,11984896,11972608,12005376,12038144,11939840,11950080,11982848,12015616,12027904,0,0
.long 3170304,3301376,3432448,3563520,4294967295,4294967295,131840,6565888,3694592,148224,536870912,24576,1264256,1409664,61440,11933696,738048,536870912,229632,274432,12042240,199192,199168,669696,4276584448,1347584,561664,205960,1376256,206080,565248,12165120,225028,0,224256,1343616,12009472,11954176,11986944,12019712,11943936,11976704,11964416,11997184,12029952,11931648,11974656,12007424,12040192,11941888,0,0
.long 3174400,3305472,3436544,3567616,4294967295,4294967295,131840,6567936,3696640,148352,536870912,24576,1321600,1426048,61440,11934720,738176,536870912,344320,274688,12058624,199196,199232,669696,4276584448,1349632,561920,205964,1409024,206208,569344,12279808,225412,0,224256,1360000,12001280,12034048,11945984,11978752,11935744,11968512,11956224,11988992,12021760,12011520,11966464,11999232,12032000,11933696,0,0
.long 3178496,3309568,3440640,3571712,4294967295,4294967295,132096,6569984,3702784,148480,24832,24576,1149696,1442432,65536,11935744,738304,354816,512,278528,11927552,199200,199168,684032,4276813824,1318912,558080,205840,1310720,205824,557056,11943936,224264,0,224256,1310976,12025856,11937792,11970560,11927552,11960320,11993088,11980800,12013568,12003328,11948032,11991040,12023808,12036096,11958272,0,0
.long 3182592,3313664,3444736,3575808,4294967295,4294967295,132096,6572032,3704832,148608,536870912,24576,1207040,1458816,65536,11936768,738432,536870912,115200,278784,11943936,199204,199232,684032,4276813824,1320960,558336,205844,1343488,205952,561152,12058624,224648,0,224256,1327360,11929600,11962368,11995136,11952128,11984896,12017664,12005376,12038144,11939840,11972608,11982848,12015616,12027904,11950080,0,0
.long 3186688,3317760,3448832,3579904,4294967295,4294967295,132352,6574080,3710976,148736,536870912,24576,1264384,1475200,69632,11937792,738560,536870912,229888,282624,12042240,199208,199168,684032,4276813824,1351680,562176,205968,1376256,206080,565248,12173312,225032,0,224256,1343744,11954176,11986944,12019712,11943936,11976704,12009472,11997184,12029952,11931648,11964416,12007424,12040192,11941888,11974656,0,0
.long 3190784,3321856,3452928,3584000,4294967295,4294967295,132352,6576128,3713024,148864,536870912,24576,1321728,1491584,69632,11938816,738688,536870912,344576,282880,12058624,199212,199232,684032,4276813824,1353728,562432,205972,1409024,206208,569344,12288000,225416,0,224256,1360128,12034048,11945984,11978752,11935744,11968512,12001280,11988992,12021760,12011520,11956224,11999232,12032000,11933696,11966464,0,0
.long 3194880,3325952,3457024,3588096,4294967295,4294967295,132608,6578176,3719168,148992,24960,24576,1149824,1507968,73728,11939840,738816,358912,768,286720,11927552,199216,199168,698368,4277043200,1323008,558592,205848,1310720,205824,557056,11952128,224268,0,224256,1311104,11970560,11927552,11960320,11993088,12025856,11937792,12013568,12003328,11948032,11980800,12023808,12036096,11958272,11991040,0,0
.long 3198976,3330048,3461120,3592192,4294967295,4294967295,132608,6580224,3721216,149120,536870912,24576,1207168,1524352,73728,11940864,738944,536870912,115456,286976,11943936,199220,199232,698368,4277043200,1325056,558848,205852,1343488,205952,561152,12066816,224652,0,224256,1327488,11995136,11952128,11984896,12017664,11929600,11962368,12038144,11939840,11972608,12005376,12015616,12027904,11950080,11982848,0,0
.long 3203072,3334144,3465216,3596288,4294967295,4294967295,132864,6582272,3727360,149248,536870912,24576,1264512,1540736,77824,11941888,739072,536870912,230144,290816,12042240,199224,199168,698368,4277043200,1355776,562688,205976,1376256,206080,565248,12181504,225036,0,224256,1343872,12019712,11943936,11976704,12009472,11954176,11986944,12029952,11931648,11964416,11997184,12040192,11941888,11974656,12007424,0,0
.long 3207168,3338240,3469312,3600384,4294967295,4294967295,132864,6584320,3729408,149376,536870912,24576,1321856,1557120,77824,11942912,739200,536870912,344832,291072,12058624,199228,199232,698368,4277043200,1357824,562944,205980,1409024,206208,569344,12296192,225420,0,224256,1360256,11978752,11935744,11968512,12001280,12034048,11945984,12021760,12011520,11956224,11988992,12032000,11933696,11966464,11999232,0,0
.long 3211264,3342336,3473408,3604480,4294967295,4294967295,133120,6586368,3735552,149504,25088,24576,1149952,1573504,16384,11943936,739328,363008,1024,294912,11927552,199232,199168,712704,4277272576,1327104,559104,205856,1310720,205824,557056,11960320,224272,0,224256,1311232,11927552,11960320,11993088,12025856,11937792,11970560,12003328,11948032,11980800,12013568,12036096,11958272,11991040,12023808,0,0
.long 3215360,3346432,3477504,3608576,4294967295,4294967295,133120,6588416,3737600,149632,536870912,24576,1207296,1589888,16384,11944960,739456,536870912,115712,295168,11943936,199236,199232,712704,4277272576,1329152,559360,205860,1343488,205952,561152,12075008,224656,0,224256,1327616,11952128,11984896,12017664,11929600,11962368,11995136,11939840,11972608,12005376,12038144,12027904,11950080,11982848,12015616,0,0
.long 3219456,3350528,3481600,3612672,4294967295,4294967295,133376,6590464,3743744,149760,536870912,24576,1264640,1606272,20480,11945984,739584,536870912,230400,299008,12042240,199240,199168,712704,4277272576,1359872,563200,205984,1376256,206080,565248,12189696,225040,0,224256,1344000,11943936,11976704,12009472,11954176,11986944,12019712,11931648,11964416,11997184,12029952,11941888,11974656,12007424,12040192,0,0
.long 3223552,3354624,3485696,3616768,4294967295,4294967295,133376,6592512,3745792,149888,536870912,24576,1321984,1622656,20480,11947008,739712,536870912,345088,299264,12058624,199244,199232,712704,4277272576,1361920,563456,205988,1409024,206208,569344,12304384,225424,0,224256,1360384,11935744,11968512,12001280,12034048,11945984,11978752,12011520,11956224,11988992,12021760,11933696,11966464,11999232,12032000,0,0
.long 3227648,3358720,3489792,3620864,4294967295,4294967295,133632,6594560,3751936,150016,25216,24576,1150080,1639040,24576,11948032,739840,367104,1280,303104,11927552,199248,199168,727040,4277501952,1331200,559616,205864,1310720,205824,557056,11968512,224276,0,224256,1311360,11993088,12025856,11937792,11970560,11927552,11960320,11948032,11980800,12013568,12003328,11958272,11991040,12023808,12036096,0,0
.long 3231744,3362816,3493888,3624960,4294967295,4294967295,133632,6596608,3753984,150144,536870912,24576,1207424,1655424,24576,11949056,739968,536870912,115968,303360,11943936,199252,199232,727040,4277501952,1333248,559872,205868,1343488,205952,561152,12083200,224660,0,224256,1327744,12017664,11929600,11962368,11995136,11952128,11984896,11972608,12005376,12038144,11939840,11950080,11982848,12015616,12027904,0,0
.long 3235840,3366912,3497984,3629056,4294967295,4294967295,133888,6598656,3760128,150272,536870912,24576,1264768,1671808,28672,11950080,740096,536870912,230656,307200,12042240,199256,199168,727040,4277501952,1363968,563712,205992,1376256,206080,565248,12197888,225044,0,224256,1344128,12009472,11954176,11986944,12019712,11943936,11976704,11964416,11997184,12029952,11931648,11974656,12007424,12040192,11941888,0,0
.long 3239936,3371008,3502080,3633152,4294967295,4294967295,133888,6600704,3762176,150400,536870912,24576,1322112,1688192,28672,11951104,740224,536870912,345344,307456,12058624,199260,199232,727040,4277501952,1366016,563968,205996,1409024,206208,569344,12312576,225428,0,224256,1360512,12001280,12034048,11945984,11978752,11935744,11968512,11956224,11988992,12021760,12011520,11966464,11999232,12032000,11933696,0,0
.long 3244032,3375104,3506176,3637248,4294967295,4294967295,134144,6602752,3768320,150528,25344,24576,1150208,1704576,32768,11952128,740352,371200,1536,311296,11927552,199264,199168,741376,4277731328,1335296,560128,205872,1310720,205824,557056,11976704,224280,0,224256,1311488,12025856,11937792,11970560,11927552,11960320,11993088,11980800,12013568,12003328,11948032,11991040,12023808,12036096,11958272,0,0
.long 3248128,3379200,3510272,3641344,4294967295,4294967295,134144,6604800,3770368,150656,536870912,24576,1207552,1720960,32768,11953152,740480,536870912,116224,311552,11943936,199268,199232,741376,4277731328,1337344,560384,205876,1343488,205952,561152,12091392,224664,0,224256,1327872,11929600,11962368,11995136,11952128,11984896,12017664,12005376,12038144,11939840,11972608,11982848,12015616,12027904,11950080,0,0
.long 3252224,3383296,3514368,3645440,4294967295,4294967295,134400,6606848,3776512,150784,536870912,24576,1264896,1737344,36864,11954176,740608,536870912,230912,315392,12042240,199272,199168,741376,4277731328,1368064,564224,206000,1376256,206080,565248,12206080,225048,0,224256,1344256,11954176,11986944,12019712,11943936,11976704,12009472,11997184,12029952,11931648,11964416,12007424,12040192,11941888,11974656,0,0
.long 3256320,3387392,3518464,3649536,4294967295,4294967295,134400,6608896,3778560,150912,536870912,24576,1322240,1753728,36864,11955200,740736,536870912,345600,315648,12058624,199276,199232,741376,4277731328,1370112,564480,206004,1409024,206208,569344,12320768,225432,0,224256,1360640,12034048,11945984,11978752,11935744,11968512,12001280,11988992,12021760,12011520,11956224,11999232,12032000,11933696,11966464,0,0
.long 3260416,3391488,3522560,3653632,4294967295,4294967295,134656,6610944,3784704,151040,25472,24576,1150336,1770112,40960,11956224,740864,375296,1792,319488,11927552,199280,199168,755712,4277960704,1339392,560640,205880,1310720,205824,557056,11984896,224284,0,224256,1311616,11970560,11927552,11960320,11993088,12025856,11937792,12013568,12003328,11948032,11980800,12023808,12036096,11958272,11991040,0,0
.long 3264512,3395584,3526656,3657728,4294967295,4294967295,134656,6612992,3786752,151168,536870912,24576,1207680,1786496,40960,11957248,740992,536870912,116480,319744,11943936,199284,199232,755712,4277960704,1341440,560896,205884,1343488,205952,561152,12099584,224668,0,224256,1328000,11995136,11952128,11984896,12017664,11929600,11962368,12038144,11939840,11972608,12005376,12015616,12027904,11950080,11982848,0,0
.long 3268608,3399680,3530752,3661824,4294967295,4294967295,134912,6615040,3792896,151296,536870912,24576,1265024,1802880,45056,11958272,741120,536870912,231168,323584,12042240,199288,199168,755712,4277960704,1372160,564736,206008,1376256,206080,565248,12214272,225052,0,224256,1344384,12019712,11943936,11976704,12009472,11954176,11986944,12029952,11931648,11964416,11997184,12040192,11941888,11974656,12007424,0,0
.long 3272704,3403776,3534848,3665920,4294967295,4294967295,134912,6617088,3794944,151424,536870912,24576,1322368,1819264,45056,11959296,741248,536870912,345856,323840,12058624,199292,199232,755712,4277960704,1374208,564992,206012,1409024,206208,569344,12328960,225436,0,224256,1360768,11978752,11935744,11968512,12001280,12034048,11945984,12021760,12011520,11956224,11988992,12032000,11933696,11966464,11999232,0,0
.long 3276800,3407872,3538944,3670016,4294967295,4294967295,135168,6619136,3801088,151552,25600,24576,1376256,768,40960,12156928,741376,265216,2048,327680,12156928,199296,199296,655360,4275896320,1376256,565248,206080,1310720,205824,557056,11993088,224288,0,225024,1376256,12222464,12255232,12167168,12199936,12156928,12189696,12177408,12210176,12242944,12232704,12187648,12220416,12253184,12265472,0,0
.long 3280896,3411968,3543040,3674112,4294967295,4294967295,135168,6621184,3803136,151680,536870912,24576,1433600,17152,40960,12157952,741504,536870912,116736,327936,12173312,199300,199360,655360,4275896320,1378304,565504,206084,1343488,205952,561152,12107776,224672,0,225024,1392640,12247040,12158976,12191744,12224512,12181504,12214272,12201984,12234752,12267520,12169216,12179456,12212224,12244992,12257280,0,0
.long 3284992,3416064,3547136,3678208,4294967295,4294967295,135424,6623232,3809280,151808,536870912,24576,1490944,33536,45056,12158976,741632,536870912,231424,331776,12271616,199304,199296,655360,4275896320,1409024,569344,206208,1376256,206080,565248,12222464,225056,0,225024,1409024,12238848,12183552,12216320,12249088,12173312,12206080,12193792,12226560,12259328,12161024,12204032,12236800,12269568,12171264,0,0
.long 3289088,3420160,3551232,3682304,4294967295,4294967295,135424,6625280,3811328,151936,536870912,24576,1548288,49920,45056,12160000,741760,536870912,346112,332032,12288000,199308,199360,655360,4275896320,1411072,569600,206212,1409024,206208,569344,12337152,225440,0,225024,1425408,12230656,12263424,12175360,12208128,12165120,12197888,12185600,12218368,12251136,12240896,12195840,12228608,12261376,12163072,0,0
.long 3293184,3424256,3555328,3686400,4294967295,4294967295,135680,6627328,3817472,152064,25728,24576,1376384,66304,49152,12161024,741888,269312,2304,335872,12156928,199312,199296,669696,4276125696,1380352,565760,206088,1310720,205824,557056,12001280,224292,0,225024,1376384,12255232,12167168,12199936,12156928,12189696,12222464,12210176,12242944,12232704,12177408,12220416,12253184,12265472,12187648,0,0
.long 3297280,3428352,3559424,3690496,4294967295,4294967295,135680,6629376,3819520,152192,536870912,24576,1433728,82688,49152,12162048,742016,536870912,116992,336128,12173312,199316,199360,669696,4276125696,1382400,566016,206092,1343488,205952,561152,12115968,224676,0,225024,1392768,12158976,12191744,12224512,12181504,12214272,12247040,12234752,12267520,12169216,12201984,12212224,12244992,12257280,12179456,0,0
.long 3301376,3432448,3563520,3694592,4294967295,4294967295,135936,6631424,3825664,152320,536870912,24576,1491072,99072,53248,12163072,742144,536870912,231680,339968,12271616,199320,199296,669696,4276125696,1413120,569856,206216,1376256,206080,565248,12230656,225060,0,225024,1409152,12183552,12216320,12249088,12173312,12206080,12238848,12226560,12259328,12161024,12193792,12236800,12269568,12171264,12204032,0,0
.long 3305472,3436544,3567616,3698688,4294967295,4294967295,135936,6633472,3827712,152448,536870912,24576,1548416,115456,53248,12164096,742272,536870912,346368,340224,12288000,199324,199360,669696,4276125696,1415168,570112,206220,1409024,206208,569344,12345344,225444,0,225024,1425536,12263424,12175360,12208128,12165120,12197888,12230656,12218368,12251136,12240896,12185600,12228608,12261376,12163072,12195840,0,0
.long 3309568,3440640,3571712,3702784,4294967295,4294967295,136192,6635520,3833856,152576,25856,24576,1376512,131840,57344,12165120,742400,273408,2560,344064,12156928,199328,199296,684032,4276355072,1384448,566272,206096,1310720,205824,557056,12009472,224296,0,225024,1376512,12199936,12156928,12189696,12222464,12255232,12167168,12242944,12232704,12177408,12210176,12253184,12265472,12187648,12220416,0,0
.long 3313664,3444736,3575808,3706880,4294967295,4294967295,136192,6637568,3835904,152704,536870912,24576,1433856,148224,57344,12166144,742528,536870912,117248,344320,12173312,199332,199360,684032,4276355072,1386496,566528,206100,1343488,205952,561152,12124160,224680,0,225024,1392896,12224512,12181504,12214272,12247040,12158976,12191744,12267520,12169216,12201984,12234752,12244992,12257280,12179456,12212224,0,0
.long 3317760,3448832,3579904,3710976,4294967295,4294967295,136448,6639616,3842048,152832,536870912,24576,1491200,164608,61440,12167168,742656,536870912,231936,348160,12271616,199336,199296,684032,4276355072,1417216,570368,206224,1376256,206080,565248,12238848,225064,0,225024,1409280,12249088,12173312,12206080,12238848,12183552,12216320,12259328,12161024,12193792,12226560,12269568,12171264,12204032,12236800,0,0
.long 3321856,3452928,3584000,3715072,4294967295,4294967295,136448,6641664,3844096,152960,536870912,24576,1548544,180992,61440,12168192,742784,536870912,346624,348416,12288000,199340,199360,684032,4276355072,1419264,570624,206228,1409024,206208,569344,12353536,225448,0,225024,1425664,12208128,12165120,12197888,12230656,12263424,12175360,12251136,12240896,12185600,12218368,12261376,12163072,12195840,12228608,0,0
.long 3325952,3457024,3588096,3719168,4294967295,4294967295,136704,6643712,3850240,153088,25984,24576,1376640,197376,65536,12169216,742912,277504,2816,352256,12156928,199344,199296,698368,4276584448,1388544,566784,206104,1310720,205824,557056,12017664,224300,0,225024,1376640,12156928,12189696,12222464,12255232,12167168,12199936,12232704,12177408,12210176,12242944,12265472,12187648,12220416,12253184,0,0
.long 3330048,3461120,3592192,3723264,4294967295,4294967295,136704,6645760,3852288,153216,536870912,24576,1433984,213760,65536,12170240,743040,536870912,117504,352512,12173312,199348,199360,698368,4276584448,1390592,567040,206108,1343488,205952,561152,12132352,224684,0,225024,1393024,12181504,12214272,12247040,12158976,12191744,12224512,12169216,12201984,12234752,12267520,12257280,12179456,12212224,12244992,0,0
.long 3334144,3465216,3596288,3727360,4294967295,4294967295,136960,6647808,3858432,153344,536870912,24576,1491328,230144,69632,12171264,743168,536870912,232192,356352,12271616,199352,199296,698368,4276584448,1421312,570880,206232,1376256,206080,565248,12247040,225068,0,225024,1409408,12173312,12206080,12238848,12183552,12216320,12249088,12161024,12193792,12226560,12259328,12171264,12204032,12236800,12269568,0,0
.long 3338240,3469312,3600384,3731456,4294967295,4294967295,136960,6649856,3860480,153472,536870912,24576,1548672,246528,69632,12172288,743296,536870912,346880,356608,12288000,199356,199360,698368,4276584448,1423360,571136,206236,1409024,206208,569344,12361728,225452,0,225024,1425792,12165120,12197888,12230656,12263424,12175360,12208128,12240896,12185600,12218368,12251136,12163072,12195840,12228608,12261376,0,0
.long 3342336,3473408,3604480,3735552,4294967295,4294967295,137216,6651904,3866624,153600,26112,24576,1376768,262912,73728,12173312,743424,281600,3072,360448,12156928,199360,199296,712704,4276813824,1392640,567296,206112,1310720,205824,557056,12025856,224304,0,225024,1376768,12222464,12255232,12167168,12199936,12156928,12189696,12177408,12210176,12242944,12232704,12187648,12220416,12253184,12265472,0,0
.long 3346432,3477504,3608576,3739648,4294967295,4294967295,137216,6653952,3868672,153728,536870912,24576,1434112,279296,73728,12174336,743552,536870912,117760,360704,12173312,199364,199360,712704,4276813824,1394688,567552,206116,1343488,205952,561152,12140544,224688,0,225024,1393152,12247040,12158976,12191744,12224512,12181504,12214272,12201984,12234752,12267520,12169216,12179456,12212224,12244992,12257280,0,0
.long 3350528,3481600,3612672,3743744,4294967295,4294967295,137472,6656000,3874816,153856,536870912,24576,1491456,295680,77824,12175360,743680,536870912,232448,364544,12271616,199368,199296,712704,4276813824,1425408,571392,206240,1376256,206080,565248,12255232,225072,0,225024,1409536,12238848,12183552,12216320,12249088,12173312,12206080,12193792,12226560,12259328,12161024,12204032,12236800,12269568,12171264,0,0
.long 3354624,3485696,3616768,3747840,4294967295,4294967295,137472,6658048,3876864,153984,536870912,24576,1548800,312064,77824,12176384,743808,536870912,347136,364800,12288000,199372,199360,712704,4276813824,1427456,571648,206244,1409024,206208,569344,12369920,225456,0,225024,1425920,12230656,12263424,12175360,12208128,12165120,12197888,12185600,12218368,12251136,12240896,12195840,12228608,12261376,12163072,0,0
.long 3358720,3489792,3620864,3751936,4294967295,4294967295,137728,6660096,3883008,154112,26240,24576,1376896,328448,16384,12177408,743936,285696,3328,368640,12156928,199376,199296,727040,4277043200,1396736,567808,206120,1310720,205824,557056,12034048,224308,0,225024,1376896,12255232,12167168,12199936,12156928,12189696,12222464,12210176,12242944,12232704,12177408,12220416,12253184,12265472,12187648,0,0
.long 3362816,3493888,3624960,3756032,4294967295,4294967295,137728,6662144,3885056,154240,536870912,24576,1434240,344832,16384,12178432,744064,536870912,118016,368896,12173312,199380,199360,727040,4277043200,1398784,568064,206124,1343488,205952,561152,12148736,224692,0,225024,1393280,12158976,12191744,12224512,12181504,12214272,12247040,12234752,12267520,12169216,12201984,12212224,12244992,12257280,12179456,0,0
.long 3366912,3497984,3629056,3760128,4294967295,4294967295,137984,6664192,3891200,154368,536870912,24576,1491584,361216,20480,12179456,744192,536870912,232704,372736,12271616,199384,199296,727040,4277043200,1429504,571904,206248,1376256,206080,565248,12263424,225076,0,225024,1409664,12183552,12216320,12249088,12173312,12206080,12238848,12226560,12259328,12161024,12193792,12236800,12269568,12171264,12204032,0,0
.long 3371008,3502080,3633152,3764224,4294967295,4294967295,137984,6666240,3893248,154496,536870912,24576,1548928,377600,20480,12180480,744320,536870912,347392,372992,12288000,199388,199360,727040,4277043200,1431552,572160,206252,1409024,206208,569344,12378112,225460,0,225024,1426048,12263424,12175360,12208128,12165120,12197888,12230656,12218368,12251136,12240896,12185600,12228608,12261376,12163072,12195840,0,0
.long 3375104,3506176,3637248,3768320,4294967295,4294967295,138240,6668288,3899392,154624,26368,24576,1377024,393984,24576,12181504,744448,289792,3328,368640,12156928,199392,199296,741376,4277272576,1400832,568320,206128,1310720,205824,557056,536870912,536870912,5242880,225024,1377024,12199936,12156928,12189696,12222464,12255232,12167168,12242944,12232704,12177408,12210176,12253184,12265472,12187648,12220416,0,0
.long 3379200,3510272,3641344,3772416,4294967295,4294967295,138240,6670336,3901440,154752,536870912,24576,1434368,410368,24576,12182528,744576,536870912,118016,368896,12173312,199396,199360,741376,4277272576,1402880,568576,206132,1343488,205952,561152,536870912,536870912,5242880,225024,1393408,12224512,12181504,12214272,12247040,12158976,12191744,12267520,12169216,12201984,12234752,12244992,12257280,12179456,12212224,0,0
.long 3383296,3514368,3645440,3776512,4294967295,4294967295,138496,6672384,3907584,154880,536870912,24576,1491712,426752,28672,12183552,744704,536870912,232704,372736,12271616,199400,199296,741376,4277272576,1433600,572416,206256,1376256,206080,565248,536870912,536870912,5242880,225024,1409792,12249088,12173312,12206080,12238848,12183552,12216320,12259328,12161024,12193792,12226560,12269568,12171264,12204032,12236800,0,0
.long 3387392,3518464,3649536,3780608,4294967295,4294967295,138496,6674432,3909632,155008,536870912,24576,1549056,443136,28672,12184576,744832,536870912,347392,372992,12288000,199404,199360,741376,4277272576,1435648,572672,206260,1409024,206208,569344,536870912,536870912,5242880,225024,1426176,12208128,12165120,12197888,12230656,12263424,12175360,12251136,12240896,12185600,12218368,12261376,12163072,12195840,12228608,0,0
.long 3391488,3522560,3653632,3784704,4294967295,4294967295,138752,6676480,3915776,155136,26496,24576,1377152,459520,32768,12185600,744960,293888,3328,368640,12156928,199408,199296,755712,4277501952,1404928,568832,206136,1310720,205824,557056,536870912,536870912,5701632,225024,1377152,12156928,12189696,12222464,12255232,12167168,12199936,12232704,12177408,12210176,12242944,12265472,12187648,12220416,12253184,0,0
.long 3395584,3526656,3657728,3788800,4294967295,4294967295,138752,6678528,3917824,155264,536870912,24576,1434496,475904,32768,12186624,745088,536870912,118016,368896,12173312,199412,199360,755712,4277501952,1406976,569088,206140,1343488,205952,561152,536870912,536870912,5701632,225024,1393536,12181504,12214272,12247040,12158976,12191744,12224512,12169216,12201984,12234752,12267520,12257280,12179456,12212224,12244992,0,0
.long 3399680,3530752,3661824,3792896,4294967295,4294967295,139008,6680576,3923968,155392,536870912,24576,1491840,492288,36864,12187648,745216,536870912,232704,372736,12271616,199416,199296,755712,4277501952,1437696,572928,206264,1376256,206080,565248,536870912,536870912,5701632,225024,1409920,12173312,12206080,12238848,12183552,12216320,12249088,12161024,12193792,12226560,12259328,12171264,12204032,12236800,12269568,0,0
.long 3403776,3534848,3665920,3796992,4294967295,4294967295,139008,6682624,3926016,155520,536870912,24576,1549184,508672,36864,12188672,745344,536870912,347392,372992,12288000,199420,199360,755712,4277501952,1439744,573184,206268,1409024,206208,569344,536870912,536870912,5701632,225024,1426304,12165120,12197888,12230656,12263424,12175360,12208128,12240896,12185600,12218368,12251136,12163072,12195840,12228608,12261376,0,0
.long 3407872,3538944,3670016,3801088,4294967295,4294967295,139264,6684672,3932160,155648,26624,26624,1377280,525056,32768,12386304,745472,297984,0,262144,12386304,199424,199424,655360,4275437568,1441792,573440,206336,1441792,206336,573440,12386304,225792,0,225792,1441792,12484608,12396544,12429312,12386304,12419072,12451840,12439552,12472320,12462080,12406784,12449792,12482560,12494848,12417024,0,0
.long 3411968,3543040,3674112,3805184,4294967295,4294967295,139264,6686720,3934208,155776,536870912,26624,1434624,541440,32768,12387328,745600,536870912,114688,262400,12402688,199428,199488,655360,4275437568,1443840,573696,206340,1474560,206464,577536,12500992,226176,0,225792,1458176,12388352,12421120,12453888,12410880,12443648,12476416,12464128,12496896,12398592,12431360,12441600,12474368,12486656,12408832,0,0
.long 3416064,3547136,3678208,3809280,4294967295,4294967295,139520,6688768,3940352,155904,536870912,26624,1491968,557824,36864,12388352,745728,536870912,229376,266240,12500992,199432,199424,655360,4275437568,1474560,577536,206464,1507328,206592,581632,12615680,226560,0,225792,1474560,12412928,12445696,12478464,12402688,12435456,12468224,12455936,12488704,12390400,12423168,12466176,12498944,12400640,12433408,0,0
.long 3420160,3551232,3682304,3813376,4294967295,4294967295,139520,6690816,3942400,156032,536870912,26624,1549312,574208,36864,12389376,745856,536870912,344064,266496,12517376,199436,199488,655360,4275437568,1476608,577792,206468,1540096,206720,585728,12730368,226944,0,225792,1490944,12492800,12404736,12437504,12394496,12427264,12460032,12447744,12480512,12470272,12414976,12457984,12490752,12392448,12425216,0,0
.long 3424256,3555328,3686400,3817472,4294967295,4294967295,139776,6692864,3948544,156160,26752,26624,1377408,590592,40960,12390400,745984,302080,256,270336,12386304,199440,199424,669696,4275666944,1445888,573952,206344,1441792,206336,573440,12394496,225796,0,225792,1441920,12429312,12386304,12419072,12451840,12484608,12396544,12472320,12462080,12406784,12439552,12482560,12494848,12417024,12449792,0,0
.long 3428352,3559424,3690496,3821568,4294967295,4294967295,139776,6694912,3950592,156288,536870912,26624,1434752,606976,40960,12391424,746112,536870912,114944,270592,12402688,199444,199488,669696,4275666944,1447936,574208,206348,1474560,206464,577536,12509184,226180,0,225792,1458304,12453888,12410880,12443648,12476416,12388352,12421120,12496896,12398592,12431360,12464128,12474368,12486656,12408832,12441600,0,0
.long 3432448,3563520,3694592,3825664,4294967295,4294967295,140032,6696960,3956736,156416,536870912,26624,1492096,623360,45056,12392448,746240,536870912,229632,274432,12500992,199448,199424,669696,4275666944,1478656,578048,206472,1507328,206592,581632,12623872,226564,0,225792,1474688,12478464,12402688,12435456,12468224,12412928,12445696,12488704,12390400,12423168,12455936,12498944,12400640,12433408,12466176,0,0
.long 3436544,3567616,3698688,3829760,4294967295,4294967295,140032,6699008,3958784,156544,536870912,26624,1549440,639744,45056,12393472,746368,536870912,344320,274688,12517376,199452,199488,669696,4275666944,1480704,578304,206476,1540096,206720,585728,12738560,226948,0,225792,1491072,12437504,12394496,12427264,12460032,12492800,12404736,12480512,12470272,12414976,12447744,12490752,12392448,12425216,12457984,0,0
.long 3440640,3571712,3702784,3833856,4294967295,4294967295,140288,6701056,3964928,156672,26880,26624,1377536,656128,49152,12394496,746496,306176,512,278528,12386304,199456,199424,684032,4275896320,1449984,574464,206352,1441792,206336,573440,12402688,225800,0,225792,1442048,12386304,12419072,12451840,12484608,12396544,12429312,12462080,12406784,12439552,12472320,12494848,12417024,12449792,12482560,0,0
.long 3444736,3575808,3706880,3837952,4294967295,4294967295,140288,6703104,3966976,156800,536870912,26624,1434880,672512,49152,12395520,746624,536870912,115200,278784,12402688,199460,199488,684032,4275896320,1452032,574720,206356,1474560,206464,577536,12517376,226184,0,225792,1458432,12410880,12443648,12476416,12388352,12421120,12453888,12398592,12431360,12464128,12496896,12486656,12408832,12441600,12474368,0,0
.long 3448832,3579904,3710976,3842048,4294967295,4294967295,140544,6705152,3973120,156928,536870912,26624,1492224,688896,53248,12396544,746752,536870912,229888,282624,12500992,199464,199424,684032,4275896320,1482752,578560,206480,1507328,206592,581632,12632064,226568,0,225792,1474816,12402688,12435456,12468224,12412928,12445696,12478464,12390400,12423168,12455936,12488704,12400640,12433408,12466176,12498944,0,0
.long 3452928,3584000,3715072,3846144,4294967295,4294967295,140544,6707200,3975168,157056,536870912,26624,1549568,705280,53248,12397568,746880,536870912,344576,282880,12517376,199468,199488,684032,4275896320,1484800,578816,206484,1540096,206720,585728,12746752,226952,0,225792,1491200,12394496,12427264,12460032,12492800,12404736,12437504,12470272,12414976,12447744,12480512,12392448,12425216,12457984,12490752,0,0
.long 3457024,3588096,3719168,3850240,4294967295,4294967295,140800,6709248,3981312,157184,27008,26624,1377664,721664,57344,12398592,747008,310272,768,286720,12386304,199472,199424,698368,4276125696,1454080,574976,206360,1441792,206336,573440,12410880,225804,0,225792,1442176,12451840,12484608,12396544,12429312,12386304,12419072,12406784,12439552,12472320,12462080,12417024,12449792,12482560,12494848,0,0
.long 3461120,3592192,3723264,3854336,4294967295,4294967295,140800,6711296,3983360,157312,536870912,26624,1435008,738048,57344,12399616,747136,536870912,115456,286976,12402688,199476,199488,698368,4276125696,1456128,575232,206364,1474560,206464,577536,12525568,226188,0,225792,1458560,12476416,12388352,12421120,12453888,12410880,12443648,12431360,12464128,12496896,12398592,12408832,12441600,12474368,12486656,0,0
.long 3465216,3596288,3727360,3858432,4294967295,4294967295,141056,6713344,3989504,157440,536870912,26624,1492352,754432,61440,12400640,747264,536870912,230144,290816,12500992,199480,199424,698368,4276125696,1486848,579072,206488,1507328,206592,581632,12640256,226572,0,225792,1474944,12468224,12412928,12445696,12478464,12402688,12435456,12423168,12455936,12488704,12390400,12433408,12466176,12498944,12400640,0,0
.long 3469312,3600384,3731456,3862528,4294967295,4294967295,141056,6715392,3991552,157568,536870912,26624,1549696,770816,61440,12401664,747392,536870912,344832,291072,12517376,199484,199488,698368,4276125696,1488896,579328,206492,1540096,206720,585728,12754944,226956,0,225792,1491328,12460032,12492800,12404736,12437504,12394496,12427264,12414976,12447744,12480512,12470272,12425216,12457984,12490752,12392448,0,0
.long 3473408,3604480,3735552,3866624,4294967295,4294967295,141312,6717440,3997696,157696,27136,26624,1377792,787200,65536,12402688,747520,314368,1024,294912,12386304,199488,199424,712704,4276355072,1458176,575488,206368,1441792,206336,573440,12419072,225808,0,225792,1442304,12484608,12396544,12429312,12386304,12419072,12451840,12439552,12472320,12462080,12406784,12449792,12482560,12494848,12417024,0,0
.long 3477504,3608576,3739648,3870720,4294967295,4294967295,141312,6719488,3999744,157824,536870912,26624,1435136,803584,65536,12403712,747648,536870912,115712,295168,12402688,199492,199488,712704,4276355072,1460224,575744,206372,1474560,206464,577536,12533760,226192,0,225792,1458688,12388352,12421120,12453888,12410880,12443648,12476416,12464128,12496896,12398592,12431360,12441600,12474368,12486656,12408832,0,0
.long 3481600,3612672,3743744,3874816,4294967295,4294967295,141568,6721536,4005888,157952,536870912,26624,1492480,819968,69632,12404736,747776,536870912,230400,299008,12500992,199496,199424,712704,4276355072,1490944,579584,206496,1507328,206592,581632,12648448,226576,0,225792,1475072,12412928,12445696,12478464,12402688,12435456,12468224,12455936,12488704,12390400,12423168,12466176,12498944,12400640,12433408,0,0
.long 3485696,3616768,3747840,3878912,4294967295,4294967295,141568,6723584,4007936,158080,536870912,26624,1549824,836352,69632,12405760,747904,536870912,345088,299264,12517376,199500,199488,712704,4276355072,1492992,579840,206500,1540096,206720,585728,12763136,226960,0,225792,1491456,12492800,12404736,12437504,12394496,12427264,12460032,12447744,12480512,12470272,12414976,12457984,12490752,12392448,12425216,0,0
.long 3489792,3620864,3751936,3883008,4294967295,4294967295,141824,6725632,4014080,158208,27264,26624,1377920,852736,73728,12406784,748032,318464,1280,303104,12386304,199504,199424,727040,4276584448,1462272,576000,206376,1441792,206336,573440,12427264,225812,0,225792,1442432,12429312,12386304,12419072,12451840,12484608,12396544,12472320,12462080,12406784,12439552,12482560,12494848,12417024,12449792,0,0
.long 3493888,3624960,3756032,3887104,4294967295,4294967295,141824,6727680,4016128,158336,536870912,26624,1435264,869120,73728,12407808,748160,536870912,115968,303360,12402688,199508,199488,727040,4276584448,1464320,576256,206380,1474560,206464,577536,12541952,226196,0,225792,1458816,12453888,12410880,12443648,12476416,12388352,12421120,12496896,12398592,12431360,12464128,12474368,12486656,12408832,12441600,0,0
.long 3497984,3629056,3760128,3891200,4294967295,4294967295,142080,6729728,4022272,158464,536870912,26624,1492608,885504,77824,12408832,748288,536870912,230656,307200,12500992,199512,199424,727040,4276584448,1495040,580096,206504,1507328,206592,581632,12656640,226580,0,225792,1475200,12478464,12402688,12435456,12468224,12412928,12445696,12488704,12390400,12423168,12455936,12498944,12400640,12433408,12466176,0,0
.long 3502080,3633152,3764224,3895296,4294967295,4294967295,142080,6731776,4024320,158592,536870912,26624,1549952,901888,77824,12409856,748416,536870912,345344,307456,12517376,199516,199488,727040,4276584448,1497088,580352,206508,1540096,206720,585728,12771328,226964,0,225792,1491584,12437504,12394496,12427264,12460032,12492800,12404736,12480512,12470272,12414976,12447744,12490752,12392448,12425216,12457984,0,0
.long 3506176,3637248,3768320,3899392,4294967295,4294967295,142336,6733824,4030464,158720,27392,26624,1378048,918272,16384,12410880,748544,322560,1536,311296,12386304,199520,199424,741376,4276813824,1466368,576512,206384,1441792,206336,573440,12435456,225816,0,225792,1442560,12386304,12419072,12451840,12484608,12396544,12429312,12462080,12406784,12439552,12472320,12494848,12417024,12449792,12482560,0,0
.long 3510272,3641344,3772416,3903488,4294967295,4294967295,142336,6735872,4032512,158848,536870912,26624,1435392,934656,16384,12411904,748672,536870912,116224,311552,12402688,199524,199488,741376,4276813824,1468416,576768,206388,1474560,206464,577536,12550144,226200,0,225792,1458944,12410880,12443648,12476416,12388352,12421120,12453888,12398592,12431360,12464128,12496896,12486656,12408832,12441600,12474368,0,0
.long 3514368,3645440,3776512,3907584,4294967295,4294967295,142592,6737920,4038656,158976,536870912,26624,1492736,951040,20480,12412928,748800,536870912,230912,315392,12500992,199528,199424,741376,4276813824,1499136,580608,206512,1507328,206592,581632,12664832,226584,0,225792,1475328,12402688,12435456,12468224,12412928,12445696,12478464,12390400,12423168,12455936,12488704,12400640,12433408,12466176,12498944,0,0
.long 3518464,3649536,3780608,3911680,4294967295,4294967295,142592,6739968,4040704,159104,536870912,26624,1550080,967424,20480,12413952,748928,536870912,345600,315648,12517376,199532,199488,741376,4276813824,1501184,580864,206516,1540096,206720,585728,12779520,226968,0,225792,1491712,12394496,12427264,12460032,12492800,12404736,12437504,12470272,12414976,12447744,12480512,12392448,12425216,12457984,12490752,0,0
.long 3522560,3653632,3784704,3915776,4294967295,4294967295,142848,6742016,4046848,159232,27520,26624,1378176,983808,24576,12414976,749056,326656,1792,319488,12386304,199536,199424,755712,4277043200,1470464,577024,206392,1441792,206336,573440,12443648,225820,0,225792,1442688,12451840,12484608,12396544,12429312,12386304,12419072,12406784,12439552,12472320,12462080,12417024,12449792,12482560,12494848,0,0
.long 3526656,3657728,3788800,3919872,4294967295,4294967295,142848,6744064,4048896,159360,536870912,26624,1435520,1000192,24576,12416000,749184,536870912,116480,319744,12402688,199540,199488,755712,4277043200,1472512,577280,206396,1474560,206464,577536,12558336,226204,0,225792,1459072,12476416,12388352,12421120,12453888,12410880,12443648,12431360,12464128,12496896,12398592,12408832,12441600,12474368,12486656,0,0
.long 3530752,3661824,3792896,3923968,4294967295,4294967295,143104,6746112,4055040,159488,536870912,26624,1492864,1016576,28672,12417024,749312,536870912,231168,323584,12500992,199544,199424,755712,4277043200,1503232,581120,206520,1507328,206592,581632,12673024,226588,0,225792,1475456,12468224,12412928,12445696,12478464,12402688,12435456,12423168,12455936,12488704,12390400,12433408,12466176,12498944,12400640,0,0
.long 3534848,3665920,3796992,3928064,4294967295,4294967295,143104,6748160,4057088,159616,536870912,26624,1550208,1032960,28672,12418048,749440,536870912,345856,323840,12517376,199548,199488,755712,4277043200,1505280,581376,206524,1540096,206720,585728,12787712,226972,0,225792,1491840,12460032,12492800,12404736,12437504,12394496,12427264,12414976,12447744,12480512,12470272,12425216,12457984,12490752,12392448,0,0
.long 3538944,3670016,3801088,3932160,4294967295,4294967295,143360,6750208,4063232,159744,27648,26624,1378304,1049344,24576,12615680,749568,330752,2048,327680,12615680,199552,199552,655360,4274978816,1507328,581632,206592,1441792,206336,573440,12451840,225824,0,226560,1507328,12658688,12615680,12648448,12681216,12713984,12625920,12701696,12691456,12636160,12668928,12711936,12724224,12646400,12679168,0,0
.long 3543040,3674112,3805184,3936256,4294967295,4294967295,143360,6752256,4065280,159872,536870912,26624,1435648,1065728,24576,12616704,749696,536870912,116736,327936,12632064,199556,199616,655360,4274978816,1509376,581888,206596,1474560,206464,577536,12566528,226208,0,226560,1523712,12683264,12640256,12673024,12705792,12617728,12650496,12726272,12627968,12660736,12693504,12703744,12716032,12638208,12670976,0,0
.long 3547136,3678208,3809280,3940352,4294967295,4294967295,143616,6754304,4071424,160000,536870912,26624,1492992,1082112,28672,12617728,749824,536870912,231424,331776,12730368,199560,199552,655360,4274978816,1540096,585728,206720,1507328,206592,581632,12681216,226592,0,226560,1540096,12707840,12632064,12664832,12697600,12642304,12675072,12718080,12619776,12652544,12685312,12728320,12630016,12662784,12695552,0,0
.long 3551232,3682304,3813376,3944448,4294967295,4294967295,143616,6756352,4073472,160128,536870912,26624,1550336,1098496,28672,12618752,749952,536870912,346112,332032,12746752,199564,199616,655360,4274978816,1542144,585984,206724,1540096,206720,585728,12795904,226976,0,226560,1556480,12666880,12623872,12656640,12689408,12722176,12634112,12709888,12699648,12644352,12677120,12720128,12621824,12654592,12687360,0,0
.long 3555328,3686400,3817472,3948544,4294967295,4294967295,143872,6758400,4079616,160256,27776,26624,1378432,1114880,32768,12619776,750080,334848,2304,335872,12615680,199568,199552,669696,4275208192,1511424,582144,206600,1441792,206336,573440,12460032,225828,0,226560,1507456,12615680,12648448,12681216,12713984,12625920,12658688,12691456,12636160,12668928,12701696,12724224,12646400,12679168,12711936,0,0
.long 3559424,3690496,3821568,3952640,4294967295,4294967295,143872,6760448,4081664,160384,536870912,26624,1435776,1131264,32768,12620800,750208,536870912,116992,336128,12632064,199572,199616,669696,4275208192,1513472,582400,206604,1474560,206464,577536,12574720,226212,0,226560,1523840,12640256,12673024,12705792,12617728,12650496,12683264,12627968,12660736,12693504,12726272,12716032,12638208,12670976,12703744,0,0
.long 3563520,3694592,3825664,3956736,4294967295,4294967295,144128,6762496,4087808,160512,536870912,26624,1493120,1147648,36864,12621824,750336,536870912,231680,339968,12730368,199576,199552,669696,4275208192,1544192,586240,206728,1507328,206592,581632,12689408,226596,0,226560,1540224,12632064,12664832,12697600,12642304,12675072,12707840,12619776,12652544,12685312,12718080,12630016,12662784,12695552,12728320,0,0
.long 3567616,3698688,3829760,3960832,4294967295,4294967295,144128,6764544,4089856,160640,536870912,26624,1550464,1164032,36864,12622848,750464,536870912,346368,340224,12746752,199580,199616,669696,4275208192,1546240,586496,206732,1540096,206720,585728,12804096,226980,0,226560,1556608,12623872,12656640,12689408,12722176,12634112,12666880,12699648,12644352,12677120,12709888,12621824,12654592,12687360,12720128,0,0
.long 3571712,3702784,3833856,3964928,4294967295,4294967295,144384,6766592,4096000,160768,27904,26624,1378560,1180416,40960,12623872,750592,338944,2560,344064,12615680,199584,199552,684032,4275437568,1515520,582656,206608,1441792,206336,573440,12468224,225832,0,226560,1507584,12681216,12713984,12625920,12658688,12615680,12648448,12636160,12668928,12701696,12691456,12646400,12679168,12711936,12724224,0,0
.long 3575808,3706880,3837952,3969024,4294967295,4294967295,144384,6768640,4098048,160896,536870912,26624,1435904,1196800,40960,12624896,750720,536870912,117248,344320,12632064,199588,199616,684032,4275437568,1517568,582912,206612,1474560,206464,577536,12582912,226216,0,226560,1523968,12705792,12617728,12650496,12683264,12640256,12673024,12660736,12693504,12726272,12627968,12638208,12670976,12703744,12716032,0,0
.long 3579904,3710976,3842048,3973120,4294967295,4294967295,144640,6770688,4104192,161024,536870912,26624,1493248,1213184,45056,12625920,750848,536870912,231936,348160,12730368,199592,199552,684032,4275437568,1548288,586752,206736,1507328,206592,581632,12697600,226600,0,226560,1540352,12697600,12642304,12675072,12707840,12632064,12664832,12652544,12685312,12718080,12619776,12662784,12695552,12728320,12630016,0,0
.long 3584000,3715072,3846144,3977216,4294967295,4294967295,144640,6772736,4106240,161152,536870912,26624,1550592,1229568,45056,12626944,750976,536870912,346624,348416,12746752,199596,199616,684032,4275437568,1550336,587008,206740,1540096,206720,585728,12812288,226984,0,226560,1556736,12689408,12722176,12634112,12666880,12623872,12656640,12644352,12677120,12709888,12699648,12654592,12687360,12720128,12621824,0,0
.long 3588096,3719168,3850240,3981312,4294967295,4294967295,144896,6774784,4112384,161280,28032,26624,1378688,1245952,49152,12627968,751104,343040,2816,352256,12615680,199600,199552,698368,4275666944,1519616,583168,206616,1441792,206336,573440,12476416,225836,0,226560,1507712,12713984,12625920,12658688,12615680,12648448,12681216,12668928,12701696,12691456,12636160,12679168,12711936,12724224,12646400,0,0
.long 3592192,3723264,3854336,3985408,4294967295,4294967295,144896,6776832,4114432,161408,536870912,26624,1436032,1262336,49152,12628992,751232,536870912,117504,352512,12632064,199604,199616,698368,4275666944,1521664,583424,206620,1474560,206464,577536,12591104,226220,0,226560,1524096,12617728,12650496,12683264,12640256,12673024,12705792,12693504,12726272,12627968,12660736,12670976,12703744,12716032,12638208,0,0
.long 3596288,3727360,3858432,3989504,4294967295,4294967295,145152,6778880,4120576,161536,536870912,26624,1493376,1278720,53248,12630016,751360,536870912,232192,356352,12730368,199608,199552,698368,4275666944,1552384,587264,206744,1507328,206592,581632,12705792,226604,0,226560,1540480,12642304,12675072,12707840,12632064,12664832,12697600,12685312,12718080,12619776,12652544,12695552,12728320,12630016,12662784,0,0
.long 3600384,3731456,3862528,3993600,4294967295,4294967295,145152,6780928,4122624,161664,536870912,26624,1550720,1295104,53248,12631040,751488,536870912,346880,356608,12746752,199612,199616,698368,4275666944,1554432,587520,206748,1540096,206720,585728,12820480,226988,0,226560,1556864,12722176,12634112,12666880,12623872,12656640,12689408,12677120,12709888,12699648,12644352,12687360,12720128,12621824,12654592,0,0
.long 3604480,3735552,3866624,3997696,4294967295,4294967295,145408,6782976,4128768,161792,28160,26624,1378816,1311488,57344,12632064,751616,347136,3072,360448,12615680,199616,199552,712704,4275896320,1523712,583680,206624,1441792,206336,573440,12484608,225840,0,226560,1507840,12658688,12615680,12648448,12681216,12713984,12625920,12701696,12691456,12636160,12668928,12711936,12724224,12646400,12679168,0,0
.long 3608576,3739648,3870720,4001792,4294967295,4294967295,145408,6785024,4130816,161920,536870912,26624,1436160,1327872,57344,12633088,751744,536870912,117760,360704,12632064,199620,199616,712704,4275896320,1525760,583936,206628,1474560,206464,577536,12599296,226224,0,226560,1524224,12683264,12640256,12673024,12705792,12617728,12650496,12726272,12627968,12660736,12693504,12703744,12716032,12638208,12670976,0,0
.long 3612672,3743744,3874816,4005888,4294967295,4294967295,145664,6787072,4136960,162048,536870912,26624,1493504,1344256,61440,12634112,751872,536870912,232448,364544,12730368,199624,199552,712704,4275896320,1556480,587776,206752,1507328,206592,581632,12713984,226608,0,226560,1540608,12707840,12632064,12664832,12697600,12642304,12675072,12718080,12619776,12652544,12685312,12728320,12630016,12662784,12695552,0,0
.long 3616768,3747840,3878912,4009984,4294967295,4294967295,145664,6789120,4139008,162176,536870912,26624,1550848,1360640,61440,12635136,752000,536870912,347136,364800,12746752,199628,199616,712704,4275896320,1558528,588032,206756,1540096,206720,585728,12828672,226992,0,226560,1556992,12666880,12623872,12656640,12689408,12722176,12634112,12709888,12699648,12644352,12677120,12720128,12621824,12654592,12687360,0,0
.long 3620864,3751936,3883008,4014080,4294967295,4294967295,145920,6791168,4145152,162304,28288,26624,1378944,1377024,65536,12636160,752128,351232,3328,368640,12615680,199632,199552,727040,4276125696,1527808,584192,206632,1441792,206336,573440,12492800,225844,0,226560,1507968,12615680,12648448,12681216,12713984,12625920,12658688,12691456,12636160,12668928,12701696,12724224,12646400,12679168,12711936,0,0
.long 3624960,3756032,3887104,4018176,4294967295,4294967295,145920,6793216,4147200,162432,536870912,26624,1436288,1393408,65536,12637184,752256,536870912,118016,368896,12632064,199636,199616,727040,4276125696,1529856,584448,206636,1474560,206464,577536,12607488,226228,0,226560,1524352,12640256,12673024,12705792,12617728,12650496,12683264,12627968,12660736,12693504,12726272,12716032,12638208,12670976,12703744,0,0
.long 3629056,3760128,3891200,4022272,4294967295,4294967295,146176,6795264,4153344,162560,536870912,26624,1493632,1409792,69632,12638208,752384,536870912,232704,372736,12730368,199640,199552,727040,4276125696,1560576,588288,206760,1507328,206592,581632,12722176,226612,0,226560,1540736,12632064,12664832,12697600,12642304,12675072,12707840,12619776,12652544,12685312,12718080,12630016,12662784,12695552,12728320,0,0
.long 3633152,3764224,3895296,4026368,4294967295,4294967295,146176,6797312,4155392,162688,536870912,26624,1550976,1426176,69632,12639232,752512,536870912,347392,372992,12746752,199644,199616,727040,4276125696,1562624,588544,206764,1540096,206720,585728,12836864,226996,0,226560,1557120,12623872,12656640,12689408,12722176,12634112,12666880,12699648,12644352,12677120,12709888,12621824,12654592,12687360,12720128,0,0
.long 3637248,3768320,3899392,4030464,4294967295,4294967295,146432,6799360,4161536,162816,28416,26624,1379072,1442560,73728,12640256,752640,355328,3328,368640,12615680,199648,199552,741376,4276355072,1531904,584704,206640,1441792,206336,573440,536870912,536870912,6160384,226560,1508096,12681216,12713984,12625920,12658688,12615680,12648448,12636160,12668928,12701696,12691456,12646400,12679168,12711936,12724224,0,0
.long 3641344,3772416,3903488,4034560,4294967295,4294967295,146432,6801408,4163584,162944,536870912,26624,1436416,1458944,73728,12641280,752768,536870912,118016,368896,12632064,199652,199616,741376,4276355072,1533952,584960,206644,1474560,206464,577536,536870912,536870912,6160384,226560,1524480,12705792,12617728,12650496,12683264,12640256,12673024,12660736,12693504,12726272,12627968,12638208,12670976,12703744,12716032,0,0
.long 3645440,3776512,3907584,4038656,4294967295,4294967295,146688,6803456,4169728,163072,536870912,26624,1493760,1475328,77824,12642304,752896,536870912,232704,372736,12730368,199656,199552,741376,4276355072,1564672,588800,206768,1507328,206592,581632,536870912,536870912,6160384,226560,1540864,12697600,12642304,12675072,12707840,12632064,12664832,12652544,12685312,12718080,12619776,12662784,12695552,12728320,12630016,0,0
.long 3649536,3780608,3911680,4042752,4294967295,4294967295,146688,6805504,4171776,163200,536870912,26624,1551104,1491712,77824,12643328,753024,536870912,347392,372992,12746752,199660,199616,741376,4276355072,1566720,589056,206772,1540096,206720,585728,536870912,536870912,6160384,226560,1557248,12689408,12722176,12634112,12666880,12623872,12656640,12644352,12677120,12709888,12699648,12654592,12687360,12720128,12621824,0,0
.long 3653632,3784704,3915776,4046848,4294967295,4294967295,146944,6807552,4177920,163328,28544,26624,1379200,1508096,16384,12644352,753152,359424,3328,368640,12615680,199664,199552,755712,4276584448,1536000,585216,206648,1441792,206336,573440,536870912,536870912,6619136,226560,1508224,12713984,12625920,12658688,12615680,12648448,12681216,12668928,12701696,12691456,12636160,12679168,12711936,12724224,12646400,0,0
.long 3657728,3788800,3919872,4050944,4294967295,4294967295,146944,6809600,4179968,163456,536870912,26624,1436544,1524480,16384,12645376,753280,536870912,118016,368896,12632064,199668,199616,755712,4276584448,1538048,585472,206652,1474560,206464,577536,536870912,536870912,6619136,226560,1524608,12617728,12650496,12683264,12640256,12673024,12705792,12693504,12726272,12627968,12660736,12670976,12703744,12716032,12638208,0,0
.long 3661824,3792896,3923968,4055040,4294967295,4294967295,147200,6811648,4186112,163584,536870912,26624,1493888,1540864,20480,12646400,753408,536870912,232704,372736,12730368,199672,199552,755712,4276584448,1568768,589312,206776,1507328,206592,581632,536870912,536870912,6619136,226560,1540992,12642304,12675072,12707840,12632064,12664832,12697600,12685312,12718080,12619776,12652544,12695552,12728320,12630016,12662784,0,0
.long 3665920,3796992,3928064,4059136,4294967295,4294967295,147200,6813696,4188160,163712,536870912,26624,1551232,1557248,20480,12647424,753536,536870912,347392,372992,12746752,199676,199616,755712,4276584448,1570816,589568,206780,1540096,206720,585728,536870912,536870912,6619136,226560,1557376,12722176,12634112,12666880,12623872,12656640,12689408,12677120,12709888,12699648,12644352,12687360,12720128,12621824,12654592,0,0
.long 3670016,3801088,3932160,4063232,4294967295,4294967295,147456,6815744,4194304,163840,28672,28672,1379328,1573632,16384,12845056,753664,363520,0,262144,12845056,199680,199680,655360,4274520064,1572864,589824,206848,1572864,206848,589824,12845056,227328,0,227328,1572864,12845056,12877824,12910592,12943360,12855296,12888064,12920832,12865536,12898304,12931072,12953600,12875776,12908544,12941312,0,0
.long 3674112,3805184,3936256,4067328,4294967295,4294967295,147456,6817792,4196352,163968,536870912,28672,1436672,1590016,16384,12846080,753792,536870912,114688,262400,12861440,199684,199744,655360,4274520064,1574912,590080,206852,1605632,206976,593920,12959744,227712,0,227328,1589248,12869632,12902400,12935168,12847104,12879872,12912640,12857344,12890112,12922880,12955648,12945408,12867584,12900352,12933120,0,0
.long 3678208,3809280,3940352,4071424,4294967295,4294967295,147712,6819840,4202496,164096,536870912,28672,1494016,1606400,20480,12847104,753920,536870912,229376,266240,12959744,199688,199680,655360,4274520064,1605632,593920,206976,1638400,207104,598016,13074432,228096,0,227328,1605632,12861440,12894208,12926976,12871680,12904448,12937216,12849152,12881920,12914688,12947456,12859392,12892160,12924928,12957696,0,0
.long 3682304,3813376,3944448,4075520,4294967295,4294967295,147712,6821888,4204544,164224,536870912,28672,1551360,1622784,20480,12848128,754048,536870912,344064,266496,12976128,199692,199744,655360,4274520064,1607680,594176,206980,1671168,207232,602112,13189120,228480,0,227328,1622016,12853248,12886016,12918784,12951552,12863488,12896256,12929024,12873728,12906496,12939264,12851200,12883968,12916736,12949504,0,0
.long 3686400,3817472,3948544,4079616,4294967295,4294967295,147968,6823936,4210688,164352,28800,28672,1379456,1639168,24576,12849152,754176,367616,256,270336,12845056,199696,199680,669696,4274749440,1576960,590336,206856,1572864,206848,589824,12853248,227332,0,227328,1572992,12910592,12943360,12855296,12888064,12845056,12877824,12865536,12898304,12931072,12920832,12875776,12908544,12941312,12953600,0,0
.long 3690496,3821568,3952640,4083712,4294967295,4294967295,147968,6825984,4212736,164480,536870912,28672,1436800,1655552,24576,12850176,754304,536870912,114944,270592,12861440,199700,199744,669696,4274749440,1579008,590592,206860,1605632,206976,593920,12967936,227716,0,227328,1589376,12935168,12847104,12879872,12912640,12869632,12902400,12890112,12922880,12955648,12857344,12867584,12900352,12933120,12945408,0,0
.long 3694592,3825664,3956736,4087808,4294967295,4294967295,148224,6828032,4218880,164608,536870912,28672,1494144,1671936,28672,12851200,754432,536870912,229632,274432,12959744,199704,199680,669696,4274749440,1609728,594432,206984,1638400,207104,598016,13082624,228100,0,227328,1605760,12926976,12871680,12904448,12937216,12861440,12894208,12881920,12914688,12947456,12849152,12892160,12924928,12957696,12859392,0,0
.long 3698688,3829760,3960832,4091904,4294967295,4294967295,148224,6830080,4220928,164736,536870912,28672,1551488,1688320,28672,12852224,754560,536870912,344320,274688,12976128,199708,199744,669696,4274749440,1611776,594688,206988,1671168,207232,602112,13197312,228484,0,227328,1622144,12918784,12951552,12863488,12896256,12853248,12886016,12873728,12906496,12939264,12929024,12883968,12916736,12949504,12851200,0,0
.long 3702784,3833856,3964928,4096000,4294967295,4294967295,148480,6832128,4227072,164864,28928,28672,1379584,1704704,32768,12853248,754688,371712,512,278528,12845056,199712,199680,684032,4274978816,1581056,590848,206864,1572864,206848,589824,12861440,227336,0,227328,1573120,12943360,12855296,12888064,12845056,12877824,12910592,12898304,12931072,12920832,12865536,12908544,12941312,12953600,12875776,0,0
.long 3706880,3837952,3969024,4100096,4294967295,4294967295,148480,6834176,4229120,164992,536870912,28672,1436928,1721088,32768,12854272,754816,536870912,115200,278784,12861440,199716,199744,684032,4274978816,1583104,591104,206868,1605632,206976,593920,12976128,227720,0,227328,1589504,12847104,12879872,12912640,12869632,12902400,12935168,12922880,12955648,12857344,12890112,12900352,12933120,12945408,12867584,0,0
.long 3710976,3842048,3973120,4104192,4294967295,4294967295,148736,6836224,4235264,165120,536870912,28672,1494272,1737472,36864,12855296,754944,536870912,229888,282624,12959744,199720,199680,684032,4274978816,1613824,594944,206992,1638400,207104,598016,13090816,228104,0,227328,1605888,12871680,12904448,12937216,12861440,12894208,12926976,12914688,12947456,12849152,12881920,12924928,12957696,12859392,12892160,0,0
.long 3715072,3846144,3977216,4108288,4294967295,4294967295,148736,6838272,4237312,165248,536870912,28672,1551616,1753856,36864,12856320,755072,536870912,344576,282880,12976128,199724,199744,684032,4274978816,1615872,595200,206996,1671168,207232,602112,13205504,228488,0,227328,1622272,12951552,12863488,12896256,12853248,12886016,12918784,12906496,12939264,12929024,12873728,12916736,12949504,12851200,12883968,0,0
.long 3719168,3850240,3981312,4112384,4294967295,4294967295,148992,6840320,4243456,165376,29056,28672,1379712,1770240,40960,12857344,755200,375808,768,286720,12845056,199728,199680,698368,4275208192,1585152,591360,206872,1572864,206848,589824,12869632,227340,0,227328,1573248,12888064,12845056,12877824,12910592,12943360,12855296,12931072,12920832,12865536,12898304,12941312,12953600,12875776,12908544,0,0
.long 3723264,3854336,3985408,4116480,4294967295,4294967295,148992,6842368,4245504,165504,536870912,28672,1437056,1786624,40960,12858368,755328,536870912,115456,286976,12861440,199732,199744,698368,4275208192,1587200,591616,206876,1605632,206976,593920,12984320,227724,0,227328,1589632,12912640,12869632,12902400,12935168,12847104,12879872,12955648,12857344,12890112,12922880,12933120,12945408,12867584,12900352,0,0
.long 3727360,3858432,3989504,4120576,4294967295,4294967295,149248,6844416,4251648,165632,536870912,28672,1494400,1803008,45056,12859392,755456,536870912,230144,290816,12959744,199736,199680,698368,4275208192,1617920,595456,207000,1638400,207104,598016,13099008,228108,0,227328,1606016,12937216,12861440,12894208,12926976,12871680,12904448,12947456,12849152,12881920,12914688,12957696,12859392,12892160,12924928,0,0
.long 3731456,3862528,3993600,4124672,4294967295,4294967295,149248,6846464,4253696,165760,536870912,28672,1551744,1819392,45056,12860416,755584,536870912,344832,291072,12976128,199740,199744,698368,4275208192,1619968,595712,207004,1671168,207232,602112,13213696,228492,0,227328,1622400,12896256,12853248,12886016,12918784,12951552,12863488,12939264,12929024,12873728,12906496,12949504,12851200,12883968,12916736,0,0
.long 3735552,3866624,3997696,4128768,4294967295,4294967295,149504,6848512,4259840,165888,29184,28672,1605632,896,49152,12861440,755712,265728,1024,294912,12845056,199744,199680,712704,4275437568,1589248,591872,206880,1572864,206848,589824,12877824,227344,0,227328,1573376,12845056,12877824,12910592,12943360,12855296,12888064,12920832,12865536,12898304,12931072,12953600,12875776,12908544,12941312,0,0
.long 3739648,3870720,4001792,4132864,4294967295,4294967295,149504,6850560,4261888,166016,536870912,28672,1662976,17280,49152,12862464,755840,536870912,115712,295168,12861440,199748,199744,712704,4275437568,1591296,592128,206884,1605632,206976,593920,12992512,227728,0,227328,1589760,12869632,12902400,12935168,12847104,12879872,12912640,12857344,12890112,12922880,12955648,12945408,12867584,12900352,12933120,0,0
.long 3743744,3874816,4005888,4136960,4294967295,4294967295,149760,6852608,4268032,166144,536870912,28672,1720320,33664,53248,12863488,755968,536870912,230400,299008,12959744,199752,199680,712704,4275437568,1622016,595968,207008,1638400,207104,598016,13107200,228112,0,227328,1606144,12861440,12894208,12926976,12871680,12904448,12937216,12849152,12881920,12914688,12947456,12859392,12892160,12924928,12957696,0,0
.long 3747840,3878912,4009984,4141056,4294967295,4294967295,149760,6854656,4270080,166272,536870912,28672,1777664,50048,53248,12864512,756096,536870912,345088,299264,12976128,199756,199744,712704,4275437568,1624064,596224,207012,1671168,207232,602112,13221888,228496,0,227328,1622528,12853248,12886016,12918784,12951552,12863488,12896256,12929024,12873728,12906496,12939264,12851200,12883968,12916736,12949504,0,0
.long 3751936,3883008,4014080,4145152,4294967295,4294967295,150016,6856704,4276224,166400,29312,28672,1605760,66432,57344,12865536,756224,269824,1280,303104,12845056,199760,199680,727040,4275666944,1593344,592384,206888,1572864,206848,589824,12886016,227348,0,227328,1573504,12910592,12943360,12855296,12888064,12845056,12877824,12865536,12898304,12931072,12920832,12875776,12908544,12941312,12953600,0,0
.long 3756032,3887104,4018176,4149248,4294967295,4294967295,150016,6858752,4278272,166528,536870912,28672,1663104,82816,57344,12866560,756352,536870912,115968,303360,12861440,199764,199744,727040,4275666944,1595392,592640,206892,1605632,206976,593920,13000704,227732,0,227328,1589888,12935168,12847104,12879872,12912640,12869632,12902400,12890112,12922880,12955648,12857344,12867584,12900352,12933120,12945408,0,0
.long 3760128,3891200,4022272,4153344,4294967295,4294967295,150272,6860800,4284416,166656,536870912,28672,1720448,99200,61440,12867584,756480,536870912,230656,307200,12959744,199768,199680,727040,4275666944,1626112,596480,207016,1638400,207104,598016,13115392,228116,0,227328,1606272,12926976,12871680,12904448,12937216,12861440,12894208,12881920,12914688,12947456,12849152,12892160,12924928,12957696,12859392,0,0
.long 3764224,3895296,4026368,4157440,4294967295,4294967295,150272,6862848,4286464,166784,536870912,28672,1777792,115584,61440,12868608,756608,536870912,345344,307456,12976128,199772,199744,727040,4275666944,1628160,596736,207020,1671168,207232,602112,13230080,228500,0,227328,1622656,12918784,12951552,12863488,12896256,12853248,12886016,12873728,12906496,12939264,12929024,12883968,12916736,12949504,12851200,0,0
.long 3768320,3899392,4030464,4161536,4294967295,4294967295,150528,6864896,4292608,166912,29440,28672,1605888,131968,65536,12869632,756736,273920,1536,311296,12845056,199776,199680,741376,4275896320,1597440,592896,206896,1572864,206848,589824,12894208,227352,0,227328,1573632,12943360,12855296,12888064,12845056,12877824,12910592,12898304,12931072,12920832,12865536,12908544,12941312,12953600,12875776,0,0
.long 3772416,3903488,4034560,4165632,4294967295,4294967295,150528,6866944,4294656,167040,536870912,28672,1663232,148352,65536,12870656,756864,536870912,116224,311552,12861440,199780,199744,741376,4275896320,1599488,593152,206900,1605632,206976,593920,13008896,227736,0,227328,1590016,12847104,12879872,12912640,12869632,12902400,12935168,12922880,12955648,12857344,12890112,12900352,12933120,12945408,12867584,0,0
.long 3776512,3907584,4038656,4169728,4294967295,4294967295,150784,6868992,4300800,167168,536870912,28672,1720576,164736,69632,12871680,756992,536870912,230912,315392,12959744,199784,199680,741376,4275896320,1630208,596992,207024,1638400,207104,598016,13123584,228120,0,227328,1606400,12871680,12904448,12937216,12861440,12894208,12926976,12914688,12947456,12849152,12881920,12924928,12957696,12859392,12892160,0,0
.long 3780608,3911680,4042752,4173824,4294967295,4294967295,150784,6871040,4302848,167296,536870912,28672,1777920,181120,69632,12872704,757120,536870912,345600,315648,12976128,199788,199744,741376,4275896320,1632256,597248,207028,1671168,207232,602112,13238272,228504,0,227328,1622784,12951552,12863488,12896256,12853248,12886016,12918784,12906496,12939264,12929024,12873728,12916736,12949504,12851200,12883968,0,0
.long 3784704,3915776,4046848,4177920,4294967295,4294967295,151040,6873088,4308992,167424,29568,28672,1606016,197504,73728,12873728,757248,278016,1792,319488,12845056,199792,199680,755712,4276125696,1601536,593408,206904,1572864,206848,589824,12902400,227356,0,227328,1573760,12888064,12845056,12877824,12910592,12943360,12855296,12931072,12920832,12865536,12898304,12941312,12953600,12875776,12908544,0,0
.long 3788800,3919872,4050944,4182016,4294967295,4294967295,151040,6875136,4311040,167552,536870912,28672,1663360,213888,73728,12874752,757376,536870912,116480,319744,12861440,199796,199744,755712,4276125696,1603584,593664,206908,1605632,206976,593920,13017088,227740,0,227328,1590144,12912640,12869632,12902400,12935168,12847104,12879872,12955648,12857344,12890112,12922880,12933120,12945408,12867584,12900352,0,0
.long 3792896,3923968,4055040,4186112,4294967295,4294967295,151296,6877184,4317184,167680,536870912,28672,1720704,230272,77824,12875776,757504,536870912,231168,323584,12959744,199800,199680,755712,4276125696,1634304,597504,207032,1638400,207104,598016,13131776,228124,0,227328,1606528,12937216,12861440,12894208,12926976,12871680,12904448,12947456,12849152,12881920,12914688,12957696,12859392,12892160,12924928,0,0
.long 3796992,3928064,4059136,4190208,4294967295,4294967295,151296,6879232,4319232,167808,536870912,28672,1778048,246656,77824,12876800,757632,536870912,345856,323840,12976128,199804,199744,755712,4276125696,1636352,597760,207036,1671168,207232,602112,13246464,228508,0,227328,1622912,12896256,12853248,12886016,12918784,12951552,12863488,12939264,12929024,12873728,12906496,12949504,12851200,12883968,12916736,0,0
.long 3801088,3932160,4063232,4194304,4294967295,4294967295,151552,6881280,4325376,167936,29696,28672,1606144,263040,73728,13074432,757760,282112,2048,327680,13074432,199808,199808,655360,4274061312,1638400,598016,207104,1572864,206848,589824,12910592,227360,0,228096,1638400,13139968,13172736,13084672,13117440,13074432,13107200,13094912,13127680,13160448,13150208,13105152,13137920,13170688,13182976,0,0
.long 3805184,3936256,4067328,4198400,4294967295,4294967295,151552,6883328,4327424,168064,536870912,28672,1663488,279424,73728,13075456,757888,536870912,116736,327936,13090816,199812,199872,655360,4274061312,1640448,598272,207108,1605632,206976,593920,13025280,227744,0,228096,1654784,13164544,13076480,13109248,13142016,13099008,13131776,13119488,13152256,13185024,13086720,13096960,13129728,13162496,13174784,0,0
.long 3809280,3940352,4071424,4202496,4294967295,4294967295,151808,6885376,4333568,168192,536870912,28672,1720832,295808,77824,13076480,758016,536870912,231424,331776,13189120,199816,199808,655360,4274061312,1671168,602112,207232,1638400,207104,598016,13139968,228128,0,228096,1671168,13156352,13101056,13133824,13166592,13090816,13123584,13111296,13144064,13176832,13078528,13121536,13154304,13187072,13088768,0,0
.long 3813376,3944448,4075520,4206592,4294967295,4294967295,151808,6887424,4335616,168320,536870912,28672,1778176,312192,77824,13077504,758144,536870912,346112,332032,13205504,199820,199872,655360,4274061312,1673216,602368,207236,1671168,207232,602112,13254656,228512,0,228096,1687552,13148160,13180928,13092864,13125632,13082624,13115392,13103104,13135872,13168640,13158400,13113344,13146112,13178880,13080576,0,0
.long 3817472,3948544,4079616,4210688,4294967295,4294967295,152064,6889472,4341760,168448,29824,28672,1606272,328576,16384,13078528,758272,286208,2304,335872,13074432,199824,199808,669696,4274290688,1642496,598528,207112,1572864,206848,589824,12918784,227364,0,228096,1638528,13172736,13084672,13117440,13074432,13107200,13139968,13127680,13160448,13150208,13094912,13137920,13170688,13182976,13105152,0,0
.long 3821568,3952640,4083712,4214784,4294967295,4294967295,152064,6891520,4343808,168576,536870912,28672,1663616,344960,16384,13079552,758400,536870912,116992,336128,13090816,199828,199872,669696,4274290688,1644544,598784,207116,1605632,206976,593920,13033472,227748,0,228096,1654912,13076480,13109248,13142016,13099008,13131776,13164544,13152256,13185024,13086720,13119488,13129728,13162496,13174784,13096960,0,0
.long 3825664,3956736,4087808,4218880,4294967295,4294967295,152320,6893568,4349952,168704,536870912,28672,1720960,361344,20480,13080576,758528,536870912,231680,339968,13189120,199832,199808,669696,4274290688,1675264,602624,207240,1638400,207104,598016,13148160,228132,0,228096,1671296,13101056,13133824,13166592,13090816,13123584,13156352,13144064,13176832,13078528,13111296,13154304,13187072,13088768,13121536,0,0
.long 3829760,3960832,4091904,4222976,4294967295,4294967295,152320,6895616,4352000,168832,536870912,28672,1778304,377728,20480,13081600,758656,536870912,346368,340224,13205504,199836,199872,669696,4274290688,1677312,602880,207244,1671168,207232,602112,13262848,228516,0,228096,1687680,13180928,13092864,13125632,13082624,13115392,13148160,13135872,13168640,13158400,13103104,13146112,13178880,13080576,13113344,0,0
.long 3833856,3964928,4096000,4227072,4294967295,4294967295,152576,6897664,4358144,168960,29952,28672,1606400,394112,24576,13082624,758784,290304,2560,344064,13074432,199840,199808,684032,4274520064,1646592,599040,207120,1572864,206848,589824,12926976,227368,0,228096,1638656,13117440,13074432,13107200,13139968,13172736,13084672,13160448,13150208,13094912,13127680,13170688,13182976,13105152,13137920,0,0
.long 3837952,3969024,4100096,4231168,4294967295,4294967295,152576,6899712,4360192,169088,536870912,28672,1663744,410496,24576,13083648,758912,536870912,117248,344320,13090816,199844,199872,684032,4274520064,1648640,599296,207124,1605632,206976,593920,13041664,227752,0,228096,1655040,13142016,13099008,13131776,13164544,13076480,13109248,13185024,13086720,13119488,13152256,13162496,13174784,13096960,13129728,0,0
.long 3842048,3973120,4104192,4235264,4294967295,4294967295,152832,6901760,4366336,169216,536870912,28672,1721088,426880,28672,13084672,759040,536870912,231936,348160,13189120,199848,199808,684032,4274520064,1679360,603136,207248,1638400,207104,598016,13156352,228136,0,228096,1671424,13166592,13090816,13123584,13156352,13101056,13133824,13176832,13078528,13111296,13144064,13187072,13088768,13121536,13154304,0,0
.long 3846144,3977216,4108288,4239360,4294967295,4294967295,152832,6903808,4368384,169344,536870912,28672,1778432,443264,28672,13085696,759168,536870912,346624,348416,13205504,199852,199872,684032,4274520064,1681408,603392,207252,1671168,207232,602112,13271040,228520,0,228096,1687808,13125632,13082624,13115392,13148160,13180928,13092864,13168640,13158400,13103104,13135872,13178880,13080576,13113344,13146112,0,0
.long 3850240,3981312,4112384,4243456,4294967295,4294967295,153088,6905856,4374528,169472,30080,28672,1606528,459648,32768,13086720,759296,294400,2816,352256,13074432,199856,199808,698368,4274749440,1650688,599552,207128,1572864,206848,589824,12935168,227372,0,228096,1638784,13074432,13107200,13139968,13172736,13084672,13117440,13150208,13094912,13127680,13160448,13182976,13105152,13137920,13170688,0,0
.long 3854336,3985408,4116480,4247552,4294967295,4294967295,153088,6907904,4376576,169600,536870912,28672,1663872,476032,32768,13087744,759424,536870912,117504,352512,13090816,199860,199872,698368,4274749440,1652736,599808,207132,1605632,206976,593920,13049856,227756,0,228096,1655168,13099008,13131776,13164544,13076480,13109248,13142016,13086720,13119488,13152256,13185024,13174784,13096960,13129728,13162496,0,0
.long 3858432,3989504,4120576,4251648,4294967295,4294967295,153344,6909952,4382720,169728,536870912,28672,1721216,492416,36864,13088768,759552,536870912,232192,356352,13189120,199864,199808,698368,4274749440,1683456,603648,207256,1638400,207104,598016,13164544,228140,0,228096,1671552,13090816,13123584,13156352,13101056,13133824,13166592,13078528,13111296,13144064,13176832,13088768,13121536,13154304,13187072,0,0
.long 3862528,3993600,4124672,4255744,4294967295,4294967295,153344,6912000,4384768,169856,536870912,28672,1778560,508800,36864,13089792,759680,536870912,346880,356608,13205504,199868,199872,698368,4274749440,1685504,603904,207260,1671168,207232,602112,13279232,228524,0,228096,1687936,13082624,13115392,13148160,13180928,13092864,13125632,13158400,13103104,13135872,13168640,13080576,13113344,13146112,13178880,0,0
.long 3866624,3997696,4128768,4259840,4294967295,4294967295,153600,6914048,4390912,169984,30208,28672,1606656,525184,40960,13090816,759808,298496,3072,360448,13074432,199872,199808,712704,4274978816,1654784,600064,207136,1572864,206848,589824,12943360,227376,0,228096,1638912,13139968,13172736,13084672,13117440,13074432,13107200,13094912,13127680,13160448,13150208,13105152,13137920,13170688,13182976,0,0
.long 3870720,4001792,4132864,4263936,4294967295,4294967295,153600,6916096,4392960,170112,536870912,28672,1664000,541568,40960,13091840,759936,536870912,117760,360704,13090816,199876,199872,712704,4274978816,1656832,600320,207140,1605632,206976,593920,13058048,227760,0,228096,1655296,13164544,13076480,13109248,13142016,13099008,13131776,13119488,13152256,13185024,13086720,13096960,13129728,13162496,13174784,0,0
.long 3874816,4005888,4136960,4268032,4294967295,4294967295,153856,6918144,4399104,170240,536870912,28672,1721344,557952,45056,13092864,760064,536870912,232448,364544,13189120,199880,199808,712704,4274978816,1687552,604160,207264,1638400,207104,598016,13172736,228144,0,228096,1671680,13156352,13101056,13133824,13166592,13090816,13123584,13111296,13144064,13176832,13078528,13121536,13154304,13187072,13088768,0,0
.long 3878912,4009984,4141056,4272128,4294967295,4294967295,153856,6920192,4401152,170368,536870912,28672,1778688,574336,45056,13093888,760192,536870912,347136,364800,13205504,199884,199872,712704,4274978816,1689600,604416,207268,1671168,207232,602112,13287424,228528,0,228096,1688064,13148160,13180928,13092864,13125632,13082624,13115392,13103104,13135872,13168640,13158400,13113344,13146112,13178880,13080576,0,0
.long 3883008,4014080,4145152,4276224,4294967295,4294967295,154112,6922240,4407296,170496,30336,28672,1606784,590720,49152,13094912,760320,302592,3328,368640,13074432,199888,199808,727040,4275208192,1658880,600576,207144,1572864,206848,589824,12951552,227380,0,228096,1639040,13172736,13084672,13117440,13074432,13107200,13139968,13127680,13160448,13150208,13094912,13137920,13170688,13182976,13105152,0,0
.long 3887104,4018176,4149248,4280320,4294967295,4294967295,154112,6924288,4409344,170624,536870912,28672,1664128,607104,49152,13095936,760448,536870912,118016,368896,13090816,199892,199872,727040,4275208192,1660928,600832,207148,1605632,206976,593920,13066240,227764,0,228096,1655424,13076480,13109248,13142016,13099008,13131776,13164544,13152256,13185024,13086720,13119488,13129728,13162496,13174784,13096960,0,0
.long 3891200,4022272,4153344,4284416,4294967295,4294967295,154368,6926336,4415488,170752,536870912,28672,1721472,623488,53248,13096960,760576,536870912,232704,372736,13189120,199896,199808,727040,4275208192,1691648,604672,207272,1638400,207104,598016,13180928,228148,0,228096,1671808,13101056,13133824,13166592,13090816,13123584,13156352,13144064,13176832,13078528,13111296,13154304,13187072,13088768,13121536,0,0
.long 3895296,4026368,4157440,4288512,4294967295,4294967295,154368,6928384,4417536,170880,536870912,28672,1778816,639872,53248,13097984,760704,536870912,347392,372992,13205504,199900,199872,727040,4275208192,1693696,604928,207276,1671168,207232,602112,13295616,228532,0,228096,1688192,13180928,13092864,13125632,13082624,13115392,13148160,13135872,13168640,13158400,13103104,13146112,13178880,13080576,13113344,0,0
.long 3899392,4030464,4161536,4292608,4294967295,4294967295,154624,6930432,4423680,171008,30464,28672,1606912,656256,57344,13099008,760832,306688,3328,368640,13074432,199904,199808,741376,4275437568,1662976,601088,207152,1572864,206848,589824,536870912,536870912,5242880,228096,1639168,13117440,13074432,13107200,13139968,13172736,13084672,13160448,13150208,13094912,13127680,13170688,13182976,13105152,13137920,0,0
.long 3903488,4034560,4165632,4296704,4294967295,4294967295,154624,6932480,4425728,171136,536870912,28672,1664256,672640,57344,13100032,760960,536870912,118016,368896,13090816,199908,199872,741376,4275437568,1665024,601344,207156,1605632,206976,593920,536870912,536870912,5242880,228096,1655552,13142016,13099008,13131776,13164544,13076480,13109248,13185024,13086720,13119488,13152256,13162496,13174784,13096960,13129728,0,0
.long 3907584,4038656,4169728,4300800,4294967295,4294967295,154880,6934528,4431872,171264,536870912,28672,1721600,689024,61440,13101056,761088,536870912,232704,372736,13189120,199912,199808,741376,4275437568,1695744,605184,207280,1638400,207104,598016,536870912,536870912,5242880,228096,1671936,13166592,13090816,13123584,13156352,13101056,13133824,13176832,13078528,13111296,13144064,13187072,13088768,13121536,13154304,0,0
.long 3911680,4042752,4173824,4304896,4294967295,4294967295,154880,6936576,4433920,171392,536870912,28672,1778944,705408,61440,13102080,761216,536870912,347392,372992,13205504,199916,199872,741376,4275437568,1697792,605440,207284,1671168,207232,602112,536870912,536870912,5242880,228096,1688320,13125632,13082624,13115392,13148160,13180928,13092864,13168640,13158400,13103104,13135872,13178880,13080576,13113344,13146112,0,0
.long 3915776,4046848,4177920,4308992,4294967295,4294967295,155136,6938624,4440064,171520,30592,28672,1607040,721792,65536,13103104,761344,310784,3328,368640,13074432,199920,199808,755712,4275666944,1667072,601600,207160,1572864,206848,589824,536870912,536870912,5701632,228096,1639296,13074432,13107200,13139968,13172736,13084672,13117440,13150208,13094912,13127680,13160448,13182976,13105152,13137920,13170688,0,0
.long 3919872,4050944,4182016,4313088,4294967295,4294967295,155136,6940672,4442112,171648,536870912,28672,1664384,738176,65536,13104128,761472,536870912,118016,368896,13090816,199924,199872,755712,4275666944,1669120,601856,207164,1605632,206976,593920,536870912,536870912,5701632,228096,1655680,13099008,13131776,13164544,13076480,13109248,13142016,13086720,13119488,13152256,13185024,13174784,13096960,13129728,13162496,0,0
.long 3923968,4055040,4186112,4317184,4294967295,4294967295,155392,6942720,4448256,171776,536870912,28672,1721728,754560,69632,13105152,761600,536870912,232704,372736,13189120,199928,199808,755712,4275666944,1699840,605696,207288,1638400,207104,598016,536870912,536870912,5701632,228096,1672064,13090816,13123584,13156352,13101056,13133824,13166592,13078528,13111296,13144064,13176832,13088768,13121536,13154304,13187072,0,0
.long 3928064,4059136,4190208,4321280,4294967295,4294967295,155392,6944768,4450304,171904,536870912,28672,1779072,770944,69632,13106176,761728,536870912,347392,372992,13205504,199932,199872,755712,4275666944,1701888,605952,207292,1671168,207232,602112,536870912,536870912,5701632,228096,1688448,13082624,13115392,13148160,13180928,13092864,13125632,13158400,13103104,13135872,13168640,13080576,13113344,13146112,13178880,0,0
.long 3932160,4063232,4194304,4325376,4294967295,4294967295,155648,6946816,4456448,172032,30720,30720,1607168,787328,65536,13303808,761856,314880,0,262144,13303808,199936,199936,655360,4273602560,1703936,606208,207360,1703936,207360,606208,13303808,228864,0,228864,1703936,13402112,13314048,13346816,13303808,13336576,13369344,13357056,13389824,13379584,13324288,13367296,13400064,13412352,13334528,0,0
.long 3936256,4067328,4198400,4329472,4294967295,4294967295,155648,6948864,4458496,172160,536870912,30720,1664512,803712,65536,13304832,761984,536870912,114688,262400,13320192,199940,200000,655360,4273602560,1705984,606464,207364,1736704,207488,610304,13418496,229248,0,228864,1720320,13305856,13338624,13371392,13328384,13361152,13393920,13381632,13414400,13316096,13348864,13359104,13391872,13404160,13326336,0,0
.long 3940352,4071424,4202496,4333568,4294967295,4294967295,155904,6950912,4464640,172288,536870912,30720,1721856,820096,69632,13305856,762112,536870912,229376,266240,13418496,199944,199936,655360,4273602560,1736704,610304,207488,1769472,207616,614400,13533184,229632,0,228864,1736704,13330432,13363200,13395968,13320192,13352960,13385728,13373440,13406208,13307904,13340672,13383680,13416448,13318144,13350912,0,0
.long 3944448,4075520,4206592,4337664,4294967295,4294967295,155904,6952960,4466688,172416,536870912,30720,1779200,836480,69632,13306880,762240,536870912,344064,266496,13434880,199948,200000,655360,4273602560,1738752,610560,207492,1802240,207744,618496,13647872,230016,0,228864,1753088,13410304,13322240,13355008,13312000,13344768,13377536,13365248,13398016,13387776,13332480,13375488,13408256,13309952,13342720,0,0
.long 3948544,4079616,4210688,4341760,4294967295,4294967295,156160,6955008,4472832,172544,30848,30720,1607296,852864,73728,13307904,762368,318976,256,270336,13303808,199952,199936,669696,4273831936,1708032,606720,207368,1703936,207360,606208,13312000,228868,0,228864,1704064,13346816,13303808,13336576,13369344,13402112,13314048,13389824,13379584,13324288,13357056,13400064,13412352,13334528,13367296,0,0
.long 3952640,4083712,4214784,4345856,4294967295,4294967295,156160,6957056,4474880,172672,536870912,30720,1664640,869248,73728,13308928,762496,536870912,114944,270592,13320192,199956,200000,669696,4273831936,1710080,606976,207372,1736704,207488,610304,13426688,229252,0,228864,1720448,13371392,13328384,13361152,13393920,13305856,13338624,13414400,13316096,13348864,13381632,13391872,13404160,13326336,13359104,0,0
.long 3956736,4087808,4218880,4349952,4294967295,4294967295,156416,6959104,4481024,172800,536870912,30720,1721984,885632,77824,13309952,762624,536870912,229632,274432,13418496,199960,199936,669696,4273831936,1740800,610816,207496,1769472,207616,614400,13541376,229636,0,228864,1736832,13395968,13320192,13352960,13385728,13330432,13363200,13406208,13307904,13340672,13373440,13416448,13318144,13350912,13383680,0,0
.long 3960832,4091904,4222976,4354048,4294967295,4294967295,156416,6961152,4483072,172928,536870912,30720,1779328,902016,77824,13310976,762752,536870912,344320,274688,13434880,199964,200000,669696,4273831936,1742848,611072,207500,1802240,207744,618496,13656064,230020,0,228864,1753216,13355008,13312000,13344768,13377536,13410304,13322240,13398016,13387776,13332480,13365248,13408256,13309952,13342720,13375488,0,0
.long 3964928,4096000,4227072,4358144,4294967295,4294967295,156672,6963200,4489216,173056,30976,30720,1607424,918400,16384,13312000,762880,323072,512,278528,13303808,199968,199936,684032,4274061312,1712128,607232,207376,1703936,207360,606208,13320192,228872,0,228864,1704192,13303808,13336576,13369344,13402112,13314048,13346816,13379584,13324288,13357056,13389824,13412352,13334528,13367296,13400064,0,0
.long 3969024,4100096,4231168,4362240,4294967295,4294967295,156672,6965248,4491264,173184,536870912,30720,1664768,934784,16384,13313024,763008,536870912,115200,278784,13320192,199972,200000,684032,4274061312,1714176,607488,207380,1736704,207488,610304,13434880,229256,0,228864,1720576,13328384,13361152,13393920,13305856,13338624,13371392,13316096,13348864,13381632,13414400,13404160,13326336,13359104,13391872,0,0
.long 3973120,4104192,4235264,4366336,4294967295,4294967295,156928,6967296,4497408,173312,536870912,30720,1722112,951168,20480,13314048,763136,536870912,229888,282624,13418496,199976,199936,684032,4274061312,1744896,611328,207504,1769472,207616,614400,13549568,229640,0,228864,1736960,13320192,13352960,13385728,13330432,13363200,13395968,13307904,13340672,13373440,13406208,13318144,13350912,13383680,13416448,0,0
.long 3977216,4108288,4239360,4370432,4294967295,4294967295,156928,6969344,4499456,173440,536870912,30720,1779456,967552,20480,13315072,763264,536870912,344576,282880,13434880,199980,200000,684032,4274061312,1746944,611584,207508,1802240,207744,618496,13664256,230024,0,228864,1753344,13312000,13344768,13377536,13410304,13322240,13355008,13387776,13332480,13365248,13398016,13309952,13342720,13375488,13408256,0,0
.long 3981312,4112384,4243456,4374528,4294967295,4294967295,157184,6971392,4505600,173568,31104,30720,1607552,983936,24576,13316096,763392,327168,768,286720,13303808,199984,199936,698368,4274290688,1716224,607744,207384,1703936,207360,606208,13328384,228876,0,228864,1704320,13369344,13402112,13314048,13346816,13303808,13336576,13324288,13357056,13389824,13379584,13334528,13367296,13400064,13412352,0,0
.long 3985408,4116480,4247552,4378624,4294967295,4294967295,157184,6973440,4507648,173696,536870912,30720,1664896,1000320,24576,13317120,763520,536870912,115456,286976,13320192,199988,200000,698368,4274290688,1718272,608000,207388,1736704,207488,610304,13443072,229260,0,228864,1720704,13393920,13305856,13338624,13371392,13328384,13361152,13348864,13381632,13414400,13316096,13326336,13359104,13391872,13404160,0,0
.long 3989504,4120576,4251648,4382720,4294967295,4294967295,157440,6975488,4513792,173824,536870912,30720,1722240,1016704,28672,13318144,763648,536870912,230144,290816,13418496,199992,199936,698368,4274290688,1748992,611840,207512,1769472,207616,614400,13557760,229644,0,228864,1737088,13385728,13330432,13363200,13395968,13320192,13352960,13340672,13373440,13406208,13307904,13350912,13383680,13416448,13318144,0,0
.long 3993600,4124672,4255744,4386816,4294967295,4294967295,157440,6977536,4515840,173952,536870912,30720,1779584,1033088,28672,13319168,763776,536870912,344832,291072,13434880,199996,200000,698368,4274290688,1751040,612096,207516,1802240,207744,618496,13672448,230028,0,228864,1753472,13377536,13410304,13322240,13355008,13312000,13344768,13332480,13365248,13398016,13387776,13342720,13375488,13408256,13309952,0,0
.long 3997696,4128768,4259840,4390912,4294967295,4294967295,157696,6979584,4521984,174080,31232,30720,1607680,1049472,32768,13320192,763904,331264,1024,294912,13303808,200000,199936,712704,4274520064,1720320,608256,207392,1703936,207360,606208,13336576,228880,0,228864,1704448,13402112,13314048,13346816,13303808,13336576,13369344,13357056,13389824,13379584,13324288,13367296,13400064,13412352,13334528,0,0
.long 4001792,4132864,4263936,4395008,4294967295,4294967295,157696,6981632,4524032,174208,536870912,30720,1665024,1065856,32768,13321216,764032,536870912,115712,295168,13320192,200004,200000,712704,4274520064,1722368,608512,207396,1736704,207488,610304,13451264,229264,0,228864,1720832,13305856,13338624,13371392,13328384,13361152,13393920,13381632,13414400,13316096,13348864,13359104,13391872,13404160,13326336,0,0
.long 4005888,4136960,4268032,4399104,4294967295,4294967295,157952,6983680,4530176,174336,536870912,30720,1722368,1082240,36864,13322240,764160,536870912,230400,299008,13418496,200008,199936,712704,4274520064,1753088,612352,207520,1769472,207616,614400,13565952,229648,0,228864,1737216,13330432,13363200,13395968,13320192,13352960,13385728,13373440,13406208,13307904,13340672,13383680,13416448,13318144,13350912,0,0
.long 4009984,4141056,4272128,4403200,4294967295,4294967295,157952,6985728,4532224,174464,536870912,30720,1779712,1098624,36864,13323264,764288,536870912,345088,299264,13434880,200012,200000,712704,4274520064,1755136,612608,207524,1802240,207744,618496,13680640,230032,0,228864,1753600,13410304,13322240,13355008,13312000,13344768,13377536,13365248,13398016,13387776,13332480,13375488,13408256,13309952,13342720,0,0
.long 4014080,4145152,4276224,4407296,4294967295,4294967295,158208,6987776,4538368,174592,31360,30720,1607808,1115008,40960,13324288,764416,335360,1280,303104,13303808,200016,199936,727040,4274749440,1724416,608768,207400,1703936,207360,606208,13344768,228884,0,228864,1704576,13346816,13303808,13336576,13369344,13402112,13314048,13389824,13379584,13324288,13357056,13400064,13412352,13334528,13367296,0,0
.long 4018176,4149248,4280320,4411392,4294967295,4294967295,158208,6989824,4540416,174720,536870912,30720,1665152,1131392,40960,13325312,764544,536870912,115968,303360,13320192,200020,200000,727040,4274749440,1726464,609024,207404,1736704,207488,610304,13459456,229268,0,228864,1720960,13371392,13328384,13361152,13393920,13305856,13338624,13414400,13316096,13348864,13381632,13391872,13404160,13326336,13359104,0,0
.long 4022272,4153344,4284416,4415488,4294967295,4294967295,158464,6991872,4546560,174848,536870912,30720,1722496,1147776,45056,13326336,764672,536870912,230656,307200,13418496,200024,199936,727040,4274749440,1757184,612864,207528,1769472,207616,614400,13574144,229652,0,228864,1737344,13395968,13320192,13352960,13385728,13330432,13363200,13406208,13307904,13340672,13373440,13416448,13318144,13350912,13383680,0,0
.long 4026368,4157440,4288512,4419584,4294967295,4294967295,158464,6993920,4548608,174976,536870912,30720,1779840,1164160,45056,13327360,764800,536870912,345344,307456,13434880,200028,200000,727040,4274749440,1759232,613120,207532,1802240,207744,618496,13688832,230036,0,228864,1753728,13355008,13312000,13344768,13377536,13410304,13322240,13398016,13387776,13332480,13365248,13408256,13309952,13342720,13375488,0,0
.long 4030464,4161536,4292608,4423680,4294967295,4294967295,158720,6995968,4554752,175104,31488,30720,1607936,1180544,49152,13328384,764928,339456,1536,311296,13303808,200032,199936,741376,4274978816,1728512,609280,207408,1703936,207360,606208,13352960,228888,0,228864,1704704,13303808,13336576,13369344,13402112,13314048,13346816,13379584,13324288,13357056,13389824,13412352,13334528,13367296,13400064,0,0
.long 4034560,4165632,4296704,4427776,4294967295,4294967295,158720,6998016,4556800,175232,536870912,30720,1665280,1196928,49152,13329408,765056,536870912,116224,311552,13320192,200036,200000,741376,4274978816,1730560,609536,207412,1736704,207488,610304,13467648,229272,0,228864,1721088,13328384,13361152,13393920,13305856,13338624,13371392,13316096,13348864,13381632,13414400,13404160,13326336,13359104,13391872,0,0
.long 4038656,4169728,4300800,4431872,4294967295,4294967295,158976,7000064,4562944,175360,536870912,30720,1722624,1213312,53248,13330432,765184,536870912,230912,315392,13418496,200040,199936,741376,4274978816,1761280,613376,207536,1769472,207616,614400,13582336,229656,0,228864,1737472,13320192,13352960,13385728,13330432,13363200,13395968,13307904,13340672,13373440,13406208,13318144,13350912,13383680,13416448,0,0
.long 4042752,4173824,4304896,4435968,4294967295,4294967295,158976,7002112,4564992,175488,536870912,30720,1779968,1229696,53248,13331456,765312,536870912,345600,315648,13434880,200044,200000,741376,4274978816,1763328,613632,207540,1802240,207744,618496,13697024,230040,0,228864,1753856,13312000,13344768,13377536,13410304,13322240,13355008,13387776,13332480,13365248,13398016,13309952,13342720,13375488,13408256,0,0
.long 4046848,4177920,4308992,4440064,4294967295,4294967295,159232,7004160,4571136,175616,31616,30720,1608064,1246080,57344,13332480,765440,343552,1792,319488,13303808,200048,199936,755712,4275208192,1732608,609792,207416,1703936,207360,606208,13361152,228892,0,228864,1704832,13369344,13402112,13314048,13346816,13303808,13336576,13324288,13357056,13389824,13379584,13334528,13367296,13400064,13412352,0,0
.long 4050944,4182016,4313088,4444160,4294967295,4294967295,159232,7006208,4573184,175744,536870912,30720,1665408,1262464,57344,13333504,765568,536870912,116480,319744,13320192,200052,200000,755712,4275208192,1734656,610048,207420,1736704,207488,610304,13475840,229276,0,228864,1721216,13393920,13305856,13338624,13371392,13328384,13361152,13348864,13381632,13414400,13316096,13326336,13359104,13391872,13404160,0,0
.long 4055040,4186112,4317184,4448256,4294967295,4294967295,159488,7008256,4579328,175872,536870912,30720,1722752,1278848,61440,13334528,765696,536870912,231168,323584,13418496,200056,199936,755712,4275208192,1765376,613888,207544,1769472,207616,614400,13590528,229660,0,228864,1737600,13385728,13330432,13363200,13395968,13320192,13352960,13340672,13373440,13406208,13307904,13350912,13383680,13416448,13318144,0,0
.long 4059136,4190208,4321280,4452352,4294967295,4294967295,159488,7010304,4581376,176000,536870912,30720,1780096,1295232,61440,13335552,765824,536870912,345856,323840,13434880,200060,200000,755712,4275208192,1767424,614144,207548,1802240,207744,618496,13705216,230044,0,228864,1753984,13377536,13410304,13322240,13355008,13312000,13344768,13332480,13365248,13398016,13387776,13342720,13375488,13408256,13309952,0,0
.long 4063232,4194304,4325376,4456448,4294967295,4294967295,159744,7012352,4587520,176128,31744,30720,1608192,1311616,57344,13533184,765952,347648,2048,327680,13533184,200064,200064,655360,4273143808,1769472,614400,207616,1703936,207360,606208,13369344,228896,0,229632,1769472,13576192,13533184,13565952,13598720,13631488,13543424,13619200,13608960,13553664,13586432,13629440,13641728,13563904,13596672,0,0
.long 4067328,4198400,4329472,4460544,4294967295,4294967295,159744,7014400,4589568,176256,536870912,30720,1665536,1328000,57344,13534208,766080,536870912,116736,327936,13549568,200068,200128,655360,4273143808,1771520,614656,207620,1736704,207488,610304,13484032,229280,0,229632,1785856,13600768,13557760,13590528,13623296,13535232,13568000,13643776,13545472,13578240,13611008,13621248,13633536,13555712,13588480,0,0
.long 4071424,4202496,4333568,4464640,4294967295,4294967295,160000,7016448,4595712,176384,536870912,30720,1722880,1344384,61440,13535232,766208,536870912,231424,331776,13647872,200072,200064,655360,4273143808,1802240,618496,207744,1769472,207616,614400,13598720,229664,0,229632,1802240,13625344,13549568,13582336,13615104,13559808,13592576,13635584,13537280,13570048,13602816,13645824,13547520,13580288,13613056,0,0
.long 4075520,4206592,4337664,4468736,4294967295,4294967295,160000,7018496,4597760,176512,536870912,30720,1780224,1360768,61440,13536256,766336,536870912,346112,332032,13664256,200076,200128,655360,4273143808,1804288,618752,207748,1802240,207744,618496,13713408,230048,0,229632,1818624,13584384,13541376,13574144,13606912,13639680,13551616,13627392,13617152,13561856,13594624,13637632,13539328,13572096,13604864,0,0
.long 4079616,4210688,4341760,4472832,4294967295,4294967295,160256,7020544,4603904,176640,31872,30720,1608320,1377152,65536,13537280,766464,351744,2304,335872,13533184,200080,200064,669696,4273373184,1773568,614912,207624,1703936,207360,606208,13377536,228900,0,229632,1769600,13533184,13565952,13598720,13631488,13543424,13576192,13608960,13553664,13586432,13619200,13641728,13563904,13596672,13629440,0,0
.long 4083712,4214784,4345856,4476928,4294967295,4294967295,160256,7022592,4605952,176768,536870912,30720,1665664,1393536,65536,13538304,766592,536870912,116992,336128,13549568,200084,200128,669696,4273373184,1775616,615168,207628,1736704,207488,610304,13492224,229284,0,229632,1785984,13557760,13590528,13623296,13535232,13568000,13600768,13545472,13578240,13611008,13643776,13633536,13555712,13588480,13621248,0,0
.long 4087808,4218880,4349952,4481024,4294967295,4294967295,160512,7024640,4612096,176896,536870912,30720,1723008,1409920,69632,13539328,766720,536870912,231680,339968,13647872,200088,200064,669696,4273373184,1806336,619008,207752,1769472,207616,614400,13606912,229668,0,229632,1802368,13549568,13582336,13615104,13559808,13592576,13625344,13537280,13570048,13602816,13635584,13547520,13580288,13613056,13645824,0,0
.long 4091904,4222976,4354048,4485120,4294967295,4294967295,160512,7026688,4614144,177024,536870912,30720,1780352,1426304,69632,13540352,766848,536870912,346368,340224,13664256,200092,200128,669696,4273373184,1808384,619264,207756,1802240,207744,618496,13721600,230052,0,229632,1818752,13541376,13574144,13606912,13639680,13551616,13584384,13617152,13561856,13594624,13627392,13539328,13572096,13604864,13637632,0,0
.long 4096000,4227072,4358144,4489216,4294967295,4294967295,160768,7028736,4620288,177152,32000,30720,1608448,1442688,73728,13541376,766976,355840,2560,344064,13533184,200096,200064,684032,4273602560,1777664,615424,207632,1703936,207360,606208,13385728,228904,0,229632,1769728,13598720,13631488,13543424,13576192,13533184,13565952,13553664,13586432,13619200,13608960,13563904,13596672,13629440,13641728,0,0
.long 4100096,4231168,4362240,4493312,4294967295,4294967295,160768,7030784,4622336,177280,536870912,30720,1665792,1459072,73728,13542400,767104,536870912,117248,344320,13549568,200100,200128,684032,4273602560,1779712,615680,207636,1736704,207488,610304,13500416,229288,0,229632,1786112,13623296,13535232,13568000,13600768,13557760,13590528,13578240,13611008,13643776,13545472,13555712,13588480,13621248,13633536,0,0
.long 4104192,4235264,4366336,4497408,4294967295,4294967295,161024,7032832,4628480,177408,536870912,30720,1723136,1475456,77824,13543424,767232,536870912,231936,348160,13647872,200104,200064,684032,4273602560,1810432,619520,207760,1769472,207616,614400,13615104,229672,0,229632,1802496,13615104,13559808,13592576,13625344,13549568,13582336,13570048,13602816,13635584,13537280,13580288,13613056,13645824,13547520,0,0
.long 4108288,4239360,4370432,4501504,4294967295,4294967295,161024,7034880,4630528,177536,536870912,30720,1780480,1491840,77824,13544448,767360,536870912,346624,348416,13664256,200108,200128,684032,4273602560,1812480,619776,207764,1802240,207744,618496,13729792,230056,0,229632,1818880,13606912,13639680,13551616,13584384,13541376,13574144,13561856,13594624,13627392,13617152,13572096,13604864,13637632,13539328,0,0
.long 4112384,4243456,4374528,4505600,4294967295,4294967295,161280,7036928,4636672,177664,32128,30720,1608576,1508224,16384,13545472,767488,359936,2816,352256,13533184,200112,200064,698368,4273831936,1781760,615936,207640,1703936,207360,606208,13393920,228908,0,229632,1769856,13631488,13543424,13576192,13533184,13565952,13598720,13586432,13619200,13608960,13553664,13596672,13629440,13641728,13563904,0,0
.long 4116480,4247552,4378624,4509696,4294967295,4294967295,161280,7038976,4638720,177792,536870912,30720,1665920,1524608,16384,13546496,767616,536870912,117504,352512,13549568,200116,200128,698368,4273831936,1783808,616192,207644,1736704,207488,610304,13508608,229292,0,229632,1786240,13535232,13568000,13600768,13557760,13590528,13623296,13611008,13643776,13545472,13578240,13588480,13621248,13633536,13555712,0,0
.long 4120576,4251648,4382720,4513792,4294967295,4294967295,161536,7041024,4644864,177920,536870912,30720,1723264,1540992,20480,13547520,767744,536870912,232192,356352,13647872,200120,200064,698368,4273831936,1814528,620032,207768,1769472,207616,614400,13623296,229676,0,229632,1802624,13559808,13592576,13625344,13549568,13582336,13615104,13602816,13635584,13537280,13570048,13613056,13645824,13547520,13580288,0,0
.long 4124672,4255744,4386816,4517888,4294967295,4294967295,161536,7043072,4646912,178048,536870912,30720,1780608,1557376,20480,13548544,767872,536870912,346880,356608,13664256,200124,200128,698368,4273831936,1816576,620288,207772,1802240,207744,618496,13737984,230060,0,229632,1819008,13639680,13551616,13584384,13541376,13574144,13606912,13594624,13627392,13617152,13561856,13604864,13637632,13539328,13572096,0,0
.long 4128768,4259840,4390912,4521984,4294967295,4294967295,161792,7045120,4653056,178176,32256,30720,1608704,1573760,24576,13549568,768000,364032,3072,360448,13533184,200128,200064,712704,4274061312,1785856,616448,207648,1703936,207360,606208,13402112,228912,0,229632,1769984,13576192,13533184,13565952,13598720,13631488,13543424,13619200,13608960,13553664,13586432,13629440,13641728,13563904,13596672,0,0
.long 4132864,4263936,4395008,4526080,4294967295,4294967295,161792,7047168,4655104,178304,536870912,30720,1666048,1590144,24576,13550592,768128,536870912,117760,360704,13549568,200132,200128,712704,4274061312,1787904,616704,207652,1736704,207488,610304,13516800,229296,0,229632,1786368,13600768,13557760,13590528,13623296,13535232,13568000,13643776,13545472,13578240,13611008,13621248,13633536,13555712,13588480,0,0
.long 4136960,4268032,4399104,4530176,4294967295,4294967295,162048,7049216,4661248,178432,536870912,30720,1723392,1606528,28672,13551616,768256,536870912,232448,364544,13647872,200136,200064,712704,4274061312,1818624,620544,207776,1769472,207616,614400,13631488,229680,0,229632,1802752,13625344,13549568,13582336,13615104,13559808,13592576,13635584,13537280,13570048,13602816,13645824,13547520,13580288,13613056,0,0
.long 4141056,4272128,4403200,4534272,4294967295,4294967295,162048,7051264,4663296,178560,536870912,30720,1780736,1622912,28672,13552640,768384,536870912,347136,364800,13664256,200140,200128,712704,4274061312,1820672,620800,207780,1802240,207744,618496,13746176,230064,0,229632,1819136,13584384,13541376,13574144,13606912,13639680,13551616,13627392,13617152,13561856,13594624,13637632,13539328,13572096,13604864,0,0
.long 4145152,4276224,4407296,4538368,4294967295,4294967295,162304,7053312,4669440,178688,32384,30720,1608832,1639296,32768,13553664,768512,368128,3328,368640,13533184,200144,200064,727040,4274290688,1789952,616960,207656,1703936,207360,606208,13410304,228916,0,229632,1770112,13533184,13565952,13598720,13631488,13543424,13576192,13608960,13553664,13586432,13619200,13641728,13563904,13596672,13629440,0,0
.long 4149248,4280320,4411392,4542464,4294967295,4294967295,162304,7055360,4671488,178816,536870912,30720,1666176,1655680,32768,13554688,768640,536870912,118016,368896,13549568,200148,200128,727040,4274290688,1792000,617216,207660,1736704,207488,610304,13524992,229300,0,229632,1786496,13557760,13590528,13623296,13535232,13568000,13600768,13545472,13578240,13611008,13643776,13633536,13555712,13588480,13621248,0,0
.long 4153344,4284416,4415488,4546560,4294967295,4294967295,162560,7057408,4677632,178944,536870912,30720,1723520,1672064,36864,13555712,768768,536870912,232704,372736,13647872,200152,200064,727040,4274290688,1822720,621056,207784,1769472,207616,614400,13639680,229684,0,229632,1802880,13549568,13582336,13615104,13559808,13592576,13625344,13537280,13570048,13602816,13635584,13547520,13580288,13613056,13645824,0,0
.long 4157440,4288512,4419584,4550656,4294967295,4294967295,162560,7059456,4679680,179072,536870912,30720,1780864,1688448,36864,13556736,768896,536870912,347392,372992,13664256,200156,200128,727040,4274290688,1824768,621312,207788,1802240,207744,618496,13754368,230068,0,229632,1819264,13541376,13574144,13606912,13639680,13551616,13584384,13617152,13561856,13594624,13627392,13539328,13572096,13604864,13637632,0,0
.long 4161536,4292608,4423680,4554752,4294967295,4294967295,162816,7061504,4685824,179200,32512,30720,1608960,1704832,40960,13557760,769024,372224,3328,368640,13533184,200160,200064,741376,4274520064,1794048,617472,207664,1703936,207360,606208,536870912,536870912,6160384,229632,1770240,13598720,13631488,13543424,13576192,13533184,13565952,13553664,13586432,13619200,13608960,13563904,13596672,13629440,13641728,0,0
.long 4165632,4296704,4427776,4558848,4294967295,4294967295,162816,7063552,4687872,179328,536870912,30720,1666304,1721216,40960,13558784,769152,536870912,118016,368896,13549568,200164,200128,741376,4274520064,1796096,617728,207668,1736704,207488,610304,536870912,536870912,6160384,229632,1786624,13623296,13535232,13568000,13600768,13557760,13590528,13578240,13611008,13643776,13545472,13555712,13588480,13621248,13633536,0,0
.long 4169728,4300800,4431872,4562944,4294967295,4294967295,163072,7065600,4694016,179456,536870912,30720,1723648,1737600,45056,13559808,769280,536870912,232704,372736,13647872,200168,200064,741376,4274520064,1826816,621568,207792,1769472,207616,614400,536870912,536870912,6160384,229632,1803008,13615104,13559808,13592576,13625344,13549568,13582336,13570048,13602816,13635584,13537280,13580288,13613056,13645824,13547520,0,0
.long 4173824,4304896,4435968,4567040,4294967295,4294967295,163072,7067648,4696064,179584,536870912,30720,1780992,1753984,45056,13560832,769408,536870912,347392,372992,13664256,200172,200128,741376,4274520064,1828864,621824,207796,1802240,207744,618496,536870912,536870912,6160384,229632,1819392,13606912,13639680,13551616,13584384,13541376,13574144,13561856,13594624,13627392,13617152,13572096,13604864,13637632,13539328,0,0
.long 4177920,4308992,4440064,4571136,4294967295,4294967295,163328,7069696,4702208,179712,32640,30720,1609088,1770368,49152,13561856,769536,376320,3328,368640,13533184,200176,200064,755712,4274749440,1798144,617984,207672,1703936,207360,606208,536870912,536870912,6619136,229632,1770368,13631488,13543424,13576192,13533184,13565952,13598720,13586432,13619200,13608960,13553664,13596672,13629440,13641728,13563904,0,0
.long 4182016,4313088,4444160,4575232,4294967295,4294967295,163328,7071744,4704256,179840,536870912,30720,1666432,1786752,49152,13562880,769664,536870912,118016,368896,13549568,200180,200128,755712,4274749440,1800192,618240,207676,1736704,207488,610304,536870912,536870912,6619136,229632,1786752,13535232,13568000,13600768,13557760,13590528,13623296,13611008,13643776,13545472,13578240,13588480,13621248,13633536,13555712,0,0
.long 4186112,4317184,4448256,4579328,4294967295,4294967295,163584,7073792,4710400,179968,536870912,30720,1723776,1803136,53248,13563904,769792,536870912,232704,372736,13647872,200184,200064,755712,4274749440,1830912,622080,207800,1769472,207616,614400,536870912,536870912,6619136,229632,1803136,13559808,13592576,13625344,13549568,13582336,13615104,13602816,13635584,13537280,13570048,13613056,13645824,13547520,13580288,0,0
.long 4190208,4321280,4452352,4583424,4294967295,4294967295,163584,7075840,4712448,180096,536870912,30720,1781120,1819520,53248,13564928,769920,536870912,347392,372992,13664256,200188,200128,755712,4274749440,1832960,622336,207804,1802240,207744,618496,536870912,536870912,6619136,229632,1819520,13639680,13551616,13584384,13541376,13574144,13606912,13594624,13627392,13617152,13561856,13604864,13637632,13539328,13572096,0,0
.long 4194304,4325376,4456448,4587520,4294967295,4294967295,163840,536870912,4718592,180224,32768,32768,536870912,536870912,49152,13762560,536870912,536870912,0,262144,13762560,200192,200192,655360,4272685056,1835008,622592,207872,1835008,207872,622592,13762560,230400,0,230400,1835008,13762560,13795328,13828096,13860864,13772800,13805568,13838336,13783040,13815808,13848576,13871104,13793280,13826048,13858816,0,0
.long 4198400,4329472,4460544,4591616,4294967295,4294967295,163840,536870912,4720640,180352,536870912,32768,536870912,536870912,49152,13763584,536870912,536870912,114688,262400,13778944,200196,200256,655360,4272685056,1837056,622848,207876,1867776,208000,626688,13877248,230784,0,230400,1851392,13787136,13819904,13852672,13764608,13797376,13830144,13774848,13807616,13840384,13873152,13862912,13785088,13817856,13850624,0,0
.long 4202496,4333568,4464640,4595712,4294967295,4294967295,164096,536870912,4726784,180480,536870912,32768,536870912,536870912,53248,13764608,536870912,536870912,229376,266240,13877248,200200,200192,655360,4272685056,1867776,626688,208000,1900544,208128,630784,13991936,231168,0,230400,1867776,13778944,13811712,13844480,13789184,13821952,13854720,13766656,13799424,13832192,13864960,13776896,13809664,13842432,13875200,0,0
.long 4206592,4337664,4468736,4599808,4294967295,4294967295,164096,536870912,4728832,180608,536870912,32768,536870912,536870912,53248,13765632,536870912,536870912,344064,266496,13893632,200204,200256,655360,4272685056,1869824,626944,208004,1933312,208256,634880,14106624,231552,0,230400,1884160,13770752,13803520,13836288,13869056,13780992,13813760,13846528,13791232,13824000,13856768,13768704,13801472,13834240,13867008,0,0
.long 4210688,4341760,4472832,4603904,4294967295,4294967295,164352,536870912,4734976,180736,32896,32768,536870912,536870912,57344,13766656,536870912,536870912,256,270336,13762560,200208,200192,669696,4272914432,1839104,623104,207880,1835008,207872,622592,13770752,230404,0,230400,1835136,13828096,13860864,13772800,13805568,13762560,13795328,13783040,13815808,13848576,13838336,13793280,13826048,13858816,13871104,0,0
.long 4214784,4345856,4476928,4608000,4294967295,4294967295,164352,536870912,4737024,180864,536870912,32768,536870912,536870912,57344,13767680,536870912,536870912,114944,270592,13778944,200212,200256,669696,4272914432,1841152,623360,207884,1867776,208000,626688,13885440,230788,0,230400,1851520,13852672,13764608,13797376,13830144,13787136,13819904,13807616,13840384,13873152,13774848,13785088,13817856,13850624,13862912,0,0
.long 4218880,4349952,4481024,4612096,4294967295,4294967295,164608,536870912,4743168,180992,536870912,32768,536870912,536870912,61440,13768704,536870912,536870912,229632,274432,13877248,200216,200192,669696,4272914432,1871872,627200,208008,1900544,208128,630784,14000128,231172,0,230400,1867904,13844480,13789184,13821952,13854720,13778944,13811712,13799424,13832192,13864960,13766656,13809664,13842432,13875200,13776896,0,0
.long 4222976,4354048,4485120,4616192,4294967295,4294967295,164608,536870912,4745216,181120,536870912,32768,536870912,536870912,61440,13769728,536870912,536870912,344320,274688,13893632,200220,200256,669696,4272914432,1873920,627456,208012,1933312,208256,634880,14114816,231556,0,230400,1884288,13836288,13869056,13780992,13813760,13770752,13803520,13791232,13824000,13856768,13846528,13801472,13834240,13867008,13768704,0,0
.long 4227072,4358144,4489216,4620288,4294967295,4294967295,164864,536870912,4751360,181248,33024,32768,536870912,536870912,65536,13770752,536870912,536870912,512,278528,13762560,200224,200192,684032,4273143808,1843200,623616,207888,1835008,207872,622592,13778944,230408,0,230400,1835264,13860864,13772800,13805568,13762560,13795328,13828096,13815808,13848576,13838336,13783040,13826048,13858816,13871104,13793280,0,0
.long 4231168,4362240,4493312,4624384,4294967295,4294967295,164864,536870912,4753408,181376,536870912,32768,536870912,536870912,65536,13771776,536870912,536870912,115200,278784,13778944,200228,200256,684032,4273143808,1845248,623872,207892,1867776,208000,626688,13893632,230792,0,230400,1851648,13764608,13797376,13830144,13787136,13819904,13852672,13840384,13873152,13774848,13807616,13817856,13850624,13862912,13785088,0,0
.long 4235264,4366336,4497408,4628480,4294967295,4294967295,165120,536870912,4759552,181504,536870912,32768,536870912,536870912,69632,13772800,536870912,536870912,229888,282624,13877248,200232,200192,684032,4273143808,1875968,627712,208016,1900544,208128,630784,14008320,231176,0,230400,1868032,13789184,13821952,13854720,13778944,13811712,13844480,13832192,13864960,13766656,13799424,13842432,13875200,13776896,13809664,0,0
.long 4239360,4370432,4501504,4632576,4294967295,4294967295,165120,536870912,4761600,181632,536870912,32768,536870912,536870912,69632,13773824,536870912,536870912,344576,282880,13893632,200236,200256,684032,4273143808,1878016,627968,208020,1933312,208256,634880,14123008,231560,0,230400,1884416,13869056,13780992,13813760,13770752,13803520,13836288,13824000,13856768,13846528,13791232,13834240,13867008,13768704,13801472,0,0
.long 4243456,4374528,4505600,4636672,4294967295,4294967295,165376,536870912,4767744,181760,33152,32768,536870912,536870912,73728,13774848,536870912,536870912,768,286720,13762560,200240,200192,698368,4273373184,1847296,624128,207896,1835008,207872,622592,13787136,230412,0,230400,1835392,13805568,13762560,13795328,13828096,13860864,13772800,13848576,13838336,13783040,13815808,13858816,13871104,13793280,13826048,0,0
.long 4247552,4378624,4509696,4640768,4294967295,4294967295,165376,536870912,4769792,181888,536870912,32768,536870912,536870912,73728,13775872,536870912,536870912,115456,286976,13778944,200244,200256,698368,4273373184,1849344,624384,207900,1867776,208000,626688,13901824,230796,0,230400,1851776,13830144,13787136,13819904,13852672,13764608,13797376,13873152,13774848,13807616,13840384,13850624,13862912,13785088,13817856,0,0
.long 4251648,4382720,4513792,4644864,4294967295,4294967295,165632,536870912,4775936,182016,536870912,32768,536870912,536870912,77824,13776896,536870912,536870912,230144,290816,13877248,200248,200192,698368,4273373184,1880064,628224,208024,1900544,208128,630784,14016512,231180,0,230400,1868160,13854720,13778944,13811712,13844480,13789184,13821952,13864960,13766656,13799424,13832192,13875200,13776896,13809664,13842432,0,0
.long 4255744,4386816,4517888,4648960,4294967295,4294967295,165632,536870912,4777984,182144,536870912,32768,536870912,536870912,77824,13777920,536870912,536870912,344832,291072,13893632,200252,200256,698368,4273373184,1882112,628480,208028,1933312,208256,634880,14131200,231564,0,230400,1884544,13813760,13770752,13803520,13836288,13869056,13780992,13856768,13846528,13791232,13824000,13867008,13768704,13801472,13834240,0,0
.long 4259840,4390912,4521984,4653056,4294967295,4294967295,165888,536870912,4784128,182272,33280,32768,536870912,536870912,16384,13778944,536870912,536870912,1024,294912,13762560,200256,200192,712704,4273602560,1851392,624640,207904,1835008,207872,622592,13795328,230416,0,230400,1835520,13762560,13795328,13828096,13860864,13772800,13805568,13838336,13783040,13815808,13848576,13871104,13793280,13826048,13858816,0,0
.long 4263936,4395008,4526080,4657152,4294967295,4294967295,165888,536870912,4786176,182400,536870912,32768,536870912,536870912,16384,13779968,536870912,536870912,115712,295168,13778944,200260,200256,712704,4273602560,1853440,624896,207908,1867776,208000,626688,13910016,230800,0,230400,1851904,13787136,13819904,13852672,13764608,13797376,13830144,13774848,13807616,13840384,13873152,13862912,13785088,13817856,13850624,0,0
.long 4268032,4399104,4530176,4661248,4294967295,4294967295,166144,536870912,4792320,182528,536870912,32768,536870912,536870912,20480,13780992,536870912,536870912,230400,299008,13877248,200264,200192,712704,4273602560,1884160,628736,208032,1900544,208128,630784,14024704,231184,0,230400,1868288,13778944,13811712,13844480,13789184,13821952,13854720,13766656,13799424,13832192,13864960,13776896,13809664,13842432,13875200,0,0
.long 4272128,4403200,4534272,4665344,4294967295,4294967295,166144,536870912,4794368,182656,536870912,32768,536870912,536870912,20480,13782016,536870912,536870912,345088,299264,13893632,200268,200256,712704,4273602560,1886208,628992,208036,1933312,208256,634880,14139392,231568,0,230400,1884672,13770752,13803520,13836288,13869056,13780992,13813760,13846528,13791232,13824000,13856768,13768704,13801472,13834240,13867008,0,0
.long 4276224,4407296,4538368,4669440,4294967295,4294967295,166400,536870912,4800512,182784,33408,32768,536870912,536870912,24576,13783040,536870912,536870912,1280,303104,13762560,200272,200192,727040,4273831936,1855488,625152,207912,1835008,207872,622592,13803520,230420,0,230400,1835648,13828096,13860864,13772800,13805568,13762560,13795328,13783040,13815808,13848576,13838336,13793280,13826048,13858816,13871104,0,0
.long 4280320,4411392,4542464,4673536,4294967295,4294967295,166400,536870912,4802560,182912,536870912,32768,536870912,536870912,24576,13784064,536870912,536870912,115968,303360,13778944,200276,200256,727040,4273831936,1857536,625408,207916,1867776,208000,626688,13918208,230804,0,230400,1852032,13852672,13764608,13797376,13830144,13787136,13819904,13807616,13840384,13873152,13774848,13785088,13817856,13850624,13862912,0,0
.long 4284416,4415488,4546560,4677632,4294967295,4294967295,166656,536870912,4808704,183040,536870912,32768,536870912,536870912,28672,13785088,536870912,536870912,230656,307200,13877248,200280,200192,727040,4273831936,1888256,629248,208040,1900544,208128,630784,14032896,231188,0,230400,1868416,13844480,13789184,13821952,13854720,13778944,13811712,13799424,13832192,13864960,13766656,13809664,13842432,13875200,13776896,0,0
.long 4288512,4419584,4550656,4681728,4294967295,4294967295,166656,536870912,4810752,183168,536870912,32768,536870912,536870912,28672,13786112,536870912,536870912,345344,307456,13893632,200284,200256,727040,4273831936,1890304,629504,208044,1933312,208256,634880,14147584,231572,0,230400,1884800,13836288,13869056,13780992,13813760,13770752,13803520,13791232,13824000,13856768,13846528,13801472,13834240,13867008,13768704,0,0
.long 4292608,4423680,4554752,4685824,4294967295,4294967295,166912,536870912,4816896,183296,33536,32768,536870912,536870912,32768,13787136,536870912,536870912,1536,311296,13762560,200288,200192,741376,4274061312,1859584,625664,207920,1835008,207872,622592,13811712,230424,0,230400,1835776,13860864,13772800,13805568,13762560,13795328,13828096,13815808,13848576,13838336,13783040,13826048,13858816,13871104,13793280,0,0
.long 4296704,4427776,4558848,4689920,4294967295,4294967295,166912,536870912,4818944,183424,536870912,32768,536870912,536870912,32768,13788160,536870912,536870912,116224,311552,13778944,200292,200256,741376,4274061312,1861632,625920,207924,1867776,208000,626688,13926400,230808,0,230400,1852160,13764608,13797376,13830144,13787136,13819904,13852672,13840384,13873152,13774848,13807616,13817856,13850624,13862912,13785088,0,0
.long 4300800,4431872,4562944,4694016,4294967295,4294967295,167168,536870912,4825088,183552,536870912,32768,536870912,536870912,36864,13789184,536870912,536870912,230912,315392,13877248,200296,200192,741376,4274061312,1892352,629760,208048,1900544,208128,630784,14041088,231192,0,230400,1868544,13789184,13821952,13854720,13778944,13811712,13844480,13832192,13864960,13766656,13799424,13842432,13875200,13776896,13809664,0,0
.long 4304896,4435968,4567040,4698112,4294967295,4294967295,167168,536870912,4827136,183680,536870912,32768,536870912,536870912,36864,13790208,536870912,536870912,345600,315648,13893632,200300,200256,741376,4274061312,1894400,630016,208052,1933312,208256,634880,14155776,231576,0,230400,1884928,13869056,13780992,13813760,13770752,13803520,13836288,13824000,13856768,13846528,13791232,13834240,13867008,13768704,13801472,0,0
.long 4308992,4440064,4571136,4702208,4294967295,4294967295,167424,536870912,4833280,183808,33664,32768,536870912,536870912,40960,13791232,536870912,536870912,1792,319488,13762560,200304,200192,755712,4274290688,1863680,626176,207928,1835008,207872,622592,13819904,230428,0,230400,1835904,13805568,13762560,13795328,13828096,13860864,13772800,13848576,13838336,13783040,13815808,13858816,13871104,13793280,13826048,0,0
.long 4313088,4444160,4575232,4706304,4294967295,4294967295,167424,536870912,4835328,183936,536870912,32768,536870912,536870912,40960,13792256,536870912,536870912,116480,319744,13778944,200308,200256,755712,4274290688,1865728,626432,207932,1867776,208000,626688,13934592,230812,0,230400,1852288,13830144,13787136,13819904,13852672,13764608,13797376,13873152,13774848,13807616,13840384,13850624,13862912,13785088,13817856,0,0
.long 4317184,4448256,4579328,4710400,4294967295,4294967295,167680,536870912,4841472,184064,536870912,32768,536870912,536870912,45056,13793280,536870912,536870912,231168,323584,13877248,200312,200192,755712,4274290688,1896448,630272,208056,1900544,208128,630784,14049280,231196,0,230400,1868672,13854720,13778944,13811712,13844480,13789184,13821952,13864960,13766656,13799424,13832192,13875200,13776896,13809664,13842432,0,0
.long 4321280,4452352,4583424,4714496,4294967295,4294967295,167680,536870912,4843520,184192,536870912,32768,536870912,536870912,45056,13794304,536870912,536870912,345856,323840,13893632,200316,200256,755712,4274290688,1898496,630528,208060,1933312,208256,634880,14163968,231580,0,230400,1885056,13813760,13770752,13803520,13836288,13869056,13780992,13856768,13846528,13791232,13824000,13867008,13768704,13801472,13834240,0,0
.long 4325376,4456448,4587520,4718592,4294967295,4294967295,167936,536870912,4849664,184320,33792,32768,536870912,536870912,40960,13991936,536870912,536870912,2048,327680,13991936,200320,200320,655360,4272226304,1900544,630784,208128,1835008,207872,622592,13828096,230432,0,231168,1900544,14057472,14090240,14002176,14034944,13991936,14024704,14012416,14045184,14077952,14067712,14022656,14055424,14088192,14100480,0,0
.long 4329472,4460544,4591616,4722688,4294967295,4294967295,167936,536870912,4851712,184448,536870912,32768,536870912,536870912,40960,13992960,536870912,536870912,116736,327936,14008320,200324,200384,655360,4272226304,1902592,631040,208132,1867776,208000,626688,13942784,230816,0,231168,1916928,14082048,13993984,14026752,14059520,14016512,14049280,14036992,14069760,14102528,14004224,14014464,14047232,14080000,14092288,0,0
.long 4333568,4464640,4595712,4726784,4294967295,4294967295,168192,536870912,4857856,184576,536870912,32768,536870912,536870912,45056,13993984,536870912,536870912,231424,331776,14106624,200328,200320,655360,4272226304,1933312,634880,208256,1900544,208128,630784,14057472,231200,0,231168,1933312,14073856,14018560,14051328,14084096,14008320,14041088,14028800,14061568,14094336,13996032,14039040,14071808,14104576,14006272,0,0
.long 4337664,4468736,4599808,4730880,4294967295,4294967295,168192,536870912,4859904,184704,536870912,32768,536870912,536870912,45056,13995008,536870912,536870912,346112,332032,14123008,200332,200384,655360,4272226304,1935360,635136,208260,1933312,208256,634880,14172160,231584,0,231168,1949696,14065664,14098432,14010368,14043136,14000128,14032896,14020608,14053376,14086144,14075904,14030848,14063616,14096384,13998080,0,0
.long 4341760,4472832,4603904,4734976,4294967295,4294967295,168448,536870912,4866048,184832,33920,32768,536870912,536870912,49152,13996032,536870912,536870912,2304,335872,13991936,200336,200320,669696,4272455680,1904640,631296,208136,1835008,207872,622592,13836288,230436,0,231168,1900672,14090240,14002176,14034944,13991936,14024704,14057472,14045184,14077952,14067712,14012416,14055424,14088192,14100480,14022656,0,0
.long 4345856,4476928,4608000,4739072,4294967295,4294967295,168448,536870912,4868096,184960,536870912,32768,536870912,536870912,49152,13997056,536870912,536870912,116992,336128,14008320,200340,200384,669696,4272455680,1906688,631552,208140,1867776,208000,626688,13950976,230820,0,231168,1917056,13993984,14026752,14059520,14016512,14049280,14082048,14069760,14102528,14004224,14036992,14047232,14080000,14092288,14014464,0,0
.long 4349952,4481024,4612096,4743168,4294967295,4294967295,168704,536870912,4874240,185088,536870912,32768,536870912,536870912,53248,13998080,536870912,536870912,231680,339968,14106624,200344,200320,669696,4272455680,1937408,635392,208264,1900544,208128,630784,14065664,231204,0,231168,1933440,14018560,14051328,14084096,14008320,14041088,14073856,14061568,14094336,13996032,14028800,14071808,14104576,14006272,14039040,0,0
.long 4354048,4485120,4616192,4747264,4294967295,4294967295,168704,536870912,4876288,185216,536870912,32768,536870912,536870912,53248,13999104,536870912,536870912,346368,340224,14123008,200348,200384,669696,4272455680,1939456,635648,208268,1933312,208256,634880,14180352,231588,0,231168,1949824,14098432,14010368,14043136,14000128,14032896,14065664,14053376,14086144,14075904,14020608,14063616,14096384,13998080,14030848,0,0
.long 4358144,4489216,4620288,4751360,4294967295,4294967295,168960,536870912,4882432,185344,34048,32768,536870912,536870912,57344,14000128,536870912,536870912,2560,344064,13991936,200352,200320,684032,4272685056,1908736,631808,208144,1835008,207872,622592,13844480,230440,0,231168,1900800,14034944,13991936,14024704,14057472,14090240,14002176,14077952,14067712,14012416,14045184,14088192,14100480,14022656,14055424,0,0
.long 4362240,4493312,4624384,4755456,4294967295,4294967295,168960,536870912,4884480,185472,536870912,32768,536870912,536870912,57344,14001152,536870912,536870912,117248,344320,14008320,200356,200384,684032,4272685056,1910784,632064,208148,1867776,208000,626688,13959168,230824,0,231168,1917184,14059520,14016512,14049280,14082048,13993984,14026752,14102528,14004224,14036992,14069760,14080000,14092288,14014464,14047232,0,0
.long 4366336,4497408,4628480,4759552,4294967295,4294967295,169216,536870912,4890624,185600,536870912,32768,536870912,536870912,61440,14002176,536870912,536870912,231936,348160,14106624,200360,200320,684032,4272685056,1941504,635904,208272,1900544,208128,630784,14073856,231208,0,231168,1933568,14084096,14008320,14041088,14073856,14018560,14051328,14094336,13996032,14028800,14061568,14104576,14006272,14039040,14071808,0,0
.long 4370432,4501504,4632576,4763648,4294967295,4294967295,169216,536870912,4892672,185728,536870912,32768,536870912,536870912,61440,14003200,536870912,536870912,346624,348416,14123008,200364,200384,684032,4272685056,1943552,636160,208276,1933312,208256,634880,14188544,231592,0,231168,1949952,14043136,14000128,14032896,14065664,14098432,14010368,14086144,14075904,14020608,14053376,14096384,13998080,14030848,14063616,0,0
.long 4374528,4505600,4636672,4767744,4294967295,4294967295,169472,536870912,4898816,185856,34176,32768,536870912,536870912,65536,14004224,536870912,536870912,2816,352256,13991936,200368,200320,698368,4272914432,1912832,632320,208152,1835008,207872,622592,13852672,230444,0,231168,1900928,13991936,14024704,14057472,14090240,14002176,14034944,14067712,14012416,14045184,14077952,14100480,14022656,14055424,14088192,0,0
.long 4378624,4509696,4640768,4771840,4294967295,4294967295,169472,536870912,4900864,185984,536870912,32768,536870912,536870912,65536,14005248,536870912,536870912,117504,352512,14008320,200372,200384,698368,4272914432,1914880,632576,208156,1867776,208000,626688,13967360,230828,0,231168,1917312,14016512,14049280,14082048,13993984,14026752,14059520,14004224,14036992,14069760,14102528,14092288,14014464,14047232,14080000,0,0
.long 4382720,4513792,4644864,4775936,4294967295,4294967295,169728,536870912,4907008,186112,536870912,32768,536870912,536870912,69632,14006272,536870912,536870912,232192,356352,14106624,200376,200320,698368,4272914432,1945600,636416,208280,1900544,208128,630784,14082048,231212,0,231168,1933696,14008320,14041088,14073856,14018560,14051328,14084096,13996032,14028800,14061568,14094336,14006272,14039040,14071808,14104576,0,0
.long 4386816,4517888,4648960,4780032,4294967295,4294967295,169728,536870912,4909056,186240,536870912,32768,536870912,536870912,69632,14007296,536870912,536870912,346880,356608,14123008,200380,200384,698368,4272914432,1947648,636672,208284,1933312,208256,634880,14196736,231596,0,231168,1950080,14000128,14032896,14065664,14098432,14010368,14043136,14075904,14020608,14053376,14086144,13998080,14030848,14063616,14096384,0,0
.long 4390912,4521984,4653056,4784128,4294967295,4294967295,169984,536870912,4915200,186368,34304,32768,536870912,536870912,73728,14008320,536870912,536870912,3072,360448,13991936,200384,200320,712704,4273143808,1916928,632832,208160,1835008,207872,622592,13860864,230448,0,231168,1901056,14057472,14090240,14002176,14034944,13991936,14024704,14012416,14045184,14077952,14067712,14022656,14055424,14088192,14100480,0,0
.long 4395008,4526080,4657152,4788224,4294967295,4294967295,169984,536870912,4917248,186496,536870912,32768,536870912,536870912,73728,14009344,536870912,536870912,117760,360704,14008320,200388,200384,712704,4273143808,1918976,633088,208164,1867776,208000,626688,13975552,230832,0,231168,1917440,14082048,13993984,14026752,14059520,14016512,14049280,14036992,14069760,14102528,14004224,14014464,14047232,14080000,14092288,0,0
.long 4399104,4530176,4661248,4792320,4294967295,4294967295,170240,536870912,4923392,186624,536870912,32768,536870912,536870912,77824,14010368,536870912,536870912,232448,364544,14106624,200392,200320,712704,4273143808,1949696,636928,208288,1900544,208128,630784,14090240,231216,0,231168,1933824,14073856,14018560,14051328,14084096,14008320,14041088,14028800,14061568,14094336,13996032,14039040,14071808,14104576,14006272,0,0
.long 4403200,4534272,4665344,4796416,4294967295,4294967295,170240,536870912,4925440,186752,536870912,32768,536870912,536870912,77824,14011392,536870912,536870912,347136,364800,14123008,200396,200384,712704,4273143808,1951744,637184,208292,1933312,208256,634880,14204928,231600,0,231168,1950208,14065664,14098432,14010368,14043136,14000128,14032896,14020608,14053376,14086144,14075904,14030848,14063616,14096384,13998080,0,0
.long 4407296,4538368,4669440,4800512,4294967295,4294967295,170496,536870912,4931584,186880,34432,32768,536870912,536870912,16384,14012416,536870912,536870912,3328,368640,13991936,200400,200320,727040,4273373184,1921024,633344,208168,1835008,207872,622592,13869056,230452,0,231168,1901184,14090240,14002176,14034944,13991936,14024704,14057472,14045184,14077952,14067712,14012416,14055424,14088192,14100480,14022656,0,0
.long 4411392,4542464,4673536,4804608,4294967295,4294967295,170496,536870912,4933632,187008,536870912,32768,536870912,536870912,16384,14013440,536870912,536870912,118016,368896,14008320,200404,200384,727040,4273373184,1923072,633600,208172,1867776,208000,626688,13983744,230836,0,231168,1917568,13993984,14026752,14059520,14016512,14049280,14082048,14069760,14102528,14004224,14036992,14047232,14080000,14092288,14014464,0,0
.long 4415488,4546560,4677632,4808704,4294967295,4294967295,170752,536870912,4939776,187136,536870912,32768,536870912,536870912,20480,14014464,536870912,536870912,232704,372736,14106624,200408,200320,727040,4273373184,1953792,637440,208296,1900544,208128,630784,14098432,231220,0,231168,1933952,14018560,14051328,14084096,14008320,14041088,14073856,14061568,14094336,13996032,14028800,14071808,14104576,14006272,14039040,0,0
.long 4419584,4550656,4681728,4812800,4294967295,4294967295,170752,536870912,4941824,187264,536870912,32768,536870912,536870912,20480,14015488,536870912,536870912,347392,372992,14123008,200412,200384,727040,4273373184,1955840,637696,208300,1933312,208256,634880,14213120,231604,0,231168,1950336,14098432,14010368,14043136,14000128,14032896,14065664,14053376,14086144,14075904,14020608,14063616,14096384,13998080,14030848,0,0
.long 4423680,4554752,4685824,4816896,4294967295,4294967295,171008,536870912,4947968,187392,34560,32768,536870912,536870912,24576,14016512,536870912,536870912,3328,368640,13991936,200416,200320,741376,4273602560,1925120,633856,208176,1835008,207872,622592,536870912,536870912,5242880,231168,1901312,14034944,13991936,14024704,14057472,14090240,14002176,14077952,14067712,14012416,14045184,14088192,14100480,14022656,14055424,0,0
.long 4427776,4558848,4689920,4820992,4294967295,4294967295,171008,536870912,4950016,187520,536870912,32768,536870912,536870912,24576,14017536,536870912,536870912,118016,368896,14008320,200420,200384,741376,4273602560,1927168,634112,208180,1867776,208000,626688,536870912,536870912,5242880,231168,1917696,14059520,14016512,14049280,14082048,13993984,14026752,14102528,14004224,14036992,14069760,14080000,14092288,14014464,14047232,0,0
.long 4431872,4562944,4694016,4825088,4294967295,4294967295,171264,536870912,4956160,187648,536870912,32768,536870912,536870912,28672,14018560,536870912,536870912,232704,372736,14106624,200424,200320,741376,4273602560,1957888,637952,208304,1900544,208128,630784,536870912,536870912,5242880,231168,1934080,14084096,14008320,14041088,14073856,14018560,14051328,14094336,13996032,14028800,14061568,14104576,14006272,14039040,14071808,0,0
.long 4435968,4567040,4698112,4829184,4294967295,4294967295,171264,536870912,4958208,187776,536870912,32768,536870912,536870912,28672,14019584,536870912,536870912,347392,372992,14123008,200428,200384,741376,4273602560,1959936,638208,208308,1933312,208256,634880,536870912,536870912,5242880,231168,1950464,14043136,14000128,14032896,14065664,14098432,14010368,14086144,14075904,14020608,14053376,14096384,13998080,14030848,14063616,0,0
.long 4440064,4571136,4702208,4833280,4294967295,4294967295,171520,536870912,4964352,187904,34688,32768,536870912,536870912,32768,14020608,536870912,536870912,3328,368640,13991936,200432,200320,755712,4273831936,1929216,634368,208184,1835008,207872,622592,536870912,536870912,5701632,231168,1901440,13991936,14024704,14057472,14090240,14002176,14034944,14067712,14012416,14045184,14077952,14100480,14022656,14055424,14088192,0,0
.long 4444160,4575232,4706304,4837376,4294967295,4294967295,171520,536870912,4966400,188032,536870912,32768,536870912,536870912,32768,14021632,536870912,536870912,118016,368896,14008320,200436,200384,755712,4273831936,1931264,634624,208188,1867776,208000,626688,536870912,536870912,5701632,231168,1917824,14016512,14049280,14082048,13993984,14026752,14059520,14004224,14036992,14069760,14102528,14092288,14014464,14047232,14080000,0,0
.long 4448256,4579328,4710400,4841472,4294967295,4294967295,171776,536870912,4972544,188160,536870912,32768,536870912,536870912,36864,14022656,536870912,536870912,232704,372736,14106624,200440,200320,755712,4273831936,1961984,638464,208312,1900544,208128,630784,536870912,536870912,5701632,231168,1934208,14008320,14041088,14073856,14018560,14051328,14084096,13996032,14028800,14061568,14094336,14006272,14039040,14071808,14104576,0,0
.long 4452352,4583424,4714496,4845568,4294967295,4294967295,171776,536870912,4974592,188288,536870912,32768,536870912,536870912,36864,14023680,536870912,536870912,347392,372992,14123008,200444,200384,755712,4273831936,1964032,638720,208316,1933312,208256,634880,536870912,536870912,5701632,231168,1950592,14000128,14032896,14065664,14098432,14010368,14043136,14075904,14020608,14053376,14086144,13998080,14030848,14063616,14096384,0,0
.long 4456448,4587520,4718592,4849664,4294967295,4294967295,172032,536870912,4980736,188416,34816,34816,536870912,536870912,32768,14221312,536870912,536870912,0,262144,14221312,200448,200448,655360,4271767552,1966080,638976,208384,1966080,208384,638976,14221312,231936,0,231936,1966080,14319616,14231552,14264320,14221312,14254080,14286848,14274560,14307328,14297088,14241792,14284800,14317568,14329856,14252032,0,0
.long 4460544,4591616,4722688,4853760,4294967295,4294967295,172032,536870912,4982784,188544,536870912,34816,536870912,536870912,32768,14222336,536870912,536870912,114688,262400,14237696,200452,200512,655360,4271767552,1968128,639232,208388,1998848,208512,643072,14336000,232320,0,231936,1982464,14223360,14256128,14288896,14245888,14278656,14311424,14299136,14331904,14233600,14266368,14276608,14309376,14321664,14243840,0,0
.long 4464640,4595712,4726784,4857856,4294967295,4294967295,172288,536870912,4988928,188672,536870912,34816,536870912,536870912,36864,14223360,536870912,536870912,229376,266240,14336000,200456,200448,655360,4271767552,1998848,643072,208512,2031616,208640,647168,14450688,232704,0,231936,1998848,14247936,14280704,14313472,14237696,14270464,14303232,14290944,14323712,14225408,14258176,14301184,14333952,14235648,14268416,0,0
.long 4468736,4599808,4730880,4861952,4294967295,4294967295,172288,536870912,4990976,188800,536870912,34816,536870912,536870912,36864,14224384,536870912,536870912,344064,266496,14352384,200460,200512,655360,4271767552,2000896,643328,208516,2064384,208768,651264,14565376,233088,0,231936,2015232,14327808,14239744,14272512,14229504,14262272,14295040,14282752,14315520,14305280,14249984,14292992,14325760,14227456,14260224,0,0
.long 4472832,4603904,4734976,4866048,4294967295,4294967295,172544,536870912,4997120,188928,34944,34816,536870912,536870912,40960,14225408,536870912,536870912,256,270336,14221312,200464,200448,669696,4271996928,1970176,639488,208392,1966080,208384,638976,14229504,231940,0,231936,1966208,14264320,14221312,14254080,14286848,14319616,14231552,14307328,14297088,14241792,14274560,14317568,14329856,14252032,14284800,0,0
.long 4476928,4608000,4739072,4870144,4294967295,4294967295,172544,536870912,4999168,189056,536870912,34816,536870912,536870912,40960,14226432,536870912,536870912,114944,270592,14237696,200468,200512,669696,4271996928,1972224,639744,208396,1998848,208512,643072,14344192,232324,0,231936,1982592,14288896,14245888,14278656,14311424,14223360,14256128,14331904,14233600,14266368,14299136,14309376,14321664,14243840,14276608,0,0
.long 4481024,4612096,4743168,4874240,4294967295,4294967295,172800,536870912,5005312,189184,536870912,34816,536870912,536870912,45056,14227456,536870912,536870912,229632,274432,14336000,200472,200448,669696,4271996928,2002944,643584,208520,2031616,208640,647168,14458880,232708,0,231936,1998976,14313472,14237696,14270464,14303232,14247936,14280704,14323712,14225408,14258176,14290944,14333952,14235648,14268416,14301184,0,0
.long 4485120,4616192,4747264,4878336,4294967295,4294967295,172800,536870912,5007360,189312,536870912,34816,536870912,536870912,45056,14228480,536870912,536870912,344320,274688,14352384,200476,200512,669696,4271996928,2004992,643840,208524,2064384,208768,651264,14573568,233092,0,231936,2015360,14272512,14229504,14262272,14295040,14327808,14239744,14315520,14305280,14249984,14282752,14325760,14227456,14260224,14292992,0,0
.long 4489216,4620288,4751360,4882432,4294967295,4294967295,173056,536870912,5013504,189440,35072,34816,536870912,536870912,49152,14229504,536870912,536870912,512,278528,14221312,200480,200448,684032,4272226304,1974272,640000,208400,1966080,208384,638976,14237696,231944,0,231936,1966336,14221312,14254080,14286848,14319616,14231552,14264320,14297088,14241792,14274560,14307328,14329856,14252032,14284800,14317568,0,0
.long 4493312,4624384,4755456,4886528,4294967295,4294967295,173056,536870912,5015552,189568,536870912,34816,536870912,536870912,49152,14230528,536870912,536870912,115200,278784,14237696,200484,200512,684032,4272226304,1976320,640256,208404,1998848,208512,643072,14352384,232328,0,231936,1982720,14245888,14278656,14311424,14223360,14256128,14288896,14233600,14266368,14299136,14331904,14321664,14243840,14276608,14309376,0,0
.long 4497408,4628480,4759552,4890624,4294967295,4294967295,173312,536870912,5021696,189696,536870912,34816,536870912,536870912,53248,14231552,536870912,536870912,229888,282624,14336000,200488,200448,684032,4272226304,2007040,644096,208528,2031616,208640,647168,14467072,232712,0,231936,1999104,14237696,14270464,14303232,14247936,14280704,14313472,14225408,14258176,14290944,14323712,14235648,14268416,14301184,14333952,0,0
.long 4501504,4632576,4763648,4894720,4294967295,4294967295,173312,536870912,5023744,189824,536870912,34816,536870912,536870912,53248,14232576,536870912,536870912,344576,282880,14352384,200492,200512,684032,4272226304,2009088,644352,208532,2064384,208768,651264,14581760,233096,0,231936,2015488,14229504,14262272,14295040,14327808,14239744,14272512,14305280,14249984,14282752,14315520,14227456,14260224,14292992,14325760,0,0
.long 4505600,4636672,4767744,4898816,4294967295,4294967295,173568,536870912,5029888,189952,35200,34816,536870912,536870912,57344,14233600,536870912,536870912,768,286720,14221312,200496,200448,698368,4272455680,1978368,640512,208408,1966080,208384,638976,14245888,231948,0,231936,1966464,14286848,14319616,14231552,14264320,14221312,14254080,14241792,14274560,14307328,14297088,14252032,14284800,14317568,14329856,0,0
.long 4509696,4640768,4771840,4902912,4294967295,4294967295,173568,536870912,5031936,190080,536870912,34816,536870912,536870912,57344,14234624,536870912,536870912,115456,286976,14237696,200500,200512,698368,4272455680,1980416,640768,208412,1998848,208512,643072,14360576,232332,0,231936,1982848,14311424,14223360,14256128,14288896,14245888,14278656,14266368,14299136,14331904,14233600,14243840,14276608,14309376,14321664,0,0
.long 4513792,4644864,4775936,4907008,4294967295,4294967295,173824,536870912,5038080,190208,536870912,34816,536870912,536870912,61440,14235648,536870912,536870912,230144,290816,14336000,200504,200448,698368,4272455680,2011136,644608,208536,2031616,208640,647168,14475264,232716,0,231936,1999232,14303232,14247936,14280704,14313472,14237696,14270464,14258176,14290944,14323712,14225408,14268416,14301184,14333952,14235648,0,0
.long 4517888,4648960,4780032,4911104,4294967295,4294967295,173824,536870912,5040128,190336,536870912,34816,536870912,536870912,61440,14236672,536870912,536870912,344832,291072,14352384,200508,200512,698368,4272455680,2013184,644864,208540,2064384,208768,651264,14589952,233100,0,231936,2015616,14295040,14327808,14239744,14272512,14229504,14262272,14249984,14282752,14315520,14305280,14260224,14292992,14325760,14227456,0,0
.long 4521984,4653056,4784128,4915200,4294967295,4294967295,174080,536870912,5046272,190464,35328,34816,536870912,536870912,65536,14237696,536870912,536870912,1024,294912,14221312,200512,200448,712704,4272685056,1982464,641024,208416,1966080,208384,638976,14254080,231952,0,231936,1966592,14319616,14231552,14264320,14221312,14254080,14286848,14274560,14307328,14297088,14241792,14284800,14317568,14329856,14252032,0,0
.long 4526080,4657152,4788224,4919296,4294967295,4294967295,174080,536870912,5048320,190592,536870912,34816,536870912,536870912,65536,14238720,536870912,536870912,115712,295168,14237696,200516,200512,712704,4272685056,1984512,641280,208420,1998848,208512,643072,14368768,232336,0,231936,1982976,14223360,14256128,14288896,14245888,14278656,14311424,14299136,14331904,14233600,14266368,14276608,14309376,14321664,14243840,0,0
.long 4530176,4661248,4792320,4923392,4294967295,4294967295,174336,536870912,5054464,190720,536870912,34816,536870912,536870912,69632,14239744,536870912,536870912,230400,299008,14336000,200520,200448,712704,4272685056,2015232,645120,208544,2031616,208640,647168,14483456,232720,0,231936,1999360,14247936,14280704,14313472,14237696,14270464,14303232,14290944,14323712,14225408,14258176,14301184,14333952,14235648,14268416,0,0
.long 4534272,4665344,4796416,4927488,4294967295,4294967295,174336,536870912,5056512,190848,536870912,34816,536870912,536870912,69632,14240768,536870912,536870912,345088,299264,14352384,200524,200512,712704,4272685056,2017280,645376,208548,2064384,208768,651264,14598144,233104,0,231936,2015744,14327808,14239744,14272512,14229504,14262272,14295040,14282752,14315520,14305280,14249984,14292992,14325760,14227456,14260224,0,0
.long 4538368,4669440,4800512,4931584,4294967295,4294967295,174592,536870912,5062656,190976,35456,34816,536870912,536870912,73728,14241792,536870912,536870912,1280,303104,14221312,200528,200448,727040,4272914432,1986560,641536,208424,1966080,208384,638976,14262272,231956,0,231936,1966720,14264320,14221312,14254080,14286848,14319616,14231552,14307328,14297088,14241792,14274560,14317568,14329856,14252032,14284800,0,0
.long 4542464,4673536,4804608,4935680,4294967295,4294967295,174592,536870912,5064704,191104,536870912,34816,536870912,536870912,73728,14242816,536870912,536870912,115968,303360,14237696,200532,200512,727040,4272914432,1988608,641792,208428,1998848,208512,643072,14376960,232340,0,231936,1983104,14288896,14245888,14278656,14311424,14223360,14256128,14331904,14233600,14266368,14299136,14309376,14321664,14243840,14276608,0,0
.long 4546560,4677632,4808704,4939776,4294967295,4294967295,174848,536870912,5070848,191232,536870912,34816,536870912,536870912,77824,14243840,536870912,536870912,230656,307200,14336000,200536,200448,727040,4272914432,2019328,645632,208552,2031616,208640,647168,14491648,232724,0,231936,1999488,14313472,14237696,14270464,14303232,14247936,14280704,14323712,14225408,14258176,14290944,14333952,14235648,14268416,14301184,0,0
.long 4550656,4681728,4812800,4943872,4294967295,4294967295,174848,536870912,5072896,191360,536870912,34816,536870912,536870912,77824,14244864,536870912,536870912,345344,307456,14352384,200540,200512,727040,4272914432,2021376,645888,208556,2064384,208768,651264,14606336,233108,0,231936,2015872,14272512,14229504,14262272,14295040,14327808,14239744,14315520,14305280,14249984,14282752,14325760,14227456,14260224,14292992,0,0
.long 4554752,4685824,4816896,4947968,4294967295,4294967295,175104,536870912,5079040,191488,35584,34816,536870912,536870912,16384,14245888,536870912,536870912,1536,311296,14221312,200544,200448,741376,4273143808,1990656,642048,208432,1966080,208384,638976,14270464,231960,0,231936,1966848,14221312,14254080,14286848,14319616,14231552,14264320,14297088,14241792,14274560,14307328,14329856,14252032,14284800,14317568,0,0
.long 4558848,4689920,4820992,4952064,4294967295,4294967295,175104,536870912,5081088,191616,536870912,34816,536870912,536870912,16384,14246912,536870912,536870912,116224,311552,14237696,200548,200512,741376,4273143808,1992704,642304,208436,1998848,208512,643072,14385152,232344,0,231936,1983232,14245888,14278656,14311424,14223360,14256128,14288896,14233600,14266368,14299136,14331904,14321664,14243840,14276608,14309376,0,0
.long 4562944,4694016,4825088,4956160,4294967295,4294967295,175360,536870912,5087232,191744,536870912,34816,536870912,536870912,20480,14247936,536870912,536870912,230912,315392,14336000,200552,200448,741376,4273143808,2023424,646144,208560,2031616,208640,647168,14499840,232728,0,231936,1999616,14237696,14270464,14303232,14247936,14280704,14313472,14225408,14258176,14290944,14323712,14235648,14268416,14301184,14333952,0,0
.long 4567040,4698112,4829184,4960256,4294967295,4294967295,175360,536870912,5089280,191872,536870912,34816,536870912,536870912,20480,14248960,536870912,536870912,345600,315648,14352384,200556,200512,741376,4273143808,2025472,646400,208564,2064384,208768,651264,14614528,233112,0,231936,2016000,14229504,14262272,14295040,14327808,14239744,14272512,14305280,14249984,14282752,14315520,14227456,14260224,14292992,14325760,0,0
.long 4571136,4702208,4833280,4964352,4294967295,4294967295,175616,536870912,5095424,192000,35712,34816,536870912,536870912,24576,14249984,536870912,536870912,1792,319488,14221312,200560,200448,755712,4273373184,1994752,642560,208440,1966080,208384,638976,14278656,231964,0,231936,1966976,14286848,14319616,14231552,14264320,14221312,14254080,14241792,14274560,14307328,14297088,14252032,14284800,14317568,14329856,0,0
.long 4575232,4706304,4837376,4968448,4294967295,4294967295,175616,536870912,5097472,192128,536870912,34816,536870912,536870912,24576,14251008,536870912,536870912,116480,319744,14237696,200564,200512,755712,4273373184,1996800,642816,208444,1998848,208512,643072,14393344,232348,0,231936,1983360,14311424,14223360,14256128,14288896,14245888,14278656,14266368,14299136,14331904,14233600,14243840,14276608,14309376,14321664,0,0
.long 4579328,4710400,4841472,4972544,4294967295,4294967295,175872,536870912,5103616,192256,536870912,34816,536870912,536870912,28672,14252032,536870912,536870912,231168,323584,14336000,200568,200448,755712,4273373184,2027520,646656,208568,2031616,208640,647168,14508032,232732,0,231936,1999744,14303232,14247936,14280704,14313472,14237696,14270464,14258176,14290944,14323712,14225408,14268416,14301184,14333952,14235648,0,0
.long 4583424,4714496,4845568,4976640,4294967295,4294967295,175872,536870912,5105664,192384,536870912,34816,536870912,536870912,28672,14253056,536870912,536870912,345856,323840,14352384,200572,200512,755712,4273373184,2029568,646912,208572,2064384,208768,651264,14622720,233116,0,231936,2016128,14295040,14327808,14239744,14272512,14229504,14262272,14249984,14282752,14315520,14305280,14260224,14292992,14325760,14227456,0,0
.long 4587520,4718592,4849664,4980736,4294967295,4294967295,176128,536870912,5111808,192512,35840,34816,536870912,536870912,24576,14450688,536870912,536870912,2048,327680,14450688,200576,200576,655360,4271308800,2031616,647168,208640,1966080,208384,638976,14286848,231968,0,232704,2031616,14493696,14450688,14483456,14516224,14548992,14460928,14536704,14526464,14471168,14503936,14546944,14559232,14481408,14514176,0,0
.long 4591616,4722688,4853760,4984832,4294967295,4294967295,176128,536870912,5113856,192640,536870912,34816,536870912,536870912,24576,14451712,536870912,536870912,116736,327936,14467072,200580,200640,655360,4271308800,2033664,647424,208644,1998848,208512,643072,14401536,232352,0,232704,2048000,14518272,14475264,14508032,14540800,14452736,14485504,14561280,14462976,14495744,14528512,14538752,14551040,14473216,14505984,0,0
.long 4595712,4726784,4857856,4988928,4294967295,4294967295,176384,536870912,5120000,192768,536870912,34816,536870912,536870912,28672,14452736,536870912,536870912,231424,331776,14565376,200584,200576,655360,4271308800,2064384,651264,208768,2031616,208640,647168,14516224,232736,0,232704,2064384,14542848,14467072,14499840,14532608,14477312,14510080,14553088,14454784,14487552,14520320,14563328,14465024,14497792,14530560,0,0
.long 4599808,4730880,4861952,4993024,4294967295,4294967295,176384,536870912,5122048,192896,536870912,34816,536870912,536870912,28672,14453760,536870912,536870912,346112,332032,14581760,200588,200640,655360,4271308800,2066432,651520,208772,2064384,208768,651264,14630912,233120,0,232704,2080768,14501888,14458880,14491648,14524416,14557184,14469120,14544896,14534656,14479360,14512128,14555136,14456832,14489600,14522368,0,0
.long 4603904,4734976,4866048,4997120,4294967295,4294967295,176640,536870912,5128192,193024,35968,34816,536870912,536870912,32768,14454784,536870912,536870912,2304,335872,14450688,200592,200576,669696,4271538176,2035712,647680,208648,1966080,208384,638976,14295040,231972,0,232704,2031744,14450688,14483456,14516224,14548992,14460928,14493696,14526464,14471168,14503936,14536704,14559232,14481408,14514176,14546944,0,0
.long 4608000,4739072,4870144,5001216,4294967295,4294967295,176640,536870912,5130240,193152,536870912,34816,536870912,536870912,32768,14455808,536870912,536870912,116992,336128,14467072,200596,200640,669696,4271538176,2037760,647936,208652,1998848,208512,643072,14409728,232356,0,232704,2048128,14475264,14508032,14540800,14452736,14485504,14518272,14462976,14495744,14528512,14561280,14551040,14473216,14505984,14538752,0,0
.long 4612096,4743168,4874240,5005312,4294967295,4294967295,176896,536870912,5136384,193280,536870912,34816,536870912,536870912,36864,14456832,536870912,536870912,231680,339968,14565376,200600,200576,669696,4271538176,2068480,651776,208776,2031616,208640,647168,14524416,232740,0,232704,2064512,14467072,14499840,14532608,14477312,14510080,14542848,14454784,14487552,14520320,14553088,14465024,14497792,14530560,14563328,0,0
.long 4616192,4747264,4878336,5009408,4294967295,4294967295,176896,536870912,5138432,193408,536870912,34816,536870912,536870912,36864,14457856,536870912,536870912,346368,340224,14581760,200604,200640,669696,4271538176,2070528,652032,208780,2064384,208768,651264,14639104,233124,0,232704,2080896,14458880,14491648,14524416,14557184,14469120,14501888,14534656,14479360,14512128,14544896,14456832,14489600,14522368,14555136,0,0
.long 4620288,4751360,4882432,5013504,4294967295,4294967295,177152,536870912,5144576,193536,36096,34816,536870912,536870912,40960,14458880,536870912,536870912,2560,344064,14450688,200608,200576,684032,4271767552,2039808,648192,208656,1966080,208384,638976,14303232,231976,0,232704,2031872,14516224,14548992,14460928,14493696,14450688,14483456,14471168,14503936,14536704,14526464,14481408,14514176,14546944,14559232,0,0
.long 4624384,4755456,4886528,5017600,4294967295,4294967295,177152,536870912,5146624,193664,536870912,34816,536870912,536870912,40960,14459904,536870912,536870912,117248,344320,14467072,200612,200640,684032,4271767552,2041856,648448,208660,1998848,208512,643072,14417920,232360,0,232704,2048256,14540800,14452736,14485504,14518272,14475264,14508032,14495744,14528512,14561280,14462976,14473216,14505984,14538752,14551040,0,0
.long 4628480,4759552,4890624,5021696,4294967295,4294967295,177408,536870912,5152768,193792,536870912,34816,536870912,536870912,45056,14460928,536870912,536870912,231936,348160,14565376,200616,200576,684032,4271767552,2072576,652288,208784,2031616,208640,647168,14532608,232744,0,232704,2064640,14532608,14477312,14510080,14542848,14467072,14499840,14487552,14520320,14553088,14454784,14497792,14530560,14563328,14465024,0,0
.long 4632576,4763648,4894720,5025792,4294967295,4294967295,177408,536870912,5154816,193920,536870912,34816,536870912,536870912,45056,14461952,536870912,536870912,346624,348416,14581760,200620,200640,684032,4271767552,2074624,652544,208788,2064384,208768,651264,14647296,233128,0,232704,2081024,14524416,14557184,14469120,14501888,14458880,14491648,14479360,14512128,14544896,14534656,14489600,14522368,14555136,14456832,0,0
.long 4636672,4767744,4898816,5029888,4294967295,4294967295,177664,536870912,5160960,194048,36224,34816,536870912,536870912,49152,14462976,536870912,536870912,2816,352256,14450688,200624,200576,698368,4271996928,2043904,648704,208664,1966080,208384,638976,14311424,231980,0,232704,2032000,14548992,14460928,14493696,14450688,14483456,14516224,14503936,14536704,14526464,14471168,14514176,14546944,14559232,14481408,0,0
.long 4640768,4771840,4902912,5033984,4294967295,4294967295,177664,536870912,5163008,194176,536870912,34816,536870912,536870912,49152,14464000,536870912,536870912,117504,352512,14467072,200628,200640,698368,4271996928,2045952,648960,208668,1998848,208512,643072,14426112,232364,0,232704,2048384,14452736,14485504,14518272,14475264,14508032,14540800,14528512,14561280,14462976,14495744,14505984,14538752,14551040,14473216,0,0
.long 4644864,4775936,4907008,5038080,4294967295,4294967295,177920,536870912,5169152,194304,536870912,34816,536870912,536870912,53248,14465024,536870912,536870912,232192,356352,14565376,200632,200576,698368,4271996928,2076672,652800,208792,2031616,208640,647168,14540800,232748,0,232704,2064768,14477312,14510080,14542848,14467072,14499840,14532608,14520320,14553088,14454784,14487552,14530560,14563328,14465024,14497792,0,0
.long 4648960,4780032,4911104,5042176,4294967295,4294967295,177920,536870912,5171200,194432,536870912,34816,536870912,536870912,53248,14466048,536870912,536870912,346880,356608,14581760,200636,200640,698368,4271996928,2078720,653056,208796,2064384,208768,651264,14655488,233132,0,232704,2081152,14557184,14469120,14501888,14458880,14491648,14524416,14512128,14544896,14534656,14479360,14522368,14555136,14456832,14489600,0,0
.long 4653056,4784128,4915200,5046272,4294967295,4294967295,178176,536870912,5177344,194560,36352,34816,536870912,536870912,57344,14467072,536870912,536870912,3072,360448,14450688,200640,200576,712704,4272226304,2048000,649216,208672,1966080,208384,638976,14319616,231984,0,232704,2032128,14493696,14450688,14483456,14516224,14548992,14460928,14536704,14526464,14471168,14503936,14546944,14559232,14481408,14514176,0,0
.long 4657152,4788224,4919296,5050368,4294967295,4294967295,178176,536870912,5179392,194688,536870912,34816,536870912,536870912,57344,14468096,536870912,536870912,117760,360704,14467072,200644,200640,712704,4272226304,2050048,649472,208676,1998848,208512,643072,14434304,232368,0,232704,2048512,14518272,14475264,14508032,14540800,14452736,14485504,14561280,14462976,14495744,14528512,14538752,14551040,14473216,14505984,0,0
.long 4661248,4792320,4923392,5054464,4294967295,4294967295,178432,536870912,5185536,194816,536870912,34816,536870912,536870912,61440,14469120,536870912,536870912,232448,364544,14565376,200648,200576,712704,4272226304,2080768,653312,208800,2031616,208640,647168,14548992,232752,0,232704,2064896,14542848,14467072,14499840,14532608,14477312,14510080,14553088,14454784,14487552,14520320,14563328,14465024,14497792,14530560,0,0
.long 4665344,4796416,4927488,5058560,4294967295,4294967295,178432,536870912,5187584,194944,536870912,34816,536870912,536870912,61440,14470144,536870912,536870912,347136,364800,14581760,200652,200640,712704,4272226304,2082816,653568,208804,2064384,208768,651264,14663680,233136,0,232704,2081280,14501888,14458880,14491648,14524416,14557184,14469120,14544896,14534656,14479360,14512128,14555136,14456832,14489600,14522368,0,0
.long 4669440,4800512,4931584,5062656,4294967295,4294967295,178688,536870912,5193728,195072,36480,34816,536870912,536870912,65536,14471168,536870912,536870912,3328,368640,14450688,200656,200576,727040,4272455680,2052096,649728,208680,1966080,208384,638976,14327808,231988,0,232704,2032256,14450688,14483456,14516224,14548992,14460928,14493696,14526464,14471168,14503936,14536704,14559232,14481408,14514176,14546944,0,0
.long 4673536,4804608,4935680,5066752,4294967295,4294967295,178688,536870912,5195776,195200,536870912,34816,536870912,536870912,65536,14472192,536870912,536870912,118016,368896,14467072,200660,200640,727040,4272455680,2054144,649984,208684,1998848,208512,643072,14442496,232372,0,232704,2048640,14475264,14508032,14540800,14452736,14485504,14518272,14462976,14495744,14528512,14561280,14551040,14473216,14505984,14538752,0,0
.long 4677632,4808704,4939776,5070848,4294967295,4294967295,178944,536870912,5201920,195328,536870912,34816,536870912,536870912,69632,14473216,536870912,536870912,232704,372736,14565376,200664,200576,727040,4272455680,2084864,653824,208808,2031616,208640,647168,14557184,232756,0,232704,2065024,14467072,14499840,14532608,14477312,14510080,14542848,14454784,14487552,14520320,14553088,14465024,14497792,14530560,14563328,0,0
.long 4681728,4812800,4943872,5074944,4294967295,4294967295,178944,536870912,5203968,195456,536870912,34816,536870912,536870912,69632,14474240,536870912,536870912,347392,372992,14581760,200668,200640,727040,4272455680,2086912,654080,208812,2064384,208768,651264,14671872,233140,0,232704,2081408,14458880,14491648,14524416,14557184,14469120,14501888,14534656,14479360,14512128,14544896,14456832,14489600,14522368,14555136,0,0
.long 4685824,4816896,4947968,5079040,4294967295,4294967295,179200,536870912,5210112,195584,36608,34816,536870912,536870912,73728,14475264,536870912,536870912,3328,368640,14450688,200672,200576,741376,4272685056,2056192,650240,208688,1966080,208384,638976,536870912,536870912,6160384,232704,2032384,14516224,14548992,14460928,14493696,14450688,14483456,14471168,14503936,14536704,14526464,14481408,14514176,14546944,14559232,0,0
.long 4689920,4820992,4952064,5083136,4294967295,4294967295,179200,536870912,5212160,195712,536870912,34816,536870912,536870912,73728,14476288,536870912,536870912,118016,368896,14467072,200676,200640,741376,4272685056,2058240,650496,208692,1998848,208512,643072,536870912,536870912,6160384,232704,2048768,14540800,14452736,14485504,14518272,14475264,14508032,14495744,14528512,14561280,14462976,14473216,14505984,14538752,14551040,0,0
.long 4694016,4825088,4956160,5087232,4294967295,4294967295,179456,536870912,5218304,195840,536870912,34816,536870912,536870912,77824,14477312,536870912,536870912,232704,372736,14565376,200680,200576,741376,4272685056,2088960,654336,208816,2031616,208640,647168,536870912,536870912,6160384,232704,2065152,14532608,14477312,14510080,14542848,14467072,14499840,14487552,14520320,14553088,14454784,14497792,14530560,14563328,14465024,0,0
.long 4698112,4829184,4960256,5091328,4294967295,4294967295,179456,536870912,5220352,195968,536870912,34816,536870912,536870912,77824,14478336,536870912,536870912,347392,372992,14581760,200684,200640,741376,4272685056,2091008,654592,208820,2064384,208768,651264,536870912,536870912,6160384,232704,2081536,14524416,14557184,14469120,14501888,14458880,14491648,14479360,14512128,14544896,14534656,14489600,14522368,14555136,14456832,0,0
.long 4702208,4833280,4964352,5095424,4294967295,4294967295,179712,536870912,5226496,196096,36736,34816,536870912,536870912,16384,14479360,536870912,536870912,3328,368640,14450688,200688,200576,755712,4272914432,2060288,650752,208696,1966080,208384,638976,536870912,536870912,6619136,232704,2032512,14548992,14460928,14493696,14450688,14483456,14516224,14503936,14536704,14526464,14471168,14514176,14546944,14559232,14481408,0,0
.long 4706304,4837376,4968448,5099520,4294967295,4294967295,179712,536870912,5228544,196224,536870912,34816,536870912,536870912,16384,14480384,536870912,536870912,118016,368896,14467072,200692,200640,755712,4272914432,2062336,651008,208700,1998848,208512,643072,536870912,536870912,6619136,232704,2048896,14452736,14485504,14518272,14475264,14508032,14540800,14528512,14561280,14462976,14495744,14505984,14538752,14551040,14473216,0,0
.long 4710400,4841472,4972544,5103616,4294967295,4294967295,179968,536870912,5234688,196352,536870912,34816,536870912,536870912,20480,14481408,536870912,536870912,232704,372736,14565376,200696,200576,755712,4272914432,2093056,654848,208824,2031616,208640,647168,536870912,536870912,6619136,232704,2065280,14477312,14510080,14542848,14467072,14499840,14532608,14520320,14553088,14454784,14487552,14530560,14563328,14465024,14497792,0,0
.long 4714496,4845568,4976640,5107712,4294967295,4294967295,179968,536870912,5236736,196480,536870912,34816,536870912,536870912,20480,14482432,536870912,536870912,347392,372992,14581760,200700,200640,755712,4272914432,2095104,655104,208828,2064384,208768,651264,536870912,536870912,6619136,232704,2081664,14557184,14469120,14501888,14458880,14491648,14524416,14512128,14544896,14534656,14479360,14522368,14555136,14456832,14489600,0,0
.size L_tab, 212992
.section .rodata,"a"
.p2align 6
.amdhsa_kernel sequential_preLN__sliding_block__dense_activation_silu__prompt_kernel
  .amdhsa_next_free_vgpr 512
  .amdhsa_next_free_sgpr 102
  .amdhsa_accum_offset 256
  .amdhsa_group_segment_fixed_size 0
  .amdhsa_kernarg_size 72
  .amdhsa_user_sgpr_count 2
  .amdhsa_user_sgpr_kernarg_segment_ptr 1
  .amdhsa_system_sgpr_workgroup_id_x 1
.end_amdhsa_kernel
```
